```python
import torch

def _softmax(x, axis=-1):
    return torch.softmax(x, dim=axis)

def _gelu(x):
    return torch.nn.functional.gelu(x, approximate='tanh')

def _silu(x):
    return torch.nn.functional.silu(x)

def _sigmoid(x):
    return torch.sigmoid(x)

def _layernorm(x, axis=-1, eps=1e-05):
    m = x.mean(dim=axis, keepdim=True)
    v = x.var(dim=axis, keepdim=True, unbiased=False)
    return (x - m) / torch.sqrt(v + eps)

def _scatter_add(tgt, idx, src, axis=0):
    return tgt.clone().index_add_(axis, idx, src)

def _segment_sum(src, seg, n):
    out = torch.zeros((n,) + src.shape[1:], dtype=src.dtype)
    return out.index_add_(0, seg, src)

def _pad(x, pw):
    flat = tuple((v for pair in reversed(pw) for v in pair))
    return torch.nn.functional.pad(x, flat)
kernel_name = 'interleave_layers__memory_aug_recurrent_mem_tr__mixer_s_mlp__prompt'

def setup_inputs():

    _w = lambda a: (lambda t: t.to(torch.bfloat16) if t.is_floating_point() else t)(torch.as_tensor(a))

    def _A_setup():
        B, S, Dm = (1, 2048, 640)
        H, Dh = (32, 192)
        M, seg = (8, 32)
        seg = min(seg, S)
        S = S // seg * seg
        return {'x': _w((lambda *s: torch.randn(*s, dtype=torch.bfloat16) * 0.05)(B, S, Dm)), 'mem0': _w((lambda *s: torch.randn(*s, dtype=torch.bfloat16) * 0.8)(B, M, Dm)), 'Wq': _w((lambda *s: torch.randn(*s, dtype=torch.bfloat16) * 0.8)(Dm, H, Dh) * Dm ** (-0.5)), 'Wk': _w((lambda *s: torch.randn(*s, dtype=torch.bfloat16) * 0.8)(Dm, H, Dh) * Dm ** (-0.5)), 'Wv': _w((lambda *s: torch.randn(*s, dtype=torch.bfloat16) * 0.8)(Dm, H, Dh) * Dm ** (-0.5)), 'Wo': _w((lambda *s: torch.randn(*s, dtype=torch.bfloat16) * 0.8)(H, Dh, Dm) * (H * Dh) ** (-0.5)), 'seg_len': seg}
    _A_in = _A_setup()

    def _B_setup():
        B, S, D, F = (1, 2048, 640, 1536)
        return {'x': _w((lambda *s: torch.randn(*s, dtype=torch.bfloat16) * 0.05)(B, S, D)), 'w1': _w((lambda *s: torch.randn(*s, dtype=torch.bfloat16) * 0.8)(D, D) * D ** (-0.5)), 'w2': _w((lambda *s: torch.randn(*s, dtype=torch.bfloat16) * 0.8)(D, D) * D ** (-0.5)), 'w3': _w((lambda *s: torch.randn(*s, dtype=torch.bfloat16) * 0.8)(D, F) * D ** (-0.5)), 'w4': _w((lambda *s: torch.randn(*s, dtype=torch.bfloat16) * 0.8)(F, D) * F ** (-0.5))}
    _B_in = _B_setup()
    return {'A_x': _A_in['x'], 'A_mem0': _A_in['mem0'], 'A_Wq': _A_in['Wq'], 'A_Wk': _A_in['Wk'], 'A_Wv': _A_in['Wv'], 'A_Wo': _A_in['Wo'], 'A_seg_len': _A_in['seg_len'], 'B_x': _B_in['x'], 'B_w1': _B_in['w1'], 'B_w2': _B_in['w2'], 'B_w3': _B_in['w3'], 'B_w4': _B_in['w4']}

def reference(A_x, A_mem0, A_Wq, A_Wk, A_Wv, A_Wo, A_seg_len, B_x, B_w1, B_w2, B_w3, B_w4):

    def _A_ref(x, mem0, Wq, Wk, Wv, Wo, seg_len):
        B, S, Dm = x.shape
        H, Dh = (Wq.shape[1], Wq.shape[2])
        M = mem0.shape[1]
        scale = Dh ** (-0.5)
        n_seg = S // seg_len
        L = M + seg_len
        idx = torch.arange(L)
        mask = (idx[:, None] < M) | (idx[:, None] >= idx[None, :])
        mem = mem0
        outs = []
        for s in range(n_seg):
            xs = x[:, s * seg_len:(s + 1) * seg_len, :].clone()
            h = torch.concatenate([mem, xs], axis=1)
            q = torch.einsum('btd,dhe->bhte', h, Wq)
            k = torch.einsum('btd,dhe->bhte', h, Wk)
            v = torch.einsum('btd,dhe->bhte', h, Wv)
            scores = torch.einsum('bhqe,bhke->bhqk', q, k) * scale
            scores = torch.where(mask[None, None], scores, -1000000000.0)
            p = _softmax(scores, axis=-1)
            o = torch.einsum('bhqk,bhke->bhqe', p, v)
            o = torch.einsum('bhte,hed->btd', o, Wo)
            mem = o[:, :M, :].clone()
            outs.append(o[:, M:, :])
        return torch.concatenate(outs, axis=1)

    def _B_ref(x, w1, w2, w3, w4):
        B, S, D = x.shape
        h = _gelu(_layernorm(x, axis=-1) @ w1)
        c = D // 4
        g0 = _pad(h[:, :, 0 * c:1 * c], ((0, 0), (1, 0), (0, 0)))[:, :S, :]
        g1 = _pad(h[:, :, 1 * c:2 * c], ((0, 0), (0, 1), (0, 0)))[:, 1:, :]
        g2 = _pad(h[:, :, 2 * c:3 * c], ((0, 0), (2, 0), (0, 0)))[:, :S, :]
        g3 = _pad(h[:, :, 3 * c:], ((0, 0), (0, 2), (0, 0)))[:, 2:, :]
        hs = torch.concatenate([g0, g1, g2, g3], axis=-1) @ w2
        x1 = x + hs
        h2 = _gelu(_layernorm(x1, axis=-1) @ w3) @ w4
        return x1 + h2
    x = A_x
    x = x + _A_ref(_layernorm(x, axis=-1), A_mem0, A_Wq, A_Wk, A_Wv, A_Wo, A_seg_len)
    x = x + _B_ref(_layernorm(x, axis=-1), B_w1, B_w2, B_w3, B_w4)
    x = x + _A_ref(_layernorm(x, axis=-1), A_mem0, A_Wq, A_Wk, A_Wv, A_Wo, A_seg_len)
    x = x + _B_ref(_layernorm(x, axis=-1), B_w1, B_w2, B_w3, B_w4)
    return x
```

```asm
; @launch grid=(256,1,1) block=(256,1,1) lds=163840
.amdgcn_target "amdgcn-amd-amdhsa--gfx950"
.text
.globl interleave_layers__memory_aug_recurrent_mem_tr__mixer_s_mlp__prompt_kernel
.p2align 8
.type interleave_layers__memory_aug_recurrent_mem_tr__mixer_s_mlp__prompt_kernel,@function
interleave_layers__memory_aug_recurrent_mem_tr__mixer_s_mlp__prompt_kernel:
  s_cmp_ge_u32 s2, 256
  s_cbranch_scc1 EXIT
  s_load_dwordx16 s[16:31], s[0:1], 0
  s_load_dwordx8 s[32:39], s[0:1], 64
  s_load_dwordx4 s[40:43], s[0:1], 96
  s_load_dwordx2 s[44:45], s[0:1], 112
  v_lshrrev_b32 v1, 6, v0
  v_and_b32 v0, 63, v0
  v_readfirstlane_b32 s46, v1
  s_mov_b32 s47, 200000
  s_mov_b32 s49, 0
  s_getreg_b32 s4, hwreg(HW_REG_XCC_ID)
  s_and_b32 s4, s4, 7
  s_waitcnt lgkmcnt(0)
  s_mov_b32 s8, s44
  s_mov_b32 s9, s45
  s_mov_b32 s10, 268435456
  s_mov_b32 s11, 0x20000
  s_mov_b32 s12, s42
  s_mov_b32 s13, s43
  s_mov_b32 s14, 256
  s_mov_b32 s15, 0x20000
  v_lshlrev_b32 v1, 3, v0
  v_mov_b64 v[4:5], 0
  s_lshl_b32 s5, s2, 2
  s_add_u32 s5, s5, s46
  s_lshl_b32 s5, s5, 9
  buffer_store_dwordx2 v[4:5], v1, s[8:11], s5 offen sc1
  s_cmp_ge_u32 s4, 4
  s_cbranch_scc1 VOTE_DONE
  s_cmp_eq_u32 s46, 0
  s_cbranch_scc1 VOTE_DONE
  s_and_b32 s52, s2, 56
  s_cbranch_scc1 VOTE_DONE
  s_mov_b64 exec, 1
  v_mov_b32 v12, 0
  s_and_b32 s53, s2, 7
  s_lshl_b32 s53, s53, 10
  s_lshr_b32 s52, s2, 6
  s_lshl_b32 s52, s52, 14
  s_add_u32 s53, s53, s52
  s_lshl_b32 s52, s46, 21
  s_add_u32 s53, s53, s52
  s_add_u32 s53, s53, 3670016
  s_add_u32 s59, s53, 0x2000
  s_mov_b32 s50, -1
  s_mov_b32 s51, -1
  s_mov_b32 s52, 0
VOTE_LOOP:
  buffer_store_dword v12, v12, s[8:11], s53 offen sc1
  buffer_store_dword v12, v12, s[8:11], s59 offen sc1
  s_waitcnt vmcnt(0)
  s_memtime s[54:55]
  s_waitcnt lgkmcnt(0)
  buffer_load_dword v13, v12, s[8:11], s53 offen sc1
  s_waitcnt vmcnt(0)
  s_memtime s[56:57]
  s_waitcnt lgkmcnt(0)
  s_sub_u32 s56, s56, s54
  s_min_u32 s50, s50, s56
  s_memtime s[54:55]
  s_waitcnt lgkmcnt(0)
  buffer_load_dword v13, v12, s[8:11], s59 offen sc1
  s_waitcnt vmcnt(0)
  s_memtime s[56:57]
  s_waitcnt lgkmcnt(0)
  s_sub_u32 s56, s56, s54
  s_min_u32 s51, s51, s56
  s_add_u32 s52, s52, 1
  s_cmp_lt_u32 s52, 2
  s_cbranch_scc1 VOTE_LOOP
  s_cmp_lt_u32 s51, s50
  s_cselect_b32 s52, 1, -1
  v_mov_b32 v13, s52
  s_lshl2_add_u32 s52, s46, 188
  v_mov_b32 v12, s52
  buffer_atomic_add v13, v12, s[12:15], 0 offen sc1
  s_mov_b64 exec, -1
VOTE_DONE:
  v_mov_b32 v2, 0
  s_cmp_lg_u32 s46, 0
  s_cbranch_scc1 TK_DONE
  s_mov_b64 exec, 1
  v_mov_b32 v1, 1
  s_lshl_b32 s5, s4, 2
  v_mov_b32 v3, s5
  buffer_atomic_add v1, v3, s[12:15], 0 offen offset:32 sc0 sc1
  s_waitcnt vmcnt(0)
  v_readfirstlane_b32 s5, v1
  s_lshl_b32 s6, s4, 5
  s_add_u32 s6, s6, s5
  s_cmp_lt_u32 s5, 32
  s_cselect_b32 s6, s6, 999
  v_mov_b32 v1, s6
  ds_write_b32 v2, v1
  s_mov_b64 exec, -1
  s_waitcnt lgkmcnt(0)
TK_DONE:
  s_barrier
  ds_read_b32 v1, v2
  s_waitcnt lgkmcnt(0)
  v_readfirstlane_b32 s3, v1
  s_barrier
  s_nop 3
DISPATCH:
  s_sub_u32 s48, s3, 0
  s_cmp_lt_u32 s3, 8
  s_cbranch_scc1 GO_CQ
  s_sub_u32 s48, s3, 8
  s_cmp_lt_u32 s3, 16
  s_cbranch_scc1 GO_CV
  s_sub_u32 s48, s3, 16
  s_cmp_lt_u32 s3, 24
  s_cbranch_scc1 GO_OW
  s_sub_u32 s48, s3, 24
  s_cmp_lt_u32 s3, 32
  s_cbranch_scc1 GO_PO
  s_sub_u32 s48, s3, 24
  s_cmp_lt_u32 s3, 40
  s_cbranch_scc1 GO_CQ
  s_sub_u32 s48, s3, 32
  s_cmp_lt_u32 s3, 48
  s_cbranch_scc1 GO_CV
  s_sub_u32 s48, s3, 40
  s_cmp_lt_u32 s3, 56
  s_cbranch_scc1 GO_OW
  s_sub_u32 s48, s3, 48
  s_cmp_lt_u32 s3, 64
  s_cbranch_scc1 GO_PO
  s_sub_u32 s48, s3, 48
  s_cmp_lt_u32 s3, 72
  s_cbranch_scc1 GO_CQ
  s_sub_u32 s48, s3, 56
  s_cmp_lt_u32 s3, 80
  s_cbranch_scc1 GO_CV
  s_sub_u32 s48, s3, 64
  s_cmp_lt_u32 s3, 88
  s_cbranch_scc1 GO_OW
  s_sub_u32 s48, s3, 72
  s_cmp_lt_u32 s3, 96
  s_cbranch_scc1 GO_PO
  s_sub_u32 s48, s3, 72
  s_cmp_lt_u32 s3, 104
  s_cbranch_scc1 GO_CQ
  s_sub_u32 s48, s3, 80
  s_cmp_lt_u32 s3, 112
  s_cbranch_scc1 GO_CV
  s_sub_u32 s48, s3, 88
  s_cmp_lt_u32 s3, 120
  s_cbranch_scc1 GO_OW
  s_sub_u32 s48, s3, 96
  s_cmp_lt_u32 s3, 128
  s_cbranch_scc1 GO_PO
  s_sub_u32 s48, s3, 80
  s_cmp_lt_u32 s3, 160
  s_cbranch_scc1 GO_P1
  s_sub_u32 s48, s3, 80
  s_cmp_lt_u32 s3, 176
  s_cbranch_scc1 GO_P1
  s_sub_u32 s48, s3, 176
  s_cmp_lt_u32 s3, 192
  s_cbranch_scc1 GO_P1
  s_sub_u32 s48, s3, 176
  s_cmp_lt_u32 s3, 224
  s_cbranch_scc1 GO_P1
  s_sub_u32 s48, s3, 224
  s_cmp_lt_u32 s3, 229
  s_cbranch_scc1 GO_W1
  s_sub_u32 s48, s3, 229
  s_cmp_lt_u32 s3, 234
  s_cbranch_scc1 GO_W2
  s_sub_u32 s48, s3, 234
  s_cmp_lt_u32 s3, 246
  s_cbranch_scc1 GO_W3
  s_sub_u32 s48, s3, 246
  s_cmp_lt_u32 s3, 256
  s_cbranch_scc1 GO_W4
GO_SPARE:
  s_waitcnt vmcnt(0)
  s_barrier
  s_cmp_lg_u32 s46, 0
  s_cbranch_scc1 arr_1
  v_mov_b32 v12, 1
  s_lshl_b32 s3, s49, 2
  v_mov_b32 v13, s3
  s_mov_b64 exec, 1
  buffer_atomic_add v12, v13, s[12:15], 0 offen sc1
  s_mov_b64 exec, -1
arr_1:
  s_lshl_b32 s3, s49, 2
  v_mov_b32 v13, s3
  s_nop 1
ibw_2:
  buffer_load_dword v12, v13, s[12:15], 0 offen sc1
  s_waitcnt vmcnt(0)
  v_cmp_ne_u32 vcc, 256, v12
  s_nop 0
  s_cbranch_vccz ibw_3
  s_sleep 8
  s_sub_u32 s47, s47, 1
  s_cbranch_scc0 ibw_2
  s_branch ABORT
ibw_3:
  s_cmp_lg_u32 s49, 0
  s_cbranch_scc1 ibok_4
  v_and_b32 v13, 7, v0
  v_lshlrev_b32 v13, 2, v13
  buffer_load_dword v12, v13, s[12:15], 0 offen offset:32 sc1
  s_waitcnt vmcnt(0)
  v_cmp_ne_u32 vcc, 32, v12
  s_nop 0
  s_cbranch_vccz ibok_4
  s_barrier
  s_mov_b32 s49, 1
  s_mov_b32 s3, s2
  s_branch DISPATCH
ibok_4:
EXIT:
  s_endpgm
ABORT:
  s_mov_b64 exec, 1
  v_mov_b32 v1, s2
  v_add_u32 v1, 0x10000, v1
  v_mov_b32 v2, 8
  buffer_store_dword v1, v2, s[12:15], 0 offen
  s_endpgm
GO_CQ:
ROLE_CQ:
  v_lshlrev_b32 v1, 4, v0
  v_and_b32 v12, 1, v0
  v_mul_u32_u24 v2, 0xaaaa, v12
  v_add_u32 v2, 0x4444, v2
  s_mov_b32 s73, s48
  s_lshr_b32 s60, s73, 3
  s_mul_i32 s71, s60, 524288
  s_add_u32 s71, s71, 2097152
  s_mul_i32 s77, s46, 6144
  s_mul_i32 s72, s73, 36864
  s_add_u32 s72, s72, s77
  s_add_u32 s72, s72, 35651584
  s_mov_b32 s74, 0x3dd53b95
  s_mov_b32 s86, 0
  s_mov_b32 s87, -1
  s_mov_b32 s88, 0x00ff00ff
  s_mov_b32 s89, 0
  v_mov_b32 v110, 0xff800000
  v_lshrrev_b32 v12, 4, v0
  v_and_b32 v13, 15, v0
  v_lshl_add_u32 v14, v12, 2, 0
  v_cmp_le_u32 s[78:79], v14, v13
  v_lshl_add_u32 v14, v12, 2, 1
  v_cmp_le_u32 s[80:81], v14, v13
  v_lshl_add_u32 v14, v12, 2, 2
  v_cmp_le_u32 s[82:83], v14, v13
  v_lshl_add_u32 v14, v12, 2, 3
  v_cmp_le_u32 s[84:85], v14, v13
  v_and_b32 v3, 3, v0
  v_lshlrev_b32 v3, 3, v3
  v_bfe_u32 v14, v0, 2, 1
  v_lshl_add_u32 v3, v14, 10, v3
  v_min_u32 v4, 3, v0
  s_lshl_b32 s60, s73, 2
  v_add_lshl_u32 v4, v4, s60, 2
  v_lshrrev_b32 v6, 5, v0
  v_mul_u32_u24 v6, 1600, v6
  v_lshl_add_u32 v6, v13, 3, v6
  v_bfe_u32 v14, v0, 4, 1
  v_lshl_add_u32 v6, v14, 2, v6
  s_mul_i32 s60, s46, 384
  s_add_u32 s60, s60, 96256
  v_add_u32 v6, s60, v6
  v_lshrrev_b32 v7, 2, v0
  v_lshlrev_b32 v7, 3, v7
  v_and_b32 v14, 1, v0
  v_mul_u32_u24 v14, 1600, v14
  v_add_u32 v7, v7, v14
  v_add_u32 v7, 96256, v7
  v_bfe_u32 v14, v0, 1, 1
  v_add_u32 v111, 3200, v7
  v_lshl_add_u32 v7, v14, 8, v7
  s_mul_i32 s60, s46, 20480
  v_add_u32 v108, s60, v1
  v_add_u32 v109, 81920, v1
  s_and_b32 s60, s73, 7
  s_cmp_lg_u32 s46, 0
  s_cbranch_scc1 cq_5
  v_and_b32 v14, 7, v0
  v_bfe_u32 v15, v0, 3, 1
  v_and_b32 v16, 1, v12
  s_lshl_b32 s61, s60, 9
  s_add_u32 s61, s61, 10240
  v_lshl_add_u32 v8, v14, 5, s61
  v_lshl_add_u32 v8, v15, 4, v8
  v_lshl_add_u32 v8, v16, 3, v8
  v_lshrrev_b32 v17, 5, v0
  v_lshl_add_u32 v8, v17, 8, v8
  s_lshr_b32 s61, s60, 1
  s_lshl_b32 s61, s61, 8
  s_and_b32 s62, s60, 1
  s_lshl3_add_u32 s61, s62, s61
  s_add_u32 s61, s61, 14336
  v_lshl_add_u32 v9, v14, 5, s61
  v_lshl_add_u32 v9, v16, 4, v9
  v_lshlrev_b32 v111, 10, v15
  v_lshl_add_u32 v111, v12, 8, v111
  v_lshl_add_u32 v111, v14, 4, v111
  v_add_u32 v111, 92160, v111
  s_nop 0
  s_branch cq_6
cq_5:
  s_sub_u32 s63, s46, 1
  s_min_u32 s63, s63, 1
  s_lshl_b32 s61, s60, 1
  s_add_u32 s61, s61, s63
  s_lshl_b32 s61, s61, 10
  s_add_u32 s61, s61, 16384
  v_add_u32 v8, s61, v1
  v_lshrrev_b32 v15, 5, v0
  v_lshlrev_b32 v15, 3, v15
  v_lshl_add_u32 v9, v13, 4, v15
  s_lshr_b32 s61, s60, 2
  s_lshl_b32 s61, s61, 1
  s_add_u32 s61, s61, s63
  s_lshl_b32 s61, s61, 10
  s_and_b32 s62, s60, 3
  s_lshl_b32 s62, s62, 8
  s_add_u32 s61, s61, s62
  s_add_u32 s61, s61, 32768
  v_add_u32 v9, s61, v9
  s_nop 1
cq_6:
  v_mov_b32 v16, -1
  s_add_u32 s60, s71, 0
  buffer_store_dword v16, v8, s[8:11], s60 offen sc1
  buffer_store_dword v16, v9, s[8:11], s60 offen sc1
  s_add_u32 s60, s71, 131072
  buffer_store_dword v16, v8, s[8:11], s60 offen sc1
  buffer_store_dword v16, v9, s[8:11], s60 offen sc1
  s_add_u32 s60, s71, 262144
  buffer_store_dword v16, v8, s[8:11], s60 offen sc1
  buffer_store_dword v16, v9, s[8:11], s60 offen sc1
  s_add_u32 s60, s71, 393216
  buffer_store_dword v16, v8, s[8:11], s60 offen sc1
  buffer_store_dword v16, v9, s[8:11], s60 offen sc1
  s_waitcnt vmcnt(0)
  s_barrier
  s_cmp_lg_u32 s46, 0
  s_cbranch_scc1 arr_7
  v_mov_b32 v12, 1
  s_lshl_b32 s3, s49, 2
  v_mov_b32 v13, s3
  s_mov_b64 exec, 1
  buffer_atomic_add v12, v13, s[12:15], 0 offen sc1
  s_mov_b64 exec, -1
arr_7:
  v_add_u32 v16, 0, v0
  v_mul_u32_u24 v17, 2731, v16
  v_lshrrev_b32 v17, 16, v17
  v_mul_u32_u24 v12, 11904, v17
  v_lshl_add_u32 v12, v16, 4, v12
  v_add_u32 v16, 64, v0
  v_mul_u32_u24 v17, 2731, v16
  v_lshrrev_b32 v17, 16, v17
  v_mul_u32_u24 v13, 11904, v17
  v_lshl_add_u32 v13, v16, 4, v13
  v_add_u32 v16, 128, v0
  v_mul_u32_u24 v17, 2731, v16
  v_lshrrev_b32 v17, 16, v17
  v_mul_u32_u24 v14, 11904, v17
  v_lshl_add_u32 v14, v16, 4, v14
  v_bfe_u32 v18, v0, 2, 1
  v_bfe_u32 v19, v0, 4, 1
  v_lshl_add_u32 v18, v19, 5, v18
  v_bfe_u32 v19, v0, 3, 1
  v_lshl_add_u32 v18, v19, 4, v18
  v_lshrrev_b32 v19, 5, v0
  v_lshl_add_u32 v18, v19, 2, v18
  v_mul_u32_u24 v18, 384, v18
  v_and_b32 v19, 3, v0
  v_lshl_add_u32 v18, v19, 3, v18
  s_mul_i32 s60, s46, 96
  v_add_u32 v18, s60, v18
  s_cmp_lt_u32 s46, 2
  s_cselect_b32 s4, s20, s22
  s_cselect_b32 s5, s21, s23
  s_mov_b32 s6, 7864320
  s_mov_b32 s7, 0x20000
  s_and_b32 s60, s46, 1
  s_mul_i32 s60, s60, 393216
  s_mul_i32 s61, s73, 384
  s_add_u32 s62, s60, s61
  s_mul_i32 s63, s46, 12288
  s_mul_i32 s65, s46, 10240
  s_add_u32 s64, s62, 0
  s_add_u32 m0, s63, 0
  s_nop 0
  buffer_load_dwordx4 v12, s[4:7], s64 offen lds
  s_add_u32 m0, s63, 1024
  s_nop 0
  buffer_load_dwordx4 v13, s[4:7], s64 offen lds
  s_add_u32 m0, s63, 2048
  s_nop 0
  buffer_load_dwordx4 v14, s[4:7], s64 offen lds
  s_add_u32 s64, s62, 98304
  s_add_u32 m0, s63, 3072
  s_nop 0
  buffer_load_dwordx4 v12, s[4:7], s64 offen lds
  s_add_u32 m0, s63, 4096
  s_nop 0
  buffer_load_dwordx4 v13, s[4:7], s64 offen lds
  s_add_u32 m0, s63, 5120
  s_nop 0
  buffer_load_dwordx4 v14, s[4:7], s64 offen lds
  s_add_u32 s64, s62, 196608
  s_add_u32 m0, s63, 6144
  s_nop 0
  buffer_load_dwordx4 v12, s[4:7], s64 offen lds
  s_add_u32 m0, s63, 7168
  s_nop 0
  buffer_load_dwordx4 v13, s[4:7], s64 offen lds
  s_add_u32 m0, s63, 8192
  s_nop 0
  buffer_load_dwordx4 v14, s[4:7], s64 offen lds
  s_add_u32 s64, s62, 294912
  s_add_u32 m0, s63, 9216
  s_nop 0
  buffer_load_dwordx4 v12, s[4:7], s64 offen lds
  s_add_u32 m0, s63, 10240
  s_nop 0
  buffer_load_dwordx4 v13, s[4:7], s64 offen lds
  s_add_u32 m0, s63, 11264
  s_nop 0
  buffer_load_dwordx4 v14, s[4:7], s64 offen lds
  s_add_u32 s64, s62, 786432
  s_add_u32 m0, s63, 49152
  s_nop 0
  buffer_load_dwordx4 v12, s[4:7], s64 offen lds
  s_add_u32 m0, s63, 50176
  s_nop 0
  buffer_load_dwordx4 v13, s[4:7], s64 offen lds
  s_add_u32 m0, s63, 51200
  s_nop 0
  buffer_load_dwordx4 v14, s[4:7], s64 offen lds
  s_add_u32 s64, s62, 884736
  s_add_u32 m0, s63, 52224
  s_nop 0
  buffer_load_dwordx4 v12, s[4:7], s64 offen lds
  s_add_u32 m0, s63, 53248
  s_nop 0
  buffer_load_dwordx4 v13, s[4:7], s64 offen lds
  s_add_u32 m0, s63, 54272
  s_nop 0
  buffer_load_dwordx4 v14, s[4:7], s64 offen lds
  s_add_u32 s64, s62, 983040
  s_add_u32 m0, s63, 55296
  s_nop 0
  buffer_load_dwordx4 v12, s[4:7], s64 offen lds
  s_add_u32 m0, s63, 56320
  s_nop 0
  buffer_load_dwordx4 v13, s[4:7], s64 offen lds
  s_add_u32 m0, s63, 57344
  s_nop 0
  buffer_load_dwordx4 v14, s[4:7], s64 offen lds
  s_add_u32 s64, s62, 1081344
  s_add_u32 m0, s63, 58368
  s_nop 0
  buffer_load_dwordx4 v12, s[4:7], s64 offen lds
  s_add_u32 m0, s63, 59392
  s_nop 0
  buffer_load_dwordx4 v13, s[4:7], s64 offen lds
  s_add_u32 m0, s63, 60416
  s_nop 0
  buffer_load_dwordx4 v14, s[4:7], s64 offen lds
  s_add_u32 s64, s62, 1572864
  s_add_u32 m0, s63, 98304
  s_nop 0
  buffer_load_dwordx4 v12, s[4:7], s64 offen lds
  s_add_u32 m0, s63, 99328
  s_nop 0
  buffer_load_dwordx4 v13, s[4:7], s64 offen lds
  s_add_u32 m0, s63, 100352
  s_nop 0
  buffer_load_dwordx4 v14, s[4:7], s64 offen lds
  s_add_u32 s64, s62, 1671168
  s_add_u32 m0, s63, 101376
  s_nop 0
  buffer_load_dwordx4 v12, s[4:7], s64 offen lds
  s_add_u32 m0, s63, 102400
  s_nop 0
  buffer_load_dwordx4 v13, s[4:7], s64 offen lds
  s_add_u32 m0, s63, 103424
  s_nop 0
  buffer_load_dwordx4 v14, s[4:7], s64 offen lds
  s_add_u32 s64, s62, 1769472
  s_add_u32 m0, s63, 104448
  s_nop 0
  buffer_load_dwordx4 v12, s[4:7], s64 offen lds
  s_add_u32 m0, s63, 105472
  s_nop 0
  buffer_load_dwordx4 v13, s[4:7], s64 offen lds
  s_add_u32 m0, s63, 106496
  s_nop 0
  buffer_load_dwordx4 v14, s[4:7], s64 offen lds
  s_add_u32 s64, s62, 1867776
  s_add_u32 m0, s63, 107520
  s_nop 0
  buffer_load_dwordx4 v12, s[4:7], s64 offen lds
  s_add_u32 m0, s63, 108544
  s_nop 0
  buffer_load_dwordx4 v13, s[4:7], s64 offen lds
  s_add_u32 m0, s63, 109568
  s_nop 0
  buffer_load_dwordx4 v14, s[4:7], s64 offen lds
  s_waitcnt vmcnt(24)
  s_barrier
  v_add_u32 v15, 0, v18
  ds_read_b64_tr_b16 v[20:21], v15 offset:0
  ds_read_b64_tr_b16 v[22:23], v15 offset:768
  ds_read_b64_tr_b16 v[24:25], v15 offset:3072
  ds_read_b64_tr_b16 v[26:27], v15 offset:3840
  ds_read_b64_tr_b16 a[64:65], v15 offset:32
  ds_read_b64_tr_b16 a[66:67], v15 offset:800
  ds_read_b64_tr_b16 a[68:69], v15 offset:3104
  ds_read_b64_tr_b16 a[70:71], v15 offset:3872
  ds_read_b64_tr_b16 a[128:129], v15 offset:64
  ds_read_b64_tr_b16 a[130:131], v15 offset:832
  ds_read_b64_tr_b16 a[132:133], v15 offset:3136
  ds_read_b64_tr_b16 a[134:135], v15 offset:3904
  s_waitcnt lgkmcnt(3)
  ds_read_b64_tr_b16 a[192:193], v15 offset:24576
  ds_read_b64_tr_b16 a[194:195], v15 offset:25344
  ds_read_b64_tr_b16 a[196:197], v15 offset:27648
  ds_read_b64_tr_b16 a[198:199], v15 offset:28416
  ds_read_b64_tr_b16 v[112:113], v15 offset:24608
  ds_read_b64_tr_b16 v[114:115], v15 offset:25376
  ds_read_b64_tr_b16 v[116:117], v15 offset:27680
  ds_read_b64_tr_b16 v[118:119], v15 offset:28448
  ds_read_b64_tr_b16 v[184:185], v15 offset:24640
  ds_read_b64_tr_b16 v[186:187], v15 offset:25408
  ds_read_b64_tr_b16 v[188:189], v15 offset:27712
  ds_read_b64_tr_b16 v[190:191], v15 offset:28480
  s_waitcnt lgkmcnt(3)
  s_waitcnt lgkmcnt(0)
  s_barrier
  s_add_u32 s64, s62, 2359296
  s_add_u32 m0, s63, 0
  s_nop 0
  buffer_load_dwordx4 v12, s[4:7], s64 offen lds
  s_add_u32 m0, s63, 1024
  s_nop 0
  buffer_load_dwordx4 v13, s[4:7], s64 offen lds
  s_add_u32 m0, s63, 2048
  s_nop 0
  buffer_load_dwordx4 v14, s[4:7], s64 offen lds
  s_add_u32 s64, s62, 2457600
  s_add_u32 m0, s63, 3072
  s_nop 0
  buffer_load_dwordx4 v12, s[4:7], s64 offen lds
  s_add_u32 m0, s63, 4096
  s_nop 0
  buffer_load_dwordx4 v13, s[4:7], s64 offen lds
  s_add_u32 m0, s63, 5120
  s_nop 0
  buffer_load_dwordx4 v14, s[4:7], s64 offen lds
  s_add_u32 s64, s62, 2555904
  s_add_u32 m0, s63, 6144
  s_nop 0
  buffer_load_dwordx4 v12, s[4:7], s64 offen lds
  s_add_u32 m0, s63, 7168
  s_nop 0
  buffer_load_dwordx4 v13, s[4:7], s64 offen lds
  s_add_u32 m0, s63, 8192
  s_nop 0
  buffer_load_dwordx4 v14, s[4:7], s64 offen lds
  s_add_u32 s64, s62, 2654208
  s_add_u32 m0, s63, 9216
  s_nop 0
  buffer_load_dwordx4 v12, s[4:7], s64 offen lds
  s_add_u32 m0, s63, 10240
  s_nop 0
  buffer_load_dwordx4 v13, s[4:7], s64 offen lds
  s_add_u32 m0, s63, 11264
  s_nop 0
  buffer_load_dwordx4 v14, s[4:7], s64 offen lds
  s_waitcnt vmcnt(24)
  s_barrier
  v_add_u32 v15, 49152, v18
  ds_read_b64_tr_b16 a[0:1], v15 offset:0
  ds_read_b64_tr_b16 a[2:3], v15 offset:768
  ds_read_b64_tr_b16 a[4:5], v15 offset:3072
  ds_read_b64_tr_b16 a[6:7], v15 offset:3840
  ds_read_b64_tr_b16 a[72:73], v15 offset:32
  ds_read_b64_tr_b16 a[74:75], v15 offset:800
  ds_read_b64_tr_b16 a[76:77], v15 offset:3104
  ds_read_b64_tr_b16 a[78:79], v15 offset:3872
  ds_read_b64_tr_b16 v[52:53], v15 offset:64
  ds_read_b64_tr_b16 v[54:55], v15 offset:832
  ds_read_b64_tr_b16 v[56:57], v15 offset:3136
  ds_read_b64_tr_b16 v[58:59], v15 offset:3904
  s_waitcnt lgkmcnt(3)
  ds_read_b64_tr_b16 a[200:201], v15 offset:24576
  ds_read_b64_tr_b16 a[202:203], v15 offset:25344
  ds_read_b64_tr_b16 a[204:205], v15 offset:27648
  ds_read_b64_tr_b16 a[206:207], v15 offset:28416
  ds_read_b64_tr_b16 v[120:121], v15 offset:24608
  ds_read_b64_tr_b16 v[122:123], v15 offset:25376
  ds_read_b64_tr_b16 v[124:125], v15 offset:27680
  ds_read_b64_tr_b16 v[126:127], v15 offset:28448
  ds_read_b64_tr_b16 v[192:193], v15 offset:24640
  ds_read_b64_tr_b16 v[194:195], v15 offset:25408
  ds_read_b64_tr_b16 v[196:197], v15 offset:27712
  ds_read_b64_tr_b16 v[198:199], v15 offset:28480
  s_waitcnt lgkmcnt(3)
  s_waitcnt lgkmcnt(0)
  s_barrier
  s_add_u32 s64, s62, 3145728
  s_add_u32 m0, s63, 49152
  s_nop 0
  buffer_load_dwordx4 v12, s[4:7], s64 offen lds
  s_add_u32 m0, s63, 50176
  s_nop 0
  buffer_load_dwordx4 v13, s[4:7], s64 offen lds
  s_add_u32 m0, s63, 51200
  s_nop 0
  buffer_load_dwordx4 v14, s[4:7], s64 offen lds
  s_add_u32 s64, s62, 3244032
  s_add_u32 m0, s63, 52224
  s_nop 0
  buffer_load_dwordx4 v12, s[4:7], s64 offen lds
  s_add_u32 m0, s63, 53248
  s_nop 0
  buffer_load_dwordx4 v13, s[4:7], s64 offen lds
  s_add_u32 m0, s63, 54272
  s_nop 0
  buffer_load_dwordx4 v14, s[4:7], s64 offen lds
  s_add_u32 s64, s62, 3342336
  s_add_u32 m0, s63, 55296
  s_nop 0
  buffer_load_dwordx4 v12, s[4:7], s64 offen lds
  s_add_u32 m0, s63, 56320
  s_nop 0
  buffer_load_dwordx4 v13, s[4:7], s64 offen lds
  s_add_u32 m0, s63, 57344
  s_nop 0
  buffer_load_dwordx4 v14, s[4:7], s64 offen lds
  s_add_u32 s64, s62, 3440640
  s_add_u32 m0, s63, 58368
  s_nop 0
  buffer_load_dwordx4 v12, s[4:7], s64 offen lds
  s_add_u32 m0, s63, 59392
  s_nop 0
  buffer_load_dwordx4 v13, s[4:7], s64 offen lds
  s_add_u32 m0, s63, 60416
  s_nop 0
  buffer_load_dwordx4 v14, s[4:7], s64 offen lds
  s_waitcnt vmcnt(24)
  s_barrier
  v_add_u32 v15, 98304, v18
  ds_read_b64_tr_b16 a[8:9], v15 offset:0
  ds_read_b64_tr_b16 a[10:11], v15 offset:768
  ds_read_b64_tr_b16 a[12:13], v15 offset:3072
  ds_read_b64_tr_b16 a[14:15], v15 offset:3840
  ds_read_b64_tr_b16 a[80:81], v15 offset:32
  ds_read_b64_tr_b16 a[82:83], v15 offset:800
  ds_read_b64_tr_b16 a[84:85], v15 offset:3104
  ds_read_b64_tr_b16 a[86:87], v15 offset:3872
  ds_read_b64_tr_b16 a[136:137], v15 offset:64
  ds_read_b64_tr_b16 a[138:139], v15 offset:832
  ds_read_b64_tr_b16 a[140:141], v15 offset:3136
  ds_read_b64_tr_b16 a[142:143], v15 offset:3904
  s_waitcnt lgkmcnt(3)
  ds_read_b64_tr_b16 a[208:209], v15 offset:24576
  ds_read_b64_tr_b16 a[210:211], v15 offset:25344
  ds_read_b64_tr_b16 a[212:213], v15 offset:27648
  ds_read_b64_tr_b16 a[214:215], v15 offset:28416
  ds_read_b64_tr_b16 v[84:85], v15 offset:24608
  ds_read_b64_tr_b16 v[86:87], v15 offset:25376
  ds_read_b64_tr_b16 v[88:89], v15 offset:27680
  ds_read_b64_tr_b16 v[90:91], v15 offset:28448
  ds_read_b64_tr_b16 v[200:201], v15 offset:24640
  ds_read_b64_tr_b16 v[202:203], v15 offset:25408
  ds_read_b64_tr_b16 v[204:205], v15 offset:27712
  ds_read_b64_tr_b16 v[206:207], v15 offset:28480
  s_waitcnt lgkmcnt(3)
  s_waitcnt lgkmcnt(0)
  s_barrier
  s_add_u32 s64, s62, 3932160
  s_add_u32 m0, s63, 98304
  s_nop 0
  buffer_load_dwordx4 v12, s[4:7], s64 offen lds
  s_add_u32 m0, s63, 99328
  s_nop 0
  buffer_load_dwordx4 v13, s[4:7], s64 offen lds
  s_add_u32 m0, s63, 100352
  s_nop 0
  buffer_load_dwordx4 v14, s[4:7], s64 offen lds
  s_add_u32 s64, s62, 4030464
  s_add_u32 m0, s63, 101376
  s_nop 0
  buffer_load_dwordx4 v12, s[4:7], s64 offen lds
  s_add_u32 m0, s63, 102400
  s_nop 0
  buffer_load_dwordx4 v13, s[4:7], s64 offen lds
  s_add_u32 m0, s63, 103424
  s_nop 0
  buffer_load_dwordx4 v14, s[4:7], s64 offen lds
  s_add_u32 s64, s62, 4128768
  s_add_u32 m0, s63, 104448
  s_nop 0
  buffer_load_dwordx4 v12, s[4:7], s64 offen lds
  s_add_u32 m0, s63, 105472
  s_nop 0
  buffer_load_dwordx4 v13, s[4:7], s64 offen lds
  s_add_u32 m0, s63, 106496
  s_nop 0
  buffer_load_dwordx4 v14, s[4:7], s64 offen lds
  s_add_u32 s64, s62, 4227072
  s_add_u32 m0, s63, 107520
  s_nop 0
  buffer_load_dwordx4 v12, s[4:7], s64 offen lds
  s_add_u32 m0, s63, 108544
  s_nop 0
  buffer_load_dwordx4 v13, s[4:7], s64 offen lds
  s_add_u32 m0, s63, 109568
  s_nop 0
  buffer_load_dwordx4 v14, s[4:7], s64 offen lds
  s_waitcnt vmcnt(24)
  s_barrier
  v_add_u32 v15, 0, v18
  ds_read_b64_tr_b16 a[16:17], v15 offset:0
  ds_read_b64_tr_b16 a[18:19], v15 offset:768
  ds_read_b64_tr_b16 a[20:21], v15 offset:3072
  ds_read_b64_tr_b16 a[22:23], v15 offset:3840
  ds_read_b64_tr_b16 v[36:37], v15 offset:32
  ds_read_b64_tr_b16 v[38:39], v15 offset:800
  ds_read_b64_tr_b16 v[40:41], v15 offset:3104
  ds_read_b64_tr_b16 v[42:43], v15 offset:3872
  ds_read_b64_tr_b16 a[144:145], v15 offset:64
  ds_read_b64_tr_b16 a[146:147], v15 offset:832
  ds_read_b64_tr_b16 a[148:149], v15 offset:3136
  ds_read_b64_tr_b16 a[150:151], v15 offset:3904
  s_waitcnt lgkmcnt(3)
  ds_read_b64_tr_b16 a[216:217], v15 offset:24576
  ds_read_b64_tr_b16 a[218:219], v15 offset:25344
  ds_read_b64_tr_b16 a[220:221], v15 offset:27648
  ds_read_b64_tr_b16 a[222:223], v15 offset:28416
  ds_read_b64_tr_b16 v[128:129], v15 offset:24608
  ds_read_b64_tr_b16 v[130:131], v15 offset:25376
  ds_read_b64_tr_b16 v[132:133], v15 offset:27680
  ds_read_b64_tr_b16 v[134:135], v15 offset:28448
  ds_read_b64_tr_b16 v[208:209], v15 offset:24640
  ds_read_b64_tr_b16 v[210:211], v15 offset:25408
  ds_read_b64_tr_b16 v[212:213], v15 offset:27712
  ds_read_b64_tr_b16 v[214:215], v15 offset:28480
  s_waitcnt lgkmcnt(3)
  s_waitcnt lgkmcnt(0)
  s_barrier
  s_add_u32 s64, s62, 4718592
  s_add_u32 m0, s63, 0
  s_nop 0
  buffer_load_dwordx4 v12, s[4:7], s64 offen lds
  s_add_u32 m0, s63, 1024
  s_nop 0
  buffer_load_dwordx4 v13, s[4:7], s64 offen lds
  s_add_u32 m0, s63, 2048
  s_nop 0
  buffer_load_dwordx4 v14, s[4:7], s64 offen lds
  s_add_u32 s64, s62, 4816896
  s_add_u32 m0, s63, 3072
  s_nop 0
  buffer_load_dwordx4 v12, s[4:7], s64 offen lds
  s_add_u32 m0, s63, 4096
  s_nop 0
  buffer_load_dwordx4 v13, s[4:7], s64 offen lds
  s_add_u32 m0, s63, 5120
  s_nop 0
  buffer_load_dwordx4 v14, s[4:7], s64 offen lds
  s_add_u32 s64, s62, 4915200
  s_add_u32 m0, s63, 6144
  s_nop 0
  buffer_load_dwordx4 v12, s[4:7], s64 offen lds
  s_add_u32 m0, s63, 7168
  s_nop 0
  buffer_load_dwordx4 v13, s[4:7], s64 offen lds
  s_add_u32 m0, s63, 8192
  s_nop 0
  buffer_load_dwordx4 v14, s[4:7], s64 offen lds
  s_add_u32 s64, s62, 5013504
  s_add_u32 m0, s63, 9216
  s_nop 0
  buffer_load_dwordx4 v12, s[4:7], s64 offen lds
  s_add_u32 m0, s63, 10240
  s_nop 0
  buffer_load_dwordx4 v13, s[4:7], s64 offen lds
  s_add_u32 m0, s63, 11264
  s_nop 0
  buffer_load_dwordx4 v14, s[4:7], s64 offen lds
  s_waitcnt vmcnt(24)
  s_barrier
  v_add_u32 v15, 49152, v18
  ds_read_b64_tr_b16 a[24:25], v15 offset:0
  ds_read_b64_tr_b16 a[26:27], v15 offset:768
  ds_read_b64_tr_b16 a[28:29], v15 offset:3072
  ds_read_b64_tr_b16 a[30:31], v15 offset:3840
  ds_read_b64_tr_b16 a[88:89], v15 offset:32
  ds_read_b64_tr_b16 a[90:91], v15 offset:800
  ds_read_b64_tr_b16 a[92:93], v15 offset:3104
  ds_read_b64_tr_b16 a[94:95], v15 offset:3872
  ds_read_b64_tr_b16 a[152:153], v15 offset:64
  ds_read_b64_tr_b16 a[154:155], v15 offset:832
  ds_read_b64_tr_b16 a[156:157], v15 offset:3136
  ds_read_b64_tr_b16 a[158:159], v15 offset:3904
  s_waitcnt lgkmcnt(3)
  ds_read_b64_tr_b16 v[68:69], v15 offset:24576
  ds_read_b64_tr_b16 v[70:71], v15 offset:25344
  ds_read_b64_tr_b16 v[72:73], v15 offset:27648
  ds_read_b64_tr_b16 v[74:75], v15 offset:28416
  ds_read_b64_tr_b16 v[136:137], v15 offset:24608
  ds_read_b64_tr_b16 v[138:139], v15 offset:25376
  ds_read_b64_tr_b16 v[140:141], v15 offset:27680
  ds_read_b64_tr_b16 v[142:143], v15 offset:28448
  ds_read_b64_tr_b16 v[216:217], v15 offset:24640
  ds_read_b64_tr_b16 v[218:219], v15 offset:25408
  ds_read_b64_tr_b16 v[220:221], v15 offset:27712
  ds_read_b64_tr_b16 v[222:223], v15 offset:28480
  s_waitcnt lgkmcnt(3)
  s_waitcnt lgkmcnt(0)
  s_barrier
  s_add_u32 s64, s62, 5505024
  s_add_u32 m0, s63, 49152
  s_nop 0
  buffer_load_dwordx4 v12, s[4:7], s64 offen lds
  s_add_u32 m0, s63, 50176
  s_nop 0
  buffer_load_dwordx4 v13, s[4:7], s64 offen lds
  s_add_u32 m0, s63, 51200
  s_nop 0
  buffer_load_dwordx4 v14, s[4:7], s64 offen lds
  s_add_u32 s64, s62, 5603328
  s_add_u32 m0, s63, 52224
  s_nop 0
  buffer_load_dwordx4 v12, s[4:7], s64 offen lds
  s_add_u32 m0, s63, 53248
  s_nop 0
  buffer_load_dwordx4 v13, s[4:7], s64 offen lds
  s_add_u32 m0, s63, 54272
  s_nop 0
  buffer_load_dwordx4 v14, s[4:7], s64 offen lds
  s_add_u32 s64, s62, 5701632
  s_add_u32 m0, s63, 55296
  s_nop 0
  buffer_load_dwordx4 v12, s[4:7], s64 offen lds
  s_add_u32 m0, s63, 56320
  s_nop 0
  buffer_load_dwordx4 v13, s[4:7], s64 offen lds
  s_add_u32 m0, s63, 57344
  s_nop 0
  buffer_load_dwordx4 v14, s[4:7], s64 offen lds
  s_add_u32 s64, s62, 5799936
  s_add_u32 m0, s63, 58368
  s_nop 0
  buffer_load_dwordx4 v12, s[4:7], s64 offen lds
  s_add_u32 m0, s63, 59392
  s_nop 0
  buffer_load_dwordx4 v13, s[4:7], s64 offen lds
  s_add_u32 m0, s63, 60416
  s_nop 0
  buffer_load_dwordx4 v14, s[4:7], s64 offen lds
  s_waitcnt vmcnt(24)
  s_barrier
  v_add_u32 v15, 98304, v18
  ds_read_b64_tr_b16 v[28:29], v15 offset:0
  ds_read_b64_tr_b16 v[30:31], v15 offset:768
  ds_read_b64_tr_b16 v[32:33], v15 offset:3072
  ds_read_b64_tr_b16 v[34:35], v15 offset:3840
  ds_read_b64_tr_b16 a[96:97], v15 offset:32
  ds_read_b64_tr_b16 a[98:99], v15 offset:800
  ds_read_b64_tr_b16 a[100:101], v15 offset:3104
  ds_read_b64_tr_b16 a[102:103], v15 offset:3872
  ds_read_b64_tr_b16 a[160:161], v15 offset:64
  ds_read_b64_tr_b16 a[162:163], v15 offset:832
  ds_read_b64_tr_b16 a[164:165], v15 offset:3136
  ds_read_b64_tr_b16 a[166:167], v15 offset:3904
  s_waitcnt lgkmcnt(3)
  ds_read_b64_tr_b16 a[224:225], v15 offset:24576
  ds_read_b64_tr_b16 a[226:227], v15 offset:25344
  ds_read_b64_tr_b16 a[228:229], v15 offset:27648
  ds_read_b64_tr_b16 a[230:231], v15 offset:28416
  ds_read_b64_tr_b16 v[144:145], v15 offset:24608
  ds_read_b64_tr_b16 v[146:147], v15 offset:25376
  ds_read_b64_tr_b16 v[148:149], v15 offset:27680
  ds_read_b64_tr_b16 v[150:151], v15 offset:28448
  ds_read_b64_tr_b16 v[224:225], v15 offset:24640
  ds_read_b64_tr_b16 v[226:227], v15 offset:25408
  ds_read_b64_tr_b16 v[228:229], v15 offset:27712
  ds_read_b64_tr_b16 v[230:231], v15 offset:28480
  s_waitcnt lgkmcnt(3)
  s_waitcnt lgkmcnt(0)
  s_barrier
  s_add_u32 s64, s62, 6291456
  s_add_u32 m0, s63, 98304
  s_nop 0
  buffer_load_dwordx4 v12, s[4:7], s64 offen lds
  s_add_u32 m0, s63, 99328
  s_nop 0
  buffer_load_dwordx4 v13, s[4:7], s64 offen lds
  s_add_u32 m0, s63, 100352
  s_nop 0
  buffer_load_dwordx4 v14, s[4:7], s64 offen lds
  s_add_u32 s64, s62, 6389760
  s_add_u32 m0, s63, 101376
  s_nop 0
  buffer_load_dwordx4 v12, s[4:7], s64 offen lds
  s_add_u32 m0, s63, 102400
  s_nop 0
  buffer_load_dwordx4 v13, s[4:7], s64 offen lds
  s_add_u32 m0, s63, 103424
  s_nop 0
  buffer_load_dwordx4 v14, s[4:7], s64 offen lds
  s_add_u32 s64, s62, 6488064
  s_add_u32 m0, s63, 104448
  s_nop 0
  buffer_load_dwordx4 v12, s[4:7], s64 offen lds
  s_add_u32 m0, s63, 105472
  s_nop 0
  buffer_load_dwordx4 v13, s[4:7], s64 offen lds
  s_add_u32 m0, s63, 106496
  s_nop 0
  buffer_load_dwordx4 v14, s[4:7], s64 offen lds
  s_add_u32 s64, s62, 6586368
  s_add_u32 m0, s63, 107520
  s_nop 0
  buffer_load_dwordx4 v12, s[4:7], s64 offen lds
  s_add_u32 m0, s63, 108544
  s_nop 0
  buffer_load_dwordx4 v13, s[4:7], s64 offen lds
  s_add_u32 m0, s63, 109568
  s_nop 0
  buffer_load_dwordx4 v14, s[4:7], s64 offen lds
  s_waitcnt vmcnt(24)
  s_barrier
  v_add_u32 v15, 0, v18
  ds_read_b64_tr_b16 a[32:33], v15 offset:0
  ds_read_b64_tr_b16 a[34:35], v15 offset:768
  ds_read_b64_tr_b16 a[36:37], v15 offset:3072
  ds_read_b64_tr_b16 a[38:39], v15 offset:3840
  ds_read_b64_tr_b16 a[104:105], v15 offset:32
  ds_read_b64_tr_b16 a[106:107], v15 offset:800
  ds_read_b64_tr_b16 a[108:109], v15 offset:3104
  ds_read_b64_tr_b16 a[110:111], v15 offset:3872
  ds_read_b64_tr_b16 v[60:61], v15 offset:64
  ds_read_b64_tr_b16 v[62:63], v15 offset:832
  ds_read_b64_tr_b16 v[64:65], v15 offset:3136
  ds_read_b64_tr_b16 v[66:67], v15 offset:3904
  s_waitcnt lgkmcnt(3)
  ds_read_b64_tr_b16 a[232:233], v15 offset:24576
  ds_read_b64_tr_b16 a[234:235], v15 offset:25344
  ds_read_b64_tr_b16 a[236:237], v15 offset:27648
  ds_read_b64_tr_b16 a[238:239], v15 offset:28416
  ds_read_b64_tr_b16 v[152:153], v15 offset:24608
  ds_read_b64_tr_b16 v[154:155], v15 offset:25376
  ds_read_b64_tr_b16 v[156:157], v15 offset:27680
  ds_read_b64_tr_b16 v[158:159], v15 offset:28448
  ds_read_b64_tr_b16 v[232:233], v15 offset:24640
  ds_read_b64_tr_b16 v[234:235], v15 offset:25408
  ds_read_b64_tr_b16 v[236:237], v15 offset:27712
  ds_read_b64_tr_b16 v[238:239], v15 offset:28480
  s_waitcnt lgkmcnt(3)
  s_waitcnt lgkmcnt(0)
  s_barrier
  s_add_u32 s64, s62, 7077888
  s_add_u32 m0, s63, 0
  s_nop 0
  buffer_load_dwordx4 v12, s[4:7], s64 offen lds
  s_add_u32 m0, s63, 1024
  s_nop 0
  buffer_load_dwordx4 v13, s[4:7], s64 offen lds
  s_add_u32 m0, s63, 2048
  s_nop 0
  buffer_load_dwordx4 v14, s[4:7], s64 offen lds
  s_add_u32 s64, s62, 7176192
  s_add_u32 m0, s63, 3072
  s_nop 0
  buffer_load_dwordx4 v12, s[4:7], s64 offen lds
  s_add_u32 m0, s63, 4096
  s_nop 0
  buffer_load_dwordx4 v13, s[4:7], s64 offen lds
  s_add_u32 m0, s63, 5120
  s_nop 0
  buffer_load_dwordx4 v14, s[4:7], s64 offen lds
  s_add_u32 s64, s62, 7274496
  s_add_u32 m0, s63, 6144
  s_nop 0
  buffer_load_dwordx4 v12, s[4:7], s64 offen lds
  s_add_u32 m0, s63, 7168
  s_nop 0
  buffer_load_dwordx4 v13, s[4:7], s64 offen lds
  s_add_u32 m0, s63, 8192
  s_nop 0
  buffer_load_dwordx4 v14, s[4:7], s64 offen lds
  s_add_u32 s64, s62, 7372800
  s_add_u32 m0, s63, 9216
  s_nop 0
  buffer_load_dwordx4 v12, s[4:7], s64 offen lds
  s_add_u32 m0, s63, 10240
  s_nop 0
  buffer_load_dwordx4 v13, s[4:7], s64 offen lds
  s_add_u32 m0, s63, 11264
  s_nop 0
  buffer_load_dwordx4 v14, s[4:7], s64 offen lds
  s_waitcnt vmcnt(24)
  s_barrier
  v_add_u32 v15, 49152, v18
  ds_read_b64_tr_b16 a[40:41], v15 offset:0
  ds_read_b64_tr_b16 a[42:43], v15 offset:768
  ds_read_b64_tr_b16 a[44:45], v15 offset:3072
  ds_read_b64_tr_b16 a[46:47], v15 offset:3840
  ds_read_b64_tr_b16 a[112:113], v15 offset:32
  ds_read_b64_tr_b16 a[114:115], v15 offset:800
  ds_read_b64_tr_b16 a[116:117], v15 offset:3104
  ds_read_b64_tr_b16 a[118:119], v15 offset:3872
  ds_read_b64_tr_b16 a[168:169], v15 offset:64
  ds_read_b64_tr_b16 a[170:171], v15 offset:832
  ds_read_b64_tr_b16 a[172:173], v15 offset:3136
  ds_read_b64_tr_b16 a[174:175], v15 offset:3904
  s_waitcnt lgkmcnt(3)
  ds_read_b64_tr_b16 a[240:241], v15 offset:24576
  ds_read_b64_tr_b16 a[242:243], v15 offset:25344
  ds_read_b64_tr_b16 a[244:245], v15 offset:27648
  ds_read_b64_tr_b16 a[246:247], v15 offset:28416
  ds_read_b64_tr_b16 v[160:161], v15 offset:24608
  ds_read_b64_tr_b16 v[162:163], v15 offset:25376
  ds_read_b64_tr_b16 v[164:165], v15 offset:27680
  ds_read_b64_tr_b16 v[166:167], v15 offset:28448
  ds_read_b64_tr_b16 v[92:93], v15 offset:24640
  ds_read_b64_tr_b16 v[94:95], v15 offset:25408
  ds_read_b64_tr_b16 v[96:97], v15 offset:27712
  ds_read_b64_tr_b16 v[98:99], v15 offset:28480
  s_waitcnt lgkmcnt(3)
  s_waitcnt lgkmcnt(0)
  s_barrier
  s_waitcnt vmcnt(12)
  s_barrier
  v_add_u32 v15, 98304, v18
  ds_read_b64_tr_b16 a[48:49], v15 offset:0
  ds_read_b64_tr_b16 a[50:51], v15 offset:768
  ds_read_b64_tr_b16 a[52:53], v15 offset:3072
  ds_read_b64_tr_b16 a[54:55], v15 offset:3840
  ds_read_b64_tr_b16 v[44:45], v15 offset:32
  ds_read_b64_tr_b16 v[46:47], v15 offset:800
  ds_read_b64_tr_b16 v[48:49], v15 offset:3104
  ds_read_b64_tr_b16 v[50:51], v15 offset:3872
  ds_read_b64_tr_b16 a[176:177], v15 offset:64
  ds_read_b64_tr_b16 a[178:179], v15 offset:832
  ds_read_b64_tr_b16 a[180:181], v15 offset:3136
  ds_read_b64_tr_b16 a[182:183], v15 offset:3904
  s_waitcnt lgkmcnt(3)
  ds_read_b64_tr_b16 a[248:249], v15 offset:24576
  ds_read_b64_tr_b16 a[250:251], v15 offset:25344
  ds_read_b64_tr_b16 a[252:253], v15 offset:27648
  ds_read_b64_tr_b16 a[254:255], v15 offset:28416
  ds_read_b64_tr_b16 v[168:169], v15 offset:24608
  ds_read_b64_tr_b16 v[170:171], v15 offset:25376
  ds_read_b64_tr_b16 v[172:173], v15 offset:27680
  ds_read_b64_tr_b16 v[174:175], v15 offset:28448
  ds_read_b64_tr_b16 v[240:241], v15 offset:24640
  ds_read_b64_tr_b16 v[242:243], v15 offset:25408
  ds_read_b64_tr_b16 v[244:245], v15 offset:27712
  ds_read_b64_tr_b16 v[246:247], v15 offset:28480
  s_waitcnt lgkmcnt(3)
  s_waitcnt lgkmcnt(0)
  s_barrier
  s_waitcnt vmcnt(0)
  s_barrier
  v_add_u32 v15, 0, v18
  ds_read_b64_tr_b16 a[56:57], v15 offset:0
  ds_read_b64_tr_b16 a[58:59], v15 offset:768
  ds_read_b64_tr_b16 a[60:61], v15 offset:3072
  ds_read_b64_tr_b16 a[62:63], v15 offset:3840
  ds_read_b64_tr_b16 a[120:121], v15 offset:32
  ds_read_b64_tr_b16 a[122:123], v15 offset:800
  ds_read_b64_tr_b16 a[124:125], v15 offset:3104
  ds_read_b64_tr_b16 a[126:127], v15 offset:3872
  ds_read_b64_tr_b16 a[184:185], v15 offset:64
  ds_read_b64_tr_b16 a[186:187], v15 offset:832
  ds_read_b64_tr_b16 a[188:189], v15 offset:3136
  ds_read_b64_tr_b16 a[190:191], v15 offset:3904
  s_waitcnt lgkmcnt(3)
  ds_read_b64_tr_b16 v[76:77], v15 offset:24576
  ds_read_b64_tr_b16 v[78:79], v15 offset:25344
  ds_read_b64_tr_b16 v[80:81], v15 offset:27648
  ds_read_b64_tr_b16 v[82:83], v15 offset:28416
  ds_read_b64_tr_b16 v[176:177], v15 offset:24608
  ds_read_b64_tr_b16 v[178:179], v15 offset:25376
  ds_read_b64_tr_b16 v[180:181], v15 offset:27680
  ds_read_b64_tr_b16 v[182:183], v15 offset:28448
  ds_read_b64_tr_b16 v[248:249], v15 offset:24640
  ds_read_b64_tr_b16 v[250:251], v15 offset:25408
  ds_read_b64_tr_b16 v[252:253], v15 offset:27712
  ds_read_b64_tr_b16 v[254:255], v15 offset:28480
  s_waitcnt lgkmcnt(3)
  s_waitcnt lgkmcnt(0)
  s_barrier
  ds_write_b128 v108, v[20:23] offset:0
  ds_write_b128 v108, v[24:27] offset:1024
  ds_write_b128 v108, v[28:31] offset:2048
  ds_write_b128 v108, v[32:35] offset:3072
  ds_write_b128 v108, v[36:39] offset:4096
  ds_write_b128 v108, v[40:43] offset:5120
  ds_write_b128 v108, v[44:47] offset:6144
  ds_write_b128 v108, v[48:51] offset:7168
  s_waitcnt lgkmcnt(2)
  ds_write_b128 v108, v[52:55] offset:8192
  ds_write_b128 v108, v[56:59] offset:9216
  ds_write_b128 v108, v[60:63] offset:10240
  ds_write_b128 v108, v[64:67] offset:11264
  ds_write_b128 v108, v[68:71] offset:12288
  ds_write_b128 v108, v[72:75] offset:13312
  ds_write_b128 v108, v[76:79] offset:14336
  ds_write_b128 v108, v[80:83] offset:15360
  s_waitcnt lgkmcnt(2)
  ds_write_b128 v108, v[84:87] offset:16384
  ds_write_b128 v108, v[88:91] offset:17408
  ds_write_b128 v108, v[92:95] offset:18432
  ds_write_b128 v108, v[96:99] offset:19456
  s_waitcnt lgkmcnt(0)
  s_lshl_b32 s3, s49, 2
  v_mov_b32 v13, s3
  s_nop 1
ibw_8:
  buffer_load_dword v12, v13, s[12:15], 0 offen sc1
  s_waitcnt vmcnt(0)
  v_cmp_ne_u32 vcc, 256, v12
  s_nop 0
  s_cbranch_vccz ibw_9
  s_sleep 8
  s_sub_u32 s47, s47, 1
  s_cbranch_scc0 ibw_8
  s_branch ABORT
ibw_9:
  s_cmp_lg_u32 s49, 0
  s_cbranch_scc1 ibok_10
  v_and_b32 v13, 7, v0
  v_lshlrev_b32 v13, 2, v13
  buffer_load_dword v12, v13, s[12:15], 0 offen offset:32 sc1
  s_waitcnt vmcnt(0)
  v_cmp_ne_u32 vcc, 32, v12
  s_nop 0
  s_cbranch_vccz ibok_10
  s_barrier
  s_mov_b32 s49, 1
  s_mov_b32 s3, s2
  s_branch DISPATCH
ibok_10:
  s_mov_b32 s50, 0
  s_mov_b32 s70, 103424
  s_add_u32 s62, s50, 0
  s_min_u32 s62, s62, 127
  s_sub_i32 s60, s62, 13
  s_sub_i32 s75, s62, 12
  s_ashr_i32 s60, s60, 1
  s_ashr_i32 s75, s75, 1
  s_sub_i32 s61, s62, 64
  s_max_i32 s60, s60, s61
  s_add_i32 s61, s61, 1
  s_max_i32 s75, s75, s61
  s_max_i32 s60, s60, 0
  s_max_i32 s75, s75, 0
  s_sub_i32 s75, s75, s60
  s_sub_i32 s76, s62, s60
  s_sub_i32 s60, s60, s76
  s_mul_i32 s60, s60, s75
  s_add_i32 s76, s76, s60
  s_and_b32 s60, s76, 1
  s_lshl_b32 s51, s75, 1
  s_add_u32 s51, s51, s60
  s_lshl_b32 s51, s51, 17
  s_add_u32 s51, s51, s71
  s_bfe_u32 s52, s76, 0x10001
  s_mul_i32 s55, s76, 1179648
  s_add_u32 s55, s55, s72
  s_lshl_b32 s56, s75, 6
  s_add_u32 s56, s56, s76
  s_lshl_b32 s56, s56, 9
  s_add_u32 s56, s56, 65536
fl_11:
  buffer_load_dword v5, v4, s[8:11], s56 offen sc1
  s_waitcnt vmcnt(0)
  v_cmp_eq_u32 vcc, 0, v5
  s_nop 0
  s_cbranch_vccz fo_12
  s_sleep 4
  s_sub_u32 s47, s47, 1
  s_cbranch_scc0 fl_11
  s_branch ABORT
fo_12:
  s_add_u32 m0, s70, s77
  s_nop 0
  buffer_load_dwordx4 v1, s[8:11], s55 offen offset:0 sc1 lds
  buffer_load_dwordx4 v1, s[8:11], s55 offen offset:1024 sc1 lds
  buffer_load_dwordx4 v1, s[8:11], s55 offen offset:2048 sc1 lds
  buffer_load_dwordx4 v1, s[8:11], s55 offen offset:3072 sc1 lds
  s_add_u32 m0, m0, 4096
  s_add_u32 s67, s55, 4096
  buffer_load_dwordx4 v1, s[8:11], s67 offen offset:0 sc1 lds
  buffer_load_dwordx4 v1, s[8:11], s67 offen offset:1024 sc1 lds
  s_add_u32 s62, s50, 1
  s_min_u32 s62, s62, 127
  s_sub_i32 s60, s62, 13
  s_sub_i32 s75, s62, 12
  s_ashr_i32 s60, s60, 1
  s_ashr_i32 s75, s75, 1
  s_sub_i32 s61, s62, 64
  s_max_i32 s60, s60, s61
  s_add_i32 s61, s61, 1
  s_max_i32 s75, s75, s61
  s_max_i32 s60, s60, 0
  s_max_i32 s75, s75, 0
  s_sub_i32 s75, s75, s60
  s_sub_i32 s76, s62, s60
  s_sub_i32 s60, s60, s76
  s_mul_i32 s60, s60, s75
  s_add_i32 s76, s76, s60
  s_and_b32 s60, s76, 1
  s_lshl_b32 s53, s75, 1
  s_add_u32 s53, s53, s60
  s_lshl_b32 s53, s53, 17
  s_add_u32 s53, s53, s71
  s_bfe_u32 s54, s76, 0x10001
  s_mul_i32 s55, s76, 1179648
  s_add_u32 s55, s55, s72
  s_lshl_b32 s56, s75, 6
  s_add_u32 s56, s56, s76
  s_lshl_b32 s56, s56, 9
  s_add_u32 s56, s56, 65536
  buffer_load_dword v5, v4, s[8:11], s56 offen sc1
CQ_SEL_F:
  s_cmp_eq_u32 s46, 0
  s_cbranch_scc1 CQ_F0
  s_cmp_eq_u32 s46, 1
  s_cbranch_scc1 CQ_F1
  s_cmp_eq_u32 s46, 2
  s_cbranch_scc1 CQ_F2
  s_cmp_eq_u32 s46, 3
  s_cbranch_scc1 CQ_F3
CQ_F0:
  s_add_u32 s66, s51, 0
  buffer_load_dwordx4 v[20:23], v1, s[8:11], s66 offen offset:0 sc1
  buffer_load_dwordx4 v[24:27], v1, s[8:11], s66 offen offset:1024 sc1
  buffer_load_dwordx4 v[28:31], v1, s[8:11], s66 offen offset:2048 sc1
  s_waitcnt vmcnt(0)
CQ_F0L:
  v_mov_b64 v[60:61], 0
  v_mov_b64 v[62:63], 0
  v_mov_b64 v[64:65], 0
  v_mov_b64 v[66:67], 0
  v_mov_b64 v[68:69], 0
  v_mov_b64 v[70:71], 0
  v_mov_b64 v[72:73], 0
  v_mov_b64 v[74:75], 0
  v_mov_b64 v[76:77], 0
  v_mov_b64 v[78:79], 0
  v_mov_b64 v[80:81], 0
  v_mov_b64 v[82:83], 0
  v_add_u32 v10, s70, v1
  s_xor_b32 s70, s70, 24576
  ds_read_b128 v[84:87], v108 offset:0
  ds_read_b128 v[88:91], v108 offset:1024
  ds_read_b128 v[92:95], v108 offset:2048
  ds_read_b128 v[96:99], v108 offset:3072
  s_waitcnt vmcnt(0)
  v_bitop3_b32 v12, v20, v22, s52 bitop3:0x7e
  v_bitop3_b32 v13, v24, v26, s52 bitop3:0x7e
  v_bitop3_b32 v14, v28, v30, s52 bitop3:0x7e
  v_or3_b32 v12, v12, v13, v14
  v_and_b32 v12, 1, v12
  v_cmp_ne_u32 vcc, 0, v12
  s_nop 0
  s_cbranch_vccz po_14
  v_bitop3_b32 v12, v20, v22, s52 bitop3:0x42
  v_bitop3_b32 v13, v24, v26, s52 bitop3:0x42
  v_and_b32 v12, v12, v13
  v_bitop3_b32 v13, v28, v30, s52 bitop3:0x42
  v_and_b32 v12, v12, v13
  v_and_b32 v12, 1, v12
  v_cmp_eq_u32 vcc, 0, v12
  s_nop 0
  s_cbranch_vccnz pg_15
lp_16:
  buffer_load_dword v12, v3, s[8:11], s66 offen offset:0 sc1
  s_waitcnt vmcnt(0)
  v_and_b32 v12, 1, v12
  v_cmp_eq_u32 vcc, s52, v12
  s_nop 0
  s_cbranch_vccnz lo_17
  s_sleep 1
  s_sub_u32 s47, s47, 1
  s_cbranch_scc0 lp_16
  s_branch ABORT
lo_17:
pg_15:
  buffer_load_dwordx4 v[20:23], v1, s[8:11], s66 offen offset:0 sc1
  buffer_load_dwordx4 v[24:27], v1, s[8:11], s66 offen offset:1024 sc1
  buffer_load_dwordx4 v[28:31], v1, s[8:11], s66 offen offset:2048 sc1
  s_nop 11
  s_nop 11
pp_13:
  buffer_load_dwordx4 v[20:23], v1, s[8:11], s66 offen offset:0 sc1
  buffer_load_dwordx4 v[24:27], v1, s[8:11], s66 offen offset:1024 sc1
  buffer_load_dwordx4 v[28:31], v1, s[8:11], s66 offen offset:2048 sc1
  s_waitcnt vmcnt(3)
  v_bitop3_b32 v12, v20, v22, s52 bitop3:0x7e
  v_bitop3_b32 v13, v24, v26, s52 bitop3:0x7e
  v_bitop3_b32 v14, v28, v30, s52 bitop3:0x7e
  v_or3_b32 v12, v12, v13, v14
  v_and_b32 v12, 1, v12
  v_cmp_ne_u32 vcc, 0, v12
  s_nop 0
  s_cbranch_vccz po_14
  s_sub_u32 s47, s47, 1
  s_cbranch_scc0 pp_13
  s_branch ABORT
po_14:
  v_smfmac_f32_16x16x64_bf16 v[64:67], v[20:23], a[64:71], v2
  s_add_u32 s62, s50, 2
  s_min_u32 s62, s62, 127
  ds_write_b128 v109, v[20:23] offset:0
  ds_write_b128 v109, v[24:27] offset:1024
  ds_write_b128 v109, v[28:31] offset:2048
  v_smfmac_f32_16x16x64_bf16 v[68:71], v[20:23], a[128:135], v2
  s_sub_i32 s60, s62, 13
  s_sub_i32 s75, s62, 12
  v_cmp_eq_u32 vcc, 0, v5
  v_smfmac_f32_16x16x64_bf16 v[60:63], v[24:27], a[0:7], v2
  s_ashr_i32 s60, s60, 1
  s_ashr_i32 s75, s75, 1
  s_sub_i32 s61, s62, 64
  v_smfmac_f32_16x16x64_bf16 v[64:67], v[24:27], a[72:79], v2
  s_max_i32 s60, s60, s61
  s_add_i32 s61, s61, 1
  s_waitcnt lgkmcnt(0)
  s_barrier
  ds_read_b128 v[32:35], v109 offset:3072
  ds_read_b128 v[36:39], v109 offset:4096
  v_smfmac_f32_16x16x64_bf16 v[60:63], v[28:31], a[8:15], v2
  s_max_i32 s75, s75, s61
  s_max_i32 s60, s60, 0
  ds_read_b128 v[40:43], v109 offset:5120
  v_smfmac_f32_16x16x64_bf16 v[64:67], v[28:31], a[80:87], v2
  s_max_i32 s75, s75, 0
  s_sub_i32 s75, s75, s60
  ds_read_b128 v[44:47], v109 offset:6144
  v_smfmac_f32_16x16x64_bf16 v[68:71], v[28:31], a[136:143], v2
  s_sub_i32 s76, s62, s60
  s_sub_i32 s60, s60, s76
  ds_read_b128 v[48:51], v109 offset:7168
  v_smfmac_f32_16x16x64_bf16 v[72:75], v[20:23], a[192:199], v2
  s_mul_i32 s60, s60, s75
  s_add_i32 s76, s76, s60
  ds_read_b128 v[52:55], v109 offset:8192
  v_smfmac_f32_16x16x64_bf16 v[76:79], v[20:23], v[112:119], v2
  s_and_b32 s60, s76, 1
  s_lshl_b32 s57, s75, 1
  ds_read_b128 v[56:59], v109 offset:9216
  v_smfmac_f32_16x16x64_bf16 v[80:83], v[20:23], v[184:191], v2
  s_add_u32 s57, s57, s60
  s_lshl_b32 s57, s57, 17
  s_add_u32 s57, s57, s71
  v_smfmac_f32_16x16x64_bf16 v[72:75], v[24:27], a[200:207], v2
  s_bfe_u32 s58, s76, 0x10001
  s_mul_i32 s59, s76, 1179648
  s_add_u32 m0, s70, s77
  s_nop 0
  buffer_load_dwordx4 v1, s[8:11], s55 offen offset:0 sc1 lds
  v_smfmac_f32_16x16x64_bf16 v[76:79], v[24:27], v[120:127], v2
  s_waitcnt lgkmcnt(6)
  s_add_u32 s59, s59, s72
  s_lshl_b32 s68, s75, 6
  v_smfmac_f32_16x16x64_bf16 v[60:63], v[32:35], a[16:23], v2
  s_waitcnt lgkmcnt(5)
  s_add_u32 s68, s68, s76
  s_lshl_b32 s68, s68, 9
  v_smfmac_f32_16x16x64_bf16 v[60:63], v[36:39], a[24:31], v2
  s_add_u32 s68, s68, 65536
  s_cmp_lg_u64 vcc, 0
  s_cselect_b32 s69, 1, 0
  v_smfmac_f32_16x16x64_bf16 v[60:63], v[20:23], v[84:91], v2
  s_waitcnt lgkmcnt(3)
  buffer_load_dwordx4 v1, s[8:11], s55 offen offset:1024 sc1 lds
  v_smfmac_f32_16x16x64_bf16 v[60:63], v[44:47], a[32:39], v2
  s_waitcnt lgkmcnt(2)
  ds_read_b128 v[84:87], v108 offset:4096
  v_smfmac_f32_16x16x64_bf16 v[60:63], v[48:51], a[40:47], v2
  s_waitcnt lgkmcnt(2)
  ds_read_b128 v[88:91], v108 offset:5120
  v_smfmac_f32_16x16x64_bf16 v[60:63], v[52:55], a[48:55], v2
  v_smfmac_f32_16x16x64_bf16 v[60:63], v[40:43], v[92:99], v2
  s_waitcnt lgkmcnt(2)
  buffer_load_dwordx4 v1, s[8:11], s55 offen offset:2048 sc1 lds
  v_smfmac_f32_16x16x64_bf16 v[60:63], v[56:59], a[56:63], v2
  ds_read_b128 v[92:95], v108 offset:6144
  v_smfmac_f32_16x16x64_bf16 v[64:67], v[36:39], a[88:95], v2
  s_waitcnt lgkmcnt(1)
  buffer_load_dword v5, v4, s[8:11], s68 offen sc1
  v_smfmac_f32_16x16x64_bf16 v[64:67], v[32:35], v[84:91], v2
  ds_read_b128 v[96:99], v108 offset:7168
  v_smfmac_f32_16x16x64_bf16 v[64:67], v[40:43], a[96:103], v2
  buffer_load_dwordx4 v1, s[8:11], s55 offen offset:3072 sc1 lds
  v_smfmac_f32_16x16x64_bf16 v[64:67], v[44:47], a[104:111], v2
  ds_read_b128 v[84:87], v108 offset:8192
  v_smfmac_f32_16x16x64_bf16 v[64:67], v[48:51], a[112:119], v2
  s_waitcnt lgkmcnt(1)
  ds_read_b128 v[88:91], v108 offset:9216
  v_smfmac_f32_16x16x64_bf16 v[64:67], v[52:55], v[92:99], v2
  ds_read_b128 v[92:95], v108 offset:10240
  v_smfmac_f32_16x16x64_bf16 v[64:67], v[56:59], a[120:127], v2
  s_add_u32 m0, m0, 4096
  s_add_u32 s67, s55, 4096
  buffer_load_dwordx4 v1, s[8:11], s67 offen offset:0 sc1 lds
  v_smfmac_f32_16x16x64_bf16 v[68:71], v[32:35], a[144:151], v2
  ds_read_b128 v[96:99], v108 offset:11264
  v_add_f32 v60, v60, v61
  v_smfmac_f32_16x16x64_bf16 v[68:71], v[36:39], a[152:159], v2
  s_waitcnt lgkmcnt(2)
  v_add_f32 v62, v62, v63
  v_cvt_pk_bf16_f32 v60, v60, v62
  v_smfmac_f32_16x16x64_bf16 v[68:71], v[24:27], v[84:91], v2
  ds_read_b128 v[84:87], v108 offset:12288
  ds_write_b32 v6, v60 offset:0
  v_smfmac_f32_16x16x64_bf16 v[68:71], v[40:43], a[160:167], v2
  buffer_load_dwordx4 v1, s[8:11], s67 offen offset:1024 sc1 lds
  ds_read_b128 v[88:91], v108 offset:13312
  v_smfmac_f32_16x16x64_bf16 v[68:71], v[48:51], a[168:175], v2
  v_add_f32 v64, v64, v65
  v_add_f32 v66, v66, v67
  v_smfmac_f32_16x16x64_bf16 v[68:71], v[52:55], a[176:183], v2
  s_waitcnt lgkmcnt(3)
  v_cvt_pk_bf16_f32 v64, v64, v66
  ds_write_b32 v6, v64 offset:128
  v_smfmac_f32_16x16x64_bf16 v[68:71], v[44:47], v[92:99], v2
  ds_read_b128 v[92:95], v108 offset:14336
  v_smfmac_f32_16x16x64_bf16 v[68:71], v[56:59], a[184:191], v2
  ds_read_b128 v[96:99], v108 offset:15360
  v_smfmac_f32_16x16x64_bf16 v[72:75], v[28:31], a[208:215], v2
  v_smfmac_f32_16x16x64_bf16 v[72:75], v[32:35], a[216:223], v2
  s_waitcnt lgkmcnt(3)
  s_nop 3
  v_add_f32 v68, v68, v69
  v_add_f32 v70, v70, v71
  v_smfmac_f32_16x16x64_bf16 v[72:75], v[36:39], v[84:91], v2
  ds_read_b128 v[84:87], v108 offset:16384
  v_cvt_pk_bf16_f32 v68, v68, v70
  v_smfmac_f32_16x16x64_bf16 v[72:75], v[40:43], a[224:231], v2
  ds_read_b128 v[88:91], v108 offset:17408
  ds_write_b32 v6, v68 offset:256
  v_smfmac_f32_16x16x64_bf16 v[72:75], v[44:47], a[232:239], v2
  ds_read_b128 v[100:103], v10 offset:12288
  v_smfmac_f32_16x16x64_bf16 v[72:75], v[48:51], a[240:247], v2
  s_waitcnt lgkmcnt(4)
  ds_read_b128 v[104:107], v10 offset:16384
  v_smfmac_f32_16x16x64_bf16 v[72:75], v[56:59], v[92:99], v2
  ds_read_b128 v[92:95], v108 offset:18432
  v_smfmac_f32_16x16x64_bf16 v[72:75], v[52:55], a[248:255], v2
  s_waitcnt lgkmcnt(3)
  s_barrier
  ds_read_b128 v[96:99], v108 offset:19456
  v_smfmac_f32_16x16x64_bf16 v[76:79], v[32:35], v[128:135], v2
  ds_read_b64_tr_b16 v[60:61], v7 offset:0
  v_smfmac_f32_16x16x64_bf16 v[76:79], v[36:39], v[136:143], v2
  ds_read_b64_tr_b16 v[62:63], v7 offset:128
  v_smfmac_f32_16x16x64_bf16 v[76:79], v[40:43], v[144:151], v2
  ds_read_b64_tr_b16 v[64:65], v7 offset:512
  v_smfmac_f32_16x16x64_bf16 v[76:79], v[44:47], v[152:159], v2
  ds_read_b64_tr_b16 v[66:67], v7 offset:640
  v_smfmac_f32_16x16x64_bf16 v[76:79], v[28:31], v[84:91], v2
  ds_read_b64_tr_b16 v[68:69], v7 offset:1024
  v_smfmac_f32_16x16x64_bf16 v[76:79], v[48:51], v[160:167], v2
  ds_read_b64_tr_b16 v[70:71], v7 offset:1152
  v_smfmac_f32_16x16x64_bf16 v[76:79], v[52:55], v[168:175], v2
  ds_read_b128 v[16:19], v10 offset:20480
  v_smfmac_f32_16x16x64_bf16 v[76:79], v[56:59], v[176:183], v2
  v_add_f32 v72, v72, v73
  v_smfmac_f32_16x16x64_bf16 v[80:83], v[24:27], v[192:199], v2
  v_add_f32 v74, v74, v75
  v_smfmac_f32_16x16x64_bf16 v[80:83], v[28:31], v[200:207], v2
  v_cvt_pk_bf16_f32 v72, v72, v74
  v_smfmac_f32_16x16x64_bf16 v[80:83], v[32:35], v[208:215], v2
  ds_write_b32 v6, v72 offset:3200
  v_smfmac_f32_16x16x64_bf16 v[80:83], v[36:39], v[216:223], v2
  s_waitcnt lgkmcnt(8)
  v_add_f32 v76, v76, v77
  v_smfmac_f32_16x16x64_bf16 v[80:83], v[48:51], v[92:99], v2
  v_add_f32 v78, v78, v79
  v_smfmac_f32_16x16x64_bf16 v[80:83], v[40:43], v[224:231], v2
  s_waitcnt lgkmcnt(1)
  v_cvt_pk_bf16_f32 v76, v76, v78
  v_mfma_f32_16x16x32_bf16 v[12:15], v[100:103], v[60:63], 0
  ds_write_b32 v6, v76 offset:3328
  v_mfma_f32_16x16x32_bf16 v[12:15], v[104:107], v[64:67], v[12:15]
  v_mfma_f32_16x16x32_bf16 v[12:15], v[16:19], v[68:71], v[12:15]
  v_smfmac_f32_16x16x64_bf16 v[80:83], v[44:47], v[232:239], v2
  v_smfmac_f32_16x16x64_bf16 v[80:83], v[52:55], v[240:247], v2
  v_smfmac_f32_16x16x64_bf16 v[80:83], v[56:59], v[248:255], v2
  s_nop 4
  ds_write_b128 v109, v[12:15] offset:10240
  s_nop 1
  v_add_f32 v80, v80, v81
  v_add_f32 v82, v82, v83
  v_cvt_pk_bf16_f32 v80, v80, v82
  ds_write_b32 v6, v80 offset:3456
  s_waitcnt vmcnt(7)
  s_waitcnt lgkmcnt(0)
  s_barrier
  ds_read_b64_tr_b16 v[84:85], v7 offset:3200
  ds_read_b64_tr_b16 v[86:87], v7 offset:3328
  ds_read_b64_tr_b16 v[88:89], v7 offset:3712
  ds_read_b64_tr_b16 v[90:91], v7 offset:3840
  ds_read_b64_tr_b16 v[92:93], v7 offset:4224
  ds_read_b64_tr_b16 v[94:95], v7 offset:4352
  ds_read_b128 v[36:39], v111
  ds_read_b128 v[40:43], v111 offset:2176
  s_waitcnt lgkmcnt(6)
  v_mfma_f32_16x16x32_bf16 v[76:79], v[84:87], v[60:63], 0
  s_waitcnt lgkmcnt(4)
  v_mfma_f32_16x16x32_bf16 v[76:79], v[88:91], v[64:67], v[76:79]
  s_waitcnt lgkmcnt(2)
  v_mfma_f32_16x16x32_bf16 v[76:79], v[92:95], v[68:71], v[76:79]
  s_waitcnt lgkmcnt(0)
  v_add_f32 v36, v36, v40
  v_add_f32 v37, v37, v41
  v_add_f32 v38, v38, v42
  v_add_f32 v39, v39, v43
  v_max3_f32 v12, v36, v37, v38
  s_nop 1
  v_permlane32_swap_b32 v76, v77
  v_permlane32_swap_b32 v78, v79
  s_nop 0
  v_add_f32_dpp v76, v77, v76 row_ror:8 row_mask:0xf bank_mask:0x3
  s_nop 1
  v_add_f32_dpp v76, v78, v79 row_ror:8 row_mask:0xf bank_mask:0xc
  v_max3_f32 v12, v12, v39, v76
  s_nop 1
  v_max_f32_dpp v12, v12, v12 row_ror:8 row_mask:0xf bank_mask:0xf
  v_mov_b32 v13, v12
  s_nop 1
  v_permlane32_swap_b32 v12, v13
  v_max_f32 v12, v12, v13
  v_mov_b32 v13, v12
  s_nop 1
  v_permlane16_swap_b32 v12, v13
  v_max_f32 v12, v12, v13
  v_mul_f32 v12, s74, v12
  v_fma_f32 v36, v36, s74, -v12
  v_fma_f32 v37, v37, s74, -v12
  v_fma_f32 v38, v38, s74, -v12
  v_fma_f32 v39, v39, s74, -v12
  v_fma_f32 v76, v76, s74, -v12
  v_exp_f32 v36, v36
  v_exp_f32 v37, v37
  v_exp_f32 v38, v38
  v_exp_f32 v39, v39
  v_exp_f32 v76, v76
  v_add_f32 v12, v36, v37
  v_add_f32 v13, v38, v39
  v_add_f32 v12, v12, v76
  v_mov_b32 v77, v76
  v_add_f32 v12, v12, v13
  s_nop 0
  v_permlane32_swap_b32 v76, v77
  v_add_f32_dpp v12, v12, v12 row_ror:8 row_mask:0xf bank_mask:0xf
  v_mov_b32 v13, v12
  s_nop 1
  v_permlane32_swap_b32 v12, v13
  v_add_f32 v12, v12, v13
  v_mov_b32 v13, v12
  s_nop 1
  v_permlane16_swap_b32 v12, v13
  v_add_f32 v12, v12, v13
  v_rcp_f32 v12, v12
  s_nop 0
  v_pk_mul_f32 v[76:77], v[76:77], v[12:13] op_sel_hi:[1,0]
  v_pk_mul_f32 v[36:37], v[36:37], v[12:13] op_sel_hi:[1,0]
  v_pk_mul_f32 v[38:39], v[38:39], v[12:13] op_sel_hi:[1,0]
  v_cvt_pk_bf16_f32 v16, v76, v77
  v_cvt_pk_bf16_f32 v14, v36, v37
  v_cvt_pk_bf16_f32 v15, v38, v39
  v_mov_b32_dpp v17, v16 row_ror:8 row_mask:0xf bank_mask:0xf
  v_and_or_b32 v14, v14, -2, s52
  s_cmp_lg_u32 s49, 0
  s_cbranch_scc1 wt_18
  buffer_store_dwordx2 v[14:15], v8, s[8:11], s51 offen
wb_19:
  v_and_or_b32 v16, v16, -2, s52
  s_mov_b64 exec, s[88:89]
  s_cmp_lg_u32 s49, 0
  s_cbranch_scc1 wt_20
  buffer_store_dwordx2 v[16:17], v9, s[8:11], s51 offen
wb_21:
  s_mov_b64 exec, -1
  s_add_u32 s66, s53, 0
  buffer_load_dwordx4 v[20:23], v1, s[8:11], s66 offen offset:0 sc1
  buffer_load_dwordx4 v[24:27], v1, s[8:11], s66 offen offset:1024 sc1
  buffer_load_dwordx4 v[28:31], v1, s[8:11], s66 offen offset:2048 sc1
  s_cmp_eq_u32 s69, 0
  s_cbranch_scc1 nd_22
fl_23:
  buffer_load_dword v12, v4, s[8:11], s56 offen sc1
  s_waitcnt vmcnt(0)
  v_cmp_eq_u32 vcc, 0, v12
  s_nop 0
  s_cbranch_vccz fo_24
  s_sleep 2
  s_sub_u32 s47, s47, 1
  s_cbranch_scc0 fl_23
  s_branch ABORT
fo_24:
  s_add_u32 m0, s70, s77
  s_nop 0
  buffer_load_dwordx4 v1, s[8:11], s55 offen offset:0 sc1 lds
  buffer_load_dwordx4 v1, s[8:11], s55 offen offset:1024 sc1 lds
  buffer_load_dwordx4 v1, s[8:11], s55 offen offset:2048 sc1 lds
  buffer_load_dwordx4 v1, s[8:11], s55 offen offset:3072 sc1 lds
  s_add_u32 m0, m0, 4096
  s_add_u32 s67, s55, 4096
  buffer_load_dwordx4 v1, s[8:11], s67 offen offset:0 sc1 lds
  buffer_load_dwordx4 v1, s[8:11], s67 offen offset:1024 sc1 lds
  s_waitcnt vmcnt(0)
nd_22:
  s_mov_b32 s51, s53
  s_mov_b32 s52, s54
  s_mov_b32 s53, s57
  s_mov_b32 s54, s58
  s_mov_b32 s55, s59
  s_mov_b32 s56, s68
  s_add_u32 s50, s50, 1
  s_cmp_lt_u32 s50, 128
  s_cbranch_scc1 CQ_F0L
  s_branch CQ_END
CQ_F1:
  s_add_u32 s66, s51, 3072
  buffer_load_dwordx4 v[32:35], v1, s[8:11], s66 offen offset:0 sc1
  buffer_load_dwordx4 v[36:39], v1, s[8:11], s66 offen offset:1024 sc1
  s_waitcnt vmcnt(0)
CQ_F1L:
  v_mov_b64 v[60:61], 0
  v_mov_b64 v[62:63], 0
  v_mov_b64 v[64:65], 0
  v_mov_b64 v[66:67], 0
  v_mov_b64 v[68:69], 0
  v_mov_b64 v[70:71], 0
  v_mov_b64 v[72:73], 0
  v_mov_b64 v[74:75], 0
  v_mov_b64 v[76:77], 0
  v_mov_b64 v[78:79], 0
  v_mov_b64 v[80:81], 0
  v_mov_b64 v[82:83], 0
  v_add_u32 v10, s70, v1
  s_xor_b32 s70, s70, 24576
  ds_read_b128 v[84:87], v108 offset:2048
  ds_read_b128 v[88:91], v108 offset:3072
  ds_read_b128 v[92:95], v108 offset:0
  ds_read_b128 v[96:99], v108 offset:1024
  s_waitcnt vmcnt(2)
  v_bitop3_b32 v12, v32, v34, s52 bitop3:0x7e
  v_bitop3_b32 v13, v36, v38, s52 bitop3:0x7e
  v_bitop3_b32 v12, v12, v13, 1 bitop3:0xa8
  v_cmp_ne_u32 vcc, 0, v12
  s_nop 0
  s_cbranch_vccz po_26
  v_bitop3_b32 v12, v32, v34, s52 bitop3:0x42
  v_bitop3_b32 v13, v36, v38, s52 bitop3:0x42
  v_and_b32 v12, v12, v13
  v_and_b32 v12, 1, v12
  v_cmp_eq_u32 vcc, 0, v12
  s_nop 0
  s_cbranch_vccnz pg_27
lp_28:
  buffer_load_dword v12, v3, s[8:11], s66 offen offset:0 sc1
  s_waitcnt vmcnt(0)
  v_and_b32 v12, 1, v12
  v_cmp_eq_u32 vcc, s52, v12
  s_nop 0
  s_cbranch_vccnz lo_29
  s_sleep 1
  s_sub_u32 s47, s47, 1
  s_cbranch_scc0 lp_28
  s_branch ABORT
lo_29:
pg_27:
  buffer_load_dwordx4 v[32:35], v1, s[8:11], s66 offen offset:0 sc1
  buffer_load_dwordx4 v[36:39], v1, s[8:11], s66 offen offset:1024 sc1
  s_nop 11
  s_nop 11
pp_25:
  buffer_load_dwordx4 v[32:35], v1, s[8:11], s66 offen offset:0 sc1
  buffer_load_dwordx4 v[36:39], v1, s[8:11], s66 offen offset:1024 sc1
  s_waitcnt vmcnt(2)
  v_bitop3_b32 v12, v32, v34, s52 bitop3:0x7e
  v_bitop3_b32 v13, v36, v38, s52 bitop3:0x7e
  v_bitop3_b32 v12, v12, v13, 1 bitop3:0xa8
  v_cmp_ne_u32 vcc, 0, v12
  s_nop 0
  s_cbranch_vccz po_26
  s_sub_u32 s47, s47, 1
  s_cbranch_scc0 pp_25
  s_branch ABORT
po_26:
  v_smfmac_f32_16x16x64_bf16 v[60:63], v[32:35], a[16:23], v2
  s_add_u32 s62, s50, 2
  s_min_u32 s62, s62, 127
  ds_write_b128 v109, v[32:35] offset:3072
  ds_write_b128 v109, v[36:39] offset:4096
  v_smfmac_f32_16x16x64_bf16 v[68:71], v[32:35], a[144:151], v2
  s_sub_i32 s60, s62, 13
  s_sub_i32 s75, s62, 12
  v_cmp_eq_u32 vcc, 0, v5
  v_smfmac_f32_16x16x64_bf16 v[60:63], v[36:39], a[24:31], v2
  s_ashr_i32 s60, s60, 1
  s_ashr_i32 s75, s75, 1
  s_sub_i32 s61, s62, 64
  v_smfmac_f32_16x16x64_bf16 v[64:67], v[36:39], a[88:95], v2
  s_max_i32 s60, s60, s61
  s_add_i32 s61, s61, 1
  s_waitcnt lgkmcnt(0)
  s_barrier
  ds_read_b128 v[40:43], v109 offset:5120
  ds_read_b128 v[44:47], v109 offset:6144
  v_smfmac_f32_16x16x64_bf16 v[68:71], v[36:39], a[152:159], v2
  s_max_i32 s75, s75, s61
  s_max_i32 s60, s60, 0
  ds_read_b128 v[48:51], v109 offset:7168
  v_smfmac_f32_16x16x64_bf16 v[72:75], v[32:35], a[216:223], v2
  s_max_i32 s75, s75, 0
  s_sub_i32 s75, s75, s60
  ds_read_b128 v[52:55], v109 offset:8192
  v_smfmac_f32_16x16x64_bf16 v[76:79], v[32:35], v[128:135], v2
  s_sub_i32 s76, s62, s60
  s_sub_i32 s60, s60, s76
  ds_read_b128 v[56:59], v109 offset:9216
  v_smfmac_f32_16x16x64_bf16 v[80:83], v[32:35], v[208:215], v2
  s_mul_i32 s60, s60, s75
  s_add_i32 s76, s76, s60
  ds_read_b128 v[20:23], v109 offset:0
  v_smfmac_f32_16x16x64_bf16 v[76:79], v[36:39], v[136:143], v2
  s_and_b32 s60, s76, 1
  s_lshl_b32 s57, s75, 1
  ds_read_b128 v[24:27], v109 offset:1024
  v_smfmac_f32_16x16x64_bf16 v[80:83], v[36:39], v[216:223], v2
  s_waitcnt lgkmcnt(5)
  s_add_u32 s57, s57, s60
  ds_read_b128 v[28:31], v109 offset:2048
  v_smfmac_f32_16x16x64_bf16 v[60:63], v[44:47], a[32:39], v2
  s_waitcnt lgkmcnt(5)
  s_lshl_b32 s57, s57, 17
  s_add_u32 s57, s57, s71
  v_smfmac_f32_16x16x64_bf16 v[60:63], v[48:51], a[40:47], v2
  s_bfe_u32 s58, s76, 0x10001
  s_mul_i32 s59, s76, 1179648
  s_add_u32 m0, s70, s77
  s_nop 0
  buffer_load_dwordx4 v1, s[8:11], s55 offen offset:0 sc1 lds
  v_smfmac_f32_16x16x64_bf16 v[60:63], v[40:43], v[84:91], v2
  s_waitcnt lgkmcnt(4)
  s_add_u32 s59, s59, s72
  ds_read_b128 v[84:87], v108 offset:4096
  v_smfmac_f32_16x16x64_bf16 v[60:63], v[52:55], a[48:55], v2
  s_waitcnt lgkmcnt(4)
  s_lshl_b32 s68, s75, 6
  ds_read_b128 v[88:91], v108 offset:5120
  v_smfmac_f32_16x16x64_bf16 v[60:63], v[56:59], a[56:63], v2
  s_waitcnt lgkmcnt(3)
  s_add_u32 s68, s68, s76
  s_lshl_b32 s68, s68, 9
  v_smfmac_f32_16x16x64_bf16 v[60:63], v[24:27], a[0:7], v2
  s_add_u32 s68, s68, 65536
  s_cmp_lg_u64 vcc, 0
  s_cselect_b32 s69, 1, 0
  buffer_load_dwordx4 v1, s[8:11], s55 offen offset:1024 sc1 lds
  v_smfmac_f32_16x16x64_bf16 v[60:63], v[20:23], v[92:99], v2
  s_waitcnt lgkmcnt(2)
  ds_read_b128 v[92:95], v108 offset:6144
  v_smfmac_f32_16x16x64_bf16 v[60:63], v[28:31], a[8:15], v2
  ds_read_b128 v[96:99], v108 offset:7168
  v_smfmac_f32_16x16x64_bf16 v[64:67], v[40:43], a[96:103], v2
  v_smfmac_f32_16x16x64_bf16 v[64:67], v[44:47], a[104:111], v2
  s_waitcnt lgkmcnt(2)
  buffer_load_dwordx4 v1, s[8:11], s55 offen offset:2048 sc1 lds
  v_smfmac_f32_16x16x64_bf16 v[64:67], v[32:35], v[84:91], v2
  ds_read_b128 v[84:87], v108 offset:10240
  v_smfmac_f32_16x16x64_bf16 v[64:67], v[48:51], a[112:119], v2
  buffer_load_dword v5, v4, s[8:11], s68 offen sc1
  v_smfmac_f32_16x16x64_bf16 v[64:67], v[56:59], a[120:127], v2
  ds_read_b128 v[88:91], v108 offset:11264
  v_smfmac_f32_16x16x64_bf16 v[64:67], v[20:23], a[64:71], v2
  s_waitcnt lgkmcnt(2)
  buffer_load_dwordx4 v1, s[8:11], s55 offen offset:3072 sc1 lds
  v_smfmac_f32_16x16x64_bf16 v[64:67], v[52:55], v[92:99], v2
  ds_read_b128 v[92:95], v108 offset:8192
  v_smfmac_f32_16x16x64_bf16 v[64:67], v[24:27], a[72:79], v2
  ds_read_b128 v[96:99], v108 offset:9216
  v_smfmac_f32_16x16x64_bf16 v[64:67], v[28:31], a[80:87], v2
  v_add_f32 v60, v60, v61
  v_smfmac_f32_16x16x64_bf16 v[68:71], v[40:43], a[160:167], v2
  s_add_u32 m0, m0, 4096
  s_add_u32 s67, s55, 4096
  buffer_load_dwordx4 v1, s[8:11], s67 offen offset:0 sc1 lds
  v_add_f32 v62, v62, v63
  v_smfmac_f32_16x16x64_bf16 v[68:71], v[48:51], a[168:175], v2
  s_waitcnt lgkmcnt(2)
  v_cvt_pk_bf16_f32 v60, v60, v62
  ds_write_b32 v6, v60 offset:0
  v_smfmac_f32_16x16x64_bf16 v[68:71], v[44:47], v[84:91], v2
  ds_read_b128 v[84:87], v108 offset:12288
  v_add_f32 v64, v64, v65
  v_smfmac_f32_16x16x64_bf16 v[68:71], v[52:55], a[176:183], v2
  ds_read_b128 v[88:91], v108 offset:13312
  v_add_f32 v66, v66, v67
  v_smfmac_f32_16x16x64_bf16 v[68:71], v[56:59], a[184:191], v2
  buffer_load_dwordx4 v1, s[8:11], s67 offen offset:1024 sc1 lds
  v_cvt_pk_bf16_f32 v64, v64, v66
  v_smfmac_f32_16x16x64_bf16 v[68:71], v[20:23], a[128:135], v2
  s_waitcnt lgkmcnt(3)
  ds_write_b32 v6, v64 offset:128
  v_smfmac_f32_16x16x64_bf16 v[68:71], v[24:27], v[92:99], v2
  ds_read_b128 v[92:95], v108 offset:14336
  v_smfmac_f32_16x16x64_bf16 v[68:71], v[28:31], a[136:143], v2
  ds_read_b128 v[96:99], v108 offset:15360
  v_smfmac_f32_16x16x64_bf16 v[72:75], v[40:43], a[224:231], v2
  v_smfmac_f32_16x16x64_bf16 v[72:75], v[44:47], a[232:239], v2
  s_waitcnt lgkmcnt(3)
  s_nop 3
  v_add_f32 v68, v68, v69
  v_add_f32 v70, v70, v71
  v_smfmac_f32_16x16x64_bf16 v[72:75], v[36:39], v[84:91], v2
  ds_read_b128 v[84:87], v108 offset:16384
  v_cvt_pk_bf16_f32 v68, v68, v70
  v_smfmac_f32_16x16x64_bf16 v[72:75], v[48:51], a[240:247], v2
  ds_read_b128 v[88:91], v108 offset:17408
  ds_write_b32 v6, v68 offset:256
  v_smfmac_f32_16x16x64_bf16 v[72:75], v[52:55], a[248:255], v2
  ds_read_b128 v[100:103], v10 offset:13312
  v_smfmac_f32_16x16x64_bf16 v[72:75], v[20:23], a[192:199], v2
  s_waitcnt lgkmcnt(4)
  ds_read_b128 v[104:107], v10 offset:17408
  v_smfmac_f32_16x16x64_bf16 v[72:75], v[56:59], v[92:99], v2
  ds_read_b128 v[92:95], v108 offset:18432
  v_smfmac_f32_16x16x64_bf16 v[72:75], v[24:27], a[200:207], v2
  s_waitcnt lgkmcnt(3)
  s_barrier
  ds_read_b128 v[96:99], v108 offset:19456
  v_smfmac_f32_16x16x64_bf16 v[72:75], v[28:31], a[208:215], v2
  ds_read_b64_tr_b16 v[60:61], v7 offset:0
  v_smfmac_f32_16x16x64_bf16 v[76:79], v[40:43], v[144:151], v2
  ds_read_b64_tr_b16 v[62:63], v7 offset:128
  v_smfmac_f32_16x16x64_bf16 v[76:79], v[44:47], v[152:159], v2
  ds_read_b64_tr_b16 v[64:65], v7 offset:512
  v_smfmac_f32_16x16x64_bf16 v[76:79], v[48:51], v[160:167], v2
  ds_read_b64_tr_b16 v[66:67], v7 offset:640
  v_smfmac_f32_16x16x64_bf16 v[76:79], v[52:55], v[168:175], v2
  ds_read_b64_tr_b16 v[68:69], v7 offset:1024
  v_smfmac_f32_16x16x64_bf16 v[76:79], v[28:31], v[84:91], v2
  ds_read_b64_tr_b16 v[70:71], v7 offset:1152
  v_smfmac_f32_16x16x64_bf16 v[76:79], v[56:59], v[176:183], v2
  ds_read_b128 v[16:19], v10 offset:21504
  v_smfmac_f32_16x16x64_bf16 v[76:79], v[20:23], v[112:119], v2
  v_add_f32 v72, v72, v73
  v_smfmac_f32_16x16x64_bf16 v[76:79], v[24:27], v[120:127], v2
  v_add_f32 v74, v74, v75
  v_smfmac_f32_16x16x64_bf16 v[80:83], v[40:43], v[224:231], v2
  v_cvt_pk_bf16_f32 v72, v72, v74
  v_smfmac_f32_16x16x64_bf16 v[80:83], v[44:47], v[232:239], v2
  ds_write_b32 v6, v72 offset:3200
  v_smfmac_f32_16x16x64_bf16 v[80:83], v[52:55], v[240:247], v2
  s_nop 1
  v_add_f32 v76, v76, v77
  v_smfmac_f32_16x16x64_bf16 v[80:83], v[56:59], v[248:255], v2
  s_waitcnt lgkmcnt(8)
  v_add_f32 v78, v78, v79
  v_smfmac_f32_16x16x64_bf16 v[80:83], v[48:51], v[92:99], v2
  s_waitcnt lgkmcnt(1)
  v_cvt_pk_bf16_f32 v76, v76, v78
  v_mfma_f32_16x16x32_bf16 v[12:15], v[100:103], v[60:63], 0
  ds_write_b32 v6, v76 offset:3328
  v_mfma_f32_16x16x32_bf16 v[12:15], v[104:107], v[64:67], v[12:15]
  v_mfma_f32_16x16x32_bf16 v[12:15], v[16:19], v[68:71], v[12:15]
  v_smfmac_f32_16x16x64_bf16 v[80:83], v[20:23], v[184:191], v2
  v_smfmac_f32_16x16x64_bf16 v[80:83], v[24:27], v[192:199], v2
  v_smfmac_f32_16x16x64_bf16 v[80:83], v[28:31], v[200:207], v2
  s_nop 4
  ds_write_b128 v109, v[12:15] offset:11264
  s_nop 1
  v_add_f32 v80, v80, v81
  v_add_f32 v82, v82, v83
  v_cvt_pk_bf16_f32 v80, v80, v82
  ds_write_b32 v6, v80 offset:3456
  s_waitcnt vmcnt(7)
  ds_read_b128 v[20:23], v10 offset:0
  ds_read_b128 v[44:47], v10 offset:12288
  ds_read_b128 v[48:51], v10 offset:14336
  ds_read_b128 v[24:27], v10 offset:2048
  s_waitcnt lgkmcnt(4)
  s_barrier
  ds_read_b64_tr_b16 v[84:85], v111 offset:0
  ds_read_b64_tr_b16 v[86:87], v111 offset:128
  ds_read_b128 v[52:55], v10 offset:16384
  ds_read_b64_tr_b16 v[88:89], v111 offset:256
  ds_read_b64_tr_b16 v[90:91], v111 offset:384
  ds_read_b128 v[56:59], v10 offset:18432
  ds_read_b64_tr_b16 v[92:93], v111 offset:512
  ds_read_b64_tr_b16 v[94:95], v111 offset:640
  ds_read_b128 v[28:31], v10 offset:4096
  ds_read_b64_tr_b16 v[96:97], v111 offset:768
  ds_read_b64_tr_b16 v[98:99], v111 offset:896
  s_waitcnt lgkmcnt(11)
  ds_read_b128 v[32:35], v10 offset:6144
  ds_read_b64_tr_b16 v[100:101], v111 offset:1024
  ds_read_b64_tr_b16 v[102:103], v111 offset:1152
  ds_read_b128 v[36:39], v10 offset:8192
  s_waitcnt lgkmcnt(11)
  ds_read_b64_tr_b16 v[104:105], v111 offset:1280
  ds_read_b64_tr_b16 v[106:107], v111 offset:1408
  ds_read_b128 v[40:43], v10 offset:10240
  ds_read_b128 v[72:75], v10 offset:20480
  s_waitcnt lgkmcnt(11)
  ds_read_b128 v[76:79], v10 offset:22528
  v_mfma_f32_16x16x32_bf16 v[60:63], v[44:47], v[20:23], 0
  v_mfma_f32_16x16x32_bf16 v[68:71], v[84:87], v[20:23], 0
  v_mfma_f32_16x16x32_bf16 v[60:63], v[48:51], v[24:27], v[60:63]
  v_mfma_f32_16x16x32_bf16 v[68:71], v[88:91], v[24:27], v[68:71]
  s_waitcnt lgkmcnt(11)
  v_mfma_f32_16x16x32_bf16 v[60:63], v[52:55], v[28:31], v[60:63]
  v_mfma_f32_16x16x32_bf16 v[68:71], v[92:95], v[28:31], v[68:71]
  s_waitcnt lgkmcnt(8)
  v_mfma_f32_16x16x32_bf16 v[60:63], v[56:59], v[32:35], v[60:63]
  v_mfma_f32_16x16x32_bf16 v[68:71], v[96:99], v[32:35], v[68:71]
  s_waitcnt lgkmcnt(5)
  s_waitcnt lgkmcnt(1)
  v_mfma_f32_16x16x32_bf16 v[60:63], v[72:75], v[36:39], v[60:63]
  v_mfma_f32_16x16x32_bf16 v[68:71], v[100:103], v[36:39], v[68:71]
  s_waitcnt lgkmcnt(0)
  v_mfma_f32_16x16x32_bf16 v[60:63], v[76:79], v[40:43], v[60:63]
  v_mfma_f32_16x16x32_bf16 v[68:71], v[104:107], v[40:43], v[68:71]
  s_nop 6
  v_cndmask_b32 v60, v110, v60, s[78:79]
  v_cndmask_b32 v61, v110, v61, s[80:81]
  v_cndmask_b32 v62, v110, v62, s[82:83]
  v_cndmask_b32 v63, v110, v63, s[84:85]
  v_cndmask_b32 v68, v68, v70, s[86:87]
  v_cndmask_b32 v69, v69, v71, s[86:87]
  v_max3_f32 v12, v60, v61, v62
  v_max3_f32 v12, v12, v63, v68
  v_max_f32 v12, v12, v69
  v_mov_b32 v13, v12
  s_nop 1
  v_permlane32_swap_b32 v12, v13
  v_max_f32 v12, v12, v13
  v_mov_b32 v13, v12
  s_nop 1
  v_permlane16_swap_b32 v12, v13
  v_max_f32 v12, v12, v13
  v_mul_f32 v12, s74, v12
  v_pk_fma_f32 v[60:61], v[60:61], s[74:75], v[12:13] op_sel_hi:[1,0,0] neg_lo:[0,0,1] neg_hi:[0,0,1]
  v_pk_fma_f32 v[62:63], v[62:63], s[74:75], v[12:13] op_sel_hi:[1,0,0] neg_lo:[0,0,1] neg_hi:[0,0,1]
  v_pk_fma_f32 v[68:69], v[68:69], s[74:75], v[12:13] op_sel_hi:[1,0,0] neg_lo:[0,0,1] neg_hi:[0,0,1]
  v_exp_f32 v60, v60
  v_exp_f32 v61, v61
  v_exp_f32 v62, v62
  v_exp_f32 v63, v63
  v_exp_f32 v68, v68
  v_exp_f32 v69, v69
  v_pk_add_f32 v[12:13], v[60:61], v[62:63]
  v_pk_add_f32 v[12:13], v[12:13], v[68:69]
  v_add_f32 v12, v12, v13
  s_add_u32 s66, s53, 3072
  buffer_load_dwordx4 v[32:35], v1, s[8:11], s66 offen offset:0 sc1
  buffer_load_dwordx4 v[36:39], v1, s[8:11], s66 offen offset:1024 sc1
  v_mov_b32 v13, v12
  s_nop 1
  v_permlane32_swap_b32 v12, v13
  v_add_f32 v12, v12, v13
  v_mov_b32 v13, v12
  s_nop 1
  v_permlane16_swap_b32 v12, v13
  v_add_f32 v12, v12, v13
  v_rcp_f32 v12, v12
  s_nop 0
  v_pk_mul_f32 v[68:69], v[68:69], v[12:13] op_sel_hi:[1,0]
  v_pk_mul_f32 v[62:63], v[62:63], v[12:13] op_sel_hi:[1,0]
  v_pk_mul_f32 v[60:61], v[60:61], v[12:13] op_sel_hi:[1,0]
  v_cvt_pk_bf16_f32 v14, v68, v69
  v_cvt_pk_bf16_f32 v15, v68, v69
  v_cvt_pk_bf16_f32 v16, v60, v61
  v_mov_b32 v17, 0
  v_cvt_pk_bf16_f32 v18, v62, v63
  v_mov_b32 v19, 0
  v_and_or_b32 v16, v16, -2, s52
  s_cmp_lg_u32 s49, 0
  s_cbranch_scc1 wt_30
  buffer_store_dwordx4 v[16:19], v8, s[8:11], s51 offen
wb_31:
  v_permlane16_swap_b32 v14, v15
  v_and_or_b32 v14, v14, -2, s52
  s_cmp_lg_u32 s49, 0
  s_cbranch_scc1 wt_32
  buffer_store_dwordx2 v[14:15], v9, s[8:11], s51 offen
wb_33:
  s_cmp_eq_u32 s69, 0
  s_cbranch_scc1 nd_34
fl_35:
  buffer_load_dword v12, v4, s[8:11], s56 offen sc1
  s_waitcnt vmcnt(0)
  v_cmp_eq_u32 vcc, 0, v12
  s_nop 0
  s_cbranch_vccz fo_36
  s_sleep 2
  s_sub_u32 s47, s47, 1
  s_cbranch_scc0 fl_35
  s_branch ABORT
fo_36:
  s_add_u32 m0, s70, s77
  s_nop 0
  buffer_load_dwordx4 v1, s[8:11], s55 offen offset:0 sc1 lds
  buffer_load_dwordx4 v1, s[8:11], s55 offen offset:1024 sc1 lds
  buffer_load_dwordx4 v1, s[8:11], s55 offen offset:2048 sc1 lds
  buffer_load_dwordx4 v1, s[8:11], s55 offen offset:3072 sc1 lds
  s_add_u32 m0, m0, 4096
  s_add_u32 s67, s55, 4096
  buffer_load_dwordx4 v1, s[8:11], s67 offen offset:0 sc1 lds
  buffer_load_dwordx4 v1, s[8:11], s67 offen offset:1024 sc1 lds
  s_waitcnt vmcnt(0)
nd_34:
  s_mov_b32 s51, s53
  s_mov_b32 s52, s54
  s_mov_b32 s53, s57
  s_mov_b32 s54, s58
  s_mov_b32 s55, s59
  s_mov_b32 s56, s68
  s_add_u32 s50, s50, 1
  s_cmp_lt_u32 s50, 128
  s_cbranch_scc1 CQ_F1L
  s_branch CQ_END
CQ_F2:
  s_add_u32 s66, s51, 5120
  buffer_load_dwordx4 v[40:43], v1, s[8:11], s66 offen offset:0 sc1
  buffer_load_dwordx4 v[44:47], v1, s[8:11], s66 offen offset:1024 sc1
  s_waitcnt vmcnt(0)
CQ_F2L:
  v_mov_b64 v[60:61], 0
  v_mov_b64 v[62:63], 0
  v_mov_b64 v[64:65], 0
  v_mov_b64 v[66:67], 0
  v_mov_b64 v[68:69], 0
  v_mov_b64 v[70:71], 0
  v_mov_b64 v[72:73], 0
  v_mov_b64 v[74:75], 0
  v_mov_b64 v[76:77], 0
  v_mov_b64 v[78:79], 0
  v_mov_b64 v[80:81], 0
  v_mov_b64 v[82:83], 0
  v_add_u32 v10, s70, v1
  s_xor_b32 s70, s70, 24576
  ds_read_b128 v[84:87], v108 offset:2048
  ds_read_b128 v[88:91], v108 offset:3072
  ds_read_b128 v[92:95], v108 offset:0
  ds_read_b128 v[96:99], v108 offset:1024
  s_waitcnt vmcnt(2)
  v_bitop3_b32 v12, v40, v42, s52 bitop3:0x7e
  v_bitop3_b32 v13, v44, v46, s52 bitop3:0x7e
  v_bitop3_b32 v12, v12, v13, 1 bitop3:0xa8
  v_cmp_ne_u32 vcc, 0, v12
  s_nop 0
  s_cbranch_vccz po_38
  v_bitop3_b32 v12, v40, v42, s52 bitop3:0x42
  v_bitop3_b32 v13, v44, v46, s52 bitop3:0x42
  v_and_b32 v12, v12, v13
  v_and_b32 v12, 1, v12
  v_cmp_eq_u32 vcc, 0, v12
  s_nop 0
  s_cbranch_vccnz pg_39
lp_40:
  buffer_load_dword v12, v3, s[8:11], s66 offen offset:0 sc1
  s_waitcnt vmcnt(0)
  v_and_b32 v12, 1, v12
  v_cmp_eq_u32 vcc, s52, v12
  s_nop 0
  s_cbranch_vccnz lo_41
  s_sleep 1
  s_sub_u32 s47, s47, 1
  s_cbranch_scc0 lp_40
  s_branch ABORT
lo_41:
pg_39:
  buffer_load_dwordx4 v[40:43], v1, s[8:11], s66 offen offset:0 sc1
  buffer_load_dwordx4 v[44:47], v1, s[8:11], s66 offen offset:1024 sc1
  s_nop 11
  s_nop 11
pp_37:
  buffer_load_dwordx4 v[40:43], v1, s[8:11], s66 offen offset:0 sc1
  buffer_load_dwordx4 v[44:47], v1, s[8:11], s66 offen offset:1024 sc1
  s_waitcnt vmcnt(2)
  v_bitop3_b32 v12, v40, v42, s52 bitop3:0x7e
  v_bitop3_b32 v13, v44, v46, s52 bitop3:0x7e
  v_bitop3_b32 v12, v12, v13, 1 bitop3:0xa8
  v_cmp_ne_u32 vcc, 0, v12
  s_nop 0
  s_cbranch_vccz po_38
  s_sub_u32 s47, s47, 1
  s_cbranch_scc0 pp_37
  s_branch ABORT
po_38:
  v_smfmac_f32_16x16x64_bf16 v[64:67], v[40:43], a[96:103], v2
  s_add_u32 s62, s50, 2
  s_min_u32 s62, s62, 127
  ds_write_b128 v109, v[40:43] offset:5120
  ds_write_b128 v109, v[44:47] offset:6144
  v_smfmac_f32_16x16x64_bf16 v[68:71], v[40:43], a[160:167], v2
  s_sub_i32 s60, s62, 13
  s_sub_i32 s75, s62, 12
  v_cmp_eq_u32 vcc, 0, v5
  v_smfmac_f32_16x16x64_bf16 v[60:63], v[44:47], a[32:39], v2
  s_ashr_i32 s60, s60, 1
  s_ashr_i32 s75, s75, 1
  s_sub_i32 s61, s62, 64
  v_smfmac_f32_16x16x64_bf16 v[64:67], v[44:47], a[104:111], v2
  s_max_i32 s60, s60, s61
  s_add_i32 s61, s61, 1
  s_waitcnt lgkmcnt(0)
  s_barrier
  ds_read_b128 v[48:51], v109 offset:7168
  ds_read_b128 v[52:55], v109 offset:8192
  v_smfmac_f32_16x16x64_bf16 v[72:75], v[40:43], a[224:231], v2
  s_max_i32 s75, s75, s61
  s_max_i32 s60, s60, 0
  ds_read_b128 v[56:59], v109 offset:9216
  v_smfmac_f32_16x16x64_bf16 v[76:79], v[40:43], v[144:151], v2
  s_max_i32 s75, s75, 0
  s_sub_i32 s75, s75, s60
  ds_read_b128 v[20:23], v109 offset:0
  v_smfmac_f32_16x16x64_bf16 v[80:83], v[40:43], v[224:231], v2
  s_sub_i32 s76, s62, s60
  s_sub_i32 s60, s60, s76
  ds_read_b128 v[24:27], v109 offset:1024
  v_smfmac_f32_16x16x64_bf16 v[72:75], v[44:47], a[232:239], v2
  s_mul_i32 s60, s60, s75
  s_add_i32 s76, s76, s60
  ds_read_b128 v[28:31], v109 offset:2048
  v_smfmac_f32_16x16x64_bf16 v[76:79], v[44:47], v[152:159], v2
  s_and_b32 s60, s76, 1
  s_lshl_b32 s57, s75, 1
  ds_read_b128 v[32:35], v109 offset:3072
  v_smfmac_f32_16x16x64_bf16 v[80:83], v[44:47], v[232:239], v2
  s_waitcnt lgkmcnt(6)
  s_add_u32 s57, s57, s60
  ds_read_b128 v[36:39], v109 offset:4096
  v_smfmac_f32_16x16x64_bf16 v[60:63], v[48:51], a[40:47], v2
  s_waitcnt lgkmcnt(6)
  s_lshl_b32 s57, s57, 17
  s_add_u32 s57, s57, s71
  v_smfmac_f32_16x16x64_bf16 v[60:63], v[52:55], a[48:55], v2
  s_bfe_u32 s58, s76, 0x10001
  s_mul_i32 s59, s76, 1179648
  s_add_u32 s59, s59, s72
  v_smfmac_f32_16x16x64_bf16 v[60:63], v[40:43], v[84:91], v2
  s_waitcnt lgkmcnt(5)
  s_lshl_b32 s68, s75, 6
  s_add_u32 m0, s70, s77
  s_nop 0
  buffer_load_dwordx4 v1, s[8:11], s55 offen offset:0 sc1 lds
  v_smfmac_f32_16x16x64_bf16 v[60:63], v[56:59], a[56:63], v2
  s_waitcnt lgkmcnt(3)
  s_add_u32 s68, s68, s76
  ds_read_b128 v[84:87], v108 offset:6144
  v_smfmac_f32_16x16x64_bf16 v[60:63], v[24:27], a[0:7], v2
  s_waitcnt lgkmcnt(3)
  s_lshl_b32 s68, s68, 9
  ds_read_b128 v[88:91], v108 offset:7168
  v_smfmac_f32_16x16x64_bf16 v[60:63], v[28:31], a[8:15], v2
  s_add_u32 s68, s68, 65536
  s_cmp_lg_u64 vcc, 0
  s_cselect_b32 s69, 1, 0
  v_smfmac_f32_16x16x64_bf16 v[60:63], v[20:23], v[92:99], v2
  s_waitcnt lgkmcnt(3)
  buffer_load_dwordx4 v1, s[8:11], s55 offen offset:1024 sc1 lds
  v_smfmac_f32_16x16x64_bf16 v[60:63], v[32:35], a[16:23], v2
  s_waitcnt lgkmcnt(2)
  ds_read_b128 v[92:95], v108 offset:4096
  v_smfmac_f32_16x16x64_bf16 v[60:63], v[36:39], a[24:31], v2
  ds_read_b128 v[96:99], v108 offset:5120
  v_smfmac_f32_16x16x64_bf16 v[64:67], v[48:51], a[112:119], v2
  v_smfmac_f32_16x16x64_bf16 v[64:67], v[56:59], a[120:127], v2
  s_waitcnt lgkmcnt(2)
  buffer_load_dwordx4 v1, s[8:11], s55 offen offset:2048 sc1 lds
  v_smfmac_f32_16x16x64_bf16 v[64:67], v[52:55], v[84:91], v2
  ds_read_b128 v[84:87], v108 offset:10240
  v_smfmac_f32_16x16x64_bf16 v[64:67], v[20:23], a[64:71], v2
  buffer_load_dword v5, v4, s[8:11], s68 offen sc1
  v_smfmac_f32_16x16x64_bf16 v[64:67], v[24:27], a[72:79], v2
  ds_read_b128 v[88:91], v108 offset:11264
  v_smfmac_f32_16x16x64_bf16 v[64:67], v[28:31], a[80:87], v2
  s_waitcnt lgkmcnt(2)
  buffer_load_dwordx4 v1, s[8:11], s55 offen offset:3072 sc1 lds
  v_smfmac_f32_16x16x64_bf16 v[64:67], v[32:35], v[92:99], v2
  ds_read_b128 v[92:95], v108 offset:8192
  v_smfmac_f32_16x16x64_bf16 v[64:67], v[36:39], a[88:95], v2
  ds_read_b128 v[96:99], v108 offset:9216
  v_smfmac_f32_16x16x64_bf16 v[68:71], v[48:51], a[168:175], v2
  v_add_f32 v60, v60, v61
  v_add_f32 v62, v62, v63
  v_smfmac_f32_16x16x64_bf16 v[68:71], v[52:55], a[176:183], v2
  s_waitcnt lgkmcnt(2)
  s_add_u32 m0, m0, 4096
  s_add_u32 s67, s55, 4096
  buffer_load_dwordx4 v1, s[8:11], s67 offen offset:0 sc1 lds
  v_smfmac_f32_16x16x64_bf16 v[68:71], v[44:47], v[84:91], v2
  ds_read_b128 v[84:87], v108 offset:14336
  v_cvt_pk_bf16_f32 v60, v60, v62
  v_smfmac_f32_16x16x64_bf16 v[68:71], v[56:59], a[184:191], v2
  ds_read_b128 v[88:91], v108 offset:15360
  ds_write_b32 v6, v60 offset:0
  v_smfmac_f32_16x16x64_bf16 v[68:71], v[20:23], a[128:135], v2
  v_add_f32 v64, v64, v65
  v_add_f32 v66, v66, v67
  v_smfmac_f32_16x16x64_bf16 v[68:71], v[28:31], a[136:143], v2
  s_waitcnt lgkmcnt(3)
  buffer_load_dwordx4 v1, s[8:11], s67 offen offset:1024 sc1 lds
  v_cvt_pk_bf16_f32 v64, v64, v66
  v_smfmac_f32_16x16x64_bf16 v[68:71], v[24:27], v[92:99], v2
  ds_read_b128 v[92:95], v108 offset:12288
  ds_write_b32 v6, v64 offset:128
  v_smfmac_f32_16x16x64_bf16 v[68:71], v[32:35], a[144:151], v2
  ds_read_b128 v[96:99], v108 offset:13312
  v_smfmac_f32_16x16x64_bf16 v[68:71], v[36:39], a[152:159], v2
  v_smfmac_f32_16x16x64_bf16 v[72:75], v[48:51], a[240:247], v2
  v_smfmac_f32_16x16x64_bf16 v[72:75], v[52:55], a[248:255], v2
  s_waitcnt lgkmcnt(4)
  s_nop 4
  v_add_f32 v68, v68, v69
  v_add_f32 v70, v70, v71
  v_smfmac_f32_16x16x64_bf16 v[72:75], v[56:59], v[84:91], v2
  ds_read_b128 v[84:87], v108 offset:16384
  v_cvt_pk_bf16_f32 v68, v68, v70
  v_smfmac_f32_16x16x64_bf16 v[72:75], v[20:23], a[192:199], v2
  ds_read_b128 v[88:91], v108 offset:17408
  ds_write_b32 v6, v68 offset:256
  v_smfmac_f32_16x16x64_bf16 v[72:75], v[24:27], a[200:207], v2
  ds_read_b128 v[100:103], v10 offset:14336
  v_smfmac_f32_16x16x64_bf16 v[72:75], v[28:31], a[208:215], v2
  s_waitcnt lgkmcnt(4)
  ds_read_b128 v[104:107], v10 offset:18432
  v_smfmac_f32_16x16x64_bf16 v[72:75], v[36:39], v[92:99], v2
  ds_read_b128 v[92:95], v108 offset:18432
  v_smfmac_f32_16x16x64_bf16 v[72:75], v[32:35], a[216:223], v2
  s_waitcnt lgkmcnt(3)
  s_barrier
  ds_read_b128 v[96:99], v108 offset:19456
  v_smfmac_f32_16x16x64_bf16 v[76:79], v[48:51], v[160:167], v2
  ds_read_b64_tr_b16 v[60:61], v7 offset:0
  v_smfmac_f32_16x16x64_bf16 v[76:79], v[52:55], v[168:175], v2
  ds_read_b64_tr_b16 v[62:63], v7 offset:128
  v_smfmac_f32_16x16x64_bf16 v[76:79], v[56:59], v[176:183], v2
  ds_read_b64_tr_b16 v[64:65], v7 offset:512
  v_smfmac_f32_16x16x64_bf16 v[76:79], v[20:23], v[112:119], v2
  ds_read_b64_tr_b16 v[66:67], v7 offset:640
  v_smfmac_f32_16x16x64_bf16 v[76:79], v[28:31], v[84:91], v2
  ds_read_b64_tr_b16 v[68:69], v7 offset:1024
  v_smfmac_f32_16x16x64_bf16 v[76:79], v[24:27], v[120:127], v2
  ds_read_b64_tr_b16 v[70:71], v7 offset:1152
  v_smfmac_f32_16x16x64_bf16 v[76:79], v[32:35], v[128:135], v2
  ds_read_b128 v[16:19], v10 offset:22528
  v_smfmac_f32_16x16x64_bf16 v[76:79], v[36:39], v[136:143], v2
  v_add_f32 v72, v72, v73
  v_smfmac_f32_16x16x64_bf16 v[80:83], v[52:55], v[240:247], v2
  v_add_f32 v74, v74, v75
  v_smfmac_f32_16x16x64_bf16 v[80:83], v[56:59], v[248:255], v2
  v_cvt_pk_bf16_f32 v72, v72, v74
  v_smfmac_f32_16x16x64_bf16 v[80:83], v[20:23], v[184:191], v2
  ds_write_b32 v6, v72 offset:3200
  v_smfmac_f32_16x16x64_bf16 v[80:83], v[24:27], v[192:199], v2
  s_waitcnt lgkmcnt(8)
  v_add_f32 v76, v76, v77
  v_smfmac_f32_16x16x64_bf16 v[80:83], v[48:51], v[92:99], v2
  s_waitcnt lgkmcnt(1)
  v_add_f32 v78, v78, v79
  v_mfma_f32_16x16x32_bf16 v[12:15], v[100:103], v[60:63], 0
  v_cvt_pk_bf16_f32 v76, v76, v78
  ds_write_b32 v6, v76 offset:3328
  v_mfma_f32_16x16x32_bf16 v[12:15], v[104:107], v[64:67], v[12:15]
  v_mfma_f32_16x16x32_bf16 v[12:15], v[16:19], v[68:71], v[12:15]
  v_smfmac_f32_16x16x64_bf16 v[80:83], v[28:31], v[200:207], v2
  v_smfmac_f32_16x16x64_bf16 v[80:83], v[32:35], v[208:215], v2
  v_smfmac_f32_16x16x64_bf16 v[80:83], v[36:39], v[216:223], v2
  s_nop 4
  ds_write_b128 v109, v[12:15] offset:12288
  s_nop 1
  v_add_f32 v80, v80, v81
  v_add_f32 v82, v82, v83
  v_cvt_pk_bf16_f32 v80, v80, v82
  ds_write_b32 v6, v80 offset:3456
  s_waitcnt vmcnt(7)
  ds_read_b128 v[20:23], v10 offset:1024
  ds_read_b128 v[44:47], v10 offset:12288
  ds_read_b128 v[48:51], v10 offset:13312
  ds_read_b128 v[24:27], v10 offset:3072
  s_waitcnt lgkmcnt(4)
  s_barrier
  ds_read_b64_tr_b16 v[84:85], v111 offset:0
  ds_read_b64_tr_b16 v[86:87], v111 offset:128
  ds_read_b128 v[52:55], v10 offset:14336
  ds_read_b64_tr_b16 v[88:89], v111 offset:256
  ds_read_b64_tr_b16 v[90:91], v111 offset:384
  ds_read_b128 v[56:59], v10 offset:15360
  ds_read_b64_tr_b16 v[92:93], v111 offset:512
  ds_read_b64_tr_b16 v[94:95], v111 offset:640
  ds_read_b128 v[28:31], v10 offset:5120
  ds_read_b64_tr_b16 v[96:97], v111 offset:768
  ds_read_b64_tr_b16 v[98:99], v111 offset:896
  s_waitcnt lgkmcnt(11)
  ds_read_b128 v[32:35], v10 offset:7168
  ds_read_b64_tr_b16 v[100:101], v111 offset:1024
  ds_read_b64_tr_b16 v[102:103], v111 offset:1152
  ds_read_b128 v[36:39], v10 offset:9216
  s_waitcnt lgkmcnt(11)
  ds_read_b64_tr_b16 v[104:105], v111 offset:1280
  ds_read_b64_tr_b16 v[106:107], v111 offset:1408
  ds_read_b128 v[40:43], v10 offset:11264
  ds_read_b128 v[72:75], v10 offset:16384
  s_waitcnt lgkmcnt(11)
  ds_read_b128 v[76:79], v10 offset:17408
  ds_read_b128 v[80:83], v10 offset:18432
  v_mfma_f32_16x16x32_bf16 v[60:63], v[44:47], v[20:23], 0
  ds_read_b128 v[44:47], v10 offset:19456
  v_mfma_f32_16x16x32_bf16 v[64:67], v[48:51], v[20:23], 0
  ds_read_b128 v[48:51], v10 offset:20480
  v_mfma_f32_16x16x32_bf16 v[68:71], v[84:87], v[20:23], 0
  v_mfma_f32_16x16x32_bf16 v[60:63], v[52:55], v[24:27], v[60:63]
  s_waitcnt lgkmcnt(11)
  ds_read_b128 v[52:55], v10 offset:21504
  v_mfma_f32_16x16x32_bf16 v[64:67], v[56:59], v[24:27], v[64:67]
  ds_read_b128 v[56:59], v10 offset:22528
  v_mfma_f32_16x16x32_bf16 v[68:71], v[88:91], v[24:27], v[68:71]
  s_waitcnt lgkmcnt(6)
  v_mfma_f32_16x16x32_bf16 v[60:63], v[72:75], v[28:31], v[60:63]
  ds_read_b128 v[72:75], v10 offset:23552
  s_waitcnt lgkmcnt(6)
  v_mfma_f32_16x16x32_bf16 v[64:67], v[76:79], v[28:31], v[64:67]
  v_mfma_f32_16x16x32_bf16 v[68:71], v[92:95], v[28:31], v[68:71]
  s_waitcnt lgkmcnt(5)
  v_mfma_f32_16x16x32_bf16 v[60:63], v[80:83], v[32:35], v[60:63]
  s_waitcnt lgkmcnt(4)
  v_mfma_f32_16x16x32_bf16 v[64:67], v[44:47], v[32:35], v[64:67]
  v_mfma_f32_16x16x32_bf16 v[68:71], v[96:99], v[32:35], v[68:71]
  s_waitcnt lgkmcnt(3)
  v_mfma_f32_16x16x32_bf16 v[60:63], v[48:51], v[36:39], v[60:63]
  s_waitcnt lgkmcnt(2)
  v_mfma_f32_16x16x32_bf16 v[64:67], v[52:55], v[36:39], v[64:67]
  v_mfma_f32_16x16x32_bf16 v[68:71], v[100:103], v[36:39], v[68:71]
  s_waitcnt lgkmcnt(1)
  v_mfma_f32_16x16x32_bf16 v[60:63], v[56:59], v[40:43], v[60:63]
  s_waitcnt lgkmcnt(0)
  v_mfma_f32_16x16x32_bf16 v[64:67], v[72:75], v[40:43], v[64:67]
  v_mfma_f32_16x16x32_bf16 v[68:71], v[104:107], v[40:43], v[68:71]
  s_nop 6
  v_cndmask_b32 v64, v110, v64, s[78:79]
  v_cndmask_b32 v65, v110, v65, s[80:81]
  v_cndmask_b32 v66, v110, v66, s[82:83]
  v_cndmask_b32 v67, v110, v67, s[84:85]
  v_cndmask_b32 v68, v68, v70, s[86:87]
  v_cndmask_b32 v69, v69, v71, s[86:87]
  v_max3_f32 v12, v60, v61, v62
  v_max3_f32 v12, v12, v63, v64
  v_max3_f32 v12, v12, v65, v66
  v_max3_f32 v12, v12, v67, v68
  v_max_f32 v12, v12, v69
  v_mov_b32 v13, v12
  s_nop 1
  v_permlane32_swap_b32 v12, v13
  v_max_f32 v12, v12, v13
  v_mov_b32 v13, v12
  s_nop 1
  v_permlane16_swap_b32 v12, v13
  v_max_f32 v12, v12, v13
  v_mul_f32 v12, s74, v12
  v_pk_fma_f32 v[60:61], v[60:61], s[74:75], v[12:13] op_sel_hi:[1,0,0] neg_lo:[0,0,1] neg_hi:[0,0,1]
  v_pk_fma_f32 v[62:63], v[62:63], s[74:75], v[12:13] op_sel_hi:[1,0,0] neg_lo:[0,0,1] neg_hi:[0,0,1]
  v_pk_fma_f32 v[64:65], v[64:65], s[74:75], v[12:13] op_sel_hi:[1,0,0] neg_lo:[0,0,1] neg_hi:[0,0,1]
  v_pk_fma_f32 v[66:67], v[66:67], s[74:75], v[12:13] op_sel_hi:[1,0,0] neg_lo:[0,0,1] neg_hi:[0,0,1]
  v_pk_fma_f32 v[68:69], v[68:69], s[74:75], v[12:13] op_sel_hi:[1,0,0] neg_lo:[0,0,1] neg_hi:[0,0,1]
  v_exp_f32 v60, v60
  v_exp_f32 v61, v61
  v_exp_f32 v62, v62
  v_exp_f32 v63, v63
  v_exp_f32 v64, v64
  v_exp_f32 v65, v65
  v_exp_f32 v66, v66
  v_exp_f32 v67, v67
  v_exp_f32 v68, v68
  v_exp_f32 v69, v69
  v_pk_add_f32 v[12:13], v[60:61], v[62:63]
  v_pk_add_f32 v[12:13], v[12:13], v[64:65]
  v_pk_add_f32 v[12:13], v[12:13], v[66:67]
  v_pk_add_f32 v[12:13], v[12:13], v[68:69]
  v_add_f32 v12, v12, v13
  s_add_u32 s66, s53, 5120
  buffer_load_dwordx4 v[40:43], v1, s[8:11], s66 offen offset:0 sc1
  buffer_load_dwordx4 v[44:47], v1, s[8:11], s66 offen offset:1024 sc1
  v_mov_b32 v13, v12
  s_nop 1
  v_permlane32_swap_b32 v12, v13
  v_add_f32 v12, v12, v13
  v_mov_b32 v13, v12
  s_nop 1
  v_permlane16_swap_b32 v12, v13
  v_add_f32 v12, v12, v13
  v_rcp_f32 v12, v12
  s_nop 0
  v_pk_mul_f32 v[68:69], v[68:69], v[12:13] op_sel_hi:[1,0]
  v_pk_mul_f32 v[66:67], v[66:67], v[12:13] op_sel_hi:[1,0]
  v_pk_mul_f32 v[64:65], v[64:65], v[12:13] op_sel_hi:[1,0]
  v_pk_mul_f32 v[62:63], v[62:63], v[12:13] op_sel_hi:[1,0]
  v_pk_mul_f32 v[60:61], v[60:61], v[12:13] op_sel_hi:[1,0]
  v_cvt_pk_bf16_f32 v14, v68, v69
  v_cvt_pk_bf16_f32 v15, v68, v69
  v_cvt_pk_bf16_f32 v16, v60, v61
  v_cvt_pk_bf16_f32 v17, v64, v65
  v_cvt_pk_bf16_f32 v18, v62, v63
  v_cvt_pk_bf16_f32 v19, v66, v67
  v_and_or_b32 v16, v16, -2, s52
  s_cmp_lg_u32 s49, 0
  s_cbranch_scc1 wt_42
  buffer_store_dwordx4 v[16:19], v8, s[8:11], s51 offen
wb_43:
  v_permlane16_swap_b32 v14, v15
  v_and_or_b32 v14, v14, -2, s52
  s_cmp_lg_u32 s49, 0
  s_cbranch_scc1 wt_44
  buffer_store_dwordx2 v[14:15], v9, s[8:11], s51 offen
wb_45:
  s_cmp_eq_u32 s69, 0
  s_cbranch_scc1 nd_46
fl_47:
  buffer_load_dword v12, v4, s[8:11], s56 offen sc1
  s_waitcnt vmcnt(0)
  v_cmp_eq_u32 vcc, 0, v12
  s_nop 0
  s_cbranch_vccz fo_48
  s_sleep 2
  s_sub_u32 s47, s47, 1
  s_cbranch_scc0 fl_47
  s_branch ABORT
fo_48:
  s_add_u32 m0, s70, s77
  s_nop 0
  buffer_load_dwordx4 v1, s[8:11], s55 offen offset:0 sc1 lds
  buffer_load_dwordx4 v1, s[8:11], s55 offen offset:1024 sc1 lds
  buffer_load_dwordx4 v1, s[8:11], s55 offen offset:2048 sc1 lds
  buffer_load_dwordx4 v1, s[8:11], s55 offen offset:3072 sc1 lds
  s_add_u32 m0, m0, 4096
  s_add_u32 s67, s55, 4096
  buffer_load_dwordx4 v1, s[8:11], s67 offen offset:0 sc1 lds
  buffer_load_dwordx4 v1, s[8:11], s67 offen offset:1024 sc1 lds
  s_waitcnt vmcnt(0)
nd_46:
  s_mov_b32 s51, s53
  s_mov_b32 s52, s54
  s_mov_b32 s53, s57
  s_mov_b32 s54, s58
  s_mov_b32 s55, s59
  s_mov_b32 s56, s68
  s_add_u32 s50, s50, 1
  s_cmp_lt_u32 s50, 128
  s_cbranch_scc1 CQ_F2L
  s_branch CQ_END
CQ_F3:
  s_add_u32 s66, s51, 7168
  buffer_load_dwordx4 v[48:51], v1, s[8:11], s66 offen offset:0 sc1
  buffer_load_dwordx4 v[52:55], v1, s[8:11], s66 offen offset:1024 sc1
  buffer_load_dwordx4 v[56:59], v1, s[8:11], s66 offen offset:2048 sc1
  s_waitcnt vmcnt(0)
CQ_F3L:
  v_mov_b64 v[60:61], 0
  v_mov_b64 v[62:63], 0
  v_mov_b64 v[64:65], 0
  v_mov_b64 v[66:67], 0
  v_mov_b64 v[68:69], 0
  v_mov_b64 v[70:71], 0
  v_mov_b64 v[72:73], 0
  v_mov_b64 v[74:75], 0
  v_mov_b64 v[76:77], 0
  v_mov_b64 v[78:79], 0
  v_mov_b64 v[80:81], 0
  v_mov_b64 v[82:83], 0
  v_add_u32 v10, s70, v1
  s_xor_b32 s70, s70, 24576
  ds_read_b128 v[84:87], v108 offset:0
  ds_read_b128 v[88:91], v108 offset:1024
  ds_read_b128 v[92:95], v108 offset:2048
  ds_read_b128 v[96:99], v108 offset:3072
  s_waitcnt vmcnt(0)
  v_bitop3_b32 v12, v48, v50, s52 bitop3:0x7e
  v_bitop3_b32 v13, v52, v54, s52 bitop3:0x7e
  v_bitop3_b32 v14, v56, v58, s52 bitop3:0x7e
  v_or3_b32 v12, v12, v13, v14
  v_and_b32 v12, 1, v12
  v_cmp_ne_u32 vcc, 0, v12
  s_nop 0
  s_cbranch_vccz po_50
  v_bitop3_b32 v12, v48, v50, s52 bitop3:0x42
  v_bitop3_b32 v13, v52, v54, s52 bitop3:0x42
  v_and_b32 v12, v12, v13
  v_bitop3_b32 v13, v56, v58, s52 bitop3:0x42
  v_and_b32 v12, v12, v13
  v_and_b32 v12, 1, v12
  v_cmp_eq_u32 vcc, 0, v12
  s_nop 0
  s_cbranch_vccnz pg_51
lp_52:
  buffer_load_dword v12, v3, s[8:11], s66 offen offset:0 sc1
  s_waitcnt vmcnt(0)
  v_and_b32 v12, 1, v12
  v_cmp_eq_u32 vcc, s52, v12
  s_nop 0
  s_cbranch_vccnz lo_53
  s_sleep 1
  s_sub_u32 s47, s47, 1
  s_cbranch_scc0 lp_52
  s_branch ABORT
lo_53:
pg_51:
  buffer_load_dwordx4 v[48:51], v1, s[8:11], s66 offen offset:0 sc1
  buffer_load_dwordx4 v[52:55], v1, s[8:11], s66 offen offset:1024 sc1
  buffer_load_dwordx4 v[56:59], v1, s[8:11], s66 offen offset:2048 sc1
  s_nop 11
  s_nop 11
pp_49:
  buffer_load_dwordx4 v[48:51], v1, s[8:11], s66 offen offset:0 sc1
  buffer_load_dwordx4 v[52:55], v1, s[8:11], s66 offen offset:1024 sc1
  buffer_load_dwordx4 v[56:59], v1, s[8:11], s66 offen offset:2048 sc1
  s_waitcnt vmcnt(3)
  v_bitop3_b32 v12, v48, v50, s52 bitop3:0x7e
  v_bitop3_b32 v13, v52, v54, s52 bitop3:0x7e
  v_bitop3_b32 v14, v56, v58, s52 bitop3:0x7e
  v_or3_b32 v12, v12, v13, v14
  v_and_b32 v12, 1, v12
  v_cmp_ne_u32 vcc, 0, v12
  s_nop 0
  s_cbranch_vccz po_50
  s_sub_u32 s47, s47, 1
  s_cbranch_scc0 pp_49
  s_branch ABORT
po_50:
  v_smfmac_f32_16x16x64_bf16 v[60:63], v[48:51], a[40:47], v2
  s_add_u32 s62, s50, 2
  s_min_u32 s62, s62, 127
  ds_write_b128 v109, v[48:51] offset:7168
  ds_write_b128 v109, v[52:55] offset:8192
  ds_write_b128 v109, v[56:59] offset:9216
  v_smfmac_f32_16x16x64_bf16 v[64:67], v[48:51], a[112:119], v2
  s_sub_i32 s60, s62, 13
  s_sub_i32 s75, s62, 12
  v_cmp_eq_u32 vcc, 0, v5
  v_smfmac_f32_16x16x64_bf16 v[68:71], v[48:51], a[168:175], v2
  s_ashr_i32 s60, s60, 1
  s_ashr_i32 s75, s75, 1
  s_sub_i32 s61, s62, 64
  v_smfmac_f32_16x16x64_bf16 v[60:63], v[52:55], a[48:55], v2
  s_max_i32 s60, s60, s61
  s_add_i32 s61, s61, 1
  s_waitcnt lgkmcnt(0)
  s_barrier
  ds_read_b128 v[20:23], v109 offset:0
  ds_read_b128 v[24:27], v109 offset:1024
  v_smfmac_f32_16x16x64_bf16 v[68:71], v[52:55], a[176:183], v2
  s_max_i32 s75, s75, s61
  s_max_i32 s60, s60, 0
  ds_read_b128 v[28:31], v109 offset:2048
  v_smfmac_f32_16x16x64_bf16 v[60:63], v[56:59], a[56:63], v2
  s_max_i32 s75, s75, 0
  s_sub_i32 s75, s75, s60
  ds_read_b128 v[32:35], v109 offset:3072
  v_smfmac_f32_16x16x64_bf16 v[64:67], v[56:59], a[120:127], v2
  s_sub_i32 s76, s62, s60
  s_sub_i32 s60, s60, s76
  ds_read_b128 v[36:39], v109 offset:4096
  v_smfmac_f32_16x16x64_bf16 v[68:71], v[56:59], a[184:191], v2
  s_mul_i32 s60, s60, s75
  s_add_i32 s76, s76, s60
  ds_read_b128 v[40:43], v109 offset:5120
  v_smfmac_f32_16x16x64_bf16 v[72:75], v[48:51], a[240:247], v2
  s_and_b32 s60, s76, 1
  s_lshl_b32 s57, s75, 1
  ds_read_b128 v[44:47], v109 offset:6144
  v_smfmac_f32_16x16x64_bf16 v[76:79], v[48:51], v[160:167], v2
  s_add_u32 s57, s57, s60
  s_lshl_b32 s57, s57, 17
  s_add_u32 s57, s57, s71
  v_smfmac_f32_16x16x64_bf16 v[72:75], v[52:55], a[248:255], v2
  s_bfe_u32 s58, s76, 0x10001
  s_mul_i32 s59, s76, 1179648
  s_add_u32 s59, s59, s72
  v_smfmac_f32_16x16x64_bf16 v[76:79], v[52:55], v[168:175], v2
  s_waitcnt lgkmcnt(5)
  s_lshl_b32 s68, s75, 6
  s_add_u32 s68, s68, s76
  v_smfmac_f32_16x16x64_bf16 v[60:63], v[24:27], a[0:7], v2
  s_lshl_b32 s68, s68, 9
  s_add_u32 s68, s68, 65536
  v_smfmac_f32_16x16x64_bf16 v[60:63], v[20:23], v[84:91], v2
  s_waitcnt lgkmcnt(4)
  s_cmp_lg_u64 vcc, 0
  s_cselect_b32 s69, 1, 0
  s_add_u32 m0, s70, s77
  s_nop 0
  buffer_load_dwordx4 v1, s[8:11], s55 offen offset:0 sc1 lds
  v_smfmac_f32_16x16x64_bf16 v[60:63], v[28:31], a[8:15], v2
  s_waitcnt lgkmcnt(3)
  ds_read_b128 v[84:87], v108 offset:6144
  v_smfmac_f32_16x16x64_bf16 v[60:63], v[32:35], a[16:23], v2
  s_waitcnt lgkmcnt(3)
  ds_read_b128 v[88:91], v108 offset:7168
  v_smfmac_f32_16x16x64_bf16 v[60:63], v[36:39], a[24:31], v2
  s_waitcnt lgkmcnt(3)
  v_smfmac_f32_16x16x64_bf16 v[60:63], v[40:43], v[92:99], v2
  s_waitcnt lgkmcnt(2)
  buffer_load_dwordx4 v1, s[8:11], s55 offen offset:1024 sc1 lds
  v_smfmac_f32_16x16x64_bf16 v[60:63], v[44:47], a[32:39], v2
  ds_read_b128 v[92:95], v108 offset:4096
  v_smfmac_f32_16x16x64_bf16 v[64:67], v[20:23], a[64:71], v2
  ds_read_b128 v[96:99], v108 offset:5120
  v_smfmac_f32_16x16x64_bf16 v[64:67], v[24:27], a[72:79], v2
  s_waitcnt lgkmcnt(2)
  s_nop 2
  v_add_f32 v60, v60, v61
  v_smfmac_f32_16x16x64_bf16 v[64:67], v[52:55], v[84:91], v2
  buffer_load_dwordx4 v1, s[8:11], s55 offen offset:2048 sc1 lds
  v_smfmac_f32_16x16x64_bf16 v[64:67], v[28:31], a[80:87], v2
  ds_read_b128 v[84:87], v108 offset:8192
  v_smfmac_f32_16x16x64_bf16 v[64:67], v[36:39], a[88:95], v2
  buffer_load_dword v5, v4, s[8:11], s68 offen sc1
  v_smfmac_f32_16x16x64_bf16 v[64:67], v[40:43], a[96:103], v2
  s_waitcnt lgkmcnt(1)
  ds_read_b128 v[88:91], v108 offset:9216
  v_smfmac_f32_16x16x64_bf16 v[64:67], v[32:35], v[92:99], v2
  buffer_load_dwordx4 v1, s[8:11], s55 offen offset:3072 sc1 lds
  v_smfmac_f32_16x16x64_bf16 v[64:67], v[44:47], a[104:111], v2
  ds_read_b128 v[92:95], v108 offset:10240
  v_smfmac_f32_16x16x64_bf16 v[68:71], v[20:23], a[128:135], v2
  s_waitcnt lgkmcnt(1)
  ds_read_b128 v[96:99], v108 offset:11264
  v_add_f32 v62, v62, v63
  v_smfmac_f32_16x16x64_bf16 v[68:71], v[24:27], v[84:91], v2
  ds_read_b128 v[84:87], v108 offset:14336
  v_cvt_pk_bf16_f32 v60, v60, v62
  v_smfmac_f32_16x16x64_bf16 v[68:71], v[28:31], a[136:143], v2
  s_add_u32 m0, m0, 4096
  s_add_u32 s67, s55, 4096
  buffer_load_dwordx4 v1, s[8:11], s67 offen offset:0 sc1 lds
  ds_read_b128 v[88:91], v108 offset:15360
  v_smfmac_f32_16x16x64_bf16 v[68:71], v[32:35], a[144:151], v2
  ds_write_b32 v6, v60 offset:0
  v_add_f32 v64, v64, v65
  v_smfmac_f32_16x16x64_bf16 v[68:71], v[36:39], a[152:159], v2
  s_waitcnt lgkmcnt(3)
  v_add_f32 v66, v66, v67
  v_cvt_pk_bf16_f32 v64, v64, v66
  v_smfmac_f32_16x16x64_bf16 v[68:71], v[44:47], v[92:99], v2
  ds_read_b128 v[92:95], v108 offset:12288
  ds_write_b32 v6, v64 offset:128
  v_smfmac_f32_16x16x64_bf16 v[68:71], v[40:43], a[160:167], v2
  buffer_load_dwordx4 v1, s[8:11], s67 offen offset:1024 sc1 lds
  ds_read_b128 v[96:99], v108 offset:13312
  v_smfmac_f32_16x16x64_bf16 v[72:75], v[20:23], a[192:199], v2
  v_smfmac_f32_16x16x64_bf16 v[72:75], v[24:27], a[200:207], v2
  s_waitcnt lgkmcnt(4)
  s_nop 2
  v_add_f32 v68, v68, v69
  v_add_f32 v70, v70, v71
  v_smfmac_f32_16x16x64_bf16 v[72:75], v[56:59], v[84:91], v2
  ds_read_b128 v[84:87], v108 offset:16384
  v_cvt_pk_bf16_f32 v68, v68, v70
  v_smfmac_f32_16x16x64_bf16 v[72:75], v[28:31], a[208:215], v2
  ds_read_b128 v[88:91], v108 offset:17408
  ds_write_b32 v6, v68 offset:256
  v_smfmac_f32_16x16x64_bf16 v[72:75], v[32:35], a[216:223], v2
  ds_read_b128 v[100:103], v10 offset:15360
  v_smfmac_f32_16x16x64_bf16 v[72:75], v[40:43], a[224:231], v2
  s_waitcnt lgkmcnt(4)
  ds_read_b128 v[104:107], v10 offset:19456
  v_smfmac_f32_16x16x64_bf16 v[72:75], v[36:39], v[92:99], v2
  ds_read_b128 v[92:95], v108 offset:18432
  v_smfmac_f32_16x16x64_bf16 v[72:75], v[44:47], a[232:239], v2
  s_waitcnt lgkmcnt(3)
  s_barrier
  ds_read_b128 v[96:99], v108 offset:19456
  v_smfmac_f32_16x16x64_bf16 v[76:79], v[56:59], v[176:183], v2
  ds_read_b64_tr_b16 v[60:61], v7 offset:0
  v_smfmac_f32_16x16x64_bf16 v[76:79], v[20:23], v[112:119], v2
  ds_read_b64_tr_b16 v[62:63], v7 offset:128
  v_smfmac_f32_16x16x64_bf16 v[76:79], v[24:27], v[120:127], v2
  ds_read_b64_tr_b16 v[64:65], v7 offset:512
  v_smfmac_f32_16x16x64_bf16 v[76:79], v[32:35], v[128:135], v2
  ds_read_b64_tr_b16 v[66:67], v7 offset:640
  v_smfmac_f32_16x16x64_bf16 v[76:79], v[28:31], v[84:91], v2
  ds_read_b64_tr_b16 v[68:69], v7 offset:1024
  v_smfmac_f32_16x16x64_bf16 v[76:79], v[36:39], v[136:143], v2
  ds_read_b64_tr_b16 v[70:71], v7 offset:1152
  v_smfmac_f32_16x16x64_bf16 v[76:79], v[40:43], v[144:151], v2
  ds_read_b128 v[16:19], v10 offset:23552
  v_smfmac_f32_16x16x64_bf16 v[76:79], v[44:47], v[152:159], v2
  v_add_f32 v72, v72, v73
  v_smfmac_f32_16x16x64_bf16 v[80:83], v[52:55], v[240:247], v2
  v_add_f32 v74, v74, v75
  v_smfmac_f32_16x16x64_bf16 v[80:83], v[56:59], v[248:255], v2
  v_cvt_pk_bf16_f32 v72, v72, v74
  v_smfmac_f32_16x16x64_bf16 v[80:83], v[20:23], v[184:191], v2
  ds_write_b32 v6, v72 offset:3200
  v_smfmac_f32_16x16x64_bf16 v[80:83], v[24:27], v[192:199], v2
  v_add_f32 v76, v76, v77
  v_smfmac_f32_16x16x64_bf16 v[80:83], v[28:31], v[200:207], v2
  s_waitcnt lgkmcnt(8)
  v_add_f32 v78, v78, v79
  v_smfmac_f32_16x16x64_bf16 v[80:83], v[48:51], v[92:99], v2
  v_cvt_pk_bf16_f32 v76, v76, v78
  v_smfmac_f32_16x16x64_bf16 v[80:83], v[32:35], v[208:215], v2
  s_waitcnt lgkmcnt(1)
  ds_write_b32 v6, v76 offset:3328
  v_mfma_f32_16x16x32_bf16 v[12:15], v[100:103], v[60:63], 0
  v_mfma_f32_16x16x32_bf16 v[12:15], v[104:107], v[64:67], v[12:15]
  v_mfma_f32_16x16x32_bf16 v[12:15], v[16:19], v[68:71], v[12:15]
  v_smfmac_f32_16x16x64_bf16 v[80:83], v[36:39], v[216:223], v2
  v_smfmac_f32_16x16x64_bf16 v[80:83], v[40:43], v[224:231], v2
  v_smfmac_f32_16x16x64_bf16 v[80:83], v[44:47], v[232:239], v2
  s_nop 4
  ds_write_b128 v109, v[12:15] offset:13312
  s_nop 1
  v_add_f32 v80, v80, v81
  v_add_f32 v82, v82, v83
  v_cvt_pk_bf16_f32 v80, v80, v82
  ds_write_b32 v6, v80 offset:3456
  s_waitcnt vmcnt(7)
  s_waitcnt lgkmcnt(0)
  s_barrier
  s_add_u32 s66, s53, 7168
  buffer_load_dwordx4 v[48:51], v1, s[8:11], s66 offen offset:0 sc1
  buffer_load_dwordx4 v[52:55], v1, s[8:11], s66 offen offset:1024 sc1
  buffer_load_dwordx4 v[56:59], v1, s[8:11], s66 offen offset:2048 sc1
  s_cmp_eq_u32 s69, 0
  s_cbranch_scc1 nd_54
fl_55:
  buffer_load_dword v12, v4, s[8:11], s56 offen sc1
  s_waitcnt vmcnt(0)
  v_cmp_eq_u32 vcc, 0, v12
  s_nop 0
  s_cbranch_vccz fo_56
  s_sleep 2
  s_sub_u32 s47, s47, 1
  s_cbranch_scc0 fl_55
  s_branch ABORT
fo_56:
  s_add_u32 m0, s70, s77
  s_nop 0
  buffer_load_dwordx4 v1, s[8:11], s55 offen offset:0 sc1 lds
  buffer_load_dwordx4 v1, s[8:11], s55 offen offset:1024 sc1 lds
  buffer_load_dwordx4 v1, s[8:11], s55 offen offset:2048 sc1 lds
  buffer_load_dwordx4 v1, s[8:11], s55 offen offset:3072 sc1 lds
  s_add_u32 m0, m0, 4096
  s_add_u32 s67, s55, 4096
  buffer_load_dwordx4 v1, s[8:11], s67 offen offset:0 sc1 lds
  buffer_load_dwordx4 v1, s[8:11], s67 offen offset:1024 sc1 lds
  s_waitcnt vmcnt(0)
nd_54:
  s_mov_b32 s51, s53
  s_mov_b32 s52, s54
  s_mov_b32 s53, s57
  s_mov_b32 s54, s58
  s_mov_b32 s55, s59
  s_mov_b32 s56, s68
  s_add_u32 s50, s50, 1
  s_cmp_lt_u32 s50, 128
  s_cbranch_scc1 CQ_F3L
  s_branch CQ_END
CQ_END:
  s_endpgm
wt_18:
  s_nop 7
  buffer_store_dwordx2 v[14:15], v8, s[8:11], s51 offen sc1
  s_branch wb_19
wt_20:
  s_nop 7
  buffer_store_dwordx2 v[16:17], v9, s[8:11], s51 offen sc1
  s_branch wb_21
wt_30:
  s_nop 7
  buffer_store_dwordx4 v[16:19], v8, s[8:11], s51 offen sc1
  s_branch wb_31
wt_32:
  s_nop 7
  buffer_store_dwordx2 v[14:15], v9, s[8:11], s51 offen sc1
  s_branch wb_33
wt_42:
  s_nop 7
  buffer_store_dwordx4 v[16:19], v8, s[8:11], s51 offen sc1
  s_branch wb_43
wt_44:
  s_nop 7
  buffer_store_dwordx2 v[14:15], v9, s[8:11], s51 offen sc1
  s_branch wb_45
GO_CV:
ROLE_CV:
  v_lshlrev_b32 v1, 4, v0
  v_and_b32 v12, 1, v0
  v_mul_u32_u24 v2, 0xaaaa, v12
  v_add_u32 v2, 0x4444, v2
  s_mov_b32 s56, s48
  s_lshr_b32 s60, s56, 3
  s_mul_i32 s55, s60, 524288
  s_add_u32 s55, s55, 2097152
  s_mul_i32 s59, s46, 3
  s_min_u32 s59, s59, 7
  s_lshl_b32 s59, s59, 10
  v_and_b32 v3, 3, v0
  v_lshlrev_b32 v3, 3, v3
  v_bfe_u32 v14, v0, 2, 1
  v_lshl_add_u32 v3, v14, 10, v3
  v_lshrrev_b32 v12, 4, v0
  v_and_b32 v13, 15, v0
  v_mul_u32_u24 v5, 832, v12
  v_lshl_add_u32 v5, v13, 3, v5
  s_lshl_b32 s60, s46, 7
  s_add_u32 s60, s60, 116736
  v_add_u32 v4, s60, v5
  s_lshr_b32 s60, s46, 1
  s_lshl_b32 s60, s60, 7
  s_and_b32 s61, s46, 1
  s_lshl_b32 s61, s61, 1
  s_add_u32 s60, s60, s61
  s_add_u32 s60, s60, 117248
  v_add_u32 v5, s60, v5
  v_bfe_u32 v6, v0, 2, 3
  v_lshrrev_b32 v15, 5, v0
  v_lshl_add_u32 v6, v15, 4, v6
  v_lshlrev_b32 v6, 3, v6
  v_and_b32 v15, 3, v0
  v_mul_u32_u24 v15, 832, v15
  v_add_u32 v6, v6, v15
  v_add_u32 v6, 116736, v6
  s_mul_i32 s60, s46, 26624
  v_add_u32 v8, s60, v1
  v_add_u32 v9, 106496, v1
  v_add_u32 v10, s59, v9
  s_and_b32 s60, s56, 7
  s_lshl_b32 s60, s60, 8
  s_mul_i32 s61, s46, 20480
  s_add_u32 s60, s60, s61
  s_add_u32 s60, s60, 40960
  v_lshl_add_u32 v7, v13, 4, s60
  v_bfe_u32 v14, v0, 4, 1
  v_lshl_add_u32 v7, v14, 3, v7
  v_lshrrev_b32 v14, 5, v0
  v_lshl_add_u32 v7, v14, 11, v7
  v_mov_b64 v[20:21], -1
  s_add_u32 s60, s55, 0
  buffer_store_dwordx2 v[20:21], v7, s[8:11], s60 offen sc1
  s_add_u32 s60, s55, 4096
  buffer_store_dwordx2 v[20:21], v7, s[8:11], s60 offen sc1
  s_add_u32 s60, s55, 8192
  buffer_store_dwordx2 v[20:21], v7, s[8:11], s60 offen sc1
  s_add_u32 s60, s55, 12288
  buffer_store_dwordx2 v[20:21], v7, s[8:11], s60 offen sc1
  s_add_u32 s60, s55, 16384
  buffer_store_dwordx2 v[20:21], v7, s[8:11], s60 offen sc1
  s_add_u32 s60, s55, 131072
  buffer_store_dwordx2 v[20:21], v7, s[8:11], s60 offen sc1
  s_add_u32 s60, s55, 135168
  buffer_store_dwordx2 v[20:21], v7, s[8:11], s60 offen sc1
  s_add_u32 s60, s55, 139264
  buffer_store_dwordx2 v[20:21], v7, s[8:11], s60 offen sc1
  s_add_u32 s60, s55, 143360
  buffer_store_dwordx2 v[20:21], v7, s[8:11], s60 offen sc1
  s_add_u32 s60, s55, 147456
  buffer_store_dwordx2 v[20:21], v7, s[8:11], s60 offen sc1
  s_add_u32 s60, s55, 262144
  buffer_store_dwordx2 v[20:21], v7, s[8:11], s60 offen sc1
  s_add_u32 s60, s55, 266240
  buffer_store_dwordx2 v[20:21], v7, s[8:11], s60 offen sc1
  s_add_u32 s60, s55, 270336
  buffer_store_dwordx2 v[20:21], v7, s[8:11], s60 offen sc1
  s_add_u32 s60, s55, 274432
  buffer_store_dwordx2 v[20:21], v7, s[8:11], s60 offen sc1
  s_add_u32 s60, s55, 278528
  buffer_store_dwordx2 v[20:21], v7, s[8:11], s60 offen sc1
  s_add_u32 s60, s55, 393216
  buffer_store_dwordx2 v[20:21], v7, s[8:11], s60 offen sc1
  s_add_u32 s60, s55, 397312
  buffer_store_dwordx2 v[20:21], v7, s[8:11], s60 offen sc1
  s_add_u32 s60, s55, 401408
  buffer_store_dwordx2 v[20:21], v7, s[8:11], s60 offen sc1
  s_add_u32 s60, s55, 405504
  buffer_store_dwordx2 v[20:21], v7, s[8:11], s60 offen sc1
  s_add_u32 s60, s55, 409600
  buffer_store_dwordx2 v[20:21], v7, s[8:11], s60 offen sc1
  s_waitcnt vmcnt(0)
  s_barrier
  s_cmp_lg_u32 s46, 0
  s_cbranch_scc1 arr_57
  v_mov_b32 v12, 1
  s_lshl_b32 s3, s49, 2
  v_mov_b32 v13, s3
  s_mov_b64 exec, 1
  buffer_atomic_add v12, v13, s[12:15], 0 offen sc1
  s_mov_b64 exec, -1
arr_57:
  v_add_u32 v16, 0, v0
  v_mul_u32_u24 v17, 2731, v16
  v_lshrrev_b32 v17, 16, v17
  v_mul_u32_u24 v12, 11904, v17
  v_lshl_add_u32 v12, v16, 4, v12
  v_add_u32 v16, 64, v0
  v_mul_u32_u24 v17, 2731, v16
  v_lshrrev_b32 v17, 16, v17
  v_mul_u32_u24 v13, 11904, v17
  v_lshl_add_u32 v13, v16, 4, v13
  v_add_u32 v16, 128, v0
  v_mul_u32_u24 v17, 2731, v16
  v_lshrrev_b32 v17, 16, v17
  v_mul_u32_u24 v14, 11904, v17
  v_lshl_add_u32 v14, v16, 4, v14
  v_bfe_u32 v19, v0, 2, 1
  v_bfe_u32 v128, v0, 4, 1
  v_lshl_add_u32 v19, v128, 5, v19
  v_bfe_u32 v128, v0, 3, 1
  v_lshl_add_u32 v19, v128, 4, v19
  v_lshrrev_b32 v128, 5, v0
  v_lshl_add_u32 v19, v128, 2, v19
  v_mul_u32_u24 v19, 384, v19
  v_and_b32 v128, 3, v0
  v_lshl_add_u32 v19, v128, 3, v19
  s_lshl_b32 s60, s46, 6
  v_add_u32 v18, s60, v19
  s_lshl_b32 s60, s46, 5
  v_add_u32 v19, s60, v19
  v_bfe_u32 v128, v0, 2, 1
  v_bfe_u32 v20, v0, 4, 1
  v_lshl_add_u32 v128, v20, 3, v128
  v_bfe_u32 v20, v0, 3, 1
  v_lshl_add_u32 v128, v20, 4, v128
  v_lshrrev_b32 v20, 5, v0
  v_lshl_add_u32 v128, v20, 2, v128
  v_mul_u32_u24 v128, 1280, v128
  v_and_b32 v20, 3, v0
  v_lshl_add_u32 v128, v20, 3, v128
  s_mul_i32 s60, s46, 320
  v_add_u32 v128, s60, v128
  s_mov_b32 s4, s24
  s_mov_b32 s5, s25
  s_mov_b32 s6, 7864320
  s_mov_b32 s7, 0x20000
  s_mul_i32 s60, s46, 393216
  s_mul_i32 s61, s56, 384
  s_add_u32 s62, s60, s61
  s_mul_i32 s60, s46, 10240
  s_mul_i32 s61, s56, 245760
  s_add_u32 s61, s60, s61
  s_mul_i32 s63, s46, 12288
  s_mul_i32 s65, s46, 10240
  s_add_u32 s64, s62, 0
  s_add_u32 m0, s63, 0
  s_nop 0
  buffer_load_dwordx4 v12, s[4:7], s64 offen lds
  s_add_u32 m0, s63, 1024
  s_nop 0
  buffer_load_dwordx4 v13, s[4:7], s64 offen lds
  s_add_u32 m0, s63, 2048
  s_nop 0
  buffer_load_dwordx4 v14, s[4:7], s64 offen lds
  s_add_u32 s64, s62, 98304
  s_add_u32 m0, s63, 3072
  s_nop 0
  buffer_load_dwordx4 v12, s[4:7], s64 offen lds
  s_add_u32 m0, s63, 4096
  s_nop 0
  buffer_load_dwordx4 v13, s[4:7], s64 offen lds
  s_add_u32 m0, s63, 5120
  s_nop 0
  buffer_load_dwordx4 v14, s[4:7], s64 offen lds
  s_add_u32 s64, s62, 196608
  s_add_u32 m0, s63, 6144
  s_nop 0
  buffer_load_dwordx4 v12, s[4:7], s64 offen lds
  s_add_u32 m0, s63, 7168
  s_nop 0
  buffer_load_dwordx4 v13, s[4:7], s64 offen lds
  s_add_u32 m0, s63, 8192
  s_nop 0
  buffer_load_dwordx4 v14, s[4:7], s64 offen lds
  s_add_u32 s64, s62, 294912
  s_add_u32 m0, s63, 9216
  s_nop 0
  buffer_load_dwordx4 v12, s[4:7], s64 offen lds
  s_add_u32 m0, s63, 10240
  s_nop 0
  buffer_load_dwordx4 v13, s[4:7], s64 offen lds
  s_add_u32 m0, s63, 11264
  s_nop 0
  buffer_load_dwordx4 v14, s[4:7], s64 offen lds
  s_add_u32 s64, s62, 1572864
  s_add_u32 m0, s63, 49152
  s_nop 0
  buffer_load_dwordx4 v12, s[4:7], s64 offen lds
  s_add_u32 m0, s63, 50176
  s_nop 0
  buffer_load_dwordx4 v13, s[4:7], s64 offen lds
  s_add_u32 m0, s63, 51200
  s_nop 0
  buffer_load_dwordx4 v14, s[4:7], s64 offen lds
  s_add_u32 s64, s62, 1671168
  s_add_u32 m0, s63, 52224
  s_nop 0
  buffer_load_dwordx4 v12, s[4:7], s64 offen lds
  s_add_u32 m0, s63, 53248
  s_nop 0
  buffer_load_dwordx4 v13, s[4:7], s64 offen lds
  s_add_u32 m0, s63, 54272
  s_nop 0
  buffer_load_dwordx4 v14, s[4:7], s64 offen lds
  s_add_u32 s64, s62, 1769472
  s_add_u32 m0, s63, 55296
  s_nop 0
  buffer_load_dwordx4 v12, s[4:7], s64 offen lds
  s_add_u32 m0, s63, 56320
  s_nop 0
  buffer_load_dwordx4 v13, s[4:7], s64 offen lds
  s_add_u32 m0, s63, 57344
  s_nop 0
  buffer_load_dwordx4 v14, s[4:7], s64 offen lds
  s_add_u32 s64, s62, 1867776
  s_add_u32 m0, s63, 58368
  s_nop 0
  buffer_load_dwordx4 v12, s[4:7], s64 offen lds
  s_add_u32 m0, s63, 59392
  s_nop 0
  buffer_load_dwordx4 v13, s[4:7], s64 offen lds
  s_add_u32 m0, s63, 60416
  s_nop 0
  buffer_load_dwordx4 v14, s[4:7], s64 offen lds
  s_add_u32 s64, s62, 3145728
  s_add_u32 m0, s63, 98304
  s_nop 0
  buffer_load_dwordx4 v12, s[4:7], s64 offen lds
  s_add_u32 m0, s63, 99328
  s_nop 0
  buffer_load_dwordx4 v13, s[4:7], s64 offen lds
  s_add_u32 m0, s63, 100352
  s_nop 0
  buffer_load_dwordx4 v14, s[4:7], s64 offen lds
  s_add_u32 s64, s62, 3244032
  s_add_u32 m0, s63, 101376
  s_nop 0
  buffer_load_dwordx4 v12, s[4:7], s64 offen lds
  s_add_u32 m0, s63, 102400
  s_nop 0
  buffer_load_dwordx4 v13, s[4:7], s64 offen lds
  s_add_u32 m0, s63, 103424
  s_nop 0
  buffer_load_dwordx4 v14, s[4:7], s64 offen lds
  s_add_u32 s64, s62, 3342336
  s_add_u32 m0, s63, 104448
  s_nop 0
  buffer_load_dwordx4 v12, s[4:7], s64 offen lds
  s_add_u32 m0, s63, 105472
  s_nop 0
  buffer_load_dwordx4 v13, s[4:7], s64 offen lds
  s_add_u32 m0, s63, 106496
  s_nop 0
  buffer_load_dwordx4 v14, s[4:7], s64 offen lds
  s_add_u32 s64, s62, 3440640
  s_add_u32 m0, s63, 107520
  s_nop 0
  buffer_load_dwordx4 v12, s[4:7], s64 offen lds
  s_add_u32 m0, s63, 108544
  s_nop 0
  buffer_load_dwordx4 v13, s[4:7], s64 offen lds
  s_add_u32 m0, s63, 109568
  s_nop 0
  buffer_load_dwordx4 v14, s[4:7], s64 offen lds
  s_waitcnt vmcnt(24)
  s_barrier
  v_add_u32 v15, 0, v18
  ds_read_b64_tr_b16 a[0:1], v15 offset:0
  ds_read_b64_tr_b16 a[2:3], v15 offset:768
  ds_read_b64_tr_b16 a[4:5], v15 offset:3072
  ds_read_b64_tr_b16 a[6:7], v15 offset:3840
  ds_read_b64_tr_b16 a[8:9], v15 offset:32
  ds_read_b64_tr_b16 a[10:11], v15 offset:800
  ds_read_b64_tr_b16 a[12:13], v15 offset:3104
  ds_read_b64_tr_b16 a[14:15], v15 offset:3872
  ds_read_b64_tr_b16 a[16:17], v15 offset:24576
  ds_read_b64_tr_b16 a[18:19], v15 offset:25344
  ds_read_b64_tr_b16 a[20:21], v15 offset:27648
  ds_read_b64_tr_b16 a[22:23], v15 offset:28416
  s_waitcnt lgkmcnt(3)
  ds_read_b64_tr_b16 a[24:25], v15 offset:24608
  ds_read_b64_tr_b16 a[26:27], v15 offset:25376
  ds_read_b64_tr_b16 a[28:29], v15 offset:27680
  ds_read_b64_tr_b16 a[30:31], v15 offset:28448
  v_add_u32 v16, 0, v19
  ds_read_b64_tr_b16 v[20:21], v16 offset:256
  ds_read_b64_tr_b16 v[22:23], v16 offset:1024
  ds_read_b64_tr_b16 v[24:25], v16 offset:3328
  ds_read_b64_tr_b16 v[26:27], v16 offset:4096
  ds_read_b64_tr_b16 v[28:29], v16 offset:24832
  ds_read_b64_tr_b16 v[30:31], v16 offset:25600
  ds_read_b64_tr_b16 v[32:33], v16 offset:27904
  ds_read_b64_tr_b16 v[34:35], v16 offset:28672
  s_waitcnt lgkmcnt(3)
  s_waitcnt lgkmcnt(0)
  s_barrier
  s_add_u32 s64, s62, 4718592
  s_add_u32 m0, s63, 0
  s_nop 0
  buffer_load_dwordx4 v12, s[4:7], s64 offen lds
  s_add_u32 m0, s63, 1024
  s_nop 0
  buffer_load_dwordx4 v13, s[4:7], s64 offen lds
  s_add_u32 m0, s63, 2048
  s_nop 0
  buffer_load_dwordx4 v14, s[4:7], s64 offen lds
  s_add_u32 s64, s62, 4816896
  s_add_u32 m0, s63, 3072
  s_nop 0
  buffer_load_dwordx4 v12, s[4:7], s64 offen lds
  s_add_u32 m0, s63, 4096
  s_nop 0
  buffer_load_dwordx4 v13, s[4:7], s64 offen lds
  s_add_u32 m0, s63, 5120
  s_nop 0
  buffer_load_dwordx4 v14, s[4:7], s64 offen lds
  s_add_u32 s64, s62, 4915200
  s_add_u32 m0, s63, 6144
  s_nop 0
  buffer_load_dwordx4 v12, s[4:7], s64 offen lds
  s_add_u32 m0, s63, 7168
  s_nop 0
  buffer_load_dwordx4 v13, s[4:7], s64 offen lds
  s_add_u32 m0, s63, 8192
  s_nop 0
  buffer_load_dwordx4 v14, s[4:7], s64 offen lds
  s_add_u32 s64, s62, 5013504
  s_add_u32 m0, s63, 9216
  s_nop 0
  buffer_load_dwordx4 v12, s[4:7], s64 offen lds
  s_add_u32 m0, s63, 10240
  s_nop 0
  buffer_load_dwordx4 v13, s[4:7], s64 offen lds
  s_add_u32 m0, s63, 11264
  s_nop 0
  buffer_load_dwordx4 v14, s[4:7], s64 offen lds
  s_waitcnt vmcnt(24)
  s_barrier
  v_add_u32 v15, 49152, v18
  ds_read_b64_tr_b16 a[32:33], v15 offset:0
  ds_read_b64_tr_b16 a[34:35], v15 offset:768
  ds_read_b64_tr_b16 a[36:37], v15 offset:3072
  ds_read_b64_tr_b16 a[38:39], v15 offset:3840
  ds_read_b64_tr_b16 a[40:41], v15 offset:32
  ds_read_b64_tr_b16 a[42:43], v15 offset:800
  ds_read_b64_tr_b16 a[44:45], v15 offset:3104
  ds_read_b64_tr_b16 a[46:47], v15 offset:3872
  ds_read_b64_tr_b16 a[48:49], v15 offset:24576
  ds_read_b64_tr_b16 a[50:51], v15 offset:25344
  ds_read_b64_tr_b16 a[52:53], v15 offset:27648
  ds_read_b64_tr_b16 a[54:55], v15 offset:28416
  s_waitcnt lgkmcnt(3)
  ds_read_b64_tr_b16 a[56:57], v15 offset:24608
  ds_read_b64_tr_b16 a[58:59], v15 offset:25376
  ds_read_b64_tr_b16 a[60:61], v15 offset:27680
  ds_read_b64_tr_b16 a[62:63], v15 offset:28448
  v_add_u32 v16, 49152, v19
  ds_read_b64_tr_b16 v[36:37], v16 offset:256
  ds_read_b64_tr_b16 v[38:39], v16 offset:1024
  ds_read_b64_tr_b16 v[40:41], v16 offset:3328
  ds_read_b64_tr_b16 v[42:43], v16 offset:4096
  ds_read_b64_tr_b16 v[44:45], v16 offset:24832
  ds_read_b64_tr_b16 v[46:47], v16 offset:25600
  ds_read_b64_tr_b16 v[48:49], v16 offset:27904
  ds_read_b64_tr_b16 v[50:51], v16 offset:28672
  s_waitcnt lgkmcnt(3)
  s_waitcnt lgkmcnt(0)
  s_barrier
  s_add_u32 s64, s62, 6291456
  s_add_u32 m0, s63, 49152
  s_nop 0
  buffer_load_dwordx4 v12, s[4:7], s64 offen lds
  s_add_u32 m0, s63, 50176
  s_nop 0
  buffer_load_dwordx4 v13, s[4:7], s64 offen lds
  s_add_u32 m0, s63, 51200
  s_nop 0
  buffer_load_dwordx4 v14, s[4:7], s64 offen lds
  s_add_u32 s64, s62, 6389760
  s_add_u32 m0, s63, 52224
  s_nop 0
  buffer_load_dwordx4 v12, s[4:7], s64 offen lds
  s_add_u32 m0, s63, 53248
  s_nop 0
  buffer_load_dwordx4 v13, s[4:7], s64 offen lds
  s_add_u32 m0, s63, 54272
  s_nop 0
  buffer_load_dwordx4 v14, s[4:7], s64 offen lds
  s_add_u32 s64, s62, 6488064
  s_add_u32 m0, s63, 55296
  s_nop 0
  buffer_load_dwordx4 v12, s[4:7], s64 offen lds
  s_add_u32 m0, s63, 56320
  s_nop 0
  buffer_load_dwordx4 v13, s[4:7], s64 offen lds
  s_add_u32 m0, s63, 57344
  s_nop 0
  buffer_load_dwordx4 v14, s[4:7], s64 offen lds
  s_add_u32 s64, s62, 6586368
  s_add_u32 m0, s63, 58368
  s_nop 0
  buffer_load_dwordx4 v12, s[4:7], s64 offen lds
  s_add_u32 m0, s63, 59392
  s_nop 0
  buffer_load_dwordx4 v13, s[4:7], s64 offen lds
  s_add_u32 m0, s63, 60416
  s_nop 0
  buffer_load_dwordx4 v14, s[4:7], s64 offen lds
  s_waitcnt vmcnt(24)
  s_barrier
  v_add_u32 v15, 98304, v18
  ds_read_b64_tr_b16 a[64:65], v15 offset:0
  ds_read_b64_tr_b16 a[66:67], v15 offset:768
  ds_read_b64_tr_b16 a[68:69], v15 offset:3072
  ds_read_b64_tr_b16 a[70:71], v15 offset:3840
  ds_read_b64_tr_b16 a[72:73], v15 offset:32
  ds_read_b64_tr_b16 a[74:75], v15 offset:800
  ds_read_b64_tr_b16 a[76:77], v15 offset:3104
  ds_read_b64_tr_b16 a[78:79], v15 offset:3872
  ds_read_b64_tr_b16 a[80:81], v15 offset:24576
  ds_read_b64_tr_b16 a[82:83], v15 offset:25344
  ds_read_b64_tr_b16 a[84:85], v15 offset:27648
  ds_read_b64_tr_b16 a[86:87], v15 offset:28416
  s_waitcnt lgkmcnt(3)
  ds_read_b64_tr_b16 a[88:89], v15 offset:24608
  ds_read_b64_tr_b16 a[90:91], v15 offset:25376
  ds_read_b64_tr_b16 a[92:93], v15 offset:27680
  ds_read_b64_tr_b16 a[94:95], v15 offset:28448
  v_add_u32 v16, 98304, v19
  ds_read_b64_tr_b16 v[52:53], v16 offset:256
  ds_read_b64_tr_b16 v[54:55], v16 offset:1024
  ds_read_b64_tr_b16 v[56:57], v16 offset:3328
  ds_read_b64_tr_b16 v[58:59], v16 offset:4096
  ds_read_b64_tr_b16 v[60:61], v16 offset:24832
  ds_read_b64_tr_b16 v[62:63], v16 offset:25600
  ds_read_b64_tr_b16 v[64:65], v16 offset:27904
  ds_read_b64_tr_b16 v[66:67], v16 offset:28672
  s_waitcnt lgkmcnt(3)
  s_waitcnt lgkmcnt(0)
  s_barrier
  s_mov_b32 s4, s26
  s_mov_b32 s5, s27
  s_mov_b32 s6, 7864320
  s_mov_b32 s7, 0x20000
  s_add_u32 s64, s61, 0
  s_add_u32 m0, s65, 98304
  s_nop 0
  buffer_load_dwordx4 v1, s[4:7], s64 offen offset:0 lds
  buffer_load_dwordx4 v1, s[4:7], s64 offen offset:1024 lds
  buffer_load_dwordx4 v1, s[4:7], s64 offen offset:2048 lds
  buffer_load_dwordx4 v1, s[4:7], s64 offen offset:3072 lds
  s_add_u32 s64, s61, 4096
  s_add_u32 m0, s65, 102400
  s_nop 0
  buffer_load_dwordx4 v1, s[4:7], s64 offen offset:0 lds
  buffer_load_dwordx4 v1, s[4:7], s64 offen offset:1024 lds
  buffer_load_dwordx4 v1, s[4:7], s64 offen offset:2048 lds
  buffer_load_dwordx4 v1, s[4:7], s64 offen offset:3072 lds
  s_add_u32 s64, s61, 8192
  s_add_u32 m0, s65, 106496
  s_nop 0
  buffer_load_dwordx4 v1, s[4:7], s64 offen offset:0 lds
  buffer_load_dwordx4 v1, s[4:7], s64 offen offset:1024 lds
  s_waitcnt vmcnt(22)
  s_barrier
  v_add_u32 v15, 0, v18
  ds_read_b64_tr_b16 a[96:97], v15 offset:0
  ds_read_b64_tr_b16 a[98:99], v15 offset:768
  ds_read_b64_tr_b16 a[100:101], v15 offset:3072
  ds_read_b64_tr_b16 a[102:103], v15 offset:3840
  ds_read_b64_tr_b16 a[104:105], v15 offset:32
  ds_read_b64_tr_b16 a[106:107], v15 offset:800
  ds_read_b64_tr_b16 a[108:109], v15 offset:3104
  ds_read_b64_tr_b16 a[110:111], v15 offset:3872
  ds_read_b64_tr_b16 a[112:113], v15 offset:24576
  ds_read_b64_tr_b16 a[114:115], v15 offset:25344
  ds_read_b64_tr_b16 a[116:117], v15 offset:27648
  ds_read_b64_tr_b16 a[118:119], v15 offset:28416
  s_waitcnt lgkmcnt(3)
  ds_read_b64_tr_b16 a[120:121], v15 offset:24608
  ds_read_b64_tr_b16 a[122:123], v15 offset:25376
  ds_read_b64_tr_b16 a[124:125], v15 offset:27680
  ds_read_b64_tr_b16 a[126:127], v15 offset:28448
  v_add_u32 v16, 0, v19
  ds_read_b64_tr_b16 v[68:69], v16 offset:256
  ds_read_b64_tr_b16 v[70:71], v16 offset:1024
  ds_read_b64_tr_b16 v[72:73], v16 offset:3328
  ds_read_b64_tr_b16 v[74:75], v16 offset:4096
  ds_read_b64_tr_b16 v[76:77], v16 offset:24832
  ds_read_b64_tr_b16 v[78:79], v16 offset:25600
  ds_read_b64_tr_b16 v[80:81], v16 offset:27904
  ds_read_b64_tr_b16 v[82:83], v16 offset:28672
  s_waitcnt lgkmcnt(3)
  s_waitcnt lgkmcnt(0)
  s_barrier
  s_add_u32 s64, s61, 40960
  s_add_u32 m0, s65, 0
  s_nop 0
  buffer_load_dwordx4 v1, s[4:7], s64 offen offset:0 lds
  buffer_load_dwordx4 v1, s[4:7], s64 offen offset:1024 lds
  buffer_load_dwordx4 v1, s[4:7], s64 offen offset:2048 lds
  buffer_load_dwordx4 v1, s[4:7], s64 offen offset:3072 lds
  s_add_u32 s64, s61, 45056
  s_add_u32 m0, s65, 4096
  s_nop 0
  buffer_load_dwordx4 v1, s[4:7], s64 offen offset:0 lds
  buffer_load_dwordx4 v1, s[4:7], s64 offen offset:1024 lds
  buffer_load_dwordx4 v1, s[4:7], s64 offen offset:2048 lds
  buffer_load_dwordx4 v1, s[4:7], s64 offen offset:3072 lds
  s_add_u32 s64, s61, 49152
  s_add_u32 m0, s65, 8192
  s_nop 0
  buffer_load_dwordx4 v1, s[4:7], s64 offen offset:0 lds
  buffer_load_dwordx4 v1, s[4:7], s64 offen offset:1024 lds
  s_waitcnt vmcnt(20)
  s_barrier
  v_add_u32 v15, 49152, v18
  ds_read_b64_tr_b16 a[128:129], v15 offset:0
  ds_read_b64_tr_b16 a[130:131], v15 offset:768
  ds_read_b64_tr_b16 a[132:133], v15 offset:3072
  ds_read_b64_tr_b16 a[134:135], v15 offset:3840
  ds_read_b64_tr_b16 a[136:137], v15 offset:32
  ds_read_b64_tr_b16 a[138:139], v15 offset:800
  ds_read_b64_tr_b16 a[140:141], v15 offset:3104
  ds_read_b64_tr_b16 a[142:143], v15 offset:3872
  ds_read_b64_tr_b16 a[144:145], v15 offset:24576
  ds_read_b64_tr_b16 a[146:147], v15 offset:25344
  ds_read_b64_tr_b16 a[148:149], v15 offset:27648
  ds_read_b64_tr_b16 a[150:151], v15 offset:28416
  s_waitcnt lgkmcnt(3)
  ds_read_b64_tr_b16 a[152:153], v15 offset:24608
  ds_read_b64_tr_b16 a[154:155], v15 offset:25376
  ds_read_b64_tr_b16 a[156:157], v15 offset:27680
  ds_read_b64_tr_b16 a[158:159], v15 offset:28448
  v_add_u32 v16, 49152, v19
  ds_read_b64_tr_b16 v[84:85], v16 offset:256
  ds_read_b64_tr_b16 v[86:87], v16 offset:1024
  ds_read_b64_tr_b16 v[88:89], v16 offset:3328
  ds_read_b64_tr_b16 v[90:91], v16 offset:4096
  ds_read_b64_tr_b16 v[92:93], v16 offset:24832
  ds_read_b64_tr_b16 v[94:95], v16 offset:25600
  ds_read_b64_tr_b16 v[96:97], v16 offset:27904
  ds_read_b64_tr_b16 v[98:99], v16 offset:28672
  s_waitcnt lgkmcnt(3)
  s_waitcnt lgkmcnt(0)
  s_barrier
  s_add_u32 s64, s61, 81920
  s_add_u32 m0, s65, 49152
  s_nop 0
  buffer_load_dwordx4 v1, s[4:7], s64 offen offset:0 lds
  buffer_load_dwordx4 v1, s[4:7], s64 offen offset:1024 lds
  buffer_load_dwordx4 v1, s[4:7], s64 offen offset:2048 lds
  buffer_load_dwordx4 v1, s[4:7], s64 offen offset:3072 lds
  s_add_u32 s64, s61, 86016
  s_add_u32 m0, s65, 53248
  s_nop 0
  buffer_load_dwordx4 v1, s[4:7], s64 offen offset:0 lds
  buffer_load_dwordx4 v1, s[4:7], s64 offen offset:1024 lds
  buffer_load_dwordx4 v1, s[4:7], s64 offen offset:2048 lds
  buffer_load_dwordx4 v1, s[4:7], s64 offen offset:3072 lds
  s_add_u32 s64, s61, 90112
  s_add_u32 m0, s65, 57344
  s_nop 0
  buffer_load_dwordx4 v1, s[4:7], s64 offen offset:0 lds
  buffer_load_dwordx4 v1, s[4:7], s64 offen offset:1024 lds
  s_waitcnt vmcnt(20)
  s_barrier
  v_add_u32 v15, 98304, v128
  ds_read_b64_tr_b16 a[160:161], v15 offset:0
  ds_read_b64_tr_b16 a[162:163], v15 offset:2560
  ds_read_b64_tr_b16 a[168:169], v15 offset:32
  ds_read_b64_tr_b16 a[170:171], v15 offset:2592
  ds_read_b64_tr_b16 a[176:177], v15 offset:64
  ds_read_b64_tr_b16 a[178:179], v15 offset:2624
  ds_read_b64_tr_b16 a[184:185], v15 offset:96
  ds_read_b64_tr_b16 a[186:187], v15 offset:2656
  ds_read_b64_tr_b16 a[192:193], v15 offset:128
  ds_read_b64_tr_b16 a[194:195], v15 offset:2688
  ds_read_b64_tr_b16 a[200:201], v15 offset:160
  ds_read_b64_tr_b16 a[202:203], v15 offset:2720
  s_waitcnt lgkmcnt(3)
  ds_read_b64_tr_b16 a[208:209], v15 offset:192
  ds_read_b64_tr_b16 a[210:211], v15 offset:2752
  ds_read_b64_tr_b16 a[216:217], v15 offset:224
  ds_read_b64_tr_b16 a[218:219], v15 offset:2784
  ds_read_b64_tr_b16 a[224:225], v15 offset:256
  ds_read_b64_tr_b16 a[226:227], v15 offset:2816
  ds_read_b64_tr_b16 a[232:233], v15 offset:288
  ds_read_b64_tr_b16 a[234:235], v15 offset:2848
  s_waitcnt lgkmcnt(0)
  s_barrier
  s_add_u32 s64, s61, 122880
  s_add_u32 m0, s65, 98304
  s_nop 0
  buffer_load_dwordx4 v1, s[4:7], s64 offen offset:0 lds
  buffer_load_dwordx4 v1, s[4:7], s64 offen offset:1024 lds
  buffer_load_dwordx4 v1, s[4:7], s64 offen offset:2048 lds
  buffer_load_dwordx4 v1, s[4:7], s64 offen offset:3072 lds
  s_add_u32 s64, s61, 126976
  s_add_u32 m0, s65, 102400
  s_nop 0
  buffer_load_dwordx4 v1, s[4:7], s64 offen offset:0 lds
  buffer_load_dwordx4 v1, s[4:7], s64 offen offset:1024 lds
  buffer_load_dwordx4 v1, s[4:7], s64 offen offset:2048 lds
  buffer_load_dwordx4 v1, s[4:7], s64 offen offset:3072 lds
  s_add_u32 s64, s61, 131072
  s_add_u32 m0, s65, 106496
  s_nop 0
  buffer_load_dwordx4 v1, s[4:7], s64 offen offset:0 lds
  buffer_load_dwordx4 v1, s[4:7], s64 offen offset:1024 lds
  s_waitcnt vmcnt(20)
  s_barrier
  v_add_u32 v15, 0, v128
  ds_read_b64_tr_b16 a[164:165], v15 offset:0
  ds_read_b64_tr_b16 a[166:167], v15 offset:2560
  ds_read_b64_tr_b16 a[172:173], v15 offset:32
  ds_read_b64_tr_b16 a[174:175], v15 offset:2592
  ds_read_b64_tr_b16 a[180:181], v15 offset:64
  ds_read_b64_tr_b16 a[182:183], v15 offset:2624
  ds_read_b64_tr_b16 a[188:189], v15 offset:96
  ds_read_b64_tr_b16 a[190:191], v15 offset:2656
  ds_read_b64_tr_b16 a[196:197], v15 offset:128
  ds_read_b64_tr_b16 a[198:199], v15 offset:2688
  ds_read_b64_tr_b16 a[204:205], v15 offset:160
  ds_read_b64_tr_b16 a[206:207], v15 offset:2720
  s_waitcnt lgkmcnt(3)
  ds_read_b64_tr_b16 a[212:213], v15 offset:192
  ds_read_b64_tr_b16 a[214:215], v15 offset:2752
  ds_read_b64_tr_b16 a[220:221], v15 offset:224
  ds_read_b64_tr_b16 a[222:223], v15 offset:2784
  ds_read_b64_tr_b16 a[228:229], v15 offset:256
  ds_read_b64_tr_b16 a[230:231], v15 offset:2816
  ds_read_b64_tr_b16 a[236:237], v15 offset:288
  ds_read_b64_tr_b16 a[238:239], v15 offset:2848
  s_waitcnt lgkmcnt(0)
  s_barrier
  s_add_u32 s64, s61, 163840
  s_add_u32 m0, s65, 0
  s_nop 0
  buffer_load_dwordx4 v1, s[4:7], s64 offen offset:0 lds
  buffer_load_dwordx4 v1, s[4:7], s64 offen offset:1024 lds
  buffer_load_dwordx4 v1, s[4:7], s64 offen offset:2048 lds
  buffer_load_dwordx4 v1, s[4:7], s64 offen offset:3072 lds
  s_add_u32 s64, s61, 167936
  s_add_u32 m0, s65, 4096
  s_nop 0
  buffer_load_dwordx4 v1, s[4:7], s64 offen offset:0 lds
  buffer_load_dwordx4 v1, s[4:7], s64 offen offset:1024 lds
  buffer_load_dwordx4 v1, s[4:7], s64 offen offset:2048 lds
  buffer_load_dwordx4 v1, s[4:7], s64 offen offset:3072 lds
  s_add_u32 s64, s61, 172032
  s_add_u32 m0, s65, 8192
  s_nop 0
  buffer_load_dwordx4 v1, s[4:7], s64 offen offset:0 lds
  buffer_load_dwordx4 v1, s[4:7], s64 offen offset:1024 lds
  s_waitcnt vmcnt(20)
  s_barrier
  v_add_u32 v15, 49152, v128
  ds_read_b64_tr_b16 a[240:241], v15 offset:0
  ds_read_b64_tr_b16 a[242:243], v15 offset:2560
  ds_read_b64_tr_b16 a[248:249], v15 offset:32
  ds_read_b64_tr_b16 a[250:251], v15 offset:2592
  ds_read_b64_tr_b16 v[136:137], v15 offset:64
  ds_read_b64_tr_b16 v[138:139], v15 offset:2624
  ds_read_b64_tr_b16 v[144:145], v15 offset:96
  ds_read_b64_tr_b16 v[146:147], v15 offset:2656
  ds_read_b64_tr_b16 v[152:153], v15 offset:128
  ds_read_b64_tr_b16 v[154:155], v15 offset:2688
  ds_read_b64_tr_b16 v[160:161], v15 offset:160
  ds_read_b64_tr_b16 v[162:163], v15 offset:2720
  s_waitcnt lgkmcnt(3)
  ds_read_b64_tr_b16 v[168:169], v15 offset:192
  ds_read_b64_tr_b16 v[170:171], v15 offset:2752
  ds_read_b64_tr_b16 v[176:177], v15 offset:224
  ds_read_b64_tr_b16 v[178:179], v15 offset:2784
  ds_read_b64_tr_b16 v[184:185], v15 offset:256
  ds_read_b64_tr_b16 v[186:187], v15 offset:2816
  ds_read_b64_tr_b16 v[192:193], v15 offset:288
  ds_read_b64_tr_b16 v[194:195], v15 offset:2848
  s_waitcnt lgkmcnt(0)
  s_barrier
  s_add_u32 s64, s61, 204800
  s_add_u32 m0, s65, 49152
  s_nop 0
  buffer_load_dwordx4 v1, s[4:7], s64 offen offset:0 lds
  buffer_load_dwordx4 v1, s[4:7], s64 offen offset:1024 lds
  buffer_load_dwordx4 v1, s[4:7], s64 offen offset:2048 lds
  buffer_load_dwordx4 v1, s[4:7], s64 offen offset:3072 lds
  s_add_u32 s64, s61, 208896
  s_add_u32 m0, s65, 53248
  s_nop 0
  buffer_load_dwordx4 v1, s[4:7], s64 offen offset:0 lds
  buffer_load_dwordx4 v1, s[4:7], s64 offen offset:1024 lds
  buffer_load_dwordx4 v1, s[4:7], s64 offen offset:2048 lds
  buffer_load_dwordx4 v1, s[4:7], s64 offen offset:3072 lds
  s_add_u32 s64, s61, 212992
  s_add_u32 m0, s65, 57344
  s_nop 0
  buffer_load_dwordx4 v1, s[4:7], s64 offen offset:0 lds
  buffer_load_dwordx4 v1, s[4:7], s64 offen offset:1024 lds
  s_waitcnt vmcnt(20)
  s_barrier
  v_add_u32 v15, 98304, v128
  ds_read_b64_tr_b16 a[244:245], v15 offset:0
  ds_read_b64_tr_b16 a[246:247], v15 offset:2560
  ds_read_b64_tr_b16 a[252:253], v15 offset:32
  ds_read_b64_tr_b16 a[254:255], v15 offset:2592
  ds_read_b64_tr_b16 v[140:141], v15 offset:64
  ds_read_b64_tr_b16 v[142:143], v15 offset:2624
  ds_read_b64_tr_b16 v[148:149], v15 offset:96
  ds_read_b64_tr_b16 v[150:151], v15 offset:2656
  ds_read_b64_tr_b16 v[156:157], v15 offset:128
  ds_read_b64_tr_b16 v[158:159], v15 offset:2688
  ds_read_b64_tr_b16 v[164:165], v15 offset:160
  ds_read_b64_tr_b16 v[166:167], v15 offset:2720
  s_waitcnt lgkmcnt(3)
  ds_read_b64_tr_b16 v[172:173], v15 offset:192
  ds_read_b64_tr_b16 v[174:175], v15 offset:2752
  ds_read_b64_tr_b16 v[180:181], v15 offset:224
  ds_read_b64_tr_b16 v[182:183], v15 offset:2784
  ds_read_b64_tr_b16 v[188:189], v15 offset:256
  ds_read_b64_tr_b16 v[190:191], v15 offset:2816
  ds_read_b64_tr_b16 v[196:197], v15 offset:288
  ds_read_b64_tr_b16 v[198:199], v15 offset:2848
  s_waitcnt lgkmcnt(0)
  s_barrier
  s_waitcnt vmcnt(10)
  s_barrier
  v_add_u32 v15, 0, v128
  ds_read_b64_tr_b16 v[100:101], v15 offset:0
  ds_read_b64_tr_b16 v[102:103], v15 offset:2560
  ds_read_b64_tr_b16 v[108:109], v15 offset:32
  ds_read_b64_tr_b16 v[110:111], v15 offset:2592
  ds_read_b64_tr_b16 v[116:117], v15 offset:64
  ds_read_b64_tr_b16 v[118:119], v15 offset:2624
  ds_read_b64_tr_b16 v[200:201], v15 offset:96
  ds_read_b64_tr_b16 v[202:203], v15 offset:2656
  ds_read_b64_tr_b16 v[208:209], v15 offset:128
  ds_read_b64_tr_b16 v[210:211], v15 offset:2688
  ds_read_b64_tr_b16 v[216:217], v15 offset:160
  ds_read_b64_tr_b16 v[218:219], v15 offset:2720
  s_waitcnt lgkmcnt(3)
  ds_read_b64_tr_b16 v[224:225], v15 offset:192
  ds_read_b64_tr_b16 v[226:227], v15 offset:2752
  ds_read_b64_tr_b16 v[232:233], v15 offset:224
  ds_read_b64_tr_b16 v[234:235], v15 offset:2784
  ds_read_b64_tr_b16 v[240:241], v15 offset:256
  ds_read_b64_tr_b16 v[242:243], v15 offset:2816
  ds_read_b64_tr_b16 v[248:249], v15 offset:288
  ds_read_b64_tr_b16 v[250:251], v15 offset:2848
  s_waitcnt lgkmcnt(0)
  s_barrier
  s_waitcnt vmcnt(0)
  s_barrier
  v_add_u32 v15, 49152, v128
  ds_read_b64_tr_b16 v[104:105], v15 offset:0
  ds_read_b64_tr_b16 v[106:107], v15 offset:2560
  ds_read_b64_tr_b16 v[112:113], v15 offset:32
  ds_read_b64_tr_b16 v[114:115], v15 offset:2592
  ds_read_b64_tr_b16 v[120:121], v15 offset:64
  ds_read_b64_tr_b16 v[122:123], v15 offset:2624
  ds_read_b64_tr_b16 v[204:205], v15 offset:96
  ds_read_b64_tr_b16 v[206:207], v15 offset:2656
  ds_read_b64_tr_b16 v[212:213], v15 offset:128
  ds_read_b64_tr_b16 v[214:215], v15 offset:2688
  ds_read_b64_tr_b16 v[220:221], v15 offset:160
  ds_read_b64_tr_b16 v[222:223], v15 offset:2720
  s_waitcnt lgkmcnt(3)
  ds_read_b64_tr_b16 v[228:229], v15 offset:192
  ds_read_b64_tr_b16 v[230:231], v15 offset:2752
  ds_read_b64_tr_b16 v[236:237], v15 offset:224
  ds_read_b64_tr_b16 v[238:239], v15 offset:2784
  ds_read_b64_tr_b16 v[244:245], v15 offset:256
  ds_read_b64_tr_b16 v[246:247], v15 offset:2816
  ds_read_b64_tr_b16 v[252:253], v15 offset:288
  ds_read_b64_tr_b16 v[254:255], v15 offset:2848
  s_waitcnt lgkmcnt(0)
  s_barrier
  ds_write_b128 v8, v[20:23] offset:0
  ds_write_b128 v8, v[24:27] offset:1024
  ds_write_b128 v8, v[28:31] offset:2048
  ds_write_b128 v8, v[32:35] offset:3072
  ds_write_b128 v8, v[36:39] offset:4096
  ds_write_b128 v8, v[40:43] offset:5120
  ds_write_b128 v8, v[44:47] offset:6144
  ds_write_b128 v8, v[48:51] offset:7168
  s_waitcnt lgkmcnt(2)
  ds_write_b128 v8, v[52:55] offset:8192
  ds_write_b128 v8, v[56:59] offset:9216
  ds_write_b128 v8, v[60:63] offset:10240
  ds_write_b128 v8, v[64:67] offset:11264
  ds_write_b128 v8, v[68:71] offset:12288
  ds_write_b128 v8, v[72:75] offset:13312
  ds_write_b128 v8, v[76:79] offset:14336
  ds_write_b128 v8, v[80:83] offset:15360
  s_waitcnt lgkmcnt(2)
  ds_write_b128 v8, v[84:87] offset:16384
  ds_write_b128 v8, v[88:91] offset:17408
  ds_write_b128 v8, v[92:95] offset:18432
  ds_write_b128 v8, v[96:99] offset:19456
  ds_write_b128 v8, v[100:103] offset:20480
  ds_write_b128 v8, v[104:107] offset:21504
  ds_write_b128 v8, v[108:111] offset:22528
  ds_write_b128 v8, v[112:115] offset:23552
  s_waitcnt lgkmcnt(2)
  ds_write_b128 v8, v[116:119] offset:24576
  ds_write_b128 v8, v[120:123] offset:25600
  s_waitcnt lgkmcnt(0)
  s_lshl_b32 s3, s49, 2
  v_mov_b32 v13, s3
  s_nop 1
ibw_58:
  buffer_load_dword v12, v13, s[12:15], 0 offen sc1
  s_waitcnt vmcnt(0)
  v_cmp_ne_u32 vcc, 256, v12
  s_nop 0
  s_cbranch_vccz ibw_59
  s_sleep 8
  s_sub_u32 s47, s47, 1
  s_cbranch_scc0 ibw_58
  s_branch ABORT
ibw_59:
  s_cmp_lg_u32 s49, 0
  s_cbranch_scc1 ibok_60
  v_and_b32 v13, 7, v0
  v_lshlrev_b32 v13, 2, v13
  buffer_load_dword v12, v13, s[12:15], 0 offen offset:32 sc1
  s_waitcnt vmcnt(0)
  v_cmp_ne_u32 vcc, 32, v12
  s_nop 0
  s_cbranch_vccz ibok_60
  s_barrier
  s_mov_b32 s49, 1
  s_mov_b32 s3, s2
  s_branch DISPATCH
ibok_60:
  s_mov_b32 s50, 0
  s_add_u32 s62, s50, 0
  s_sub_i32 s60, s62, 13
  s_sub_i32 s57, s62, 12
  s_ashr_i32 s60, s60, 1
  s_ashr_i32 s57, s57, 1
  s_sub_i32 s61, s62, 64
  s_max_i32 s60, s60, s61
  s_add_i32 s61, s61, 1
  s_max_i32 s57, s57, s61
  s_max_i32 s60, s60, 0
  s_max_i32 s57, s57, 0
  s_sub_i32 s57, s57, s60
  s_sub_i32 s58, s62, s60
  s_sub_i32 s60, s60, s58
  s_mul_i32 s60, s60, s57
  s_add_i32 s58, s58, s60
  s_and_b32 s60, s58, 1
  s_lshl_b32 s51, s57, 1
  s_add_u32 s51, s51, s60
  s_lshl_b32 s51, s51, 17
  s_add_u32 s51, s51, s55
  s_bfe_u32 s52, s58, 0x10001
CV_SEL_F:
  s_cmp_eq_u32 s46, 0
  s_cbranch_scc1 CV_F0
  s_cmp_eq_u32 s46, 1
  s_cbranch_scc1 CV_F1
  s_cmp_eq_u32 s46, 2
  s_cbranch_scc1 CV_F2
  s_cmp_eq_u32 s46, 3
  s_cbranch_scc1 CV_F3
CV_F0:
  ds_read_b128 v[112:115], v8 offset:0
  ds_read_b128 v[116:119], v8 offset:1024
  ds_read_b128 v[120:123], v8 offset:2048
  ds_read_b128 v[124:127], v8 offset:3072
  ds_read_b128 v[128:131], v8 offset:4096
  ds_read_b128 v[132:135], v8 offset:5120
  v_mov_b64 v[60:61], 0
  v_mov_b64 v[62:63], 0
  v_mov_b64 v[64:65], 0
  v_mov_b64 v[66:67], 0
  v_mov_b64 v[68:69], 0
  v_mov_b64 v[70:71], 0
  v_mov_b64 v[72:73], 0
  v_mov_b64 v[74:75], 0
  v_mov_b64 v[76:77], 0
  v_mov_b64 v[78:79], 0
  v_mov_b64 v[80:81], 0
  v_mov_b64 v[82:83], 0
  v_mov_b64 v[84:85], 0
  v_mov_b64 v[86:87], 0
  v_mov_b64 v[88:89], 0
  v_mov_b64 v[90:91], 0
  v_mov_b64 v[92:93], 0
  v_mov_b64 v[94:95], 0
  v_mov_b64 v[96:97], 0
  v_mov_b64 v[98:99], 0
  v_mov_b64 v[100:101], 0
  v_mov_b64 v[102:103], 0
  v_mov_b64 v[104:105], 0
  v_mov_b64 v[106:107], 0
  v_mov_b64 v[108:109], 0
  v_mov_b64 v[110:111], 0
  s_add_u32 s66, s51, 0
  s_waitcnt lgkmcnt(0)
  buffer_load_dwordx4 v[20:23], v1, s[8:11], s66 offen offset:0 sc1
  buffer_load_dwordx4 v[24:27], v1, s[8:11], s66 offen offset:1024 sc1
  buffer_load_dwordx4 v[28:31], v1, s[8:11], s66 offen offset:2048 sc1
  s_waitcnt vmcnt(0)
  v_bitop3_b32 v12, v20, v22, s52 bitop3:0x7e
  v_bitop3_b32 v13, v24, v26, s52 bitop3:0x7e
  v_bitop3_b32 v14, v28, v30, s52 bitop3:0x7e
  v_or3_b32 v12, v12, v13, v14
  v_and_b32 v12, 1, v12
  v_cmp_ne_u32 vcc, 0, v12
  s_nop 0
  s_cbranch_vccz po_62
  v_bitop3_b32 v12, v20, v22, s52 bitop3:0x42
  v_bitop3_b32 v13, v24, v26, s52 bitop3:0x42
  v_and_b32 v12, v12, v13
  v_bitop3_b32 v13, v28, v30, s52 bitop3:0x42
  v_and_b32 v12, v12, v13
  v_and_b32 v12, 1, v12
  v_cmp_eq_u32 vcc, 0, v12
  s_nop 0
  s_cbranch_vccnz pg_63
lp_64:
  buffer_load_dword v12, v3, s[8:11], s66 offen offset:0 sc1
  s_waitcnt vmcnt(0)
  v_and_b32 v12, 1, v12
  v_cmp_eq_u32 vcc, s52, v12
  s_nop 0
  s_cbranch_vccnz lo_65
  s_sleep 1
  s_sub_u32 s47, s47, 1
  s_cbranch_scc0 lp_64
  s_branch ABORT
lo_65:
pg_63:
  buffer_load_dwordx4 v[20:23], v1, s[8:11], s66 offen offset:0 sc1
  buffer_load_dwordx4 v[24:27], v1, s[8:11], s66 offen offset:1024 sc1
  buffer_load_dwordx4 v[28:31], v1, s[8:11], s66 offen offset:2048 sc1
  s_nop 11
  s_nop 11
pp_61:
  buffer_load_dwordx4 v[20:23], v1, s[8:11], s66 offen offset:0 sc1
  buffer_load_dwordx4 v[24:27], v1, s[8:11], s66 offen offset:1024 sc1
  buffer_load_dwordx4 v[28:31], v1, s[8:11], s66 offen offset:2048 sc1
  s_waitcnt vmcnt(3)
  v_bitop3_b32 v12, v20, v22, s52 bitop3:0x7e
  v_bitop3_b32 v13, v24, v26, s52 bitop3:0x7e
  v_bitop3_b32 v14, v28, v30, s52 bitop3:0x7e
  v_or3_b32 v12, v12, v13, v14
  v_and_b32 v12, 1, v12
  v_cmp_ne_u32 vcc, 0, v12
  s_nop 0
  s_cbranch_vccz po_62
  s_sub_u32 s47, s47, 1
  s_cbranch_scc0 pp_61
  s_branch ABORT
po_62:
  v_smfmac_f32_16x16x64_bf16 v[60:63], v[20:23], a[0:7], v2
  s_add_u32 s62, s50, 1
  s_sub_i32 s60, s62, 13
  ds_write_b128 v9, v[20:23] offset:0
  ds_write_b128 v9, v[24:27] offset:1024
  ds_write_b128 v9, v[28:31] offset:2048
  v_smfmac_f32_16x16x64_bf16 v[64:67], v[20:23], a[8:15], v2
  s_sub_i32 s57, s62, 12
  s_ashr_i32 s60, s60, 1
  s_waitcnt lgkmcnt(0)
  s_barrier
  ds_read_b128 v[32:35], v9 offset:3072
  ds_read_b128 v[36:39], v9 offset:4096
  ds_read_b128 v[40:43], v9 offset:5120
  v_smfmac_f32_16x16x64_bf16 v[68:71], v[20:23], v[112:119], v2
  s_ashr_i32 s57, s57, 1
  s_sub_i32 s61, s62, 64
  ds_read_b128 v[112:115], v8 offset:6144
  v_smfmac_f32_16x16x64_bf16 v[60:63], v[24:27], a[16:23], v2
  s_max_i32 s60, s60, s61
  s_add_i32 s61, s61, 1
  ds_read_b128 v[44:47], v9 offset:6144
  v_smfmac_f32_16x16x64_bf16 v[64:67], v[24:27], a[24:31], v2
  s_max_i32 s57, s57, s61
  s_max_i32 s60, s60, 0
  ds_read_b128 v[116:119], v8 offset:7168
  v_smfmac_f32_16x16x64_bf16 v[68:71], v[24:27], v[120:127], v2
  s_max_i32 s57, s57, 0
  s_sub_i32 s57, s57, s60
  ds_read_b128 v[48:51], v9 offset:7168
  v_smfmac_f32_16x16x64_bf16 v[60:63], v[28:31], a[32:39], v2
  s_sub_i32 s58, s62, s60
  s_sub_i32 s60, s60, s58
  ds_read_b128 v[120:123], v8 offset:8192
  v_smfmac_f32_16x16x64_bf16 v[64:67], v[28:31], a[40:47], v2
  s_mul_i32 s60, s60, s57
  s_add_i32 s58, s58, s60
  ds_read_b128 v[52:55], v9 offset:8192
  v_smfmac_f32_16x16x64_bf16 v[68:71], v[28:31], v[128:135], v2
  s_waitcnt lgkmcnt(8)
  s_and_b32 s60, s58, 1
  ds_read_b128 v[124:127], v8 offset:9216
  v_smfmac_f32_16x16x64_bf16 v[60:63], v[32:35], a[48:55], v2
  s_lshl_b32 s53, s57, 1
  s_add_u32 s53, s53, s60
  ds_read_b128 v[56:59], v9 offset:9216
  v_smfmac_f32_16x16x64_bf16 v[64:67], v[32:35], a[56:63], v2
  s_waitcnt lgkmcnt(5)
  s_lshl_b32 s53, s53, 17
  ds_read_b128 v[128:131], v8 offset:10240
  v_smfmac_f32_16x16x64_bf16 v[68:71], v[32:35], v[112:119], v2
  s_add_u32 s53, s53, s55
  s_bfe_u32 s54, s58, 0x10001
  ds_read_b128 v[132:135], v8 offset:11264
  v_smfmac_f32_16x16x64_bf16 v[60:63], v[36:39], a[64:71], v2
  ds_read_b128 v[112:115], v8 offset:12288
  v_smfmac_f32_16x16x64_bf16 v[64:67], v[36:39], a[72:79], v2
  s_waitcnt lgkmcnt(4)
  ds_read_b128 v[116:119], v8 offset:13312
  v_smfmac_f32_16x16x64_bf16 v[68:71], v[36:39], v[120:127], v2
  ds_read_b128 v[120:123], v8 offset:14336
  v_smfmac_f32_16x16x64_bf16 v[60:63], v[40:43], a[80:87], v2
  ds_read_b128 v[124:127], v8 offset:15360
  v_smfmac_f32_16x16x64_bf16 v[64:67], v[40:43], a[88:95], v2
  s_waitcnt lgkmcnt(4)
  v_smfmac_f32_16x16x64_bf16 v[68:71], v[40:43], v[128:135], v2
  ds_read_b128 v[128:131], v8 offset:16384
  v_smfmac_f32_16x16x64_bf16 v[60:63], v[44:47], a[96:103], v2
  ds_read_b128 v[132:135], v8 offset:17408
  v_smfmac_f32_16x16x64_bf16 v[64:67], v[44:47], a[104:111], v2
  s_waitcnt lgkmcnt(4)
  v_smfmac_f32_16x16x64_bf16 v[68:71], v[44:47], v[112:119], v2
  ds_read_b128 v[112:115], v8 offset:18432
  v_smfmac_f32_16x16x64_bf16 v[60:63], v[48:51], a[112:119], v2
  ds_read_b128 v[116:119], v8 offset:19456
  v_smfmac_f32_16x16x64_bf16 v[64:67], v[48:51], a[120:127], v2
  s_waitcnt lgkmcnt(4)
  v_smfmac_f32_16x16x64_bf16 v[68:71], v[48:51], v[120:127], v2
  ds_read_b128 v[120:123], v8 offset:20480
  v_smfmac_f32_16x16x64_bf16 v[60:63], v[52:55], a[128:135], v2
  ds_read_b128 v[124:127], v8 offset:21504
  v_smfmac_f32_16x16x64_bf16 v[64:67], v[52:55], a[136:143], v2
  s_waitcnt lgkmcnt(4)
  v_smfmac_f32_16x16x64_bf16 v[68:71], v[52:55], v[128:135], v2
  ds_read_b128 v[128:131], v8 offset:22528
  v_smfmac_f32_16x16x64_bf16 v[60:63], v[56:59], a[144:151], v2
  ds_read_b128 v[132:135], v8 offset:23552
  v_smfmac_f32_16x16x64_bf16 v[64:67], v[56:59], a[152:159], v2
  s_waitcnt lgkmcnt(4)
  v_smfmac_f32_16x16x64_bf16 v[68:71], v[56:59], v[112:119], v2
  s_waitcnt vmcnt(0)
  s_nop 2
  v_add_f32 v60, v60, v61
  v_add_f32 v62, v62, v63
  v_add_f32 v64, v64, v65
  v_add_f32 v66, v66, v67
  v_cvt_pk_bf16_f32 v12, v60, v64
  v_cvt_pk_bf16_f32 v13, v62, v66
  ds_write_b64 v4, v[12:13]
  v_add_f32 v68, v68, v69
  v_add_f32 v70, v70, v71
  v_cvt_pk_bf16_f32 v14, v68, v70
  ds_write_b16 v5, v14
  ds_write_b16_d16_hi v5, v14 offset:4
  s_waitcnt lgkmcnt(0)
  s_barrier
  ds_read_b64_tr_b16 v[20:21], v6 offset:0
  ds_read_b64_tr_b16 v[22:23], v6 offset:64
  ds_read_b64_tr_b16 v[24:25], v6 offset:256
  ds_read_b64_tr_b16 v[26:27], v6 offset:320
  ds_read_b64_tr_b16 v[28:29], v6 offset:512
  ds_read_b64_tr_b16 v[30:31], v6 offset:576
  s_waitcnt lgkmcnt(4)
  v_smfmac_f32_16x16x64_bf16 v[72:75], v[20:23], a[160:167], v2
  ds_read_b128 v[112:115], v8 offset:24576
  v_smfmac_f32_16x16x64_bf16 v[76:79], v[20:23], a[168:175], v2
  s_waitcnt lgkmcnt(3)
  ds_read_b128 v[116:119], v8 offset:25600
  v_smfmac_f32_16x16x64_bf16 v[72:75], v[24:27], a[240:247], v2
  v_smfmac_f32_16x16x64_bf16 v[76:79], v[24:27], a[248:255], v2
  s_waitcnt lgkmcnt(2)
  v_smfmac_f32_16x16x64_bf16 v[72:75], v[28:31], v[120:127], v2
  v_smfmac_f32_16x16x64_bf16 v[76:79], v[28:31], v[128:135], v2
  v_smfmac_f32_16x16x64_bf16 v[80:83], v[20:23], a[176:183], v2
  v_smfmac_f32_16x16x64_bf16 v[84:87], v[20:23], a[184:191], v2
  s_nop 4
  v_add_f32 v72, v72, v73
  v_add_f32 v74, v74, v75
  v_smfmac_f32_16x16x64_bf16 v[80:83], v[24:27], v[136:143], v2
  s_add_u32 s67, s51, 0
  v_cvt_pk_bf16_f32 v60, v72, v74
  v_add_f32 v76, v76, v77
  v_smfmac_f32_16x16x64_bf16 v[84:87], v[24:27], v[144:151], v2
  s_waitcnt lgkmcnt(0)
  v_add_f32 v78, v78, v79
  v_cvt_pk_bf16_f32 v61, v76, v78
  v_smfmac_f32_16x16x64_bf16 v[80:83], v[28:31], v[112:119], v2
  s_nop 0
  v_permlane32_swap_b32 v60, v61
  v_smfmac_f32_16x16x64_bf16 v[84:87], v[28:31], v[200:207], v2
  v_and_or_b32 v60, v60, -2, s52
  s_cmp_lg_u32 s49, 0
  s_cbranch_scc1 wt_66
  buffer_store_dwordx2 v[60:61], v7, s[8:11], s67 offen
wb_67:
  v_smfmac_f32_16x16x64_bf16 v[88:91], v[20:23], a[192:199], v2
  v_smfmac_f32_16x16x64_bf16 v[92:95], v[20:23], a[200:207], v2
  v_add_f32 v80, v80, v81
  v_add_f32 v82, v82, v83
  v_smfmac_f32_16x16x64_bf16 v[88:91], v[24:27], v[152:159], v2
  s_add_u32 s67, s51, 4096
  v_cvt_pk_bf16_f32 v62, v80, v82
  v_add_f32 v84, v84, v85
  v_smfmac_f32_16x16x64_bf16 v[92:95], v[24:27], v[160:167], v2
  v_add_f32 v86, v86, v87
  v_cvt_pk_bf16_f32 v63, v84, v86
  v_smfmac_f32_16x16x64_bf16 v[88:91], v[28:31], v[208:215], v2
  s_nop 0
  v_permlane32_swap_b32 v62, v63
  v_smfmac_f32_16x16x64_bf16 v[92:95], v[28:31], v[216:223], v2
  v_and_or_b32 v62, v62, -2, s52
  s_cmp_lg_u32 s49, 0
  s_cbranch_scc1 wt_68
  buffer_store_dwordx2 v[62:63], v7, s[8:11], s67 offen
wb_69:
  v_smfmac_f32_16x16x64_bf16 v[96:99], v[20:23], a[208:215], v2
  v_smfmac_f32_16x16x64_bf16 v[100:103], v[20:23], a[216:223], v2
  v_add_f32 v88, v88, v89
  v_add_f32 v90, v90, v91
  v_smfmac_f32_16x16x64_bf16 v[96:99], v[24:27], v[168:175], v2
  s_add_u32 s67, s51, 8192
  v_cvt_pk_bf16_f32 v64, v88, v90
  v_add_f32 v92, v92, v93
  v_smfmac_f32_16x16x64_bf16 v[100:103], v[24:27], v[176:183], v2
  v_add_f32 v94, v94, v95
  v_cvt_pk_bf16_f32 v65, v92, v94
  v_smfmac_f32_16x16x64_bf16 v[96:99], v[28:31], v[224:231], v2
  s_nop 0
  v_permlane32_swap_b32 v64, v65
  v_smfmac_f32_16x16x64_bf16 v[100:103], v[28:31], v[232:239], v2
  v_and_or_b32 v64, v64, -2, s52
  s_cmp_lg_u32 s49, 0
  s_cbranch_scc1 wt_70
  buffer_store_dwordx2 v[64:65], v7, s[8:11], s67 offen
wb_71:
  v_smfmac_f32_16x16x64_bf16 v[104:107], v[20:23], a[224:231], v2
  v_smfmac_f32_16x16x64_bf16 v[108:111], v[20:23], a[232:239], v2
  v_add_f32 v96, v96, v97
  v_add_f32 v98, v98, v99
  v_smfmac_f32_16x16x64_bf16 v[104:107], v[24:27], v[184:191], v2
  s_add_u32 s67, s51, 12288
  v_cvt_pk_bf16_f32 v66, v96, v98
  v_add_f32 v100, v100, v101
  v_smfmac_f32_16x16x64_bf16 v[108:111], v[24:27], v[192:199], v2
  v_add_f32 v102, v102, v103
  v_cvt_pk_bf16_f32 v67, v100, v102
  v_smfmac_f32_16x16x64_bf16 v[104:107], v[28:31], v[240:247], v2
  s_nop 0
  v_permlane32_swap_b32 v66, v67
  v_smfmac_f32_16x16x64_bf16 v[108:111], v[28:31], v[248:255], v2
  v_and_or_b32 v66, v66, -2, s52
  s_cmp_lg_u32 s49, 0
  s_cbranch_scc1 wt_72
  buffer_store_dwordx2 v[66:67], v7, s[8:11], s67 offen
wb_73:
  s_nop 0
  v_add_f32 v104, v104, v105
  v_add_f32 v106, v106, v107
  v_cvt_pk_bf16_f32 v68, v104, v106
  v_add_f32 v108, v108, v109
  v_add_f32 v110, v110, v111
  v_cvt_pk_bf16_f32 v69, v108, v110
  s_add_u32 s67, s51, 16384
  s_nop 0
  v_permlane32_swap_b32 v68, v69
  v_and_or_b32 v68, v68, -2, s52
  s_cmp_lg_u32 s49, 0
  s_cbranch_scc1 wt_74
  buffer_store_dwordx2 v[68:69], v7, s[8:11], s67 offen
wb_75:
  s_mov_b32 s51, s53
  s_mov_b32 s52, s54
  s_add_u32 s50, s50, 1
  s_cmp_lt_u32 s50, 128
  s_cbranch_scc1 CV_F0
  s_branch CV_END
CV_F1:
  ds_read_b128 v[112:115], v8 offset:6144
  ds_read_b128 v[116:119], v8 offset:7168
  ds_read_b128 v[120:123], v8 offset:8192
  ds_read_b128 v[124:127], v8 offset:9216
  ds_read_b128 v[128:131], v8 offset:10240
  ds_read_b128 v[132:135], v8 offset:11264
  v_mov_b64 v[60:61], 0
  v_mov_b64 v[62:63], 0
  v_mov_b64 v[64:65], 0
  v_mov_b64 v[66:67], 0
  v_mov_b64 v[68:69], 0
  v_mov_b64 v[70:71], 0
  v_mov_b64 v[72:73], 0
  v_mov_b64 v[74:75], 0
  v_mov_b64 v[76:77], 0
  v_mov_b64 v[78:79], 0
  v_mov_b64 v[80:81], 0
  v_mov_b64 v[82:83], 0
  v_mov_b64 v[84:85], 0
  v_mov_b64 v[86:87], 0
  v_mov_b64 v[88:89], 0
  v_mov_b64 v[90:91], 0
  v_mov_b64 v[92:93], 0
  v_mov_b64 v[94:95], 0
  v_mov_b64 v[96:97], 0
  v_mov_b64 v[98:99], 0
  v_mov_b64 v[100:101], 0
  v_mov_b64 v[102:103], 0
  v_mov_b64 v[104:105], 0
  v_mov_b64 v[106:107], 0
  v_mov_b64 v[108:109], 0
  v_mov_b64 v[110:111], 0
  s_add_u32 s66, s51, 3072
  s_waitcnt lgkmcnt(0)
  buffer_load_dwordx4 v[32:35], v1, s[8:11], s66 offen offset:0 sc1
  buffer_load_dwordx4 v[36:39], v1, s[8:11], s66 offen offset:1024 sc1
  buffer_load_dwordx4 v[40:43], v1, s[8:11], s66 offen offset:2048 sc1
  s_waitcnt vmcnt(0)
  v_bitop3_b32 v12, v32, v34, s52 bitop3:0x7e
  v_bitop3_b32 v13, v36, v38, s52 bitop3:0x7e
  v_bitop3_b32 v14, v40, v42, s52 bitop3:0x7e
  v_or3_b32 v12, v12, v13, v14
  v_and_b32 v12, 1, v12
  v_cmp_ne_u32 vcc, 0, v12
  s_nop 0
  s_cbranch_vccz po_77
  v_bitop3_b32 v12, v32, v34, s52 bitop3:0x42
  v_bitop3_b32 v13, v36, v38, s52 bitop3:0x42
  v_and_b32 v12, v12, v13
  v_bitop3_b32 v13, v40, v42, s52 bitop3:0x42
  v_and_b32 v12, v12, v13
  v_and_b32 v12, 1, v12
  v_cmp_eq_u32 vcc, 0, v12
  s_nop 0
  s_cbranch_vccnz pg_78
lp_79:
  buffer_load_dword v12, v3, s[8:11], s66 offen offset:0 sc1
  s_waitcnt vmcnt(0)
  v_and_b32 v12, 1, v12
  v_cmp_eq_u32 vcc, s52, v12
  s_nop 0
  s_cbranch_vccnz lo_80
  s_sleep 1
  s_sub_u32 s47, s47, 1
  s_cbranch_scc0 lp_79
  s_branch ABORT
lo_80:
pg_78:
  buffer_load_dwordx4 v[32:35], v1, s[8:11], s66 offen offset:0 sc1
  buffer_load_dwordx4 v[36:39], v1, s[8:11], s66 offen offset:1024 sc1
  buffer_load_dwordx4 v[40:43], v1, s[8:11], s66 offen offset:2048 sc1
  s_nop 11
  s_nop 11
pp_76:
  buffer_load_dwordx4 v[32:35], v1, s[8:11], s66 offen offset:0 sc1
  buffer_load_dwordx4 v[36:39], v1, s[8:11], s66 offen offset:1024 sc1
  buffer_load_dwordx4 v[40:43], v1, s[8:11], s66 offen offset:2048 sc1
  s_waitcnt vmcnt(3)
  v_bitop3_b32 v12, v32, v34, s52 bitop3:0x7e
  v_bitop3_b32 v13, v36, v38, s52 bitop3:0x7e
  v_bitop3_b32 v14, v40, v42, s52 bitop3:0x7e
  v_or3_b32 v12, v12, v13, v14
  v_and_b32 v12, 1, v12
  v_cmp_ne_u32 vcc, 0, v12
  s_nop 0
  s_cbranch_vccz po_77
  s_sub_u32 s47, s47, 1
  s_cbranch_scc0 pp_76
  s_branch ABORT
po_77:
  v_smfmac_f32_16x16x64_bf16 v[60:63], v[32:35], a[48:55], v2
  s_add_u32 s62, s50, 1
  s_sub_i32 s60, s62, 13
  ds_write_b128 v9, v[32:35] offset:3072
  ds_write_b128 v9, v[36:39] offset:4096
  ds_write_b128 v9, v[40:43] offset:5120
  v_smfmac_f32_16x16x64_bf16 v[64:67], v[32:35], a[56:63], v2
  s_sub_i32 s57, s62, 12
  s_ashr_i32 s60, s60, 1
  s_waitcnt lgkmcnt(0)
  s_barrier
  ds_read_b128 v[44:47], v9 offset:6144
  ds_read_b128 v[48:51], v9 offset:7168
  ds_read_b128 v[52:55], v9 offset:8192
  v_smfmac_f32_16x16x64_bf16 v[68:71], v[32:35], v[112:119], v2
  s_ashr_i32 s57, s57, 1
  s_sub_i32 s61, s62, 64
  ds_read_b128 v[112:115], v8 offset:12288
  v_smfmac_f32_16x16x64_bf16 v[60:63], v[36:39], a[64:71], v2
  s_max_i32 s60, s60, s61
  s_add_i32 s61, s61, 1
  ds_read_b128 v[56:59], v9 offset:9216
  v_smfmac_f32_16x16x64_bf16 v[64:67], v[36:39], a[72:79], v2
  s_max_i32 s57, s57, s61
  s_max_i32 s60, s60, 0
  ds_read_b128 v[116:119], v8 offset:13312
  v_smfmac_f32_16x16x64_bf16 v[68:71], v[36:39], v[120:127], v2
  s_max_i32 s57, s57, 0
  s_sub_i32 s57, s57, s60
  ds_read_b128 v[20:23], v9 offset:0
  v_smfmac_f32_16x16x64_bf16 v[60:63], v[40:43], a[80:87], v2
  s_sub_i32 s58, s62, s60
  s_sub_i32 s60, s60, s58
  ds_read_b128 v[120:123], v8 offset:14336
  v_smfmac_f32_16x16x64_bf16 v[64:67], v[40:43], a[88:95], v2
  s_mul_i32 s60, s60, s57
  s_add_i32 s58, s58, s60
  ds_read_b128 v[24:27], v9 offset:1024
  v_smfmac_f32_16x16x64_bf16 v[68:71], v[40:43], v[128:135], v2
  s_waitcnt lgkmcnt(8)
  s_and_b32 s60, s58, 1
  ds_read_b128 v[124:127], v8 offset:15360
  v_smfmac_f32_16x16x64_bf16 v[60:63], v[44:47], a[96:103], v2
  s_lshl_b32 s53, s57, 1
  s_add_u32 s53, s53, s60
  ds_read_b128 v[28:31], v9 offset:2048
  v_smfmac_f32_16x16x64_bf16 v[64:67], v[44:47], a[104:111], v2
  s_waitcnt lgkmcnt(5)
  s_lshl_b32 s53, s53, 17
  ds_read_b128 v[128:131], v8 offset:16384
  v_smfmac_f32_16x16x64_bf16 v[68:71], v[44:47], v[112:119], v2
  s_add_u32 s53, s53, s55
  s_bfe_u32 s54, s58, 0x10001
  ds_read_b128 v[132:135], v8 offset:17408
  v_smfmac_f32_16x16x64_bf16 v[60:63], v[48:51], a[112:119], v2
  ds_read_b128 v[112:115], v8 offset:18432
  v_smfmac_f32_16x16x64_bf16 v[64:67], v[48:51], a[120:127], v2
  s_waitcnt lgkmcnt(4)
  ds_read_b128 v[116:119], v8 offset:19456
  v_smfmac_f32_16x16x64_bf16 v[68:71], v[48:51], v[120:127], v2
  ds_read_b128 v[120:123], v8 offset:0
  v_smfmac_f32_16x16x64_bf16 v[60:63], v[52:55], a[128:135], v2
  ds_read_b128 v[124:127], v8 offset:1024
  v_smfmac_f32_16x16x64_bf16 v[64:67], v[52:55], a[136:143], v2
  s_waitcnt lgkmcnt(4)
  v_smfmac_f32_16x16x64_bf16 v[68:71], v[52:55], v[128:135], v2
  ds_read_b128 v[128:131], v8 offset:2048
  v_smfmac_f32_16x16x64_bf16 v[60:63], v[56:59], a[144:151], v2
  ds_read_b128 v[132:135], v8 offset:3072
  v_smfmac_f32_16x16x64_bf16 v[64:67], v[56:59], a[152:159], v2
  s_waitcnt lgkmcnt(4)
  v_smfmac_f32_16x16x64_bf16 v[68:71], v[56:59], v[112:119], v2
  ds_read_b128 v[112:115], v8 offset:4096
  v_smfmac_f32_16x16x64_bf16 v[60:63], v[20:23], a[0:7], v2
  ds_read_b128 v[116:119], v8 offset:5120
  v_smfmac_f32_16x16x64_bf16 v[64:67], v[20:23], a[8:15], v2
  s_waitcnt lgkmcnt(4)
  v_smfmac_f32_16x16x64_bf16 v[68:71], v[20:23], v[120:127], v2
  ds_read_b128 v[120:123], v8 offset:20480
  v_smfmac_f32_16x16x64_bf16 v[60:63], v[24:27], a[16:23], v2
  ds_read_b128 v[124:127], v8 offset:21504
  v_smfmac_f32_16x16x64_bf16 v[64:67], v[24:27], a[24:31], v2
  s_waitcnt lgkmcnt(4)
  v_smfmac_f32_16x16x64_bf16 v[68:71], v[24:27], v[128:135], v2
  ds_read_b128 v[128:131], v8 offset:22528
  v_smfmac_f32_16x16x64_bf16 v[60:63], v[28:31], a[32:39], v2
  ds_read_b128 v[132:135], v8 offset:23552
  v_smfmac_f32_16x16x64_bf16 v[64:67], v[28:31], a[40:47], v2
  s_waitcnt lgkmcnt(4)
  v_smfmac_f32_16x16x64_bf16 v[68:71], v[28:31], v[112:119], v2
  s_waitcnt vmcnt(0)
  s_nop 2
  v_add_f32 v60, v60, v61
  v_add_f32 v62, v62, v63
  v_add_f32 v64, v64, v65
  v_add_f32 v66, v66, v67
  v_cvt_pk_bf16_f32 v12, v60, v64
  v_cvt_pk_bf16_f32 v13, v62, v66
  ds_write_b64 v4, v[12:13]
  v_add_f32 v68, v68, v69
  v_add_f32 v70, v70, v71
  v_cvt_pk_bf16_f32 v14, v68, v70
  ds_write_b16 v5, v14
  ds_write_b16_d16_hi v5, v14 offset:4
  s_waitcnt lgkmcnt(0)
  s_barrier
  ds_read_b64_tr_b16 v[32:33], v6 offset:0
  ds_read_b64_tr_b16 v[34:35], v6 offset:64
  ds_read_b64_tr_b16 v[36:37], v6 offset:256
  ds_read_b64_tr_b16 v[38:39], v6 offset:320
  ds_read_b64_tr_b16 v[40:41], v6 offset:512
  ds_read_b64_tr_b16 v[42:43], v6 offset:576
  s_waitcnt lgkmcnt(4)
  v_smfmac_f32_16x16x64_bf16 v[72:75], v[32:35], a[160:167], v2
  ds_read_b128 v[112:115], v8 offset:24576
  v_smfmac_f32_16x16x64_bf16 v[76:79], v[32:35], a[168:175], v2
  s_waitcnt lgkmcnt(3)
  ds_read_b128 v[116:119], v8 offset:25600
  v_smfmac_f32_16x16x64_bf16 v[72:75], v[36:39], a[240:247], v2
  v_smfmac_f32_16x16x64_bf16 v[76:79], v[36:39], a[248:255], v2
  s_waitcnt lgkmcnt(2)
  v_smfmac_f32_16x16x64_bf16 v[72:75], v[40:43], v[120:127], v2
  v_smfmac_f32_16x16x64_bf16 v[76:79], v[40:43], v[128:135], v2
  v_smfmac_f32_16x16x64_bf16 v[80:83], v[32:35], a[176:183], v2
  v_smfmac_f32_16x16x64_bf16 v[84:87], v[32:35], a[184:191], v2
  s_nop 4
  v_add_f32 v72, v72, v73
  v_add_f32 v74, v74, v75
  v_smfmac_f32_16x16x64_bf16 v[80:83], v[36:39], v[136:143], v2
  s_add_u32 s67, s51, 0
  v_cvt_pk_bf16_f32 v60, v72, v74
  v_add_f32 v76, v76, v77
  v_smfmac_f32_16x16x64_bf16 v[84:87], v[36:39], v[144:151], v2
  s_waitcnt lgkmcnt(0)
  v_add_f32 v78, v78, v79
  v_cvt_pk_bf16_f32 v61, v76, v78
  v_smfmac_f32_16x16x64_bf16 v[80:83], v[40:43], v[112:119], v2
  s_nop 0
  v_permlane32_swap_b32 v60, v61
  v_smfmac_f32_16x16x64_bf16 v[84:87], v[40:43], v[200:207], v2
  v_and_or_b32 v60, v60, -2, s52
  s_cmp_lg_u32 s49, 0
  s_cbranch_scc1 wt_81
  buffer_store_dwordx2 v[60:61], v7, s[8:11], s67 offen
wb_82:
  v_smfmac_f32_16x16x64_bf16 v[88:91], v[32:35], a[192:199], v2
  v_smfmac_f32_16x16x64_bf16 v[92:95], v[32:35], a[200:207], v2
  v_add_f32 v80, v80, v81
  v_add_f32 v82, v82, v83
  v_smfmac_f32_16x16x64_bf16 v[88:91], v[36:39], v[152:159], v2
  s_add_u32 s67, s51, 4096
  v_cvt_pk_bf16_f32 v62, v80, v82
  v_add_f32 v84, v84, v85
  v_smfmac_f32_16x16x64_bf16 v[92:95], v[36:39], v[160:167], v2
  v_add_f32 v86, v86, v87
  v_cvt_pk_bf16_f32 v63, v84, v86
  v_smfmac_f32_16x16x64_bf16 v[88:91], v[40:43], v[208:215], v2
  s_nop 0
  v_permlane32_swap_b32 v62, v63
  v_smfmac_f32_16x16x64_bf16 v[92:95], v[40:43], v[216:223], v2
  v_and_or_b32 v62, v62, -2, s52
  s_cmp_lg_u32 s49, 0
  s_cbranch_scc1 wt_83
  buffer_store_dwordx2 v[62:63], v7, s[8:11], s67 offen
wb_84:
  v_smfmac_f32_16x16x64_bf16 v[96:99], v[32:35], a[208:215], v2
  v_smfmac_f32_16x16x64_bf16 v[100:103], v[32:35], a[216:223], v2
  v_add_f32 v88, v88, v89
  v_add_f32 v90, v90, v91
  v_smfmac_f32_16x16x64_bf16 v[96:99], v[36:39], v[168:175], v2
  s_add_u32 s67, s51, 8192
  v_cvt_pk_bf16_f32 v64, v88, v90
  v_add_f32 v92, v92, v93
  v_smfmac_f32_16x16x64_bf16 v[100:103], v[36:39], v[176:183], v2
  v_add_f32 v94, v94, v95
  v_cvt_pk_bf16_f32 v65, v92, v94
  v_smfmac_f32_16x16x64_bf16 v[96:99], v[40:43], v[224:231], v2
  s_nop 0
  v_permlane32_swap_b32 v64, v65
  v_smfmac_f32_16x16x64_bf16 v[100:103], v[40:43], v[232:239], v2
  v_and_or_b32 v64, v64, -2, s52
  s_cmp_lg_u32 s49, 0
  s_cbranch_scc1 wt_85
  buffer_store_dwordx2 v[64:65], v7, s[8:11], s67 offen
wb_86:
  v_smfmac_f32_16x16x64_bf16 v[104:107], v[32:35], a[224:231], v2
  v_smfmac_f32_16x16x64_bf16 v[108:111], v[32:35], a[232:239], v2
  v_add_f32 v96, v96, v97
  v_add_f32 v98, v98, v99
  v_smfmac_f32_16x16x64_bf16 v[104:107], v[36:39], v[184:191], v2
  s_add_u32 s67, s51, 12288
  v_cvt_pk_bf16_f32 v66, v96, v98
  v_add_f32 v100, v100, v101
  v_smfmac_f32_16x16x64_bf16 v[108:111], v[36:39], v[192:199], v2
  v_add_f32 v102, v102, v103
  v_cvt_pk_bf16_f32 v67, v100, v102
  v_smfmac_f32_16x16x64_bf16 v[104:107], v[40:43], v[240:247], v2
  s_nop 0
  v_permlane32_swap_b32 v66, v67
  v_smfmac_f32_16x16x64_bf16 v[108:111], v[40:43], v[248:255], v2
  v_and_or_b32 v66, v66, -2, s52
  s_cmp_lg_u32 s49, 0
  s_cbranch_scc1 wt_87
  buffer_store_dwordx2 v[66:67], v7, s[8:11], s67 offen
wb_88:
  s_nop 0
  v_add_f32 v104, v104, v105
  v_add_f32 v106, v106, v107
  v_cvt_pk_bf16_f32 v68, v104, v106
  v_add_f32 v108, v108, v109
  v_add_f32 v110, v110, v111
  v_cvt_pk_bf16_f32 v69, v108, v110
  s_add_u32 s67, s51, 16384
  s_nop 0
  v_permlane32_swap_b32 v68, v69
  v_and_or_b32 v68, v68, -2, s52
  s_cmp_lg_u32 s49, 0
  s_cbranch_scc1 wt_89
  buffer_store_dwordx2 v[68:69], v7, s[8:11], s67 offen
wb_90:
  s_mov_b32 s51, s53
  s_mov_b32 s52, s54
  s_add_u32 s50, s50, 1
  s_cmp_lt_u32 s50, 128
  s_cbranch_scc1 CV_F1
  s_branch CV_END
CV_F2:
  ds_read_b128 v[112:115], v8 offset:12288
  ds_read_b128 v[116:119], v8 offset:13312
  ds_read_b128 v[120:123], v8 offset:14336
  ds_read_b128 v[124:127], v8 offset:15360
  ds_read_b128 v[128:131], v8 offset:16384
  ds_read_b128 v[132:135], v8 offset:17408
  v_mov_b64 v[60:61], 0
  v_mov_b64 v[62:63], 0
  v_mov_b64 v[64:65], 0
  v_mov_b64 v[66:67], 0
  v_mov_b64 v[68:69], 0
  v_mov_b64 v[70:71], 0
  v_mov_b64 v[72:73], 0
  v_mov_b64 v[74:75], 0
  v_mov_b64 v[76:77], 0
  v_mov_b64 v[78:79], 0
  v_mov_b64 v[80:81], 0
  v_mov_b64 v[82:83], 0
  v_mov_b64 v[84:85], 0
  v_mov_b64 v[86:87], 0
  v_mov_b64 v[88:89], 0
  v_mov_b64 v[90:91], 0
  v_mov_b64 v[92:93], 0
  v_mov_b64 v[94:95], 0
  v_mov_b64 v[96:97], 0
  v_mov_b64 v[98:99], 0
  v_mov_b64 v[100:101], 0
  v_mov_b64 v[102:103], 0
  v_mov_b64 v[104:105], 0
  v_mov_b64 v[106:107], 0
  v_mov_b64 v[108:109], 0
  v_mov_b64 v[110:111], 0
  s_add_u32 s66, s51, 6144
  s_waitcnt lgkmcnt(0)
  buffer_load_dwordx4 v[44:47], v1, s[8:11], s66 offen offset:0 sc1
  buffer_load_dwordx4 v[48:51], v1, s[8:11], s66 offen offset:1024 sc1
  s_waitcnt vmcnt(0)
  v_bitop3_b32 v12, v44, v46, s52 bitop3:0x7e
  v_bitop3_b32 v13, v48, v50, s52 bitop3:0x7e
  v_bitop3_b32 v12, v12, v13, 1 bitop3:0xa8
  v_cmp_ne_u32 vcc, 0, v12
  s_nop 0
  s_cbranch_vccz po_92
  v_bitop3_b32 v12, v44, v46, s52 bitop3:0x42
  v_bitop3_b32 v13, v48, v50, s52 bitop3:0x42
  v_and_b32 v12, v12, v13
  v_and_b32 v12, 1, v12
  v_cmp_eq_u32 vcc, 0, v12
  s_nop 0
  s_cbranch_vccnz pg_93
lp_94:
  buffer_load_dword v12, v3, s[8:11], s66 offen offset:0 sc1
  s_waitcnt vmcnt(0)
  v_and_b32 v12, 1, v12
  v_cmp_eq_u32 vcc, s52, v12
  s_nop 0
  s_cbranch_vccnz lo_95
  s_sleep 1
  s_sub_u32 s47, s47, 1
  s_cbranch_scc0 lp_94
  s_branch ABORT
lo_95:
pg_93:
  buffer_load_dwordx4 v[44:47], v1, s[8:11], s66 offen offset:0 sc1
  buffer_load_dwordx4 v[48:51], v1, s[8:11], s66 offen offset:1024 sc1
  s_nop 11
  s_nop 11
pp_91:
  buffer_load_dwordx4 v[44:47], v1, s[8:11], s66 offen offset:0 sc1
  buffer_load_dwordx4 v[48:51], v1, s[8:11], s66 offen offset:1024 sc1
  s_waitcnt vmcnt(2)
  v_bitop3_b32 v12, v44, v46, s52 bitop3:0x7e
  v_bitop3_b32 v13, v48, v50, s52 bitop3:0x7e
  v_bitop3_b32 v12, v12, v13, 1 bitop3:0xa8
  v_cmp_ne_u32 vcc, 0, v12
  s_nop 0
  s_cbranch_vccz po_92
  s_sub_u32 s47, s47, 1
  s_cbranch_scc0 pp_91
  s_branch ABORT
po_92:
  v_smfmac_f32_16x16x64_bf16 v[60:63], v[44:47], a[96:103], v2
  s_add_u32 s62, s50, 1
  s_sub_i32 s60, s62, 13
  ds_write_b128 v9, v[44:47] offset:6144
  ds_write_b128 v9, v[48:51] offset:7168
  v_smfmac_f32_16x16x64_bf16 v[64:67], v[44:47], a[104:111], v2
  s_sub_i32 s57, s62, 12
  s_ashr_i32 s60, s60, 1
  s_waitcnt lgkmcnt(0)
  s_barrier
  ds_read_b128 v[52:55], v9 offset:8192
  ds_read_b128 v[56:59], v9 offset:9216
  ds_read_b128 v[20:23], v9 offset:0
  v_smfmac_f32_16x16x64_bf16 v[68:71], v[44:47], v[112:119], v2
  s_ashr_i32 s57, s57, 1
  s_sub_i32 s61, s62, 64
  ds_read_b128 v[112:115], v8 offset:18432
  v_smfmac_f32_16x16x64_bf16 v[60:63], v[48:51], a[112:119], v2
  s_max_i32 s60, s60, s61
  s_add_i32 s61, s61, 1
  ds_read_b128 v[24:27], v9 offset:1024
  v_smfmac_f32_16x16x64_bf16 v[64:67], v[48:51], a[120:127], v2
  s_max_i32 s57, s57, s61
  s_max_i32 s60, s60, 0
  ds_read_b128 v[116:119], v8 offset:19456
  v_smfmac_f32_16x16x64_bf16 v[68:71], v[48:51], v[120:127], v2
  s_waitcnt lgkmcnt(5)
  s_max_i32 s57, s57, 0
  ds_read_b128 v[28:31], v9 offset:2048
  v_smfmac_f32_16x16x64_bf16 v[60:63], v[52:55], a[128:135], v2
  s_sub_i32 s57, s57, s60
  s_sub_i32 s58, s62, s60
  ds_read_b128 v[120:123], v8 offset:0
  v_smfmac_f32_16x16x64_bf16 v[64:67], v[52:55], a[136:143], v2
  s_sub_i32 s60, s60, s58
  s_mul_i32 s60, s60, s57
  ds_read_b128 v[32:35], v9 offset:3072
  v_smfmac_f32_16x16x64_bf16 v[68:71], v[52:55], v[128:135], v2
  s_waitcnt lgkmcnt(7)
  s_add_i32 s58, s58, s60
  ds_read_b128 v[124:127], v8 offset:1024
  v_smfmac_f32_16x16x64_bf16 v[60:63], v[56:59], a[144:151], v2
  s_and_b32 s60, s58, 1
  s_lshl_b32 s53, s57, 1
  ds_read_b128 v[36:39], v9 offset:4096
  v_smfmac_f32_16x16x64_bf16 v[64:67], v[56:59], a[152:159], v2
  s_waitcnt lgkmcnt(5)
  s_add_u32 s53, s53, s60
  ds_read_b128 v[128:131], v8 offset:2048
  v_smfmac_f32_16x16x64_bf16 v[68:71], v[56:59], v[112:119], v2
  s_lshl_b32 s53, s53, 17
  s_add_u32 s53, s53, s55
  ds_read_b128 v[40:43], v9 offset:5120
  v_smfmac_f32_16x16x64_bf16 v[60:63], v[20:23], a[0:7], v2
  s_bfe_u32 s54, s58, 0x10001
  ds_read_b128 v[132:135], v8 offset:3072
  v_smfmac_f32_16x16x64_bf16 v[64:67], v[20:23], a[8:15], v2
  s_waitcnt lgkmcnt(4)
  ds_read_b128 v[112:115], v8 offset:4096
  v_smfmac_f32_16x16x64_bf16 v[68:71], v[20:23], v[120:127], v2
  ds_read_b128 v[116:119], v8 offset:5120
  v_smfmac_f32_16x16x64_bf16 v[60:63], v[24:27], a[16:23], v2
  ds_read_b128 v[120:123], v8 offset:6144
  v_smfmac_f32_16x16x64_bf16 v[64:67], v[24:27], a[24:31], v2
  s_waitcnt lgkmcnt(3)
  ds_read_b128 v[124:127], v8 offset:7168
  v_smfmac_f32_16x16x64_bf16 v[68:71], v[24:27], v[128:135], v2
  ds_read_b128 v[128:131], v8 offset:8192
  v_smfmac_f32_16x16x64_bf16 v[60:63], v[28:31], a[32:39], v2
  ds_read_b128 v[132:135], v8 offset:9216
  v_smfmac_f32_16x16x64_bf16 v[64:67], v[28:31], a[40:47], v2
  s_waitcnt lgkmcnt(4)
  v_smfmac_f32_16x16x64_bf16 v[68:71], v[28:31], v[112:119], v2
  ds_read_b128 v[112:115], v8 offset:10240
  v_smfmac_f32_16x16x64_bf16 v[60:63], v[32:35], a[48:55], v2
  ds_read_b128 v[116:119], v8 offset:11264
  v_smfmac_f32_16x16x64_bf16 v[64:67], v[32:35], a[56:63], v2
  s_waitcnt lgkmcnt(4)
  v_smfmac_f32_16x16x64_bf16 v[68:71], v[32:35], v[120:127], v2
  ds_read_b128 v[120:123], v8 offset:20480
  v_smfmac_f32_16x16x64_bf16 v[60:63], v[36:39], a[64:71], v2
  ds_read_b128 v[124:127], v8 offset:21504
  v_smfmac_f32_16x16x64_bf16 v[64:67], v[36:39], a[72:79], v2
  s_waitcnt lgkmcnt(4)
  v_smfmac_f32_16x16x64_bf16 v[68:71], v[36:39], v[128:135], v2
  ds_read_b128 v[128:131], v8 offset:22528
  v_smfmac_f32_16x16x64_bf16 v[60:63], v[40:43], a[80:87], v2
  ds_read_b128 v[132:135], v8 offset:23552
  v_smfmac_f32_16x16x64_bf16 v[64:67], v[40:43], a[88:95], v2
  s_waitcnt lgkmcnt(4)
  v_smfmac_f32_16x16x64_bf16 v[68:71], v[40:43], v[112:119], v2
  s_waitcnt vmcnt(0)
  s_nop 2
  v_add_f32 v60, v60, v61
  v_add_f32 v62, v62, v63
  v_add_f32 v64, v64, v65
  v_add_f32 v66, v66, v67
  v_cvt_pk_bf16_f32 v12, v60, v64
  v_cvt_pk_bf16_f32 v13, v62, v66
  ds_write_b64 v4, v[12:13]
  v_add_f32 v68, v68, v69
  v_add_f32 v70, v70, v71
  v_cvt_pk_bf16_f32 v14, v68, v70
  ds_write_b16 v5, v14
  ds_write_b16_d16_hi v5, v14 offset:4
  s_waitcnt lgkmcnt(0)
  s_barrier
  ds_read_b64_tr_b16 v[44:45], v6 offset:0
  ds_read_b64_tr_b16 v[46:47], v6 offset:64
  ds_read_b64_tr_b16 v[48:49], v6 offset:256
  ds_read_b64_tr_b16 v[50:51], v6 offset:320
  ds_read_b64_tr_b16 v[52:53], v6 offset:512
  ds_read_b64_tr_b16 v[54:55], v6 offset:576
  s_waitcnt lgkmcnt(4)
  v_smfmac_f32_16x16x64_bf16 v[72:75], v[44:47], a[160:167], v2
  ds_read_b128 v[112:115], v8 offset:24576
  v_smfmac_f32_16x16x64_bf16 v[76:79], v[44:47], a[168:175], v2
  s_waitcnt lgkmcnt(3)
  ds_read_b128 v[116:119], v8 offset:25600
  v_smfmac_f32_16x16x64_bf16 v[72:75], v[48:51], a[240:247], v2
  v_smfmac_f32_16x16x64_bf16 v[76:79], v[48:51], a[248:255], v2
  s_waitcnt lgkmcnt(2)
  v_smfmac_f32_16x16x64_bf16 v[72:75], v[52:55], v[120:127], v2
  v_smfmac_f32_16x16x64_bf16 v[76:79], v[52:55], v[128:135], v2
  v_smfmac_f32_16x16x64_bf16 v[80:83], v[44:47], a[176:183], v2
  v_smfmac_f32_16x16x64_bf16 v[84:87], v[44:47], a[184:191], v2
  s_nop 4
  v_add_f32 v72, v72, v73
  v_add_f32 v74, v74, v75
  v_smfmac_f32_16x16x64_bf16 v[80:83], v[48:51], v[136:143], v2
  s_add_u32 s67, s51, 0
  v_cvt_pk_bf16_f32 v60, v72, v74
  v_add_f32 v76, v76, v77
  v_smfmac_f32_16x16x64_bf16 v[84:87], v[48:51], v[144:151], v2
  s_waitcnt lgkmcnt(0)
  v_add_f32 v78, v78, v79
  v_cvt_pk_bf16_f32 v61, v76, v78
  v_smfmac_f32_16x16x64_bf16 v[80:83], v[52:55], v[112:119], v2
  s_nop 0
  v_permlane32_swap_b32 v60, v61
  v_smfmac_f32_16x16x64_bf16 v[84:87], v[52:55], v[200:207], v2
  v_and_or_b32 v60, v60, -2, s52
  s_cmp_lg_u32 s49, 0
  s_cbranch_scc1 wt_96
  buffer_store_dwordx2 v[60:61], v7, s[8:11], s67 offen
wb_97:
  v_smfmac_f32_16x16x64_bf16 v[88:91], v[44:47], a[192:199], v2
  v_smfmac_f32_16x16x64_bf16 v[92:95], v[44:47], a[200:207], v2
  v_add_f32 v80, v80, v81
  v_add_f32 v82, v82, v83
  v_smfmac_f32_16x16x64_bf16 v[88:91], v[48:51], v[152:159], v2
  s_add_u32 s67, s51, 4096
  v_cvt_pk_bf16_f32 v62, v80, v82
  v_add_f32 v84, v84, v85
  v_smfmac_f32_16x16x64_bf16 v[92:95], v[48:51], v[160:167], v2
  v_add_f32 v86, v86, v87
  v_cvt_pk_bf16_f32 v63, v84, v86
  v_smfmac_f32_16x16x64_bf16 v[88:91], v[52:55], v[208:215], v2
  s_nop 0
  v_permlane32_swap_b32 v62, v63
  v_smfmac_f32_16x16x64_bf16 v[92:95], v[52:55], v[216:223], v2
  v_and_or_b32 v62, v62, -2, s52
  s_cmp_lg_u32 s49, 0
  s_cbranch_scc1 wt_98
  buffer_store_dwordx2 v[62:63], v7, s[8:11], s67 offen
wb_99:
  v_smfmac_f32_16x16x64_bf16 v[96:99], v[44:47], a[208:215], v2
  v_smfmac_f32_16x16x64_bf16 v[100:103], v[44:47], a[216:223], v2
  v_add_f32 v88, v88, v89
  v_add_f32 v90, v90, v91
  v_smfmac_f32_16x16x64_bf16 v[96:99], v[48:51], v[168:175], v2
  s_add_u32 s67, s51, 8192
  v_cvt_pk_bf16_f32 v64, v88, v90
  v_add_f32 v92, v92, v93
  v_smfmac_f32_16x16x64_bf16 v[100:103], v[48:51], v[176:183], v2
  v_add_f32 v94, v94, v95
  v_cvt_pk_bf16_f32 v65, v92, v94
  v_smfmac_f32_16x16x64_bf16 v[96:99], v[52:55], v[224:231], v2
  s_nop 0
  v_permlane32_swap_b32 v64, v65
  v_smfmac_f32_16x16x64_bf16 v[100:103], v[52:55], v[232:239], v2
  v_and_or_b32 v64, v64, -2, s52
  s_cmp_lg_u32 s49, 0
  s_cbranch_scc1 wt_100
  buffer_store_dwordx2 v[64:65], v7, s[8:11], s67 offen
wb_101:
  v_smfmac_f32_16x16x64_bf16 v[104:107], v[44:47], a[224:231], v2
  v_smfmac_f32_16x16x64_bf16 v[108:111], v[44:47], a[232:239], v2
  v_add_f32 v96, v96, v97
  v_add_f32 v98, v98, v99
  v_smfmac_f32_16x16x64_bf16 v[104:107], v[48:51], v[184:191], v2
  s_add_u32 s67, s51, 12288
  v_cvt_pk_bf16_f32 v66, v96, v98
  v_add_f32 v100, v100, v101
  v_smfmac_f32_16x16x64_bf16 v[108:111], v[48:51], v[192:199], v2
  v_add_f32 v102, v102, v103
  v_cvt_pk_bf16_f32 v67, v100, v102
  v_smfmac_f32_16x16x64_bf16 v[104:107], v[52:55], v[240:247], v2
  s_nop 0
  v_permlane32_swap_b32 v66, v67
  v_smfmac_f32_16x16x64_bf16 v[108:111], v[52:55], v[248:255], v2
  v_and_or_b32 v66, v66, -2, s52
  s_cmp_lg_u32 s49, 0
  s_cbranch_scc1 wt_102
  buffer_store_dwordx2 v[66:67], v7, s[8:11], s67 offen
wb_103:
  s_nop 0
  v_add_f32 v104, v104, v105
  v_add_f32 v106, v106, v107
  v_cvt_pk_bf16_f32 v68, v104, v106
  v_add_f32 v108, v108, v109
  v_add_f32 v110, v110, v111
  v_cvt_pk_bf16_f32 v69, v108, v110
  s_add_u32 s67, s51, 16384
  s_nop 0
  v_permlane32_swap_b32 v68, v69
  v_and_or_b32 v68, v68, -2, s52
  s_cmp_lg_u32 s49, 0
  s_cbranch_scc1 wt_104
  buffer_store_dwordx2 v[68:69], v7, s[8:11], s67 offen
wb_105:
  s_mov_b32 s51, s53
  s_mov_b32 s52, s54
  s_add_u32 s50, s50, 1
  s_cmp_lt_u32 s50, 128
  s_cbranch_scc1 CV_F2
  s_branch CV_END
CV_F3:
  ds_read_b128 v[112:115], v8 offset:16384
  ds_read_b128 v[116:119], v8 offset:17408
  ds_read_b128 v[120:123], v8 offset:18432
  ds_read_b128 v[124:127], v8 offset:19456
  ds_read_b128 v[128:131], v8 offset:0
  ds_read_b128 v[132:135], v8 offset:1024
  v_mov_b64 v[60:61], 0
  v_mov_b64 v[62:63], 0
  v_mov_b64 v[64:65], 0
  v_mov_b64 v[66:67], 0
  v_mov_b64 v[68:69], 0
  v_mov_b64 v[70:71], 0
  v_mov_b64 v[72:73], 0
  v_mov_b64 v[74:75], 0
  v_mov_b64 v[76:77], 0
  v_mov_b64 v[78:79], 0
  v_mov_b64 v[80:81], 0
  v_mov_b64 v[82:83], 0
  v_mov_b64 v[84:85], 0
  v_mov_b64 v[86:87], 0
  v_mov_b64 v[88:89], 0
  v_mov_b64 v[90:91], 0
  v_mov_b64 v[92:93], 0
  v_mov_b64 v[94:95], 0
  v_mov_b64 v[96:97], 0
  v_mov_b64 v[98:99], 0
  v_mov_b64 v[100:101], 0
  v_mov_b64 v[102:103], 0
  v_mov_b64 v[104:105], 0
  v_mov_b64 v[106:107], 0
  v_mov_b64 v[108:109], 0
  v_mov_b64 v[110:111], 0
  s_add_u32 s66, s51, 8192
  s_waitcnt lgkmcnt(0)
  buffer_load_dwordx4 v[52:55], v1, s[8:11], s66 offen offset:0 sc1
  buffer_load_dwordx4 v[56:59], v1, s[8:11], s66 offen offset:1024 sc1
  s_waitcnt vmcnt(0)
  v_bitop3_b32 v12, v52, v54, s52 bitop3:0x7e
  v_bitop3_b32 v13, v56, v58, s52 bitop3:0x7e
  v_bitop3_b32 v12, v12, v13, 1 bitop3:0xa8
  v_cmp_ne_u32 vcc, 0, v12
  s_nop 0
  s_cbranch_vccz po_107
  v_bitop3_b32 v12, v52, v54, s52 bitop3:0x42
  v_bitop3_b32 v13, v56, v58, s52 bitop3:0x42
  v_and_b32 v12, v12, v13
  v_and_b32 v12, 1, v12
  v_cmp_eq_u32 vcc, 0, v12
  s_nop 0
  s_cbranch_vccnz pg_108
lp_109:
  buffer_load_dword v12, v3, s[8:11], s66 offen offset:0 sc1
  s_waitcnt vmcnt(0)
  v_and_b32 v12, 1, v12
  v_cmp_eq_u32 vcc, s52, v12
  s_nop 0
  s_cbranch_vccnz lo_110
  s_sleep 1
  s_sub_u32 s47, s47, 1
  s_cbranch_scc0 lp_109
  s_branch ABORT
lo_110:
pg_108:
  buffer_load_dwordx4 v[52:55], v1, s[8:11], s66 offen offset:0 sc1
  buffer_load_dwordx4 v[56:59], v1, s[8:11], s66 offen offset:1024 sc1
  s_nop 11
  s_nop 11
pp_106:
  buffer_load_dwordx4 v[52:55], v1, s[8:11], s66 offen offset:0 sc1
  buffer_load_dwordx4 v[56:59], v1, s[8:11], s66 offen offset:1024 sc1
  s_waitcnt vmcnt(2)
  v_bitop3_b32 v12, v52, v54, s52 bitop3:0x7e
  v_bitop3_b32 v13, v56, v58, s52 bitop3:0x7e
  v_bitop3_b32 v12, v12, v13, 1 bitop3:0xa8
  v_cmp_ne_u32 vcc, 0, v12
  s_nop 0
  s_cbranch_vccz po_107
  s_sub_u32 s47, s47, 1
  s_cbranch_scc0 pp_106
  s_branch ABORT
po_107:
  v_smfmac_f32_16x16x64_bf16 v[60:63], v[52:55], a[128:135], v2
  s_add_u32 s62, s50, 1
  s_sub_i32 s60, s62, 13
  ds_write_b128 v9, v[52:55] offset:8192
  ds_write_b128 v9, v[56:59] offset:9216
  v_smfmac_f32_16x16x64_bf16 v[64:67], v[52:55], a[136:143], v2
  s_sub_i32 s57, s62, 12
  s_ashr_i32 s60, s60, 1
  s_waitcnt lgkmcnt(0)
  s_barrier
  ds_read_b128 v[20:23], v9 offset:0
  ds_read_b128 v[24:27], v9 offset:1024
  ds_read_b128 v[28:31], v9 offset:2048
  v_smfmac_f32_16x16x64_bf16 v[68:71], v[52:55], v[112:119], v2
  s_ashr_i32 s57, s57, 1
  s_sub_i32 s61, s62, 64
  ds_read_b128 v[112:115], v8 offset:2048
  v_smfmac_f32_16x16x64_bf16 v[60:63], v[56:59], a[144:151], v2
  s_max_i32 s60, s60, s61
  s_add_i32 s61, s61, 1
  ds_read_b128 v[32:35], v9 offset:3072
  v_smfmac_f32_16x16x64_bf16 v[64:67], v[56:59], a[152:159], v2
  s_max_i32 s57, s57, s61
  s_max_i32 s60, s60, 0
  ds_read_b128 v[116:119], v8 offset:3072
  v_smfmac_f32_16x16x64_bf16 v[68:71], v[56:59], v[120:127], v2
  s_waitcnt lgkmcnt(5)
  s_max_i32 s57, s57, 0
  ds_read_b128 v[36:39], v9 offset:4096
  v_smfmac_f32_16x16x64_bf16 v[60:63], v[20:23], a[0:7], v2
  s_sub_i32 s57, s57, s60
  s_sub_i32 s58, s62, s60
  ds_read_b128 v[120:123], v8 offset:4096
  v_smfmac_f32_16x16x64_bf16 v[64:67], v[20:23], a[8:15], v2
  s_sub_i32 s60, s60, s58
  s_mul_i32 s60, s60, s57
  ds_read_b128 v[40:43], v9 offset:5120
  v_smfmac_f32_16x16x64_bf16 v[68:71], v[20:23], v[128:135], v2
  s_waitcnt lgkmcnt(7)
  s_add_i32 s58, s58, s60
  ds_read_b128 v[124:127], v8 offset:5120
  v_smfmac_f32_16x16x64_bf16 v[60:63], v[24:27], a[16:23], v2
  s_and_b32 s60, s58, 1
  s_lshl_b32 s53, s57, 1
  ds_read_b128 v[44:47], v9 offset:6144
  v_smfmac_f32_16x16x64_bf16 v[64:67], v[24:27], a[24:31], v2
  s_waitcnt lgkmcnt(5)
  s_add_u32 s53, s53, s60
  ds_read_b128 v[128:131], v8 offset:6144
  v_smfmac_f32_16x16x64_bf16 v[68:71], v[24:27], v[112:119], v2
  s_lshl_b32 s53, s53, 17
  s_add_u32 s53, s53, s55
  ds_read_b128 v[48:51], v9 offset:7168
  v_smfmac_f32_16x16x64_bf16 v[60:63], v[28:31], a[32:39], v2
  s_bfe_u32 s54, s58, 0x10001
  ds_read_b128 v[132:135], v8 offset:7168
  v_smfmac_f32_16x16x64_bf16 v[64:67], v[28:31], a[40:47], v2
  s_waitcnt lgkmcnt(4)
  ds_read_b128 v[112:115], v8 offset:8192
  v_smfmac_f32_16x16x64_bf16 v[68:71], v[28:31], v[120:127], v2
  ds_read_b128 v[116:119], v8 offset:9216
  v_smfmac_f32_16x16x64_bf16 v[60:63], v[32:35], a[48:55], v2
  ds_read_b128 v[120:123], v8 offset:10240
  v_smfmac_f32_16x16x64_bf16 v[64:67], v[32:35], a[56:63], v2
  s_waitcnt lgkmcnt(3)
  ds_read_b128 v[124:127], v8 offset:11264
  v_smfmac_f32_16x16x64_bf16 v[68:71], v[32:35], v[128:135], v2
  ds_read_b128 v[128:131], v8 offset:12288
  v_smfmac_f32_16x16x64_bf16 v[60:63], v[36:39], a[64:71], v2
  ds_read_b128 v[132:135], v8 offset:13312
  v_smfmac_f32_16x16x64_bf16 v[64:67], v[36:39], a[72:79], v2
  s_waitcnt lgkmcnt(4)
  v_smfmac_f32_16x16x64_bf16 v[68:71], v[36:39], v[112:119], v2
  ds_read_b128 v[112:115], v8 offset:14336
  v_smfmac_f32_16x16x64_bf16 v[60:63], v[40:43], a[80:87], v2
  ds_read_b128 v[116:119], v8 offset:15360
  v_smfmac_f32_16x16x64_bf16 v[64:67], v[40:43], a[88:95], v2
  s_waitcnt lgkmcnt(4)
  v_smfmac_f32_16x16x64_bf16 v[68:71], v[40:43], v[120:127], v2
  ds_read_b128 v[120:123], v8 offset:20480
  v_smfmac_f32_16x16x64_bf16 v[60:63], v[44:47], a[96:103], v2
  ds_read_b128 v[124:127], v8 offset:21504
  v_smfmac_f32_16x16x64_bf16 v[64:67], v[44:47], a[104:111], v2
  s_waitcnt lgkmcnt(4)
  v_smfmac_f32_16x16x64_bf16 v[68:71], v[44:47], v[128:135], v2
  ds_read_b128 v[128:131], v8 offset:22528
  v_smfmac_f32_16x16x64_bf16 v[60:63], v[48:51], a[112:119], v2
  ds_read_b128 v[132:135], v8 offset:23552
  v_smfmac_f32_16x16x64_bf16 v[64:67], v[48:51], a[120:127], v2
  s_waitcnt lgkmcnt(4)
  v_smfmac_f32_16x16x64_bf16 v[68:71], v[48:51], v[112:119], v2
  s_waitcnt vmcnt(0)
  s_nop 2
  v_add_f32 v60, v60, v61
  v_add_f32 v62, v62, v63
  v_add_f32 v64, v64, v65
  v_add_f32 v66, v66, v67
  v_cvt_pk_bf16_f32 v12, v60, v64
  v_cvt_pk_bf16_f32 v13, v62, v66
  ds_write_b64 v4, v[12:13]
  v_add_f32 v68, v68, v69
  v_add_f32 v70, v70, v71
  v_cvt_pk_bf16_f32 v14, v68, v70
  ds_write_b16 v5, v14
  ds_write_b16_d16_hi v5, v14 offset:4
  s_waitcnt lgkmcnt(0)
  s_barrier
  ds_read_b64_tr_b16 v[44:45], v6 offset:0
  ds_read_b64_tr_b16 v[46:47], v6 offset:64
  ds_read_b64_tr_b16 v[48:49], v6 offset:256
  ds_read_b64_tr_b16 v[50:51], v6 offset:320
  ds_read_b64_tr_b16 v[52:53], v6 offset:512
  ds_read_b64_tr_b16 v[54:55], v6 offset:576
  s_waitcnt lgkmcnt(4)
  v_smfmac_f32_16x16x64_bf16 v[72:75], v[44:47], a[160:167], v2
  ds_read_b128 v[112:115], v8 offset:24576
  v_smfmac_f32_16x16x64_bf16 v[76:79], v[44:47], a[168:175], v2
  s_waitcnt lgkmcnt(3)
  ds_read_b128 v[116:119], v8 offset:25600
  v_smfmac_f32_16x16x64_bf16 v[72:75], v[48:51], a[240:247], v2
  v_smfmac_f32_16x16x64_bf16 v[76:79], v[48:51], a[248:255], v2
  s_waitcnt lgkmcnt(2)
  v_smfmac_f32_16x16x64_bf16 v[72:75], v[52:55], v[120:127], v2
  v_smfmac_f32_16x16x64_bf16 v[76:79], v[52:55], v[128:135], v2
  v_smfmac_f32_16x16x64_bf16 v[80:83], v[44:47], a[176:183], v2
  v_smfmac_f32_16x16x64_bf16 v[84:87], v[44:47], a[184:191], v2
  s_nop 4
  v_add_f32 v72, v72, v73
  v_add_f32 v74, v74, v75
  v_smfmac_f32_16x16x64_bf16 v[80:83], v[48:51], v[136:143], v2
  s_add_u32 s67, s51, 0
  v_cvt_pk_bf16_f32 v60, v72, v74
  v_add_f32 v76, v76, v77
  v_smfmac_f32_16x16x64_bf16 v[84:87], v[48:51], v[144:151], v2
  s_waitcnt lgkmcnt(0)
  v_add_f32 v78, v78, v79
  v_cvt_pk_bf16_f32 v61, v76, v78
  v_smfmac_f32_16x16x64_bf16 v[80:83], v[52:55], v[112:119], v2
  s_nop 0
  v_permlane32_swap_b32 v60, v61
  v_smfmac_f32_16x16x64_bf16 v[84:87], v[52:55], v[200:207], v2
  v_and_or_b32 v60, v60, -2, s52
  s_cmp_lg_u32 s49, 0
  s_cbranch_scc1 wt_111
  buffer_store_dwordx2 v[60:61], v7, s[8:11], s67 offen
wb_112:
  v_smfmac_f32_16x16x64_bf16 v[88:91], v[44:47], a[192:199], v2
  v_smfmac_f32_16x16x64_bf16 v[92:95], v[44:47], a[200:207], v2
  v_add_f32 v80, v80, v81
  v_add_f32 v82, v82, v83
  v_smfmac_f32_16x16x64_bf16 v[88:91], v[48:51], v[152:159], v2
  s_add_u32 s67, s51, 4096
  v_cvt_pk_bf16_f32 v62, v80, v82
  v_add_f32 v84, v84, v85
  v_smfmac_f32_16x16x64_bf16 v[92:95], v[48:51], v[160:167], v2
  v_add_f32 v86, v86, v87
  v_cvt_pk_bf16_f32 v63, v84, v86
  v_smfmac_f32_16x16x64_bf16 v[88:91], v[52:55], v[208:215], v2
  s_nop 0
  v_permlane32_swap_b32 v62, v63
  v_smfmac_f32_16x16x64_bf16 v[92:95], v[52:55], v[216:223], v2
  v_and_or_b32 v62, v62, -2, s52
  s_cmp_lg_u32 s49, 0
  s_cbranch_scc1 wt_113
  buffer_store_dwordx2 v[62:63], v7, s[8:11], s67 offen
wb_114:
  v_smfmac_f32_16x16x64_bf16 v[96:99], v[44:47], a[208:215], v2
  v_smfmac_f32_16x16x64_bf16 v[100:103], v[44:47], a[216:223], v2
  v_add_f32 v88, v88, v89
  v_add_f32 v90, v90, v91
  v_smfmac_f32_16x16x64_bf16 v[96:99], v[48:51], v[168:175], v2
  s_add_u32 s67, s51, 8192
  v_cvt_pk_bf16_f32 v64, v88, v90
  v_add_f32 v92, v92, v93
  v_smfmac_f32_16x16x64_bf16 v[100:103], v[48:51], v[176:183], v2
  v_add_f32 v94, v94, v95
  v_cvt_pk_bf16_f32 v65, v92, v94
  v_smfmac_f32_16x16x64_bf16 v[96:99], v[52:55], v[224:231], v2
  s_nop 0
  v_permlane32_swap_b32 v64, v65
  v_smfmac_f32_16x16x64_bf16 v[100:103], v[52:55], v[232:239], v2
  v_and_or_b32 v64, v64, -2, s52
  s_cmp_lg_u32 s49, 0
  s_cbranch_scc1 wt_115
  buffer_store_dwordx2 v[64:65], v7, s[8:11], s67 offen
wb_116:
  v_smfmac_f32_16x16x64_bf16 v[104:107], v[44:47], a[224:231], v2
  v_smfmac_f32_16x16x64_bf16 v[108:111], v[44:47], a[232:239], v2
  v_add_f32 v96, v96, v97
  v_add_f32 v98, v98, v99
  v_smfmac_f32_16x16x64_bf16 v[104:107], v[48:51], v[184:191], v2
  s_add_u32 s67, s51, 12288
  v_cvt_pk_bf16_f32 v66, v96, v98
  v_add_f32 v100, v100, v101
  v_smfmac_f32_16x16x64_bf16 v[108:111], v[48:51], v[192:199], v2
  v_add_f32 v102, v102, v103
  v_cvt_pk_bf16_f32 v67, v100, v102
  v_smfmac_f32_16x16x64_bf16 v[104:107], v[52:55], v[240:247], v2
  s_nop 0
  v_permlane32_swap_b32 v66, v67
  v_smfmac_f32_16x16x64_bf16 v[108:111], v[52:55], v[248:255], v2
  v_and_or_b32 v66, v66, -2, s52
  s_cmp_lg_u32 s49, 0
  s_cbranch_scc1 wt_117
  buffer_store_dwordx2 v[66:67], v7, s[8:11], s67 offen
wb_118:
  s_nop 0
  v_add_f32 v104, v104, v105
  v_add_f32 v106, v106, v107
  v_cvt_pk_bf16_f32 v68, v104, v106
  v_add_f32 v108, v108, v109
  v_add_f32 v110, v110, v111
  v_cvt_pk_bf16_f32 v69, v108, v110
  s_add_u32 s67, s51, 16384
  s_nop 0
  v_permlane32_swap_b32 v68, v69
  v_and_or_b32 v68, v68, -2, s52
  s_cmp_lg_u32 s49, 0
  s_cbranch_scc1 wt_119
  buffer_store_dwordx2 v[68:69], v7, s[8:11], s67 offen
wb_120:
  s_mov_b32 s51, s53
  s_mov_b32 s52, s54
  s_add_u32 s50, s50, 1
  s_cmp_lt_u32 s50, 128
  s_cbranch_scc1 CV_F3
  s_branch CV_END
CV_END:
  s_endpgm
wt_66:
  s_nop 7
  buffer_store_dwordx2 v[60:61], v7, s[8:11], s67 offen sc1
  s_branch wb_67
wt_68:
  s_nop 7
  buffer_store_dwordx2 v[62:63], v7, s[8:11], s67 offen sc1
  s_branch wb_69
wt_70:
  s_nop 7
  buffer_store_dwordx2 v[64:65], v7, s[8:11], s67 offen sc1
  s_branch wb_71
wt_72:
  s_nop 7
  buffer_store_dwordx2 v[66:67], v7, s[8:11], s67 offen sc1
  s_branch wb_73
wt_74:
  s_nop 7
  buffer_store_dwordx2 v[68:69], v7, s[8:11], s67 offen sc1
  s_branch wb_75
wt_81:
  s_nop 7
  buffer_store_dwordx2 v[60:61], v7, s[8:11], s67 offen sc1
  s_branch wb_82
wt_83:
  s_nop 7
  buffer_store_dwordx2 v[62:63], v7, s[8:11], s67 offen sc1
  s_branch wb_84
wt_85:
  s_nop 7
  buffer_store_dwordx2 v[64:65], v7, s[8:11], s67 offen sc1
  s_branch wb_86
wt_87:
  s_nop 7
  buffer_store_dwordx2 v[66:67], v7, s[8:11], s67 offen sc1
  s_branch wb_88
wt_89:
  s_nop 7
  buffer_store_dwordx2 v[68:69], v7, s[8:11], s67 offen sc1
  s_branch wb_90
wt_96:
  s_nop 7
  buffer_store_dwordx2 v[60:61], v7, s[8:11], s67 offen sc1
  s_branch wb_97
wt_98:
  s_nop 7
  buffer_store_dwordx2 v[62:63], v7, s[8:11], s67 offen sc1
  s_branch wb_99
wt_100:
  s_nop 7
  buffer_store_dwordx2 v[64:65], v7, s[8:11], s67 offen sc1
  s_branch wb_101
wt_102:
  s_nop 7
  buffer_store_dwordx2 v[66:67], v7, s[8:11], s67 offen sc1
  s_branch wb_103
wt_104:
  s_nop 7
  buffer_store_dwordx2 v[68:69], v7, s[8:11], s67 offen sc1
  s_branch wb_105
wt_111:
  s_nop 7
  buffer_store_dwordx2 v[60:61], v7, s[8:11], s67 offen sc1
  s_branch wb_112
wt_113:
  s_nop 7
  buffer_store_dwordx2 v[62:63], v7, s[8:11], s67 offen sc1
  s_branch wb_114
wt_115:
  s_nop 7
  buffer_store_dwordx2 v[64:65], v7, s[8:11], s67 offen sc1
  s_branch wb_116
wt_117:
  s_nop 7
  buffer_store_dwordx2 v[66:67], v7, s[8:11], s67 offen sc1
  s_branch wb_118
wt_119:
  s_nop 7
  buffer_store_dwordx2 v[68:69], v7, s[8:11], s67 offen sc1
  s_branch wb_120
GO_OW:
ROLE_OW:
  v_lshlrev_b32 v1, 4, v0
  v_mov_b32 v5, 1
  s_lshr_b32 s56, s48, 3
  s_and_b32 s57, s48, 1
  s_bfe_u32 s58, s48, 0x20001
  s_mul_i32 s55, s56, 524288
  s_lshl_b32 s60, s57, 18
  s_add_u32 s55, s55, s60
  s_add_u32 s55, s55, 2097152
  s_lshl_b32 s74, s46, 1
  s_add_u32 s74, s74, 2
  s_cmp_eq_u32 s46, 0
  s_cselect_b32 s74, 0, s74
  s_cselect_b32 s75, 2, 3
  s_mov_b32 s82, 0x33333333
  s_mov_b32 s83, 0x33333333
  v_and_b32 v32, 1, v0
  v_mul_u32_u24 v26, 0xaaaa, v32
  v_add_u32 v26, 0x4444, v26
  v_bfe_u32 v32, v0, 2, 2
  v_and_b32 v33, 7, v0
  v_bfe_u32 v34, v0, 3, 1
  v_lshrrev_b32 v42, 4, v0
  v_and_b32 v43, 1, v0
  v_lshl_add_u32 v42, v42, 1, v43
  v_bfe_u32 v43, v0, 1, 1
  v_lshlrev_b32 v21, 3, v0
  v_add_u32 v21, 0x1000, v21
  s_mul_i32 s61, s58, 10
  s_add_u32 s74, s74, s61
  s_add_u32 s75, s75, s61
  s_lshl_b32 s60, s74, 13
  v_add_u32 v8, s60, v1
  v_add_u32 v9, 0x2000, v8
  s_lshl_b32 s60, s75, 13
  v_add_u32 v10, s60, v1
  s_lshl_b32 s60, s74, 11
  s_add_u32 s60, s60, 40960
  v_add_u32 v11, s60, v1
  s_lshr_b32 s60, s74, 1
  s_lshl_b32 s60, s60, 11
  s_and_b32 s61, s60, 0xffffe000
  s_add_u32 s60, s60, s61
  s_and_b32 s61, s74, 1
  s_lshl3_add_u32 s60, s61, s60
  v_add_u32 v24, s60, v1
  s_lshr_b32 s60, s74, 2
  s_lshl_b32 s60, s60, 10
  s_lshl4_add_u32 s60, s61, s60
  s_and_b32 s61, s74, 2
  s_lshl2_add_u32 s60, s61, s60
  v_lshl_add_u32 v22, v32, 8, s60
  v_lshl_add_u32 v22, v42, 5, v22
  v_lshl_add_u32 v22, v43, 4, v22
  s_lshl_b32 s60, s75, 11
  s_add_u32 s60, s60, 40960
  v_add_u32 v12, s60, v1
  s_lshr_b32 s60, s75, 1
  s_lshl_b32 s60, s60, 11
  s_and_b32 s61, s60, 0xffffe000
  s_add_u32 s60, s60, s61
  s_and_b32 s61, s75, 1
  s_lshl3_add_u32 s60, s61, s60
  v_add_u32 v25, s60, v1
  s_lshr_b32 s60, s75, 2
  s_lshl_b32 s60, s60, 10
  s_lshl4_add_u32 s60, s61, s60
  s_and_b32 s61, s75, 2
  s_lshl2_add_u32 s60, s61, s60
  v_lshl_add_u32 v23, v32, 8, s60
  v_lshl_add_u32 v23, v42, 5, v23
  s_lshl_b32 s60, s74, 11
  s_lshl_b32 s61, s75, 11
  s_cmp_lt_u32 s46, 2
  s_cselect_b32 s61, s61, s60
  v_lshl_add_u32 v2, v34, 11, s60
  v_mov_b32 v35, s61
  v_cmp_gt_u32 vcc, 16, v0
  s_nop 1
  v_cndmask_b32 v2, v35, v2, vcc
  v_lshl_add_u32 v2, v33, 8, v2
  v_add_u32 v2, 41208, v2
  s_add_u32 s60, s46, 0
  s_and_b32 s60, s60, 3
  s_lshl_b32 s78, s60, 11
  s_lshl_b32 s61, s60, 10
  v_add_u32 v13, s61, v1
  s_lshl_b32 s61, s60, 12
  v_add_u32 v17, s61, v1
  s_add_u32 s60, s46, 1
  s_and_b32 s60, s60, 3
  s_lshl_b32 s79, s60, 11
  s_lshl_b32 s61, s60, 10
  v_add_u32 v14, s61, v1
  s_lshl_b32 s61, s60, 12
  v_add_u32 v18, s61, v1
  s_add_u32 s60, s46, 2
  s_and_b32 s60, s60, 3
  s_lshl_b32 s80, s60, 11
  s_lshl_b32 s61, s60, 10
  v_add_u32 v15, s61, v1
  s_lshl_b32 s61, s60, 12
  v_add_u32 v19, s61, v1
  s_add_u32 s60, s46, 3
  s_and_b32 s60, s60, 3
  s_lshl_b32 s81, s60, 11
  s_lshl_b32 s61, s60, 10
  v_add_u32 v16, s61, v1
  s_lshl_b32 s61, s60, 12
  v_add_u32 v20, s61, v1
  v_add_u32 v31, 0x4000, v13
  s_lshl_b32 s60, s56, 7
  s_lshl_b32 s61, s58, 2
  s_add_u32 s60, s60, s61
  v_lshl_add_u32 v3, v33, 4, s60
  s_lshl_b32 s60, s57, 15
  s_add_u32 s73, s60, 196608
  s_add_u32 s61, s61, s46
  s_lshl_b32 s76, s56, 7
  s_lshl2_add_u32 s76, s61, s76
  s_add_u32 s76, s76, s73
  s_add_u32 s76, s76, 512
  s_lshl_b32 s59, s61, 14
  s_mul_i32 s60, s57, 524288
  s_add_u32 s59, s59, s60
  s_add_u32 s59, s59, 4194304
  s_mul_i32 s69, s57, 2097152
  s_mul_i32 s60, s56, 81920
  s_add_u32 s69, s69, s60
  s_add_u32 s69, s69, 6291456
  s_lshl1_add_u32 s60, s56, s57
  s_mul_i32 s71, s60, 1310720
  s_add_u32 s71, s71, 24117248
  s_mov_b32 s4, s18
  s_mov_b32 s5, s19
  s_mov_b32 s6, 10240
  s_mov_b32 s7, 0x20000
  v_mul_u32_u24 v36, 1280, v42
  v_lshl_add_u32 v36, v32, 3, v36
  v_lshl_add_u32 v37, v43, 5, v36
  s_lshl_b32 s60, s74, 5
  buffer_load_dwordx2 v[38:39], v37, s[4:7], s60 offen
  s_lshl_b32 s60, s75, 5
  buffer_load_dwordx2 v[40:41], v36, s[4:7], s60 offen
  v_mov_b32 v204, -1
  v_mov_b32 v205, -1
  v_mov_b32 v206, -1
  v_mov_b32 v207, -1
  s_lshl_b32 s61, s56, 10
  s_add_u32 s60, s59, 0
  s_add_u32 s61, s61, s60
  buffer_store_dwordx4 v[204:207], v1, s[8:11], s61 offen sc1
  s_lshl_b32 s61, s56, 9
  s_add_u32 s61, s61, s60
  buffer_store_dwordx2 v[204:205], v21, s[8:11], s61 offen sc1
  s_lshl_b32 s61, s56, 10
  s_add_u32 s60, s59, 8192
  s_add_u32 s61, s61, s60
  buffer_store_dwordx4 v[204:207], v1, s[8:11], s61 offen sc1
  s_lshl_b32 s61, s56, 9
  s_add_u32 s61, s61, s60
  buffer_store_dwordx2 v[204:205], v21, s[8:11], s61 offen sc1
  s_lshl_b32 s61, s56, 10
  s_add_u32 s60, s59, 262144
  s_add_u32 s61, s61, s60
  buffer_store_dwordx4 v[204:207], v1, s[8:11], s61 offen sc1
  s_lshl_b32 s61, s56, 9
  s_add_u32 s61, s61, s60
  buffer_store_dwordx2 v[204:205], v21, s[8:11], s61 offen sc1
  s_lshl_b32 s61, s56, 10
  s_add_u32 s60, s59, 270336
  s_add_u32 s61, s61, s60
  buffer_store_dwordx4 v[204:207], v1, s[8:11], s61 offen sc1
  s_lshl_b32 s61, s56, 9
  s_add_u32 s61, s61, s60
  buffer_store_dwordx2 v[204:205], v21, s[8:11], s61 offen sc1
  s_add_u32 s60, s69, 0
  buffer_store_dwordx4 v[204:207], v24, s[8:11], s60 offen offset:0 sc1
  buffer_store_dwordx2 v[204:205], v25, s[8:11], s60 offen offset:0 sc1
  buffer_store_dwordx4 v[204:207], v24, s[8:11], s60 offen offset:1024 sc1
  buffer_store_dwordx2 v[204:205], v25, s[8:11], s60 offen offset:1024 sc1
  s_add_u32 s60, s69, 8192
  buffer_store_dwordx4 v[204:207], v24, s[8:11], s60 offen offset:0 sc1
  buffer_store_dwordx2 v[204:205], v25, s[8:11], s60 offen offset:0 sc1
  buffer_store_dwordx4 v[204:207], v24, s[8:11], s60 offen offset:1024 sc1
  buffer_store_dwordx2 v[204:205], v25, s[8:11], s60 offen offset:1024 sc1
  s_add_u32 s60, s69, 327680
  buffer_store_dwordx4 v[204:207], v24, s[8:11], s60 offen offset:0 sc1
  buffer_store_dwordx2 v[204:205], v25, s[8:11], s60 offen offset:0 sc1
  buffer_store_dwordx4 v[204:207], v24, s[8:11], s60 offen offset:1024 sc1
  buffer_store_dwordx2 v[204:205], v25, s[8:11], s60 offen offset:1024 sc1
  s_add_u32 s60, s69, 335872
  buffer_store_dwordx4 v[204:207], v24, s[8:11], s60 offen offset:0 sc1
  buffer_store_dwordx2 v[204:205], v25, s[8:11], s60 offen offset:0 sc1
  buffer_store_dwordx4 v[204:207], v24, s[8:11], s60 offen offset:1024 sc1
  buffer_store_dwordx2 v[204:205], v25, s[8:11], s60 offen offset:1024 sc1
  s_add_u32 s60, s69, 655360
  buffer_store_dwordx4 v[204:207], v24, s[8:11], s60 offen offset:0 sc1
  buffer_store_dwordx2 v[204:205], v25, s[8:11], s60 offen offset:0 sc1
  buffer_store_dwordx4 v[204:207], v24, s[8:11], s60 offen offset:1024 sc1
  buffer_store_dwordx2 v[204:205], v25, s[8:11], s60 offen offset:1024 sc1
  s_add_u32 s60, s69, 663552
  buffer_store_dwordx4 v[204:207], v24, s[8:11], s60 offen offset:0 sc1
  buffer_store_dwordx2 v[204:205], v25, s[8:11], s60 offen offset:0 sc1
  buffer_store_dwordx4 v[204:207], v24, s[8:11], s60 offen offset:1024 sc1
  buffer_store_dwordx2 v[204:205], v25, s[8:11], s60 offen offset:1024 sc1
  s_add_u32 s60, s69, 983040
  buffer_store_dwordx4 v[204:207], v24, s[8:11], s60 offen offset:0 sc1
  buffer_store_dwordx2 v[204:205], v25, s[8:11], s60 offen offset:0 sc1
  buffer_store_dwordx4 v[204:207], v24, s[8:11], s60 offen offset:1024 sc1
  buffer_store_dwordx2 v[204:205], v25, s[8:11], s60 offen offset:1024 sc1
  s_add_u32 s60, s69, 991232
  buffer_store_dwordx4 v[204:207], v24, s[8:11], s60 offen offset:0 sc1
  buffer_store_dwordx2 v[204:205], v25, s[8:11], s60 offen offset:0 sc1
  buffer_store_dwordx4 v[204:207], v24, s[8:11], s60 offen offset:1024 sc1
  buffer_store_dwordx2 v[204:205], v25, s[8:11], s60 offen offset:1024 sc1
  s_add_u32 s60, s55, 131072
  buffer_store_dwordx2 v[204:205], v22, s[8:11], s60 offen sc1
  buffer_store_dwordx2 v[204:205], v23, s[8:11], s60 offen sc1
  s_waitcnt vmcnt(0)
  v_and_b32 v38, -2, v38
  v_and_b32 v40, -2, v40
  buffer_store_dwordx2 v[38:39], v22, s[8:11], s55 offen sc1
  buffer_store_dwordx2 v[40:41], v23, s[8:11], s55 offen sc1
  s_waitcnt vmcnt(0)
  s_barrier
  s_cmp_lg_u32 s46, 0
  s_cbranch_scc1 arr_121
  v_mov_b32 v32, 1
  s_lshl_b32 s3, s49, 2
  v_mov_b32 v33, s3
  s_mov_b64 exec, 1
  buffer_atomic_add v32, v33, s[12:15], 0 offen sc1
  s_mov_b64 exec, -1
arr_121:
  s_and_b32 s60, s46, 1
  s_lshr_b32 s61, s46, 1
  v_and_b32 v32, 15, v0
  v_mul_u32_u24 v44, 1280, v32
  v_lshrrev_b32 v33, 4, v0
  v_lshl_add_u32 v44, v33, 3, v44
  s_mul_i32 s62, s60, 20480
  s_mul_i32 s63, s61, 640
  s_add_u32 s62, s62, s63
  v_add_u32 v44, s62, v44
  v_lshlrev_b32 v45, 8, v33
  v_lshl_add_u32 v45, v32, 3, v45
  s_mul_i32 s62, s61, 2560
  s_lshl_b32 s63, s60, 7
  s_add_u32 s62, s62, s63
  s_add_u32 s62, s62, 40960
  v_add_u32 v45, s62, v45
  s_mul_i32 s65, s61, 20480
  s_lshl_b32 s63, s60, 10
  s_add_u32 s65, s65, s63
  s_mov_b32 s4, s16
  s_mov_b32 s5, s17
  s_mov_b32 s6, 2621440
  s_mov_b32 s7, 0x20000
  s_add_u32 s62, s48, 0
  s_mul_i32 s62, s62, 40960
  buffer_load_dwordx2 v[48:49], v44, s[4:7], s62 offen offset:0
  buffer_load_dwordx2 v[50:51], v44, s[4:7], s62 offen offset:32
  buffer_load_dwordx2 v[52:53], v44, s[4:7], s62 offen offset:64
  buffer_load_dwordx2 v[54:55], v44, s[4:7], s62 offen offset:96
  buffer_load_dwordx2 v[56:57], v44, s[4:7], s62 offen offset:128
  buffer_load_dwordx2 v[58:59], v44, s[4:7], s62 offen offset:160
  buffer_load_dwordx2 v[60:61], v44, s[4:7], s62 offen offset:192
  buffer_load_dwordx2 v[62:63], v44, s[4:7], s62 offen offset:224
  buffer_load_dwordx2 v[64:65], v44, s[4:7], s62 offen offset:256
  buffer_load_dwordx2 v[66:67], v44, s[4:7], s62 offen offset:288
  buffer_load_dwordx2 v[68:69], v44, s[4:7], s62 offen offset:320
  buffer_load_dwordx2 v[70:71], v44, s[4:7], s62 offen offset:352
  buffer_load_dwordx2 v[72:73], v44, s[4:7], s62 offen offset:384
  buffer_load_dwordx2 v[74:75], v44, s[4:7], s62 offen offset:416
  buffer_load_dwordx2 v[76:77], v44, s[4:7], s62 offen offset:448
  buffer_load_dwordx2 v[78:79], v44, s[4:7], s62 offen offset:480
  buffer_load_dwordx2 v[80:81], v44, s[4:7], s62 offen offset:512
  buffer_load_dwordx2 v[82:83], v44, s[4:7], s62 offen offset:544
  buffer_load_dwordx2 v[84:85], v44, s[4:7], s62 offen offset:576
  buffer_load_dwordx2 v[86:87], v44, s[4:7], s62 offen offset:608
  s_add_u32 s62, s48, 32
  s_mul_i32 s62, s62, 40960
  buffer_load_dwordx2 v[88:89], v44, s[4:7], s62 offen offset:0
  buffer_load_dwordx2 v[90:91], v44, s[4:7], s62 offen offset:32
  buffer_load_dwordx2 v[92:93], v44, s[4:7], s62 offen offset:64
  buffer_load_dwordx2 v[94:95], v44, s[4:7], s62 offen offset:96
  buffer_load_dwordx2 v[96:97], v44, s[4:7], s62 offen offset:128
  buffer_load_dwordx2 v[98:99], v44, s[4:7], s62 offen offset:160
  buffer_load_dwordx2 v[100:101], v44, s[4:7], s62 offen offset:192
  buffer_load_dwordx2 v[102:103], v44, s[4:7], s62 offen offset:224
  buffer_load_dwordx2 v[104:105], v44, s[4:7], s62 offen offset:256
  buffer_load_dwordx2 v[106:107], v44, s[4:7], s62 offen offset:288
  buffer_load_dwordx2 v[108:109], v44, s[4:7], s62 offen offset:320
  buffer_load_dwordx2 v[110:111], v44, s[4:7], s62 offen offset:352
  buffer_load_dwordx2 v[112:113], v44, s[4:7], s62 offen offset:384
  buffer_load_dwordx2 v[114:115], v44, s[4:7], s62 offen offset:416
  buffer_load_dwordx2 v[116:117], v44, s[4:7], s62 offen offset:448
  buffer_load_dwordx2 v[118:119], v44, s[4:7], s62 offen offset:480
  buffer_load_dwordx2 v[120:121], v44, s[4:7], s62 offen offset:512
  buffer_load_dwordx2 v[122:123], v44, s[4:7], s62 offen offset:544
  buffer_load_dwordx2 v[124:125], v44, s[4:7], s62 offen offset:576
  buffer_load_dwordx2 v[126:127], v44, s[4:7], s62 offen offset:608
  s_add_u32 s62, s48, 0
  s_mul_i32 s64, s62, 46080
  s_add_u32 s64, s64, 10485760
  s_add_u32 s63, s64, s65
  s_waitcnt vmcnt(20)
  buffer_store_dwordx4 v[48:51], v1, s[8:11], s63 offen offset:0 sc1
  buffer_store_dwordx4 v[52:55], v1, s[8:11], s63 offen offset:2048 sc1
  s_add_u32 s63, s63, 4096
  buffer_store_dwordx4 v[56:59], v1, s[8:11], s63 offen offset:0 sc1
  buffer_store_dwordx4 v[60:63], v1, s[8:11], s63 offen offset:2048 sc1
  s_add_u32 s63, s63, 4096
  buffer_store_dwordx4 v[64:67], v1, s[8:11], s63 offen offset:0 sc1
  buffer_store_dwordx4 v[68:71], v1, s[8:11], s63 offen offset:2048 sc1
  s_add_u32 s63, s63, 4096
  buffer_store_dwordx4 v[72:75], v1, s[8:11], s63 offen offset:0 sc1
  buffer_store_dwordx4 v[76:79], v1, s[8:11], s63 offen offset:2048 sc1
  s_add_u32 s63, s63, 4096
  buffer_store_dwordx4 v[80:83], v1, s[8:11], s63 offen offset:0 sc1
  buffer_store_dwordx4 v[84:87], v1, s[8:11], s63 offen offset:2048 sc1
  s_add_u32 s63, s63, 4096
  v_mov_b64 v[32:33], 0
  v_lshlrev_b32 v128, 16, v48
  v_and_b32 v129, 0xffff0000, v48
  v_add_f32 v32, v32, v128
  v_fmac_f32 v33, v128, v128
  v_add_f32 v32, v32, v129
  v_fmac_f32 v33, v129, v129
  v_lshlrev_b32 v128, 16, v49
  v_and_b32 v129, 0xffff0000, v49
  v_add_f32 v32, v32, v128
  v_fmac_f32 v33, v128, v128
  v_add_f32 v32, v32, v129
  v_fmac_f32 v33, v129, v129
  v_lshlrev_b32 v128, 16, v50
  v_and_b32 v129, 0xffff0000, v50
  v_add_f32 v32, v32, v128
  v_fmac_f32 v33, v128, v128
  v_add_f32 v32, v32, v129
  v_fmac_f32 v33, v129, v129
  v_lshlrev_b32 v128, 16, v51
  v_and_b32 v129, 0xffff0000, v51
  v_add_f32 v32, v32, v128
  v_fmac_f32 v33, v128, v128
  v_add_f32 v32, v32, v129
  v_fmac_f32 v33, v129, v129
  v_lshlrev_b32 v128, 16, v52
  v_and_b32 v129, 0xffff0000, v52
  v_add_f32 v32, v32, v128
  v_fmac_f32 v33, v128, v128
  v_add_f32 v32, v32, v129
  v_fmac_f32 v33, v129, v129
  v_lshlrev_b32 v128, 16, v53
  v_and_b32 v129, 0xffff0000, v53
  v_add_f32 v32, v32, v128
  v_fmac_f32 v33, v128, v128
  v_add_f32 v32, v32, v129
  v_fmac_f32 v33, v129, v129
  v_lshlrev_b32 v128, 16, v54
  v_and_b32 v129, 0xffff0000, v54
  v_add_f32 v32, v32, v128
  v_fmac_f32 v33, v128, v128
  v_add_f32 v32, v32, v129
  v_fmac_f32 v33, v129, v129
  v_lshlrev_b32 v128, 16, v55
  v_and_b32 v129, 0xffff0000, v55
  v_add_f32 v32, v32, v128
  v_fmac_f32 v33, v128, v128
  v_add_f32 v32, v32, v129
  v_fmac_f32 v33, v129, v129
  v_lshlrev_b32 v128, 16, v56
  v_and_b32 v129, 0xffff0000, v56
  v_add_f32 v32, v32, v128
  v_fmac_f32 v33, v128, v128
  v_add_f32 v32, v32, v129
  v_fmac_f32 v33, v129, v129
  v_lshlrev_b32 v128, 16, v57
  v_and_b32 v129, 0xffff0000, v57
  v_add_f32 v32, v32, v128
  v_fmac_f32 v33, v128, v128
  v_add_f32 v32, v32, v129
  v_fmac_f32 v33, v129, v129
  v_lshlrev_b32 v128, 16, v58
  v_and_b32 v129, 0xffff0000, v58
  v_add_f32 v32, v32, v128
  v_fmac_f32 v33, v128, v128
  v_add_f32 v32, v32, v129
  v_fmac_f32 v33, v129, v129
  v_lshlrev_b32 v128, 16, v59
  v_and_b32 v129, 0xffff0000, v59
  v_add_f32 v32, v32, v128
  v_fmac_f32 v33, v128, v128
  v_add_f32 v32, v32, v129
  v_fmac_f32 v33, v129, v129
  v_lshlrev_b32 v128, 16, v60
  v_and_b32 v129, 0xffff0000, v60
  v_add_f32 v32, v32, v128
  v_fmac_f32 v33, v128, v128
  v_add_f32 v32, v32, v129
  v_fmac_f32 v33, v129, v129
  v_lshlrev_b32 v128, 16, v61
  v_and_b32 v129, 0xffff0000, v61
  v_add_f32 v32, v32, v128
  v_fmac_f32 v33, v128, v128
  v_add_f32 v32, v32, v129
  v_fmac_f32 v33, v129, v129
  v_lshlrev_b32 v128, 16, v62
  v_and_b32 v129, 0xffff0000, v62
  v_add_f32 v32, v32, v128
  v_fmac_f32 v33, v128, v128
  v_add_f32 v32, v32, v129
  v_fmac_f32 v33, v129, v129
  v_lshlrev_b32 v128, 16, v63
  v_and_b32 v129, 0xffff0000, v63
  v_add_f32 v32, v32, v128
  v_fmac_f32 v33, v128, v128
  v_add_f32 v32, v32, v129
  v_fmac_f32 v33, v129, v129
  v_lshlrev_b32 v128, 16, v64
  v_and_b32 v129, 0xffff0000, v64
  v_add_f32 v32, v32, v128
  v_fmac_f32 v33, v128, v128
  v_add_f32 v32, v32, v129
  v_fmac_f32 v33, v129, v129
  v_lshlrev_b32 v128, 16, v65
  v_and_b32 v129, 0xffff0000, v65
  v_add_f32 v32, v32, v128
  v_fmac_f32 v33, v128, v128
  v_add_f32 v32, v32, v129
  v_fmac_f32 v33, v129, v129
  v_lshlrev_b32 v128, 16, v66
  v_and_b32 v129, 0xffff0000, v66
  v_add_f32 v32, v32, v128
  v_fmac_f32 v33, v128, v128
  v_add_f32 v32, v32, v129
  v_fmac_f32 v33, v129, v129
  v_lshlrev_b32 v128, 16, v67
  v_and_b32 v129, 0xffff0000, v67
  v_add_f32 v32, v32, v128
  v_fmac_f32 v33, v128, v128
  v_add_f32 v32, v32, v129
  v_fmac_f32 v33, v129, v129
  v_lshlrev_b32 v128, 16, v68
  v_and_b32 v129, 0xffff0000, v68
  v_add_f32 v32, v32, v128
  v_fmac_f32 v33, v128, v128
  v_add_f32 v32, v32, v129
  v_fmac_f32 v33, v129, v129
  v_lshlrev_b32 v128, 16, v69
  v_and_b32 v129, 0xffff0000, v69
  v_add_f32 v32, v32, v128
  v_fmac_f32 v33, v128, v128
  v_add_f32 v32, v32, v129
  v_fmac_f32 v33, v129, v129
  v_lshlrev_b32 v128, 16, v70
  v_and_b32 v129, 0xffff0000, v70
  v_add_f32 v32, v32, v128
  v_fmac_f32 v33, v128, v128
  v_add_f32 v32, v32, v129
  v_fmac_f32 v33, v129, v129
  v_lshlrev_b32 v128, 16, v71
  v_and_b32 v129, 0xffff0000, v71
  v_add_f32 v32, v32, v128
  v_fmac_f32 v33, v128, v128
  v_add_f32 v32, v32, v129
  v_fmac_f32 v33, v129, v129
  v_lshlrev_b32 v128, 16, v72
  v_and_b32 v129, 0xffff0000, v72
  v_add_f32 v32, v32, v128
  v_fmac_f32 v33, v128, v128
  v_add_f32 v32, v32, v129
  v_fmac_f32 v33, v129, v129
  v_lshlrev_b32 v128, 16, v73
  v_and_b32 v129, 0xffff0000, v73
  v_add_f32 v32, v32, v128
  v_fmac_f32 v33, v128, v128
  v_add_f32 v32, v32, v129
  v_fmac_f32 v33, v129, v129
  v_lshlrev_b32 v128, 16, v74
  v_and_b32 v129, 0xffff0000, v74
  v_add_f32 v32, v32, v128
  v_fmac_f32 v33, v128, v128
  v_add_f32 v32, v32, v129
  v_fmac_f32 v33, v129, v129
  v_lshlrev_b32 v128, 16, v75
  v_and_b32 v129, 0xffff0000, v75
  v_add_f32 v32, v32, v128
  v_fmac_f32 v33, v128, v128
  v_add_f32 v32, v32, v129
  v_fmac_f32 v33, v129, v129
  v_lshlrev_b32 v128, 16, v76
  v_and_b32 v129, 0xffff0000, v76
  v_add_f32 v32, v32, v128
  v_fmac_f32 v33, v128, v128
  v_add_f32 v32, v32, v129
  v_fmac_f32 v33, v129, v129
  v_lshlrev_b32 v128, 16, v77
  v_and_b32 v129, 0xffff0000, v77
  v_add_f32 v32, v32, v128
  v_fmac_f32 v33, v128, v128
  v_add_f32 v32, v32, v129
  v_fmac_f32 v33, v129, v129
  v_lshlrev_b32 v128, 16, v78
  v_and_b32 v129, 0xffff0000, v78
  v_add_f32 v32, v32, v128
  v_fmac_f32 v33, v128, v128
  v_add_f32 v32, v32, v129
  v_fmac_f32 v33, v129, v129
  v_lshlrev_b32 v128, 16, v79
  v_and_b32 v129, 0xffff0000, v79
  v_add_f32 v32, v32, v128
  v_fmac_f32 v33, v128, v128
  v_add_f32 v32, v32, v129
  v_fmac_f32 v33, v129, v129
  v_lshlrev_b32 v128, 16, v80
  v_and_b32 v129, 0xffff0000, v80
  v_add_f32 v32, v32, v128
  v_fmac_f32 v33, v128, v128
  v_add_f32 v32, v32, v129
  v_fmac_f32 v33, v129, v129
  v_lshlrev_b32 v128, 16, v81
  v_and_b32 v129, 0xffff0000, v81
  v_add_f32 v32, v32, v128
  v_fmac_f32 v33, v128, v128
  v_add_f32 v32, v32, v129
  v_fmac_f32 v33, v129, v129
  v_lshlrev_b32 v128, 16, v82
  v_and_b32 v129, 0xffff0000, v82
  v_add_f32 v32, v32, v128
  v_fmac_f32 v33, v128, v128
  v_add_f32 v32, v32, v129
  v_fmac_f32 v33, v129, v129
  v_lshlrev_b32 v128, 16, v83
  v_and_b32 v129, 0xffff0000, v83
  v_add_f32 v32, v32, v128
  v_fmac_f32 v33, v128, v128
  v_add_f32 v32, v32, v129
  v_fmac_f32 v33, v129, v129
  v_lshlrev_b32 v128, 16, v84
  v_and_b32 v129, 0xffff0000, v84
  v_add_f32 v32, v32, v128
  v_fmac_f32 v33, v128, v128
  v_add_f32 v32, v32, v129
  v_fmac_f32 v33, v129, v129
  v_lshlrev_b32 v128, 16, v85
  v_and_b32 v129, 0xffff0000, v85
  v_add_f32 v32, v32, v128
  v_fmac_f32 v33, v128, v128
  v_add_f32 v32, v32, v129
  v_fmac_f32 v33, v129, v129
  v_lshlrev_b32 v128, 16, v86
  v_and_b32 v129, 0xffff0000, v86
  v_add_f32 v32, v32, v128
  v_fmac_f32 v33, v128, v128
  v_add_f32 v32, v32, v129
  v_fmac_f32 v33, v129, v129
  v_lshlrev_b32 v128, 16, v87
  v_and_b32 v129, 0xffff0000, v87
  v_add_f32 v32, v32, v128
  v_fmac_f32 v33, v128, v128
  v_add_f32 v32, v32, v129
  v_fmac_f32 v33, v129, v129
  v_mov_b64 v[34:35], 0
  buffer_store_dwordx2 v[32:33], v45, s[8:11], s64 offen sc1
  buffer_store_dwordx2 v[34:35], v45, s[8:11], s64 offen offset:1024 sc1
  buffer_store_dwordx2 v[34:35], v45, s[8:11], s64 offen offset:1536 sc1
  s_add_u32 s62, s48, 32
  s_mul_i32 s64, s62, 46080
  s_add_u32 s64, s64, 10485760
  s_add_u32 s63, s64, s65
  s_waitcnt vmcnt(13)
  buffer_store_dwordx4 v[88:91], v1, s[8:11], s63 offen offset:0 sc1
  buffer_store_dwordx4 v[92:95], v1, s[8:11], s63 offen offset:2048 sc1
  s_add_u32 s63, s63, 4096
  buffer_store_dwordx4 v[96:99], v1, s[8:11], s63 offen offset:0 sc1
  buffer_store_dwordx4 v[100:103], v1, s[8:11], s63 offen offset:2048 sc1
  s_add_u32 s63, s63, 4096
  buffer_store_dwordx4 v[104:107], v1, s[8:11], s63 offen offset:0 sc1
  buffer_store_dwordx4 v[108:111], v1, s[8:11], s63 offen offset:2048 sc1
  s_add_u32 s63, s63, 4096
  buffer_store_dwordx4 v[112:115], v1, s[8:11], s63 offen offset:0 sc1
  buffer_store_dwordx4 v[116:119], v1, s[8:11], s63 offen offset:2048 sc1
  s_add_u32 s63, s63, 4096
  buffer_store_dwordx4 v[120:123], v1, s[8:11], s63 offen offset:0 sc1
  buffer_store_dwordx4 v[124:127], v1, s[8:11], s63 offen offset:2048 sc1
  s_add_u32 s63, s63, 4096
  v_mov_b64 v[32:33], 0
  v_lshlrev_b32 v128, 16, v88
  v_and_b32 v129, 0xffff0000, v88
  v_add_f32 v32, v32, v128
  v_fmac_f32 v33, v128, v128
  v_add_f32 v32, v32, v129
  v_fmac_f32 v33, v129, v129
  v_lshlrev_b32 v128, 16, v89
  v_and_b32 v129, 0xffff0000, v89
  v_add_f32 v32, v32, v128
  v_fmac_f32 v33, v128, v128
  v_add_f32 v32, v32, v129
  v_fmac_f32 v33, v129, v129
  v_lshlrev_b32 v128, 16, v90
  v_and_b32 v129, 0xffff0000, v90
  v_add_f32 v32, v32, v128
  v_fmac_f32 v33, v128, v128
  v_add_f32 v32, v32, v129
  v_fmac_f32 v33, v129, v129
  v_lshlrev_b32 v128, 16, v91
  v_and_b32 v129, 0xffff0000, v91
  v_add_f32 v32, v32, v128
  v_fmac_f32 v33, v128, v128
  v_add_f32 v32, v32, v129
  v_fmac_f32 v33, v129, v129
  v_lshlrev_b32 v128, 16, v92
  v_and_b32 v129, 0xffff0000, v92
  v_add_f32 v32, v32, v128
  v_fmac_f32 v33, v128, v128
  v_add_f32 v32, v32, v129
  v_fmac_f32 v33, v129, v129
  v_lshlrev_b32 v128, 16, v93
  v_and_b32 v129, 0xffff0000, v93
  v_add_f32 v32, v32, v128
  v_fmac_f32 v33, v128, v128
  v_add_f32 v32, v32, v129
  v_fmac_f32 v33, v129, v129
  v_lshlrev_b32 v128, 16, v94
  v_and_b32 v129, 0xffff0000, v94
  v_add_f32 v32, v32, v128
  v_fmac_f32 v33, v128, v128
  v_add_f32 v32, v32, v129
  v_fmac_f32 v33, v129, v129
  v_lshlrev_b32 v128, 16, v95
  v_and_b32 v129, 0xffff0000, v95
  v_add_f32 v32, v32, v128
  v_fmac_f32 v33, v128, v128
  v_add_f32 v32, v32, v129
  v_fmac_f32 v33, v129, v129
  v_lshlrev_b32 v128, 16, v96
  v_and_b32 v129, 0xffff0000, v96
  v_add_f32 v32, v32, v128
  v_fmac_f32 v33, v128, v128
  v_add_f32 v32, v32, v129
  v_fmac_f32 v33, v129, v129
  v_lshlrev_b32 v128, 16, v97
  v_and_b32 v129, 0xffff0000, v97
  v_add_f32 v32, v32, v128
  v_fmac_f32 v33, v128, v128
  v_add_f32 v32, v32, v129
  v_fmac_f32 v33, v129, v129
  v_lshlrev_b32 v128, 16, v98
  v_and_b32 v129, 0xffff0000, v98
  v_add_f32 v32, v32, v128
  v_fmac_f32 v33, v128, v128
  v_add_f32 v32, v32, v129
  v_fmac_f32 v33, v129, v129
  v_lshlrev_b32 v128, 16, v99
  v_and_b32 v129, 0xffff0000, v99
  v_add_f32 v32, v32, v128
  v_fmac_f32 v33, v128, v128
  v_add_f32 v32, v32, v129
  v_fmac_f32 v33, v129, v129
  v_lshlrev_b32 v128, 16, v100
  v_and_b32 v129, 0xffff0000, v100
  v_add_f32 v32, v32, v128
  v_fmac_f32 v33, v128, v128
  v_add_f32 v32, v32, v129
  v_fmac_f32 v33, v129, v129
  v_lshlrev_b32 v128, 16, v101
  v_and_b32 v129, 0xffff0000, v101
  v_add_f32 v32, v32, v128
  v_fmac_f32 v33, v128, v128
  v_add_f32 v32, v32, v129
  v_fmac_f32 v33, v129, v129
  v_lshlrev_b32 v128, 16, v102
  v_and_b32 v129, 0xffff0000, v102
  v_add_f32 v32, v32, v128
  v_fmac_f32 v33, v128, v128
  v_add_f32 v32, v32, v129
  v_fmac_f32 v33, v129, v129
  v_lshlrev_b32 v128, 16, v103
  v_and_b32 v129, 0xffff0000, v103
  v_add_f32 v32, v32, v128
  v_fmac_f32 v33, v128, v128
  v_add_f32 v32, v32, v129
  v_fmac_f32 v33, v129, v129
  v_lshlrev_b32 v128, 16, v104
  v_and_b32 v129, 0xffff0000, v104
  v_add_f32 v32, v32, v128
  v_fmac_f32 v33, v128, v128
  v_add_f32 v32, v32, v129
  v_fmac_f32 v33, v129, v129
  v_lshlrev_b32 v128, 16, v105
  v_and_b32 v129, 0xffff0000, v105
  v_add_f32 v32, v32, v128
  v_fmac_f32 v33, v128, v128
  v_add_f32 v32, v32, v129
  v_fmac_f32 v33, v129, v129
  v_lshlrev_b32 v128, 16, v106
  v_and_b32 v129, 0xffff0000, v106
  v_add_f32 v32, v32, v128
  v_fmac_f32 v33, v128, v128
  v_add_f32 v32, v32, v129
  v_fmac_f32 v33, v129, v129
  v_lshlrev_b32 v128, 16, v107
  v_and_b32 v129, 0xffff0000, v107
  v_add_f32 v32, v32, v128
  v_fmac_f32 v33, v128, v128
  v_add_f32 v32, v32, v129
  v_fmac_f32 v33, v129, v129
  v_lshlrev_b32 v128, 16, v108
  v_and_b32 v129, 0xffff0000, v108
  v_add_f32 v32, v32, v128
  v_fmac_f32 v33, v128, v128
  v_add_f32 v32, v32, v129
  v_fmac_f32 v33, v129, v129
  v_lshlrev_b32 v128, 16, v109
  v_and_b32 v129, 0xffff0000, v109
  v_add_f32 v32, v32, v128
  v_fmac_f32 v33, v128, v128
  v_add_f32 v32, v32, v129
  v_fmac_f32 v33, v129, v129
  v_lshlrev_b32 v128, 16, v110
  v_and_b32 v129, 0xffff0000, v110
  v_add_f32 v32, v32, v128
  v_fmac_f32 v33, v128, v128
  v_add_f32 v32, v32, v129
  v_fmac_f32 v33, v129, v129
  v_lshlrev_b32 v128, 16, v111
  v_and_b32 v129, 0xffff0000, v111
  v_add_f32 v32, v32, v128
  v_fmac_f32 v33, v128, v128
  v_add_f32 v32, v32, v129
  v_fmac_f32 v33, v129, v129
  v_lshlrev_b32 v128, 16, v112
  v_and_b32 v129, 0xffff0000, v112
  v_add_f32 v32, v32, v128
  v_fmac_f32 v33, v128, v128
  v_add_f32 v32, v32, v129
  v_fmac_f32 v33, v129, v129
  v_lshlrev_b32 v128, 16, v113
  v_and_b32 v129, 0xffff0000, v113
  v_add_f32 v32, v32, v128
  v_fmac_f32 v33, v128, v128
  v_add_f32 v32, v32, v129
  v_fmac_f32 v33, v129, v129
  v_lshlrev_b32 v128, 16, v114
  v_and_b32 v129, 0xffff0000, v114
  v_add_f32 v32, v32, v128
  v_fmac_f32 v33, v128, v128
  v_add_f32 v32, v32, v129
  v_fmac_f32 v33, v129, v129
  v_lshlrev_b32 v128, 16, v115
  v_and_b32 v129, 0xffff0000, v115
  v_add_f32 v32, v32, v128
  v_fmac_f32 v33, v128, v128
  v_add_f32 v32, v32, v129
  v_fmac_f32 v33, v129, v129
  v_lshlrev_b32 v128, 16, v116
  v_and_b32 v129, 0xffff0000, v116
  v_add_f32 v32, v32, v128
  v_fmac_f32 v33, v128, v128
  v_add_f32 v32, v32, v129
  v_fmac_f32 v33, v129, v129
  v_lshlrev_b32 v128, 16, v117
  v_and_b32 v129, 0xffff0000, v117
  v_add_f32 v32, v32, v128
  v_fmac_f32 v33, v128, v128
  v_add_f32 v32, v32, v129
  v_fmac_f32 v33, v129, v129
  v_lshlrev_b32 v128, 16, v118
  v_and_b32 v129, 0xffff0000, v118
  v_add_f32 v32, v32, v128
  v_fmac_f32 v33, v128, v128
  v_add_f32 v32, v32, v129
  v_fmac_f32 v33, v129, v129
  v_lshlrev_b32 v128, 16, v119
  v_and_b32 v129, 0xffff0000, v119
  v_add_f32 v32, v32, v128
  v_fmac_f32 v33, v128, v128
  v_add_f32 v32, v32, v129
  v_fmac_f32 v33, v129, v129
  v_lshlrev_b32 v128, 16, v120
  v_and_b32 v129, 0xffff0000, v120
  v_add_f32 v32, v32, v128
  v_fmac_f32 v33, v128, v128
  v_add_f32 v32, v32, v129
  v_fmac_f32 v33, v129, v129
  v_lshlrev_b32 v128, 16, v121
  v_and_b32 v129, 0xffff0000, v121
  v_add_f32 v32, v32, v128
  v_fmac_f32 v33, v128, v128
  v_add_f32 v32, v32, v129
  v_fmac_f32 v33, v129, v129
  v_lshlrev_b32 v128, 16, v122
  v_and_b32 v129, 0xffff0000, v122
  v_add_f32 v32, v32, v128
  v_fmac_f32 v33, v128, v128
  v_add_f32 v32, v32, v129
  v_fmac_f32 v33, v129, v129
  v_lshlrev_b32 v128, 16, v123
  v_and_b32 v129, 0xffff0000, v123
  v_add_f32 v32, v32, v128
  v_fmac_f32 v33, v128, v128
  v_add_f32 v32, v32, v129
  v_fmac_f32 v33, v129, v129
  v_lshlrev_b32 v128, 16, v124
  v_and_b32 v129, 0xffff0000, v124
  v_add_f32 v32, v32, v128
  v_fmac_f32 v33, v128, v128
  v_add_f32 v32, v32, v129
  v_fmac_f32 v33, v129, v129
  v_lshlrev_b32 v128, 16, v125
  v_and_b32 v129, 0xffff0000, v125
  v_add_f32 v32, v32, v128
  v_fmac_f32 v33, v128, v128
  v_add_f32 v32, v32, v129
  v_fmac_f32 v33, v129, v129
  v_lshlrev_b32 v128, 16, v126
  v_and_b32 v129, 0xffff0000, v126
  v_add_f32 v32, v32, v128
  v_fmac_f32 v33, v128, v128
  v_add_f32 v32, v32, v129
  v_fmac_f32 v33, v129, v129
  v_lshlrev_b32 v128, 16, v127
  v_and_b32 v129, 0xffff0000, v127
  v_add_f32 v32, v32, v128
  v_fmac_f32 v33, v128, v128
  v_add_f32 v32, v32, v129
  v_fmac_f32 v33, v129, v129
  v_mov_b64 v[34:35], 0
  buffer_store_dwordx2 v[32:33], v45, s[8:11], s64 offen sc1
  buffer_store_dwordx2 v[34:35], v45, s[8:11], s64 offen offset:1024 sc1
  buffer_store_dwordx2 v[34:35], v45, s[8:11], s64 offen offset:1536 sc1
  s_lshl_b32 s3, s49, 2
  v_mov_b32 v37, s3
  s_nop 1
ibw_122:
  buffer_load_dword v36, v37, s[12:15], 0 offen sc1
  s_waitcnt vmcnt(0)
  v_cmp_ne_u32 vcc, 256, v36
  s_nop 0
  s_cbranch_vccz ibw_123
  s_sleep 8
  s_sub_u32 s47, s47, 1
  s_cbranch_scc0 ibw_122
  s_branch ABORT
ibw_123:
  s_cmp_lg_u32 s49, 0
  s_cbranch_scc1 ibok_124
  v_and_b32 v37, 7, v0
  v_lshlrev_b32 v37, 2, v37
  buffer_load_dword v36, v37, s[12:15], 0 offen offset:32 sc1
  s_waitcnt vmcnt(0)
  v_cmp_ne_u32 vcc, 32, v36
  s_nop 0
  s_cbranch_vccz ibok_124
  s_barrier
  s_mov_b32 s49, 1
  s_mov_b32 s3, s2
  s_branch DISPATCH
ibok_124:
  s_lshl_b32 s60, s48, 9
  s_lshl_b32 s61, s46, 2
  s_add_u32 s60, s60, s61
  s_add_u32 s60, s60, 0
  s_mov_b64 exec, 1
  buffer_store_dword v5, v1, s[8:11], s60 offen sc1
  s_mov_b64 exec, -1
  s_add_u32 s60, s60, 16384
  s_mov_b64 exec, 1
  buffer_store_dword v5, v1, s[8:11], s60 offen sc1
  s_mov_b64 exec, -1
  v_mov_b32 v33, 192
  buffer_load_dword v32, v33, s[12:15], 0 offen sc1
  s_waitcnt vmcnt(0)
  v_readfirstlane_b32 s60, v32
  s_cmp_gt_i32 s60, 0
  s_cselect_b32 s60, 0x2000, 0
  s_add_u32 s59, s59, s60
  v_mov_b32 v33, 196
  buffer_load_dword v32, v33, s[12:15], 0 offen sc1
  s_waitcnt vmcnt(0)
  v_readfirstlane_b32 s60, v32
  s_cmp_gt_i32 s60, 0
  s_cselect_b32 s60, 0x2000, 0
  v_mov_b32 v33, 200
  buffer_load_dword v32, v33, s[12:15], 0 offen sc1
  s_waitcnt vmcnt(0)
  v_readfirstlane_b32 s61, v32
  s_cmp_gt_i32 s61, 0
  s_cselect_b32 s61, 0x2000, 0
  s_cmp_eq_u32 s57, 0
  s_cselect_b32 s60, s60, s61
  s_add_u32 s69, s69, s60
  s_mov_b32 s50, 0
  s_mov_b32 s93, 536870912
fl_125:
  buffer_load_dword v4, v3, s[8:11], s73 offen sc1
  s_waitcnt vmcnt(0)
  v_cmp_eq_u32 vcc, 0, v4
  s_nop 0
  s_cbranch_vccz fo_126
  s_sleep 8
  s_sub_u32 s47, s47, 1
  s_cbranch_scc0 fl_125
  s_branch ABORT
fo_126:
OW_SEL_F:
  s_cmp_ge_u32 s46, 2
  s_cbranch_scc1 OW_F2
  s_branch OW_F3
OW_F3:
  s_mov_b32 s77, s71
  s_add_u32 s65, s77, s78
  buffer_load_dwordx4 a[0:3], v8, s[8:11], s65 offen offset:0 sc1
  buffer_load_dwordx4 a[4:7], v8, s[8:11], s65 offen offset:1024 sc1
  buffer_load_dwordx4 a[32:35], v9, s[8:11], s65 offen offset:0 sc1
  buffer_load_dwordx4 a[36:39], v9, s[8:11], s65 offen offset:1024 sc1
  buffer_load_dwordx4 a[64:67], v10, s[8:11], s65 offen offset:0 sc1
  buffer_load_dwordx4 a[68:71], v10, s[8:11], s65 offen offset:1024 sc1
  s_add_u32 s65, s77, s79
  buffer_load_dwordx4 a[8:11], v8, s[8:11], s65 offen offset:0 sc1
  buffer_load_dwordx4 a[12:15], v8, s[8:11], s65 offen offset:1024 sc1
  buffer_load_dwordx4 a[40:43], v9, s[8:11], s65 offen offset:0 sc1
  buffer_load_dwordx4 a[44:47], v9, s[8:11], s65 offen offset:1024 sc1
  buffer_load_dwordx4 a[72:75], v10, s[8:11], s65 offen offset:0 sc1
  buffer_load_dwordx4 a[76:79], v10, s[8:11], s65 offen offset:1024 sc1
  s_add_u32 s65, s77, s80
  buffer_load_dwordx4 a[16:19], v8, s[8:11], s65 offen offset:0 sc1
  buffer_load_dwordx4 a[20:23], v8, s[8:11], s65 offen offset:1024 sc1
  buffer_load_dwordx4 a[48:51], v9, s[8:11], s65 offen offset:0 sc1
  buffer_load_dwordx4 a[52:55], v9, s[8:11], s65 offen offset:1024 sc1
  buffer_load_dwordx4 a[80:83], v10, s[8:11], s65 offen offset:0 sc1
  buffer_load_dwordx4 a[84:87], v10, s[8:11], s65 offen offset:1024 sc1
  s_add_u32 s65, s77, s81
  buffer_load_dwordx4 a[24:27], v8, s[8:11], s65 offen offset:0 sc1
  buffer_load_dwordx4 a[28:31], v8, s[8:11], s65 offen offset:1024 sc1
  buffer_load_dwordx4 a[56:59], v9, s[8:11], s65 offen offset:0 sc1
  buffer_load_dwordx4 a[60:63], v9, s[8:11], s65 offen offset:1024 sc1
  buffer_load_dwordx4 a[88:91], v10, s[8:11], s65 offen offset:0 sc1
  buffer_load_dwordx4 a[92:95], v10, s[8:11], s65 offen offset:1024 sc1
  s_and_b32 s60, s50, 1
  s_lshl_b32 s51, s60, 17
  s_add_u32 s51, s51, s55
  s_xor_b32 s53, s51, 131072
  s_bfe_u32 s52, s50, 0x10001
  s_xor_b32 s54, s52, s60
  s_mul_i32 s68, s60, 262144
  s_add_u32 s68, s68, s59
  s_and_b32 s60, s50, 3
  s_mul_i32 s70, s60, 327680
  s_add_u32 s70, s70, s69
  s_bfe_u32 s72, s50, 0x10002
  s_add_u32 s94, s50, 1
  s_and_b32 s60, s94, 1
  s_mul_i32 s77, s60, 327680
  s_add_u32 s77, s77, s71
  s_add_u32 s66, s51, 10240
  s_add_u32 s67, s51, 14336
  s_add_u32 s63, s51, 16384
  s_lshl_b32 s84, s56, 10
  s_add_u32 s84, s84, s68
  s_lshl_b32 s85, s56, 9
  s_add_u32 s85, s85, s68
  s_xor_b32 s86, s84, 1024
  s_xor_b32 s89, s85, 512
  s_xor_b32 s87, s84, 2048
  s_xor_b32 s90, s85, 1024
  s_xor_b32 s88, s84, 3072
  s_xor_b32 s91, s85, 1536
OW_F3L0:
  v_mov_b64 v[88:89], 0
  v_mov_b64 v[90:91], 0
  v_mov_b64 v[92:93], 0
  v_mov_b64 v[94:95], 0
  v_mov_b64 v[96:97], 0
  v_mov_b64 v[98:99], 0
  s_waitcnt vmcnt(0)
  v_mov_b32 v32, s94
  s_mov_b64 exec, 1
  s_cmp_lg_u32 s49, 0
  s_cbranch_scc1 wt_127
  buffer_store_dword v32, v1, s[8:11], s76 offen
wb_128:
  s_mov_b64 exec, -1
lp_129:
  buffer_load_dword v32, v2, s[8:11], s51 offen offset:0 sc1
  s_waitcnt vmcnt(0)
  v_and_b32 v32, 1, v32
  v_cmp_eq_u32 vcc, s52, v32
  s_nop 0
  s_cbranch_vccnz lo_130
  s_sub_u32 s47, s47, 1
  s_cbranch_scc0 lp_129
  s_branch ABORT
lo_130:
pp_131:
  buffer_load_dwordx4 v[44:47], v11, s[8:11], s51 offen offset:0 sc1
  buffer_load_dwordx4 v[48:51], v11, s[8:11], s51 offen offset:1024 sc1
  buffer_load_dwordx4 v[52:55], v11, s[8:11], s51 offen offset:2048 sc1
  buffer_load_dwordx4 v[56:59], v11, s[8:11], s51 offen offset:3072 sc1
  buffer_load_dwordx4 v[60:63], v12, s[8:11], s51 offen offset:0 sc1
  buffer_load_dwordx4 v[64:67], v12, s[8:11], s51 offen offset:1024 sc1
  buffer_load_dwordx4 v[68:71], v13, s[8:11], s66 offen sc1
  buffer_load_dwordx4 v[84:87], v1, s[8:11], s67 offen sc1
  s_waitcnt vmcnt(0)
  v_bitop3_b32 v32, v44, v46, s52 bitop3:0x7e
  v_bitop3_b32 v33, v48, v50, s52 bitop3:0x7e
  v_bitop3_b32 v34, v52, v54, s52 bitop3:0x7e
  v_or3_b32 v32, v32, v33, v34
  v_bitop3_b32 v33, v56, v58, s52 bitop3:0x7e
  v_bitop3_b32 v34, v60, v62, s52 bitop3:0x7e
  v_or3_b32 v32, v32, v33, v34
  v_bitop3_b32 v33, v64, v66, s52 bitop3:0x7e
  v_bitop3_b32 v32, v32, v33, 1 bitop3:0xa8
  v_cmp_ne_u32 vcc, 0, v32
  s_nop 0
  s_cbranch_vccz po_132
  s_sub_u32 s47, s47, 1
  s_cbranch_scc0 pp_131
  s_branch ABORT
po_132:
  v_bitop3_b32 v32, v68, v70, s52 bitop3:0x7e
  v_bitop3_b32 v33, v84, v86, s52 bitop3:0x7e
  v_bitop3_b32 v32, v32, v33, 1 bitop3:0xa8
  v_cmp_ne_u32 vcc, 0, v32
  s_nop 0
  s_cbranch_vccz pk_133
  buffer_load_dwordx4 v[68:71], v13, s[8:11], s66 offen sc1
  buffer_load_dwordx4 v[84:87], v1, s[8:11], s67 offen sc1
pp_134:
  buffer_load_dwordx4 v[68:71], v13, s[8:11], s66 offen sc1
  buffer_load_dwordx4 v[84:87], v1, s[8:11], s67 offen sc1
  s_waitcnt vmcnt(2)
  v_bitop3_b32 v32, v68, v70, s52 bitop3:0x7e
  v_bitop3_b32 v33, v84, v86, s52 bitop3:0x7e
  v_bitop3_b32 v32, v32, v33, 1 bitop3:0xa8
  v_cmp_ne_u32 vcc, 0, v32
  s_nop 0
  s_cbranch_vccz po_135
  s_sub_u32 s47, s47, 1
  s_cbranch_scc0 pp_134
  s_branch ABORT
po_135:
pk_133:
  ds_write_b128 v13, v[68:71] offset:0
  v_smfmac_f32_16x16x64_bf16 v[88:91], v[68:71], a[0:7], v26
  v_smfmac_f32_16x16x64_bf16 v[92:95], v[68:71], a[32:39], v26
  s_waitcnt lgkmcnt(0)
  s_barrier
  ds_read_b128 v[72:75], v14 offset:0
  ds_read_b128 v[76:79], v15 offset:0
  ds_read_b128 v[80:83], v16 offset:0
  v_smfmac_f32_16x16x64_bf16 v[96:99], v[68:71], a[64:71], v26
  v_smfmac_f32_16x16x64_bf16 v[88:91], v[84:87], v[44:51], v26
  v_smfmac_f32_16x16x64_bf16 v[92:95], v[84:87], v[52:59], v26
  v_smfmac_f32_16x16x64_bf16 v[96:99], v[84:87], v[60:67], v26
  s_waitcnt lgkmcnt(2)
  v_smfmac_f32_16x16x64_bf16 v[88:91], v[72:75], a[8:15], v26
  v_smfmac_f32_16x16x64_bf16 v[92:95], v[72:75], a[40:47], v26
  v_smfmac_f32_16x16x64_bf16 v[96:99], v[72:75], a[72:79], v26
  s_waitcnt lgkmcnt(1)
  v_smfmac_f32_16x16x64_bf16 v[88:91], v[76:79], a[16:23], v26
  v_smfmac_f32_16x16x64_bf16 v[92:95], v[76:79], a[48:55], v26
  v_smfmac_f32_16x16x64_bf16 v[96:99], v[76:79], a[80:87], v26
  s_waitcnt lgkmcnt(0)
  v_smfmac_f32_16x16x64_bf16 v[88:91], v[80:83], a[24:31], v26
  v_smfmac_f32_16x16x64_bf16 v[92:95], v[80:83], a[56:63], v26
  v_smfmac_f32_16x16x64_bf16 v[96:99], v[80:83], a[88:95], v26
  s_nop 5
  v_add_f32 v100, v88, v89
  v_add_f32 v101, v90, v91
  v_add_f32 v102, v92, v93
  v_add_f32 v103, v94, v95
  v_and_or_b32 v100, v100, -2, s52
  buffer_store_dwordx4 v[100:103], v1, s[8:11], s84 offen sc1
  v_add_f32 v104, v96, v97
  v_add_f32 v105, v98, v99
  v_and_or_b32 v104, v104, -2, s52
  buffer_store_dwordx2 v[104:105], v21, s[8:11], s85 offen sc1
  s_sleep 6
  buffer_load_dword v4, v3, s[8:11], s73 offen sc1
  buffer_load_dwordx4 v[112:115], v1, s[8:11], s86 offen sc1
  buffer_load_dwordx4 v[116:119], v1, s[8:11], s87 offen sc1
  buffer_load_dwordx4 v[120:123], v1, s[8:11], s88 offen sc1
  buffer_load_dwordx2 v[124:125], v21, s[8:11], s89 offen sc1
  buffer_load_dwordx2 v[128:129], v21, s[8:11], s90 offen sc1
  buffer_load_dwordx2 v[132:133], v21, s[8:11], s91 offen sc1
  s_sleep 4
  buffer_load_dwordx4 v[184:187], v17, s[8:11], s63 offen offset:0 sc1
  buffer_load_dwordx4 v[188:191], v17, s[8:11], s63 offen offset:1024 sc1
  buffer_load_dwordx4 v[192:195], v17, s[8:11], s63 offen offset:2048 sc1
  buffer_load_dwordx4 v[196:199], v17, s[8:11], s63 offen offset:3072 sc1
  buffer_load_dwordx4 v[200:203], v31, s[8:11], s63 offen sc1
  s_waitcnt vmcnt(5)
  v_bitop3_b32 v32, v112, v116, s52 bitop3:0x7e
  v_bitop3_b32 v33, v120, v124, s52 bitop3:0x7e
  v_bitop3_b32 v34, v128, v132, s52 bitop3:0x7e
  v_or3_b32 v32, v32, v33, v34
  v_and_b32 v32, 1, v32
  v_cmp_ne_u32 vcc, 0, v32
  s_nop 0
  s_cbranch_vccz po_138
pt_137:
  buffer_load_dwordx4 v[112:115], v1, s[8:11], s86 offen sc1
  buffer_load_dwordx4 v[116:119], v1, s[8:11], s87 offen sc1
  buffer_load_dwordx4 v[120:123], v1, s[8:11], s88 offen sc1
  buffer_load_dwordx2 v[124:125], v21, s[8:11], s89 offen sc1
  buffer_load_dwordx2 v[128:129], v21, s[8:11], s90 offen sc1
  buffer_load_dwordx2 v[132:133], v21, s[8:11], s91 offen sc1
  s_waitcnt vmcnt(0)
  v_bitop3_b32 v32, v112, v116, s52 bitop3:0x7e
  v_bitop3_b32 v33, v120, v124, s52 bitop3:0x7e
  v_bitop3_b32 v34, v128, v132, s52 bitop3:0x7e
  v_or3_b32 v32, v32, v33, v34
  v_and_b32 v32, 1, v32
  v_cmp_ne_u32 vcc, 0, v32
  s_nop 0
  s_cbranch_vccz po_138
  s_sub_u32 s47, s47, 1
  s_cbranch_scc0 pt_137
  s_branch ABORT
po_138:
xo_136:
  s_mov_b32 vcc_lo, 0x55555555
  s_mov_b32 vcc_hi, vcc_lo
  v_pk_add_f32 v[100:101], v[100:101], v[112:113]
  v_pk_add_f32 v[88:89], v[116:117], v[120:121]
  v_pk_add_f32 v[102:103], v[102:103], v[114:115]
  v_pk_add_f32 v[90:91], v[118:119], v[122:123]
  v_pk_add_f32 v[104:105], v[104:105], v[124:125]
  v_pk_add_f32 v[92:93], v[128:129], v[132:133]
  v_pk_add_f32 v[100:101], v[100:101], v[88:89]
  v_pk_add_f32 v[102:103], v[102:103], v[90:91]
  v_pk_add_f32 v[104:105], v[104:105], v[92:93]
  v_cndmask_b32_dpp v88, v101, v100, vcc quad_perm:[1,0,3,2] row_mask:0xf bank_mask:0xf
  v_cndmask_b32_dpp v90, v103, v102, vcc quad_perm:[1,0,3,2] row_mask:0xf bank_mask:0xf
  v_cndmask_b32_dpp v92, v105, v104, vcc quad_perm:[1,0,3,2] row_mask:0xf bank_mask:0xf
  s_not_b64 vcc, vcc
  v_cndmask_b32_dpp v89, v100, v101, vcc quad_perm:[1,0,3,2] row_mask:0xf bank_mask:0xf
  v_cndmask_b32_dpp v91, v102, v103, vcc quad_perm:[1,0,3,2] row_mask:0xf bank_mask:0xf
  v_cndmask_b32_dpp v93, v104, v105, vcc quad_perm:[1,0,3,2] row_mask:0xf bank_mask:0xf
  s_mov_b64 vcc, s[82:83]
  v_cvt_pk_bf16_f32 v94, v88, v89
  v_cvt_pk_bf16_f32 v96, v90, v91
  v_cvt_pk_bf16_f32 v98, v92, v93
  s_nop 0
  v_cndmask_b32_dpp v88, v96, v94, vcc quad_perm:[2,3,0,1] row_mask:0xf bank_mask:0xf
  s_not_b64 vcc, vcc
  v_cndmask_b32_dpp v89, v94, v96, vcc quad_perm:[2,3,0,1] row_mask:0xf bank_mask:0xf
  v_and_or_b32 v88, v88, -2, s54
  s_cmp_lg_u32 s49, 0
  s_cbranch_scc1 wt_140
  buffer_store_dwordx2 v[88:89], v22, s[8:11], s53 offen
wb_141:
  v_mov_b32_dpp v99, v98 quad_perm:[2,3,0,1] row_mask:0xf bank_mask:0xf
  v_and_or_b32 v98, v98, -2, s54
  s_mov_b64 exec, s[82:83]
  s_cmp_lg_u32 s49, 0
  s_cbranch_scc1 wt_142
  buffer_store_dwordx2 v[98:99], v23, s[8:11], s53 offen
wb_143:
  s_mov_b64 exec, -1
  s_min_u32 s60, s94, 63
gv_145:
  v_cmp_ge_i32 vcc, s60, v4
  s_nop 0
  s_cbranch_vccz gv_144
  buffer_load_dword v4, v3, s[8:11], s73 offen sc1
  s_waitcnt vmcnt(0)
  s_sleep 1
  s_sub_u32 s47, s47, 1
  s_cbranch_scc0 gv_145
  s_branch ABORT
gv_144:
  s_waitcnt vmcnt(2)
  v_bitop3_b32 v32, v184, v188, s52 bitop3:0x7e
  v_bitop3_b32 v33, v192, v196, s52 bitop3:0x7e
  v_bitop3_b32 v34, v200, v202, s52 bitop3:0x7e
  v_or3_b32 v32, v32, v33, v34
  v_and_b32 v32, 1, v32
  v_cmp_ne_u32 vcc, 0, v32
  s_nop 0
  s_cbranch_vccz po_147
pt_146:
  buffer_load_dwordx4 v[184:187], v17, s[8:11], s63 offen offset:0 sc1
  buffer_load_dwordx4 v[188:191], v17, s[8:11], s63 offen offset:1024 sc1
  buffer_load_dwordx4 v[192:195], v17, s[8:11], s63 offen offset:2048 sc1
  buffer_load_dwordx4 v[196:199], v17, s[8:11], s63 offen offset:3072 sc1
  buffer_load_dwordx4 v[200:203], v31, s[8:11], s63 offen sc1
  s_waitcnt vmcnt(0)
  v_bitop3_b32 v32, v184, v188, s52 bitop3:0x7e
  v_bitop3_b32 v33, v192, v196, s52 bitop3:0x7e
  v_bitop3_b32 v34, v200, v202, s52 bitop3:0x7e
  v_or3_b32 v32, v32, v33, v34
  v_and_b32 v32, 1, v32
  v_cmp_ne_u32 vcc, 0, v32
  s_nop 0
  s_cbranch_vccz po_147
  s_sub_u32 s47, s47, 1
  s_cbranch_scc0 pt_146
  s_branch ABORT
po_147:
  ds_write_b128 v17, v[184:187] offset:4096
  ds_write_b128 v17, v[188:191] offset:5120
  ds_write_b128 v17, v[192:195] offset:6144
  ds_write_b128 v17, v[196:199] offset:7168
  ds_write_b128 v31, v[200:203] offset:4096
  s_waitcnt lgkmcnt(0)
  s_barrier
  ds_read_b128 v[160:163], v17 offset:4096
  ds_read_b128 v[164:167], v17 offset:5120
  ds_read_b128 v[168:171], v17 offset:6144
  ds_read_b128 v[172:175], v17 offset:7168
  ds_read_b128 v[176:179], v18 offset:4096
  s_waitcnt lgkmcnt(4)
  v_mfma_f32_16x16x32_bf16 v[136:139], a[0:3], v[160:163], 0
  ds_read_b128 v[180:183], v18 offset:5120
  v_mfma_f32_16x16x32_bf16 v[144:147], a[32:35], v[160:163], 0
  s_add_u32 s65, s77, s78
  buffer_load_dwordx4 a[96:99], v8, s[8:11], s65 offen offset:0 sc1
  v_mfma_f32_16x16x32_bf16 v[152:155], a[64:67], v[160:163], 0
  s_waitcnt lgkmcnt(4)
  v_mfma_f32_16x16x32_bf16 v[140:143], a[0:3], v[164:167], 0
  ds_read_b128 v[160:163], v18 offset:6144
  buffer_load_dwordx4 a[100:103], v8, s[8:11], s65 offen offset:1024 sc1
  v_mfma_f32_16x16x32_bf16 v[148:151], a[32:35], v[164:167], 0
  v_mfma_f32_16x16x32_bf16 v[156:159], a[64:67], v[164:167], 0
  buffer_load_dwordx4 a[128:131], v9, s[8:11], s65 offen offset:0 sc1
  s_waitcnt lgkmcnt(4)
  v_mfma_f32_16x16x32_bf16 v[136:139], a[4:7], v[168:171], v[136:139]
  ds_read_b128 v[164:167], v18 offset:7168
  v_mfma_f32_16x16x32_bf16 v[144:147], a[36:39], v[168:171], v[144:147]
  buffer_load_dwordx4 a[132:135], v9, s[8:11], s65 offen offset:1024 sc1
  v_mfma_f32_16x16x32_bf16 v[152:155], a[68:71], v[168:171], v[152:155]
  s_waitcnt lgkmcnt(4)
  v_mfma_f32_16x16x32_bf16 v[140:143], a[4:7], v[172:175], v[140:143]
  ds_read_b128 v[168:171], v19 offset:4096
  buffer_load_dwordx4 a[160:163], v10, s[8:11], s65 offen offset:0 sc1
  v_mfma_f32_16x16x32_bf16 v[148:151], a[36:39], v[172:175], v[148:151]
  v_mfma_f32_16x16x32_bf16 v[156:159], a[68:71], v[172:175], v[156:159]
  buffer_load_dwordx4 a[164:167], v10, s[8:11], s65 offen offset:1024 sc1
  s_waitcnt lgkmcnt(4)
  v_mfma_f32_16x16x32_bf16 v[136:139], a[8:11], v[176:179], v[136:139]
  ds_read_b128 v[172:175], v19 offset:5120
  v_mfma_f32_16x16x32_bf16 v[144:147], a[40:43], v[176:179], v[144:147]
  s_add_u32 s65, s77, s79
  buffer_load_dwordx4 a[104:107], v8, s[8:11], s65 offen offset:0 sc1
  v_mfma_f32_16x16x32_bf16 v[152:155], a[72:75], v[176:179], v[152:155]
  s_waitcnt lgkmcnt(4)
  v_mfma_f32_16x16x32_bf16 v[140:143], a[8:11], v[180:183], v[140:143]
  ds_read_b128 v[176:179], v19 offset:6144
  buffer_load_dwordx4 a[108:111], v8, s[8:11], s65 offen offset:1024 sc1
  v_mfma_f32_16x16x32_bf16 v[148:151], a[40:43], v[180:183], v[148:151]
  v_mfma_f32_16x16x32_bf16 v[156:159], a[72:75], v[180:183], v[156:159]
  buffer_load_dwordx4 a[136:139], v9, s[8:11], s65 offen offset:0 sc1
  s_waitcnt lgkmcnt(4)
  v_mfma_f32_16x16x32_bf16 v[136:139], a[12:15], v[160:163], v[136:139]
  ds_read_b128 v[180:183], v19 offset:7168
  v_mfma_f32_16x16x32_bf16 v[144:147], a[44:47], v[160:163], v[144:147]
  buffer_load_dwordx4 a[140:143], v9, s[8:11], s65 offen offset:1024 sc1
  v_mfma_f32_16x16x32_bf16 v[152:155], a[76:79], v[160:163], v[152:155]
  s_waitcnt lgkmcnt(4)
  v_mfma_f32_16x16x32_bf16 v[140:143], a[12:15], v[164:167], v[140:143]
  ds_read_b128 v[160:163], v20 offset:4096
  buffer_load_dwordx4 a[168:171], v10, s[8:11], s65 offen offset:0 sc1
  v_mfma_f32_16x16x32_bf16 v[148:151], a[44:47], v[164:167], v[148:151]
  v_mfma_f32_16x16x32_bf16 v[156:159], a[76:79], v[164:167], v[156:159]
  buffer_load_dwordx4 a[172:175], v10, s[8:11], s65 offen offset:1024 sc1
  s_waitcnt lgkmcnt(4)
  v_mfma_f32_16x16x32_bf16 v[136:139], a[16:19], v[168:171], v[136:139]
  ds_read_b128 v[164:167], v20 offset:5120
  v_mfma_f32_16x16x32_bf16 v[144:147], a[48:51], v[168:171], v[144:147]
  s_add_u32 s65, s77, s80
  buffer_load_dwordx4 a[112:115], v8, s[8:11], s65 offen offset:0 sc1
  v_mfma_f32_16x16x32_bf16 v[152:155], a[80:83], v[168:171], v[152:155]
  s_waitcnt lgkmcnt(4)
  v_mfma_f32_16x16x32_bf16 v[140:143], a[16:19], v[172:175], v[140:143]
  ds_read_b128 v[168:171], v20 offset:6144
  buffer_load_dwordx4 a[116:119], v8, s[8:11], s65 offen offset:1024 sc1
  v_mfma_f32_16x16x32_bf16 v[148:151], a[48:51], v[172:175], v[148:151]
  v_mfma_f32_16x16x32_bf16 v[156:159], a[80:83], v[172:175], v[156:159]
  buffer_load_dwordx4 a[144:147], v9, s[8:11], s65 offen offset:0 sc1
  s_waitcnt lgkmcnt(4)
  v_mfma_f32_16x16x32_bf16 v[136:139], a[20:23], v[176:179], v[136:139]
  ds_read_b128 v[172:175], v20 offset:7168
  v_mfma_f32_16x16x32_bf16 v[144:147], a[52:55], v[176:179], v[144:147]
  buffer_load_dwordx4 a[148:151], v9, s[8:11], s65 offen offset:1024 sc1
  v_mfma_f32_16x16x32_bf16 v[152:155], a[84:87], v[176:179], v[152:155]
  s_waitcnt lgkmcnt(4)
  v_mfma_f32_16x16x32_bf16 v[140:143], a[20:23], v[180:183], v[140:143]
  ds_read_b128 v[176:179], v1 offset:20480
  buffer_load_dwordx4 a[176:179], v10, s[8:11], s65 offen offset:0 sc1
  v_mfma_f32_16x16x32_bf16 v[148:151], a[52:55], v[180:183], v[148:151]
  v_mfma_f32_16x16x32_bf16 v[156:159], a[84:87], v[180:183], v[156:159]
  buffer_load_dwordx4 a[180:183], v10, s[8:11], s65 offen offset:1024 sc1
  s_waitcnt lgkmcnt(4)
  v_mfma_f32_16x16x32_bf16 v[136:139], a[24:27], v[160:163], v[136:139]
  ds_read_b128 v[180:183], v1 offset:21504
  v_mfma_f32_16x16x32_bf16 v[144:147], a[56:59], v[160:163], v[144:147]
  s_add_u32 s65, s77, s81
  buffer_load_dwordx4 a[120:123], v8, s[8:11], s65 offen offset:0 sc1
  v_mfma_f32_16x16x32_bf16 v[152:155], a[88:91], v[160:163], v[152:155]
  s_waitcnt lgkmcnt(4)
  v_mfma_f32_16x16x32_bf16 v[140:143], a[24:27], v[164:167], v[140:143]
  ds_read_b128 v[160:163], v1 offset:22528
  buffer_load_dwordx4 a[124:127], v8, s[8:11], s65 offen offset:1024 sc1
  v_mfma_f32_16x16x32_bf16 v[148:151], a[56:59], v[164:167], v[148:151]
  v_mfma_f32_16x16x32_bf16 v[156:159], a[88:91], v[164:167], v[156:159]
  buffer_load_dwordx4 a[152:155], v9, s[8:11], s65 offen offset:0 sc1
  s_waitcnt lgkmcnt(4)
  v_mfma_f32_16x16x32_bf16 v[136:139], a[28:31], v[168:171], v[136:139]
  ds_read_b128 v[164:167], v1 offset:23552
  v_mfma_f32_16x16x32_bf16 v[144:147], a[60:63], v[168:171], v[144:147]
  buffer_load_dwordx4 a[156:159], v9, s[8:11], s65 offen offset:1024 sc1
  v_mfma_f32_16x16x32_bf16 v[152:155], a[92:95], v[168:171], v[152:155]
  s_waitcnt lgkmcnt(4)
  v_mfma_f32_16x16x32_bf16 v[140:143], a[28:31], v[172:175], v[140:143]
  buffer_load_dwordx4 a[184:187], v10, s[8:11], s65 offen offset:0 sc1
  v_mfma_f32_16x16x32_bf16 v[148:151], a[60:63], v[172:175], v[148:151]
  v_mfma_f32_16x16x32_bf16 v[156:159], a[92:95], v[172:175], v[156:159]
  buffer_load_dwordx4 a[188:191], v10, s[8:11], s65 offen offset:1024 sc1
  s_waitcnt lgkmcnt(3)
  v_mfma_f32_16x16x32_bf16 v[136:139], v[44:47], v[176:179], v[136:139]
  v_mfma_f32_16x16x32_bf16 v[144:147], v[52:55], v[176:179], v[144:147]
  v_mfma_f32_16x16x32_bf16 v[152:155], v[60:63], v[176:179], v[152:155]
  s_waitcnt lgkmcnt(2)
  v_mfma_f32_16x16x32_bf16 v[140:143], v[44:47], v[180:183], v[140:143]
  v_mfma_f32_16x16x32_bf16 v[148:151], v[52:55], v[180:183], v[148:151]
  v_mfma_f32_16x16x32_bf16 v[156:159], v[60:63], v[180:183], v[156:159]
  s_waitcnt lgkmcnt(1)
  v_mfma_f32_16x16x32_bf16 v[136:139], v[48:51], v[160:163], v[136:139]
  v_mfma_f32_16x16x32_bf16 v[144:147], v[56:59], v[160:163], v[144:147]
  v_mfma_f32_16x16x32_bf16 v[152:155], v[64:67], v[160:163], v[152:155]
  s_waitcnt lgkmcnt(0)
  v_mfma_f32_16x16x32_bf16 v[140:143], v[48:51], v[164:167], v[140:143]
  v_mfma_f32_16x16x32_bf16 v[148:151], v[56:59], v[164:167], v[148:151]
  v_mfma_f32_16x16x32_bf16 v[156:159], v[64:67], v[164:167], v[156:159]
  s_nop 1
  v_cvt_pk_bf16_f32 v204, v136, v137
  v_cvt_pk_bf16_f32 v205, v138, v139
  v_and_or_b32 v204, v204, -2, s72
  v_cvt_pk_bf16_f32 v206, v144, v145
  v_cvt_pk_bf16_f32 v207, v146, v147
  v_and_or_b32 v206, v206, -2, s72
  v_cvt_pk_bf16_f32 v208, v140, v141
  v_cvt_pk_bf16_f32 v209, v142, v143
  v_and_or_b32 v208, v208, -2, s72
  v_cvt_pk_bf16_f32 v210, v148, v149
  v_cvt_pk_bf16_f32 v211, v150, v151
  v_and_or_b32 v210, v210, -2, s72
  v_cvt_pk_bf16_f32 v212, v152, v153
  v_cvt_pk_bf16_f32 v213, v154, v155
  v_and_or_b32 v212, v212, -2, s72
  v_cvt_pk_bf16_f32 v214, v156, v157
  v_cvt_pk_bf16_f32 v215, v158, v159
  v_and_or_b32 v214, v214, -2, s72
  s_mov_b32 s93, s70
  buffer_store_dwordx4 v[204:207], v24, s[8:11], s93 offen offset:0 sc1
  buffer_store_dwordx4 v[208:211], v24, s[8:11], s93 offen offset:1024 sc1
  buffer_store_dwordx2 v[212:213], v25, s[8:11], s93 offen offset:0 sc1
  buffer_store_dwordx2 v[214:215], v25, s[8:11], s93 offen offset:1024 sc1
  s_cmp_eq_u32 s50, 63
  s_cbranch_scc1 OW_END
  s_add_u32 s50, s50, 1
  s_and_b32 s60, s50, 1
  s_lshl_b32 s51, s60, 17
  s_add_u32 s51, s51, s55
  s_xor_b32 s53, s51, 131072
  s_bfe_u32 s52, s50, 0x10001
  s_xor_b32 s54, s52, s60
  s_mul_i32 s68, s60, 262144
  s_add_u32 s68, s68, s59
  s_and_b32 s60, s50, 3
  s_mul_i32 s70, s60, 327680
  s_add_u32 s70, s70, s69
  s_bfe_u32 s72, s50, 0x10002
  s_add_u32 s94, s50, 1
  s_and_b32 s60, s94, 1
  s_mul_i32 s77, s60, 327680
  s_add_u32 s77, s77, s71
  s_add_u32 s66, s51, 10240
  s_add_u32 s67, s51, 14336
  s_add_u32 s63, s51, 16384
  s_lshl_b32 s84, s56, 10
  s_add_u32 s84, s84, s68
  s_lshl_b32 s85, s56, 9
  s_add_u32 s85, s85, s68
  s_xor_b32 s86, s84, 1024
  s_xor_b32 s89, s85, 512
  s_xor_b32 s87, s84, 2048
  s_xor_b32 s90, s85, 1024
  s_xor_b32 s88, s84, 3072
  s_xor_b32 s91, s85, 1536
OW_F3L1:
  v_mov_b64 v[88:89], 0
  v_mov_b64 v[90:91], 0
  v_mov_b64 v[92:93], 0
  v_mov_b64 v[94:95], 0
  v_mov_b64 v[96:97], 0
  v_mov_b64 v[98:99], 0
  s_waitcnt vmcnt(0)
  v_mov_b32 v32, s94
  s_mov_b64 exec, 1
  s_cmp_lg_u32 s49, 0
  s_cbranch_scc1 wt_149
  buffer_store_dword v32, v1, s[8:11], s76 offen
wb_150:
  s_mov_b64 exec, -1
lp_151:
  buffer_load_dword v32, v2, s[8:11], s51 offen offset:0 sc1
  s_waitcnt vmcnt(0)
  v_and_b32 v32, 1, v32
  v_cmp_eq_u32 vcc, s52, v32
  s_nop 0
  s_cbranch_vccnz lo_152
  s_sub_u32 s47, s47, 1
  s_cbranch_scc0 lp_151
  s_branch ABORT
lo_152:
pp_153:
  buffer_load_dwordx4 v[44:47], v11, s[8:11], s51 offen offset:0 sc1
  buffer_load_dwordx4 v[48:51], v11, s[8:11], s51 offen offset:1024 sc1
  buffer_load_dwordx4 v[52:55], v11, s[8:11], s51 offen offset:2048 sc1
  buffer_load_dwordx4 v[56:59], v11, s[8:11], s51 offen offset:3072 sc1
  buffer_load_dwordx4 v[60:63], v12, s[8:11], s51 offen offset:0 sc1
  buffer_load_dwordx4 v[64:67], v12, s[8:11], s51 offen offset:1024 sc1
  buffer_load_dwordx4 v[68:71], v13, s[8:11], s66 offen sc1
  buffer_load_dwordx4 v[84:87], v1, s[8:11], s67 offen sc1
  s_waitcnt vmcnt(0)
  v_bitop3_b32 v32, v44, v46, s52 bitop3:0x7e
  v_bitop3_b32 v33, v48, v50, s52 bitop3:0x7e
  v_bitop3_b32 v34, v52, v54, s52 bitop3:0x7e
  v_or3_b32 v32, v32, v33, v34
  v_bitop3_b32 v33, v56, v58, s52 bitop3:0x7e
  v_bitop3_b32 v34, v60, v62, s52 bitop3:0x7e
  v_or3_b32 v32, v32, v33, v34
  v_bitop3_b32 v33, v64, v66, s52 bitop3:0x7e
  v_bitop3_b32 v32, v32, v33, 1 bitop3:0xa8
  v_cmp_ne_u32 vcc, 0, v32
  s_nop 0
  s_cbranch_vccz po_154
  s_sub_u32 s47, s47, 1
  s_cbranch_scc0 pp_153
  s_branch ABORT
po_154:
  v_bitop3_b32 v32, v68, v70, s52 bitop3:0x7e
  v_bitop3_b32 v33, v84, v86, s52 bitop3:0x7e
  v_bitop3_b32 v32, v32, v33, 1 bitop3:0xa8
  v_cmp_ne_u32 vcc, 0, v32
  s_nop 0
  s_cbranch_vccz pk_155
  buffer_load_dwordx4 v[68:71], v13, s[8:11], s66 offen sc1
  buffer_load_dwordx4 v[84:87], v1, s[8:11], s67 offen sc1
pp_156:
  buffer_load_dwordx4 v[68:71], v13, s[8:11], s66 offen sc1
  buffer_load_dwordx4 v[84:87], v1, s[8:11], s67 offen sc1
  s_waitcnt vmcnt(2)
  v_bitop3_b32 v32, v68, v70, s52 bitop3:0x7e
  v_bitop3_b32 v33, v84, v86, s52 bitop3:0x7e
  v_bitop3_b32 v32, v32, v33, 1 bitop3:0xa8
  v_cmp_ne_u32 vcc, 0, v32
  s_nop 0
  s_cbranch_vccz po_157
  s_sub_u32 s47, s47, 1
  s_cbranch_scc0 pp_156
  s_branch ABORT
po_157:
pk_155:
  ds_write_b128 v13, v[68:71] offset:0
  v_smfmac_f32_16x16x64_bf16 v[88:91], v[68:71], a[96:103], v26
  v_smfmac_f32_16x16x64_bf16 v[92:95], v[68:71], a[128:135], v26
  s_waitcnt lgkmcnt(0)
  s_barrier
  ds_read_b128 v[72:75], v14 offset:0
  ds_read_b128 v[76:79], v15 offset:0
  ds_read_b128 v[80:83], v16 offset:0
  v_smfmac_f32_16x16x64_bf16 v[96:99], v[68:71], a[160:167], v26
  v_smfmac_f32_16x16x64_bf16 v[88:91], v[84:87], v[44:51], v26
  v_smfmac_f32_16x16x64_bf16 v[92:95], v[84:87], v[52:59], v26
  v_smfmac_f32_16x16x64_bf16 v[96:99], v[84:87], v[60:67], v26
  s_waitcnt lgkmcnt(2)
  v_smfmac_f32_16x16x64_bf16 v[88:91], v[72:75], a[104:111], v26
  v_smfmac_f32_16x16x64_bf16 v[92:95], v[72:75], a[136:143], v26
  v_smfmac_f32_16x16x64_bf16 v[96:99], v[72:75], a[168:175], v26
  s_waitcnt lgkmcnt(1)
  v_smfmac_f32_16x16x64_bf16 v[88:91], v[76:79], a[112:119], v26
  v_smfmac_f32_16x16x64_bf16 v[92:95], v[76:79], a[144:151], v26
  v_smfmac_f32_16x16x64_bf16 v[96:99], v[76:79], a[176:183], v26
  s_waitcnt lgkmcnt(0)
  v_smfmac_f32_16x16x64_bf16 v[88:91], v[80:83], a[120:127], v26
  v_smfmac_f32_16x16x64_bf16 v[92:95], v[80:83], a[152:159], v26
  v_smfmac_f32_16x16x64_bf16 v[96:99], v[80:83], a[184:191], v26
  s_nop 5
  v_add_f32 v100, v88, v89
  v_add_f32 v101, v90, v91
  v_add_f32 v102, v92, v93
  v_add_f32 v103, v94, v95
  v_and_or_b32 v100, v100, -2, s52
  buffer_store_dwordx4 v[100:103], v1, s[8:11], s84 offen sc1
  v_add_f32 v104, v96, v97
  v_add_f32 v105, v98, v99
  v_and_or_b32 v104, v104, -2, s52
  buffer_store_dwordx2 v[104:105], v21, s[8:11], s85 offen sc1
  s_sleep 6
  buffer_load_dword v4, v3, s[8:11], s73 offen sc1
  buffer_load_dwordx4 v[112:115], v1, s[8:11], s86 offen sc1
  buffer_load_dwordx4 v[116:119], v1, s[8:11], s87 offen sc1
  buffer_load_dwordx4 v[120:123], v1, s[8:11], s88 offen sc1
  buffer_load_dwordx2 v[124:125], v21, s[8:11], s89 offen sc1
  buffer_load_dwordx2 v[128:129], v21, s[8:11], s90 offen sc1
  buffer_load_dwordx2 v[132:133], v21, s[8:11], s91 offen sc1
  s_sleep 4
  buffer_load_dwordx4 v[184:187], v17, s[8:11], s63 offen offset:0 sc1
  buffer_load_dwordx4 v[188:191], v17, s[8:11], s63 offen offset:1024 sc1
  buffer_load_dwordx4 v[192:195], v17, s[8:11], s63 offen offset:2048 sc1
  buffer_load_dwordx4 v[196:199], v17, s[8:11], s63 offen offset:3072 sc1
  buffer_load_dwordx4 v[200:203], v31, s[8:11], s63 offen sc1
  s_waitcnt vmcnt(5)
  v_bitop3_b32 v32, v112, v116, s52 bitop3:0x7e
  v_bitop3_b32 v33, v120, v124, s52 bitop3:0x7e
  v_bitop3_b32 v34, v128, v132, s52 bitop3:0x7e
  v_or3_b32 v32, v32, v33, v34
  v_and_b32 v32, 1, v32
  v_cmp_ne_u32 vcc, 0, v32
  s_nop 0
  s_cbranch_vccz po_160
pt_159:
  buffer_load_dwordx4 v[112:115], v1, s[8:11], s86 offen sc1
  buffer_load_dwordx4 v[116:119], v1, s[8:11], s87 offen sc1
  buffer_load_dwordx4 v[120:123], v1, s[8:11], s88 offen sc1
  buffer_load_dwordx2 v[124:125], v21, s[8:11], s89 offen sc1
  buffer_load_dwordx2 v[128:129], v21, s[8:11], s90 offen sc1
  buffer_load_dwordx2 v[132:133], v21, s[8:11], s91 offen sc1
  s_waitcnt vmcnt(0)
  v_bitop3_b32 v32, v112, v116, s52 bitop3:0x7e
  v_bitop3_b32 v33, v120, v124, s52 bitop3:0x7e
  v_bitop3_b32 v34, v128, v132, s52 bitop3:0x7e
  v_or3_b32 v32, v32, v33, v34
  v_and_b32 v32, 1, v32
  v_cmp_ne_u32 vcc, 0, v32
  s_nop 0
  s_cbranch_vccz po_160
  s_sub_u32 s47, s47, 1
  s_cbranch_scc0 pt_159
  s_branch ABORT
po_160:
xo_158:
  s_mov_b32 vcc_lo, 0x55555555
  s_mov_b32 vcc_hi, vcc_lo
  v_pk_add_f32 v[100:101], v[100:101], v[112:113]
  v_pk_add_f32 v[88:89], v[116:117], v[120:121]
  v_pk_add_f32 v[102:103], v[102:103], v[114:115]
  v_pk_add_f32 v[90:91], v[118:119], v[122:123]
  v_pk_add_f32 v[104:105], v[104:105], v[124:125]
  v_pk_add_f32 v[92:93], v[128:129], v[132:133]
  v_pk_add_f32 v[100:101], v[100:101], v[88:89]
  v_pk_add_f32 v[102:103], v[102:103], v[90:91]
  v_pk_add_f32 v[104:105], v[104:105], v[92:93]
  v_cndmask_b32_dpp v88, v101, v100, vcc quad_perm:[1,0,3,2] row_mask:0xf bank_mask:0xf
  v_cndmask_b32_dpp v90, v103, v102, vcc quad_perm:[1,0,3,2] row_mask:0xf bank_mask:0xf
  v_cndmask_b32_dpp v92, v105, v104, vcc quad_perm:[1,0,3,2] row_mask:0xf bank_mask:0xf
  s_not_b64 vcc, vcc
  v_cndmask_b32_dpp v89, v100, v101, vcc quad_perm:[1,0,3,2] row_mask:0xf bank_mask:0xf
  v_cndmask_b32_dpp v91, v102, v103, vcc quad_perm:[1,0,3,2] row_mask:0xf bank_mask:0xf
  v_cndmask_b32_dpp v93, v104, v105, vcc quad_perm:[1,0,3,2] row_mask:0xf bank_mask:0xf
  s_mov_b64 vcc, s[82:83]
  v_cvt_pk_bf16_f32 v94, v88, v89
  v_cvt_pk_bf16_f32 v96, v90, v91
  v_cvt_pk_bf16_f32 v98, v92, v93
  s_nop 0
  v_cndmask_b32_dpp v88, v96, v94, vcc quad_perm:[2,3,0,1] row_mask:0xf bank_mask:0xf
  s_not_b64 vcc, vcc
  v_cndmask_b32_dpp v89, v94, v96, vcc quad_perm:[2,3,0,1] row_mask:0xf bank_mask:0xf
  v_and_or_b32 v88, v88, -2, s54
  s_cmp_lg_u32 s49, 0
  s_cbranch_scc1 wt_162
  buffer_store_dwordx2 v[88:89], v22, s[8:11], s53 offen
wb_163:
  v_mov_b32_dpp v99, v98 quad_perm:[2,3,0,1] row_mask:0xf bank_mask:0xf
  v_and_or_b32 v98, v98, -2, s54
  s_mov_b64 exec, s[82:83]
  s_cmp_lg_u32 s49, 0
  s_cbranch_scc1 wt_164
  buffer_store_dwordx2 v[98:99], v23, s[8:11], s53 offen
wb_165:
  s_mov_b64 exec, -1
  s_min_u32 s60, s94, 63
gv_167:
  v_cmp_ge_i32 vcc, s60, v4
  s_nop 0
  s_cbranch_vccz gv_166
  buffer_load_dword v4, v3, s[8:11], s73 offen sc1
  s_waitcnt vmcnt(0)
  s_sleep 1
  s_sub_u32 s47, s47, 1
  s_cbranch_scc0 gv_167
  s_branch ABORT
gv_166:
  s_waitcnt vmcnt(2)
  v_bitop3_b32 v32, v184, v188, s52 bitop3:0x7e
  v_bitop3_b32 v33, v192, v196, s52 bitop3:0x7e
  v_bitop3_b32 v34, v200, v202, s52 bitop3:0x7e
  v_or3_b32 v32, v32, v33, v34
  v_and_b32 v32, 1, v32
  v_cmp_ne_u32 vcc, 0, v32
  s_nop 0
  s_cbranch_vccz po_169
pt_168:
  buffer_load_dwordx4 v[184:187], v17, s[8:11], s63 offen offset:0 sc1
  buffer_load_dwordx4 v[188:191], v17, s[8:11], s63 offen offset:1024 sc1
  buffer_load_dwordx4 v[192:195], v17, s[8:11], s63 offen offset:2048 sc1
  buffer_load_dwordx4 v[196:199], v17, s[8:11], s63 offen offset:3072 sc1
  buffer_load_dwordx4 v[200:203], v31, s[8:11], s63 offen sc1
  s_waitcnt vmcnt(0)
  v_bitop3_b32 v32, v184, v188, s52 bitop3:0x7e
  v_bitop3_b32 v33, v192, v196, s52 bitop3:0x7e
  v_bitop3_b32 v34, v200, v202, s52 bitop3:0x7e
  v_or3_b32 v32, v32, v33, v34
  v_and_b32 v32, 1, v32
  v_cmp_ne_u32 vcc, 0, v32
  s_nop 0
  s_cbranch_vccz po_169
  s_sub_u32 s47, s47, 1
  s_cbranch_scc0 pt_168
  s_branch ABORT
po_169:
  ds_write_b128 v17, v[184:187] offset:4096
  ds_write_b128 v17, v[188:191] offset:5120
  ds_write_b128 v17, v[192:195] offset:6144
  ds_write_b128 v17, v[196:199] offset:7168
  ds_write_b128 v31, v[200:203] offset:4096
  s_waitcnt lgkmcnt(0)
  s_barrier
  ds_read_b128 v[160:163], v17 offset:4096
  ds_read_b128 v[164:167], v17 offset:5120
  ds_read_b128 v[168:171], v17 offset:6144
  ds_read_b128 v[172:175], v17 offset:7168
  ds_read_b128 v[176:179], v18 offset:4096
  s_waitcnt lgkmcnt(4)
  v_mfma_f32_16x16x32_bf16 v[136:139], a[96:99], v[160:163], 0
  ds_read_b128 v[180:183], v18 offset:5120
  v_mfma_f32_16x16x32_bf16 v[144:147], a[128:131], v[160:163], 0
  s_add_u32 s65, s77, s78
  buffer_load_dwordx4 a[0:3], v8, s[8:11], s65 offen offset:0 sc1
  v_mfma_f32_16x16x32_bf16 v[152:155], a[160:163], v[160:163], 0
  s_waitcnt lgkmcnt(4)
  v_mfma_f32_16x16x32_bf16 v[140:143], a[96:99], v[164:167], 0
  ds_read_b128 v[160:163], v18 offset:6144
  buffer_load_dwordx4 a[4:7], v8, s[8:11], s65 offen offset:1024 sc1
  v_mfma_f32_16x16x32_bf16 v[148:151], a[128:131], v[164:167], 0
  v_mfma_f32_16x16x32_bf16 v[156:159], a[160:163], v[164:167], 0
  buffer_load_dwordx4 a[32:35], v9, s[8:11], s65 offen offset:0 sc1
  s_waitcnt lgkmcnt(4)
  v_mfma_f32_16x16x32_bf16 v[136:139], a[100:103], v[168:171], v[136:139]
  ds_read_b128 v[164:167], v18 offset:7168
  v_mfma_f32_16x16x32_bf16 v[144:147], a[132:135], v[168:171], v[144:147]
  buffer_load_dwordx4 a[36:39], v9, s[8:11], s65 offen offset:1024 sc1
  v_mfma_f32_16x16x32_bf16 v[152:155], a[164:167], v[168:171], v[152:155]
  s_waitcnt lgkmcnt(4)
  v_mfma_f32_16x16x32_bf16 v[140:143], a[100:103], v[172:175], v[140:143]
  ds_read_b128 v[168:171], v19 offset:4096
  buffer_load_dwordx4 a[64:67], v10, s[8:11], s65 offen offset:0 sc1
  v_mfma_f32_16x16x32_bf16 v[148:151], a[132:135], v[172:175], v[148:151]
  v_mfma_f32_16x16x32_bf16 v[156:159], a[164:167], v[172:175], v[156:159]
  buffer_load_dwordx4 a[68:71], v10, s[8:11], s65 offen offset:1024 sc1
  s_waitcnt lgkmcnt(4)
  v_mfma_f32_16x16x32_bf16 v[136:139], a[104:107], v[176:179], v[136:139]
  ds_read_b128 v[172:175], v19 offset:5120
  v_mfma_f32_16x16x32_bf16 v[144:147], a[136:139], v[176:179], v[144:147]
  s_add_u32 s65, s77, s79
  buffer_load_dwordx4 a[8:11], v8, s[8:11], s65 offen offset:0 sc1
  v_mfma_f32_16x16x32_bf16 v[152:155], a[168:171], v[176:179], v[152:155]
  s_waitcnt lgkmcnt(4)
  v_mfma_f32_16x16x32_bf16 v[140:143], a[104:107], v[180:183], v[140:143]
  ds_read_b128 v[176:179], v19 offset:6144
  buffer_load_dwordx4 a[12:15], v8, s[8:11], s65 offen offset:1024 sc1
  v_mfma_f32_16x16x32_bf16 v[148:151], a[136:139], v[180:183], v[148:151]
  v_mfma_f32_16x16x32_bf16 v[156:159], a[168:171], v[180:183], v[156:159]
  buffer_load_dwordx4 a[40:43], v9, s[8:11], s65 offen offset:0 sc1
  s_waitcnt lgkmcnt(4)
  v_mfma_f32_16x16x32_bf16 v[136:139], a[108:111], v[160:163], v[136:139]
  ds_read_b128 v[180:183], v19 offset:7168
  v_mfma_f32_16x16x32_bf16 v[144:147], a[140:143], v[160:163], v[144:147]
  buffer_load_dwordx4 a[44:47], v9, s[8:11], s65 offen offset:1024 sc1
  v_mfma_f32_16x16x32_bf16 v[152:155], a[172:175], v[160:163], v[152:155]
  s_waitcnt lgkmcnt(4)
  v_mfma_f32_16x16x32_bf16 v[140:143], a[108:111], v[164:167], v[140:143]
  ds_read_b128 v[160:163], v20 offset:4096
  buffer_load_dwordx4 a[72:75], v10, s[8:11], s65 offen offset:0 sc1
  v_mfma_f32_16x16x32_bf16 v[148:151], a[140:143], v[164:167], v[148:151]
  v_mfma_f32_16x16x32_bf16 v[156:159], a[172:175], v[164:167], v[156:159]
  buffer_load_dwordx4 a[76:79], v10, s[8:11], s65 offen offset:1024 sc1
  s_waitcnt lgkmcnt(4)
  v_mfma_f32_16x16x32_bf16 v[136:139], a[112:115], v[168:171], v[136:139]
  ds_read_b128 v[164:167], v20 offset:5120
  v_mfma_f32_16x16x32_bf16 v[144:147], a[144:147], v[168:171], v[144:147]
  s_add_u32 s65, s77, s80
  buffer_load_dwordx4 a[16:19], v8, s[8:11], s65 offen offset:0 sc1
  v_mfma_f32_16x16x32_bf16 v[152:155], a[176:179], v[168:171], v[152:155]
  s_waitcnt lgkmcnt(4)
  v_mfma_f32_16x16x32_bf16 v[140:143], a[112:115], v[172:175], v[140:143]
  ds_read_b128 v[168:171], v20 offset:6144
  buffer_load_dwordx4 a[20:23], v8, s[8:11], s65 offen offset:1024 sc1
  v_mfma_f32_16x16x32_bf16 v[148:151], a[144:147], v[172:175], v[148:151]
  v_mfma_f32_16x16x32_bf16 v[156:159], a[176:179], v[172:175], v[156:159]
  buffer_load_dwordx4 a[48:51], v9, s[8:11], s65 offen offset:0 sc1
  s_waitcnt lgkmcnt(4)
  v_mfma_f32_16x16x32_bf16 v[136:139], a[116:119], v[176:179], v[136:139]
  ds_read_b128 v[172:175], v20 offset:7168
  v_mfma_f32_16x16x32_bf16 v[144:147], a[148:151], v[176:179], v[144:147]
  buffer_load_dwordx4 a[52:55], v9, s[8:11], s65 offen offset:1024 sc1
  v_mfma_f32_16x16x32_bf16 v[152:155], a[180:183], v[176:179], v[152:155]
  s_waitcnt lgkmcnt(4)
  v_mfma_f32_16x16x32_bf16 v[140:143], a[116:119], v[180:183], v[140:143]
  ds_read_b128 v[176:179], v1 offset:20480
  buffer_load_dwordx4 a[80:83], v10, s[8:11], s65 offen offset:0 sc1
  v_mfma_f32_16x16x32_bf16 v[148:151], a[148:151], v[180:183], v[148:151]
  v_mfma_f32_16x16x32_bf16 v[156:159], a[180:183], v[180:183], v[156:159]
  buffer_load_dwordx4 a[84:87], v10, s[8:11], s65 offen offset:1024 sc1
  s_waitcnt lgkmcnt(4)
  v_mfma_f32_16x16x32_bf16 v[136:139], a[120:123], v[160:163], v[136:139]
  ds_read_b128 v[180:183], v1 offset:21504
  v_mfma_f32_16x16x32_bf16 v[144:147], a[152:155], v[160:163], v[144:147]
  s_add_u32 s65, s77, s81
  buffer_load_dwordx4 a[24:27], v8, s[8:11], s65 offen offset:0 sc1
  v_mfma_f32_16x16x32_bf16 v[152:155], a[184:187], v[160:163], v[152:155]
  s_waitcnt lgkmcnt(4)
  v_mfma_f32_16x16x32_bf16 v[140:143], a[120:123], v[164:167], v[140:143]
  ds_read_b128 v[160:163], v1 offset:22528
  buffer_load_dwordx4 a[28:31], v8, s[8:11], s65 offen offset:1024 sc1
  v_mfma_f32_16x16x32_bf16 v[148:151], a[152:155], v[164:167], v[148:151]
  v_mfma_f32_16x16x32_bf16 v[156:159], a[184:187], v[164:167], v[156:159]
  buffer_load_dwordx4 a[56:59], v9, s[8:11], s65 offen offset:0 sc1
  s_waitcnt lgkmcnt(4)
  v_mfma_f32_16x16x32_bf16 v[136:139], a[124:127], v[168:171], v[136:139]
  ds_read_b128 v[164:167], v1 offset:23552
  v_mfma_f32_16x16x32_bf16 v[144:147], a[156:159], v[168:171], v[144:147]
  buffer_load_dwordx4 a[60:63], v9, s[8:11], s65 offen offset:1024 sc1
  v_mfma_f32_16x16x32_bf16 v[152:155], a[188:191], v[168:171], v[152:155]
  s_waitcnt lgkmcnt(4)
  v_mfma_f32_16x16x32_bf16 v[140:143], a[124:127], v[172:175], v[140:143]
  buffer_load_dwordx4 a[88:91], v10, s[8:11], s65 offen offset:0 sc1
  v_mfma_f32_16x16x32_bf16 v[148:151], a[156:159], v[172:175], v[148:151]
  v_mfma_f32_16x16x32_bf16 v[156:159], a[188:191], v[172:175], v[156:159]
  buffer_load_dwordx4 a[92:95], v10, s[8:11], s65 offen offset:1024 sc1
  s_waitcnt lgkmcnt(3)
  v_mfma_f32_16x16x32_bf16 v[136:139], v[44:47], v[176:179], v[136:139]
  v_mfma_f32_16x16x32_bf16 v[144:147], v[52:55], v[176:179], v[144:147]
  v_mfma_f32_16x16x32_bf16 v[152:155], v[60:63], v[176:179], v[152:155]
  s_waitcnt lgkmcnt(2)
  v_mfma_f32_16x16x32_bf16 v[140:143], v[44:47], v[180:183], v[140:143]
  v_mfma_f32_16x16x32_bf16 v[148:151], v[52:55], v[180:183], v[148:151]
  v_mfma_f32_16x16x32_bf16 v[156:159], v[60:63], v[180:183], v[156:159]
  s_waitcnt lgkmcnt(1)
  v_mfma_f32_16x16x32_bf16 v[136:139], v[48:51], v[160:163], v[136:139]
  v_mfma_f32_16x16x32_bf16 v[144:147], v[56:59], v[160:163], v[144:147]
  v_mfma_f32_16x16x32_bf16 v[152:155], v[64:67], v[160:163], v[152:155]
  s_waitcnt lgkmcnt(0)
  v_mfma_f32_16x16x32_bf16 v[140:143], v[48:51], v[164:167], v[140:143]
  v_mfma_f32_16x16x32_bf16 v[148:151], v[56:59], v[164:167], v[148:151]
  v_mfma_f32_16x16x32_bf16 v[156:159], v[64:67], v[164:167], v[156:159]
  s_nop 1
  v_cvt_pk_bf16_f32 v204, v136, v137
  v_cvt_pk_bf16_f32 v205, v138, v139
  v_and_or_b32 v204, v204, -2, s72
  v_cvt_pk_bf16_f32 v206, v144, v145
  v_cvt_pk_bf16_f32 v207, v146, v147
  v_and_or_b32 v206, v206, -2, s72
  v_cvt_pk_bf16_f32 v208, v140, v141
  v_cvt_pk_bf16_f32 v209, v142, v143
  v_and_or_b32 v208, v208, -2, s72
  v_cvt_pk_bf16_f32 v210, v148, v149
  v_cvt_pk_bf16_f32 v211, v150, v151
  v_and_or_b32 v210, v210, -2, s72
  v_cvt_pk_bf16_f32 v212, v152, v153
  v_cvt_pk_bf16_f32 v213, v154, v155
  v_and_or_b32 v212, v212, -2, s72
  v_cvt_pk_bf16_f32 v214, v156, v157
  v_cvt_pk_bf16_f32 v215, v158, v159
  v_and_or_b32 v214, v214, -2, s72
  s_mov_b32 s93, s70
  buffer_store_dwordx4 v[204:207], v24, s[8:11], s93 offen offset:0 sc1
  buffer_store_dwordx4 v[208:211], v24, s[8:11], s93 offen offset:1024 sc1
  buffer_store_dwordx2 v[212:213], v25, s[8:11], s93 offen offset:0 sc1
  buffer_store_dwordx2 v[214:215], v25, s[8:11], s93 offen offset:1024 sc1
  s_cmp_eq_u32 s50, 63
  s_cbranch_scc1 OW_END
  s_add_u32 s50, s50, 1
  s_and_b32 s60, s50, 1
  s_lshl_b32 s51, s60, 17
  s_add_u32 s51, s51, s55
  s_xor_b32 s53, s51, 131072
  s_bfe_u32 s52, s50, 0x10001
  s_xor_b32 s54, s52, s60
  s_mul_i32 s68, s60, 262144
  s_add_u32 s68, s68, s59
  s_and_b32 s60, s50, 3
  s_mul_i32 s70, s60, 327680
  s_add_u32 s70, s70, s69
  s_bfe_u32 s72, s50, 0x10002
  s_add_u32 s94, s50, 1
  s_and_b32 s60, s94, 1
  s_mul_i32 s77, s60, 327680
  s_add_u32 s77, s77, s71
  s_add_u32 s66, s51, 10240
  s_add_u32 s67, s51, 14336
  s_add_u32 s63, s51, 16384
  s_lshl_b32 s84, s56, 10
  s_add_u32 s84, s84, s68
  s_lshl_b32 s85, s56, 9
  s_add_u32 s85, s85, s68
  s_xor_b32 s86, s84, 1024
  s_xor_b32 s89, s85, 512
  s_xor_b32 s87, s84, 2048
  s_xor_b32 s90, s85, 1024
  s_xor_b32 s88, s84, 3072
  s_xor_b32 s91, s85, 1536
  s_branch OW_F3L0
OW_F2:
  s_mov_b32 s77, s71
  s_add_u32 s65, s77, s78
  buffer_load_dwordx4 a[0:3], v8, s[8:11], s65 offen offset:0 sc1
  buffer_load_dwordx4 a[4:7], v8, s[8:11], s65 offen offset:1024 sc1
  buffer_load_dwordx4 a[32:35], v9, s[8:11], s65 offen offset:0 sc1
  buffer_load_dwordx4 a[36:39], v9, s[8:11], s65 offen offset:1024 sc1
  s_add_u32 s65, s77, s79
  buffer_load_dwordx4 a[8:11], v8, s[8:11], s65 offen offset:0 sc1
  buffer_load_dwordx4 a[12:15], v8, s[8:11], s65 offen offset:1024 sc1
  buffer_load_dwordx4 a[40:43], v9, s[8:11], s65 offen offset:0 sc1
  buffer_load_dwordx4 a[44:47], v9, s[8:11], s65 offen offset:1024 sc1
  s_add_u32 s65, s77, s80
  buffer_load_dwordx4 a[16:19], v8, s[8:11], s65 offen offset:0 sc1
  buffer_load_dwordx4 a[20:23], v8, s[8:11], s65 offen offset:1024 sc1
  buffer_load_dwordx4 a[48:51], v9, s[8:11], s65 offen offset:0 sc1
  buffer_load_dwordx4 a[52:55], v9, s[8:11], s65 offen offset:1024 sc1
  s_add_u32 s65, s77, s81
  buffer_load_dwordx4 a[24:27], v8, s[8:11], s65 offen offset:0 sc1
  buffer_load_dwordx4 a[28:31], v8, s[8:11], s65 offen offset:1024 sc1
  buffer_load_dwordx4 a[56:59], v9, s[8:11], s65 offen offset:0 sc1
  buffer_load_dwordx4 a[60:63], v9, s[8:11], s65 offen offset:1024 sc1
  s_and_b32 s60, s50, 1
  s_lshl_b32 s51, s60, 17
  s_add_u32 s51, s51, s55
  s_xor_b32 s53, s51, 131072
  s_bfe_u32 s52, s50, 0x10001
  s_xor_b32 s54, s52, s60
  s_mul_i32 s68, s60, 262144
  s_add_u32 s68, s68, s59
  s_and_b32 s60, s50, 3
  s_mul_i32 s70, s60, 327680
  s_add_u32 s70, s70, s69
  s_bfe_u32 s72, s50, 0x10002
  s_add_u32 s94, s50, 1
  s_and_b32 s60, s94, 1
  s_mul_i32 s77, s60, 327680
  s_add_u32 s77, s77, s71
  s_add_u32 s66, s51, 10240
  s_add_u32 s67, s51, 14336
  s_add_u32 s63, s51, 16384
  s_lshl_b32 s84, s56, 10
  s_add_u32 s84, s84, s68
  s_lshl_b32 s85, s56, 9
  s_add_u32 s85, s85, s68
  s_xor_b32 s86, s84, 1024
  s_xor_b32 s89, s85, 512
  s_xor_b32 s87, s84, 2048
  s_xor_b32 s90, s85, 1024
  s_xor_b32 s88, s84, 3072
  s_xor_b32 s91, s85, 1536
OW_F2L0:
  v_mov_b64 v[88:89], 0
  v_mov_b64 v[90:91], 0
  v_mov_b64 v[92:93], 0
  v_mov_b64 v[94:95], 0
  s_waitcnt vmcnt(0)
  v_mov_b32 v32, s94
  s_mov_b64 exec, 1
  s_cmp_lg_u32 s49, 0
  s_cbranch_scc1 wt_171
  buffer_store_dword v32, v1, s[8:11], s76 offen
wb_172:
  s_mov_b64 exec, -1
lp_173:
  buffer_load_dword v32, v2, s[8:11], s51 offen offset:0 sc1
  s_waitcnt vmcnt(0)
  v_and_b32 v32, 1, v32
  v_cmp_eq_u32 vcc, s52, v32
  s_nop 0
  s_cbranch_vccnz lo_174
  s_sub_u32 s47, s47, 1
  s_cbranch_scc0 lp_173
  s_branch ABORT
lo_174:
pp_175:
  buffer_load_dwordx4 v[44:47], v11, s[8:11], s51 offen offset:0 sc1
  buffer_load_dwordx4 v[48:51], v11, s[8:11], s51 offen offset:1024 sc1
  buffer_load_dwordx4 v[52:55], v11, s[8:11], s51 offen offset:2048 sc1
  buffer_load_dwordx4 v[56:59], v11, s[8:11], s51 offen offset:3072 sc1
  buffer_load_dwordx4 v[68:71], v13, s[8:11], s66 offen sc1
  buffer_load_dwordx4 v[84:87], v1, s[8:11], s67 offen sc1
  s_waitcnt vmcnt(0)
  v_bitop3_b32 v32, v44, v46, s52 bitop3:0x7e
  v_bitop3_b32 v33, v48, v50, s52 bitop3:0x7e
  v_bitop3_b32 v34, v52, v54, s52 bitop3:0x7e
  v_or3_b32 v32, v32, v33, v34
  v_bitop3_b32 v33, v56, v58, s52 bitop3:0x7e
  v_bitop3_b32 v32, v32, v33, 1 bitop3:0xa8
  v_cmp_ne_u32 vcc, 0, v32
  s_nop 0
  s_cbranch_vccz po_176
  s_sub_u32 s47, s47, 1
  s_cbranch_scc0 pp_175
  s_branch ABORT
po_176:
  v_bitop3_b32 v32, v68, v70, s52 bitop3:0x7e
  v_bitop3_b32 v33, v84, v86, s52 bitop3:0x7e
  v_bitop3_b32 v32, v32, v33, 1 bitop3:0xa8
  v_cmp_ne_u32 vcc, 0, v32
  s_nop 0
  s_cbranch_vccz pk_177
  buffer_load_dwordx4 v[68:71], v13, s[8:11], s66 offen sc1
  buffer_load_dwordx4 v[84:87], v1, s[8:11], s67 offen sc1
pp_178:
  buffer_load_dwordx4 v[68:71], v13, s[8:11], s66 offen sc1
  buffer_load_dwordx4 v[84:87], v1, s[8:11], s67 offen sc1
  s_waitcnt vmcnt(2)
  v_bitop3_b32 v32, v68, v70, s52 bitop3:0x7e
  v_bitop3_b32 v33, v84, v86, s52 bitop3:0x7e
  v_bitop3_b32 v32, v32, v33, 1 bitop3:0xa8
  v_cmp_ne_u32 vcc, 0, v32
  s_nop 0
  s_cbranch_vccz po_179
  s_sub_u32 s47, s47, 1
  s_cbranch_scc0 pp_178
  s_branch ABORT
po_179:
pk_177:
  ds_write_b128 v13, v[68:71] offset:0
  v_smfmac_f32_16x16x64_bf16 v[88:91], v[68:71], a[0:7], v26
  v_smfmac_f32_16x16x64_bf16 v[92:95], v[68:71], a[32:39], v26
  s_waitcnt lgkmcnt(0)
  s_barrier
  ds_read_b128 v[72:75], v14 offset:0
  ds_read_b128 v[76:79], v15 offset:0
  ds_read_b128 v[80:83], v16 offset:0
  v_smfmac_f32_16x16x64_bf16 v[88:91], v[84:87], v[44:51], v26
  v_smfmac_f32_16x16x64_bf16 v[92:95], v[84:87], v[52:59], v26
  s_waitcnt lgkmcnt(2)
  v_smfmac_f32_16x16x64_bf16 v[88:91], v[72:75], a[8:15], v26
  v_smfmac_f32_16x16x64_bf16 v[92:95], v[72:75], a[40:47], v26
  s_waitcnt lgkmcnt(1)
  v_smfmac_f32_16x16x64_bf16 v[88:91], v[76:79], a[16:23], v26
  v_smfmac_f32_16x16x64_bf16 v[92:95], v[76:79], a[48:55], v26
  s_waitcnt lgkmcnt(0)
  v_smfmac_f32_16x16x64_bf16 v[88:91], v[80:83], a[24:31], v26
  v_smfmac_f32_16x16x64_bf16 v[92:95], v[80:83], a[56:63], v26
  s_nop 6
  v_add_f32 v100, v88, v89
  v_add_f32 v101, v90, v91
  v_add_f32 v102, v92, v93
  v_add_f32 v103, v94, v95
  v_and_or_b32 v100, v100, -2, s52
  buffer_store_dwordx4 v[100:103], v1, s[8:11], s84 offen sc1
  s_sleep 6
  buffer_load_dword v4, v3, s[8:11], s73 offen sc1
  buffer_load_dwordx4 v[112:115], v1, s[8:11], s86 offen sc1
  buffer_load_dwordx4 v[116:119], v1, s[8:11], s87 offen sc1
  buffer_load_dwordx4 v[120:123], v1, s[8:11], s88 offen sc1
  s_sleep 4
  buffer_load_dwordx4 v[184:187], v17, s[8:11], s63 offen offset:0 sc1
  buffer_load_dwordx4 v[188:191], v17, s[8:11], s63 offen offset:1024 sc1
  buffer_load_dwordx4 v[192:195], v17, s[8:11], s63 offen offset:2048 sc1
  buffer_load_dwordx4 v[196:199], v17, s[8:11], s63 offen offset:3072 sc1
  buffer_load_dwordx4 v[200:203], v31, s[8:11], s63 offen sc1
  s_waitcnt vmcnt(5)
  v_bitop3_b32 v32, v112, v116, s52 bitop3:0x7e
  v_bitop3_b32 v32, v120, v32, s52 bitop3:0xde
  v_and_b32 v32, 1, v32
  v_cmp_ne_u32 vcc, 0, v32
  s_nop 0
  s_cbranch_vccz po_182
pt_181:
  buffer_load_dwordx4 v[112:115], v1, s[8:11], s86 offen sc1
  buffer_load_dwordx4 v[116:119], v1, s[8:11], s87 offen sc1
  buffer_load_dwordx4 v[120:123], v1, s[8:11], s88 offen sc1
  s_waitcnt vmcnt(0)
  v_bitop3_b32 v32, v112, v116, s52 bitop3:0x7e
  v_bitop3_b32 v32, v120, v32, s52 bitop3:0xde
  v_and_b32 v32, 1, v32
  v_cmp_ne_u32 vcc, 0, v32
  s_nop 0
  s_cbranch_vccz po_182
  s_sub_u32 s47, s47, 1
  s_cbranch_scc0 pt_181
  s_branch ABORT
po_182:
xo_180:
  s_mov_b32 vcc_lo, 0x55555555
  s_mov_b32 vcc_hi, vcc_lo
  v_pk_add_f32 v[100:101], v[100:101], v[112:113]
  v_pk_add_f32 v[88:89], v[116:117], v[120:121]
  v_pk_add_f32 v[102:103], v[102:103], v[114:115]
  v_pk_add_f32 v[90:91], v[118:119], v[122:123]
  v_pk_add_f32 v[100:101], v[100:101], v[88:89]
  v_pk_add_f32 v[102:103], v[102:103], v[90:91]
  s_nop 0
  v_cndmask_b32_dpp v88, v101, v100, vcc quad_perm:[1,0,3,2] row_mask:0xf bank_mask:0xf
  v_cndmask_b32_dpp v90, v103, v102, vcc quad_perm:[1,0,3,2] row_mask:0xf bank_mask:0xf
  s_not_b64 vcc, vcc
  v_cndmask_b32_dpp v89, v100, v101, vcc quad_perm:[1,0,3,2] row_mask:0xf bank_mask:0xf
  v_cndmask_b32_dpp v91, v102, v103, vcc quad_perm:[1,0,3,2] row_mask:0xf bank_mask:0xf
  s_mov_b64 vcc, s[82:83]
  v_cvt_pk_bf16_f32 v94, v88, v89
  v_cvt_pk_bf16_f32 v96, v90, v91
  s_nop 1
  v_cndmask_b32_dpp v88, v96, v94, vcc quad_perm:[2,3,0,1] row_mask:0xf bank_mask:0xf
  s_not_b64 vcc, vcc
  v_cndmask_b32_dpp v89, v94, v96, vcc quad_perm:[2,3,0,1] row_mask:0xf bank_mask:0xf
  v_and_or_b32 v88, v88, -2, s54
  s_cmp_lg_u32 s49, 0
  s_cbranch_scc1 wt_184
  buffer_store_dwordx2 v[88:89], v22, s[8:11], s53 offen
wb_185:
  s_min_u32 s60, s94, 63
gv_187:
  v_cmp_ge_i32 vcc, s60, v4
  s_nop 0
  s_cbranch_vccz gv_186
  buffer_load_dword v4, v3, s[8:11], s73 offen sc1
  s_waitcnt vmcnt(0)
  s_sleep 1
  s_sub_u32 s47, s47, 1
  s_cbranch_scc0 gv_187
  s_branch ABORT
gv_186:
  s_waitcnt vmcnt(1)
  v_bitop3_b32 v32, v184, v188, s52 bitop3:0x7e
  v_bitop3_b32 v33, v192, v196, s52 bitop3:0x7e
  v_bitop3_b32 v34, v200, v202, s52 bitop3:0x7e
  v_or3_b32 v32, v32, v33, v34
  v_and_b32 v32, 1, v32
  v_cmp_ne_u32 vcc, 0, v32
  s_nop 0
  s_cbranch_vccz po_189
pt_188:
  buffer_load_dwordx4 v[184:187], v17, s[8:11], s63 offen offset:0 sc1
  buffer_load_dwordx4 v[188:191], v17, s[8:11], s63 offen offset:1024 sc1
  buffer_load_dwordx4 v[192:195], v17, s[8:11], s63 offen offset:2048 sc1
  buffer_load_dwordx4 v[196:199], v17, s[8:11], s63 offen offset:3072 sc1
  buffer_load_dwordx4 v[200:203], v31, s[8:11], s63 offen sc1
  s_waitcnt vmcnt(0)
  v_bitop3_b32 v32, v184, v188, s52 bitop3:0x7e
  v_bitop3_b32 v33, v192, v196, s52 bitop3:0x7e
  v_bitop3_b32 v34, v200, v202, s52 bitop3:0x7e
  v_or3_b32 v32, v32, v33, v34
  v_and_b32 v32, 1, v32
  v_cmp_ne_u32 vcc, 0, v32
  s_nop 0
  s_cbranch_vccz po_189
  s_sub_u32 s47, s47, 1
  s_cbranch_scc0 pt_188
  s_branch ABORT
po_189:
  ds_write_b128 v17, v[184:187] offset:4096
  ds_write_b128 v17, v[188:191] offset:5120
  ds_write_b128 v17, v[192:195] offset:6144
  ds_write_b128 v17, v[196:199] offset:7168
  ds_write_b128 v31, v[200:203] offset:4096
  s_waitcnt lgkmcnt(0)
  s_barrier
  ds_read_b128 v[160:163], v17 offset:4096
  ds_read_b128 v[164:167], v17 offset:5120
  ds_read_b128 v[168:171], v17 offset:6144
  ds_read_b128 v[172:175], v17 offset:7168
  ds_read_b128 v[176:179], v18 offset:4096
  s_waitcnt lgkmcnt(4)
  v_mfma_f32_16x16x32_bf16 v[136:139], a[0:3], v[160:163], 0
  ds_read_b128 v[180:183], v18 offset:5120
  v_mfma_f32_16x16x32_bf16 v[144:147], a[32:35], v[160:163], 0
  s_add_u32 s65, s77, s78
  buffer_load_dwordx4 a[96:99], v8, s[8:11], s65 offen offset:0 sc1
  s_waitcnt lgkmcnt(4)
  v_mfma_f32_16x16x32_bf16 v[140:143], a[0:3], v[164:167], 0
  ds_read_b128 v[160:163], v18 offset:6144
  v_mfma_f32_16x16x32_bf16 v[148:151], a[32:35], v[164:167], 0
  buffer_load_dwordx4 a[100:103], v8, s[8:11], s65 offen offset:1024 sc1
  s_waitcnt lgkmcnt(4)
  v_mfma_f32_16x16x32_bf16 v[136:139], a[4:7], v[168:171], v[136:139]
  ds_read_b128 v[164:167], v18 offset:7168
  v_mfma_f32_16x16x32_bf16 v[144:147], a[36:39], v[168:171], v[144:147]
  buffer_load_dwordx4 a[128:131], v9, s[8:11], s65 offen offset:0 sc1
  s_waitcnt lgkmcnt(4)
  v_mfma_f32_16x16x32_bf16 v[140:143], a[4:7], v[172:175], v[140:143]
  ds_read_b128 v[168:171], v19 offset:4096
  v_mfma_f32_16x16x32_bf16 v[148:151], a[36:39], v[172:175], v[148:151]
  buffer_load_dwordx4 a[132:135], v9, s[8:11], s65 offen offset:1024 sc1
  s_waitcnt lgkmcnt(4)
  v_mfma_f32_16x16x32_bf16 v[136:139], a[8:11], v[176:179], v[136:139]
  ds_read_b128 v[172:175], v19 offset:5120
  v_mfma_f32_16x16x32_bf16 v[144:147], a[40:43], v[176:179], v[144:147]
  s_add_u32 s65, s77, s79
  buffer_load_dwordx4 a[104:107], v8, s[8:11], s65 offen offset:0 sc1
  s_waitcnt lgkmcnt(4)
  v_mfma_f32_16x16x32_bf16 v[140:143], a[8:11], v[180:183], v[140:143]
  ds_read_b128 v[176:179], v19 offset:6144
  v_mfma_f32_16x16x32_bf16 v[148:151], a[40:43], v[180:183], v[148:151]
  buffer_load_dwordx4 a[108:111], v8, s[8:11], s65 offen offset:1024 sc1
  s_waitcnt lgkmcnt(4)
  v_mfma_f32_16x16x32_bf16 v[136:139], a[12:15], v[160:163], v[136:139]
  ds_read_b128 v[180:183], v19 offset:7168
  v_mfma_f32_16x16x32_bf16 v[144:147], a[44:47], v[160:163], v[144:147]
  buffer_load_dwordx4 a[136:139], v9, s[8:11], s65 offen offset:0 sc1
  s_waitcnt lgkmcnt(4)
  v_mfma_f32_16x16x32_bf16 v[140:143], a[12:15], v[164:167], v[140:143]
  ds_read_b128 v[160:163], v20 offset:4096
  v_mfma_f32_16x16x32_bf16 v[148:151], a[44:47], v[164:167], v[148:151]
  buffer_load_dwordx4 a[140:143], v9, s[8:11], s65 offen offset:1024 sc1
  s_waitcnt lgkmcnt(4)
  v_mfma_f32_16x16x32_bf16 v[136:139], a[16:19], v[168:171], v[136:139]
  ds_read_b128 v[164:167], v20 offset:5120
  v_mfma_f32_16x16x32_bf16 v[144:147], a[48:51], v[168:171], v[144:147]
  s_add_u32 s65, s77, s80
  buffer_load_dwordx4 a[112:115], v8, s[8:11], s65 offen offset:0 sc1
  s_waitcnt lgkmcnt(4)
  v_mfma_f32_16x16x32_bf16 v[140:143], a[16:19], v[172:175], v[140:143]
  ds_read_b128 v[168:171], v20 offset:6144
  v_mfma_f32_16x16x32_bf16 v[148:151], a[48:51], v[172:175], v[148:151]
  buffer_load_dwordx4 a[116:119], v8, s[8:11], s65 offen offset:1024 sc1
  s_waitcnt lgkmcnt(4)
  v_mfma_f32_16x16x32_bf16 v[136:139], a[20:23], v[176:179], v[136:139]
  ds_read_b128 v[172:175], v20 offset:7168
  v_mfma_f32_16x16x32_bf16 v[144:147], a[52:55], v[176:179], v[144:147]
  buffer_load_dwordx4 a[144:147], v9, s[8:11], s65 offen offset:0 sc1
  s_waitcnt lgkmcnt(4)
  v_mfma_f32_16x16x32_bf16 v[140:143], a[20:23], v[180:183], v[140:143]
  ds_read_b128 v[176:179], v1 offset:20480
  v_mfma_f32_16x16x32_bf16 v[148:151], a[52:55], v[180:183], v[148:151]
  buffer_load_dwordx4 a[148:151], v9, s[8:11], s65 offen offset:1024 sc1
  s_waitcnt lgkmcnt(4)
  v_mfma_f32_16x16x32_bf16 v[136:139], a[24:27], v[160:163], v[136:139]
  ds_read_b128 v[180:183], v1 offset:21504
  v_mfma_f32_16x16x32_bf16 v[144:147], a[56:59], v[160:163], v[144:147]
  s_add_u32 s65, s77, s81
  buffer_load_dwordx4 a[120:123], v8, s[8:11], s65 offen offset:0 sc1
  s_waitcnt lgkmcnt(4)
  v_mfma_f32_16x16x32_bf16 v[140:143], a[24:27], v[164:167], v[140:143]
  ds_read_b128 v[160:163], v1 offset:22528
  v_mfma_f32_16x16x32_bf16 v[148:151], a[56:59], v[164:167], v[148:151]
  buffer_load_dwordx4 a[124:127], v8, s[8:11], s65 offen offset:1024 sc1
  s_waitcnt lgkmcnt(4)
  v_mfma_f32_16x16x32_bf16 v[136:139], a[28:31], v[168:171], v[136:139]
  ds_read_b128 v[164:167], v1 offset:23552
  v_mfma_f32_16x16x32_bf16 v[144:147], a[60:63], v[168:171], v[144:147]
  buffer_load_dwordx4 a[152:155], v9, s[8:11], s65 offen offset:0 sc1
  s_waitcnt lgkmcnt(4)
  v_mfma_f32_16x16x32_bf16 v[140:143], a[28:31], v[172:175], v[140:143]
  v_mfma_f32_16x16x32_bf16 v[148:151], a[60:63], v[172:175], v[148:151]
  buffer_load_dwordx4 a[156:159], v9, s[8:11], s65 offen offset:1024 sc1
  s_waitcnt lgkmcnt(3)
  v_mfma_f32_16x16x32_bf16 v[136:139], v[44:47], v[176:179], v[136:139]
  v_mfma_f32_16x16x32_bf16 v[144:147], v[52:55], v[176:179], v[144:147]
  s_waitcnt lgkmcnt(2)
  v_mfma_f32_16x16x32_bf16 v[140:143], v[44:47], v[180:183], v[140:143]
  v_mfma_f32_16x16x32_bf16 v[148:151], v[52:55], v[180:183], v[148:151]
  s_waitcnt lgkmcnt(1)
  v_mfma_f32_16x16x32_bf16 v[136:139], v[48:51], v[160:163], v[136:139]
  v_mfma_f32_16x16x32_bf16 v[144:147], v[56:59], v[160:163], v[144:147]
  s_waitcnt lgkmcnt(0)
  v_mfma_f32_16x16x32_bf16 v[140:143], v[48:51], v[164:167], v[140:143]
  v_mfma_f32_16x16x32_bf16 v[148:151], v[56:59], v[164:167], v[148:151]
  s_nop 3
  v_cvt_pk_bf16_f32 v204, v136, v137
  v_cvt_pk_bf16_f32 v205, v138, v139
  v_and_or_b32 v204, v204, -2, s72
  v_cvt_pk_bf16_f32 v206, v144, v145
  v_cvt_pk_bf16_f32 v207, v146, v147
  v_and_or_b32 v206, v206, -2, s72
  v_cvt_pk_bf16_f32 v208, v140, v141
  v_cvt_pk_bf16_f32 v209, v142, v143
  v_and_or_b32 v208, v208, -2, s72
  v_cvt_pk_bf16_f32 v210, v148, v149
  v_cvt_pk_bf16_f32 v211, v150, v151
  v_and_or_b32 v210, v210, -2, s72
  s_mov_b32 s93, s70
  buffer_store_dwordx4 v[204:207], v24, s[8:11], s93 offen offset:0 sc1
  buffer_store_dwordx4 v[208:211], v24, s[8:11], s93 offen offset:1024 sc1
  s_cmp_eq_u32 s50, 63
  s_cbranch_scc1 OW_END
  s_add_u32 s50, s50, 1
  s_and_b32 s60, s50, 1
  s_lshl_b32 s51, s60, 17
  s_add_u32 s51, s51, s55
  s_xor_b32 s53, s51, 131072
  s_bfe_u32 s52, s50, 0x10001
  s_xor_b32 s54, s52, s60
  s_mul_i32 s68, s60, 262144
  s_add_u32 s68, s68, s59
  s_and_b32 s60, s50, 3
  s_mul_i32 s70, s60, 327680
  s_add_u32 s70, s70, s69
  s_bfe_u32 s72, s50, 0x10002
  s_add_u32 s94, s50, 1
  s_and_b32 s60, s94, 1
  s_mul_i32 s77, s60, 327680
  s_add_u32 s77, s77, s71
  s_add_u32 s66, s51, 10240
  s_add_u32 s67, s51, 14336
  s_add_u32 s63, s51, 16384
  s_lshl_b32 s84, s56, 10
  s_add_u32 s84, s84, s68
  s_lshl_b32 s85, s56, 9
  s_add_u32 s85, s85, s68
  s_xor_b32 s86, s84, 1024
  s_xor_b32 s89, s85, 512
  s_xor_b32 s87, s84, 2048
  s_xor_b32 s90, s85, 1024
  s_xor_b32 s88, s84, 3072
  s_xor_b32 s91, s85, 1536
OW_F2L1:
  v_mov_b64 v[88:89], 0
  v_mov_b64 v[90:91], 0
  v_mov_b64 v[92:93], 0
  v_mov_b64 v[94:95], 0
  s_waitcnt vmcnt(0)
  v_mov_b32 v32, s94
  s_mov_b64 exec, 1
  s_cmp_lg_u32 s49, 0
  s_cbranch_scc1 wt_191
  buffer_store_dword v32, v1, s[8:11], s76 offen
wb_192:
  s_mov_b64 exec, -1
lp_193:
  buffer_load_dword v32, v2, s[8:11], s51 offen offset:0 sc1
  s_waitcnt vmcnt(0)
  v_and_b32 v32, 1, v32
  v_cmp_eq_u32 vcc, s52, v32
  s_nop 0
  s_cbranch_vccnz lo_194
  s_sub_u32 s47, s47, 1
  s_cbranch_scc0 lp_193
  s_branch ABORT
lo_194:
pp_195:
  buffer_load_dwordx4 v[44:47], v11, s[8:11], s51 offen offset:0 sc1
  buffer_load_dwordx4 v[48:51], v11, s[8:11], s51 offen offset:1024 sc1
  buffer_load_dwordx4 v[52:55], v11, s[8:11], s51 offen offset:2048 sc1
  buffer_load_dwordx4 v[56:59], v11, s[8:11], s51 offen offset:3072 sc1
  buffer_load_dwordx4 v[68:71], v13, s[8:11], s66 offen sc1
  buffer_load_dwordx4 v[84:87], v1, s[8:11], s67 offen sc1
  s_waitcnt vmcnt(0)
  v_bitop3_b32 v32, v44, v46, s52 bitop3:0x7e
  v_bitop3_b32 v33, v48, v50, s52 bitop3:0x7e
  v_bitop3_b32 v34, v52, v54, s52 bitop3:0x7e
  v_or3_b32 v32, v32, v33, v34
  v_bitop3_b32 v33, v56, v58, s52 bitop3:0x7e
  v_bitop3_b32 v32, v32, v33, 1 bitop3:0xa8
  v_cmp_ne_u32 vcc, 0, v32
  s_nop 0
  s_cbranch_vccz po_196
  s_sub_u32 s47, s47, 1
  s_cbranch_scc0 pp_195
  s_branch ABORT
po_196:
  v_bitop3_b32 v32, v68, v70, s52 bitop3:0x7e
  v_bitop3_b32 v33, v84, v86, s52 bitop3:0x7e
  v_bitop3_b32 v32, v32, v33, 1 bitop3:0xa8
  v_cmp_ne_u32 vcc, 0, v32
  s_nop 0
  s_cbranch_vccz pk_197
  buffer_load_dwordx4 v[68:71], v13, s[8:11], s66 offen sc1
  buffer_load_dwordx4 v[84:87], v1, s[8:11], s67 offen sc1
pp_198:
  buffer_load_dwordx4 v[68:71], v13, s[8:11], s66 offen sc1
  buffer_load_dwordx4 v[84:87], v1, s[8:11], s67 offen sc1
  s_waitcnt vmcnt(2)
  v_bitop3_b32 v32, v68, v70, s52 bitop3:0x7e
  v_bitop3_b32 v33, v84, v86, s52 bitop3:0x7e
  v_bitop3_b32 v32, v32, v33, 1 bitop3:0xa8
  v_cmp_ne_u32 vcc, 0, v32
  s_nop 0
  s_cbranch_vccz po_199
  s_sub_u32 s47, s47, 1
  s_cbranch_scc0 pp_198
  s_branch ABORT
po_199:
pk_197:
  ds_write_b128 v13, v[68:71] offset:0
  v_smfmac_f32_16x16x64_bf16 v[88:91], v[68:71], a[96:103], v26
  v_smfmac_f32_16x16x64_bf16 v[92:95], v[68:71], a[128:135], v26
  s_waitcnt lgkmcnt(0)
  s_barrier
  ds_read_b128 v[72:75], v14 offset:0
  ds_read_b128 v[76:79], v15 offset:0
  ds_read_b128 v[80:83], v16 offset:0
  v_smfmac_f32_16x16x64_bf16 v[88:91], v[84:87], v[44:51], v26
  v_smfmac_f32_16x16x64_bf16 v[92:95], v[84:87], v[52:59], v26
  s_waitcnt lgkmcnt(2)
  v_smfmac_f32_16x16x64_bf16 v[88:91], v[72:75], a[104:111], v26
  v_smfmac_f32_16x16x64_bf16 v[92:95], v[72:75], a[136:143], v26
  s_waitcnt lgkmcnt(1)
  v_smfmac_f32_16x16x64_bf16 v[88:91], v[76:79], a[112:119], v26
  v_smfmac_f32_16x16x64_bf16 v[92:95], v[76:79], a[144:151], v26
  s_waitcnt lgkmcnt(0)
  v_smfmac_f32_16x16x64_bf16 v[88:91], v[80:83], a[120:127], v26
  v_smfmac_f32_16x16x64_bf16 v[92:95], v[80:83], a[152:159], v26
  s_nop 6
  v_add_f32 v100, v88, v89
  v_add_f32 v101, v90, v91
  v_add_f32 v102, v92, v93
  v_add_f32 v103, v94, v95
  v_and_or_b32 v100, v100, -2, s52
  buffer_store_dwordx4 v[100:103], v1, s[8:11], s84 offen sc1
  s_sleep 6
  buffer_load_dword v4, v3, s[8:11], s73 offen sc1
  buffer_load_dwordx4 v[112:115], v1, s[8:11], s86 offen sc1
  buffer_load_dwordx4 v[116:119], v1, s[8:11], s87 offen sc1
  buffer_load_dwordx4 v[120:123], v1, s[8:11], s88 offen sc1
  s_sleep 4
  buffer_load_dwordx4 v[184:187], v17, s[8:11], s63 offen offset:0 sc1
  buffer_load_dwordx4 v[188:191], v17, s[8:11], s63 offen offset:1024 sc1
  buffer_load_dwordx4 v[192:195], v17, s[8:11], s63 offen offset:2048 sc1
  buffer_load_dwordx4 v[196:199], v17, s[8:11], s63 offen offset:3072 sc1
  buffer_load_dwordx4 v[200:203], v31, s[8:11], s63 offen sc1
  s_waitcnt vmcnt(5)
  v_bitop3_b32 v32, v112, v116, s52 bitop3:0x7e
  v_bitop3_b32 v32, v120, v32, s52 bitop3:0xde
  v_and_b32 v32, 1, v32
  v_cmp_ne_u32 vcc, 0, v32
  s_nop 0
  s_cbranch_vccz po_202
pt_201:
  buffer_load_dwordx4 v[112:115], v1, s[8:11], s86 offen sc1
  buffer_load_dwordx4 v[116:119], v1, s[8:11], s87 offen sc1
  buffer_load_dwordx4 v[120:123], v1, s[8:11], s88 offen sc1
  s_waitcnt vmcnt(0)
  v_bitop3_b32 v32, v112, v116, s52 bitop3:0x7e
  v_bitop3_b32 v32, v120, v32, s52 bitop3:0xde
  v_and_b32 v32, 1, v32
  v_cmp_ne_u32 vcc, 0, v32
  s_nop 0
  s_cbranch_vccz po_202
  s_sub_u32 s47, s47, 1
  s_cbranch_scc0 pt_201
  s_branch ABORT
po_202:
xo_200:
  s_mov_b32 vcc_lo, 0x55555555
  s_mov_b32 vcc_hi, vcc_lo
  v_pk_add_f32 v[100:101], v[100:101], v[112:113]
  v_pk_add_f32 v[88:89], v[116:117], v[120:121]
  v_pk_add_f32 v[102:103], v[102:103], v[114:115]
  v_pk_add_f32 v[90:91], v[118:119], v[122:123]
  v_pk_add_f32 v[100:101], v[100:101], v[88:89]
  v_pk_add_f32 v[102:103], v[102:103], v[90:91]
  s_nop 0
  v_cndmask_b32_dpp v88, v101, v100, vcc quad_perm:[1,0,3,2] row_mask:0xf bank_mask:0xf
  v_cndmask_b32_dpp v90, v103, v102, vcc quad_perm:[1,0,3,2] row_mask:0xf bank_mask:0xf
  s_not_b64 vcc, vcc
  v_cndmask_b32_dpp v89, v100, v101, vcc quad_perm:[1,0,3,2] row_mask:0xf bank_mask:0xf
  v_cndmask_b32_dpp v91, v102, v103, vcc quad_perm:[1,0,3,2] row_mask:0xf bank_mask:0xf
  s_mov_b64 vcc, s[82:83]
  v_cvt_pk_bf16_f32 v94, v88, v89
  v_cvt_pk_bf16_f32 v96, v90, v91
  s_nop 1
  v_cndmask_b32_dpp v88, v96, v94, vcc quad_perm:[2,3,0,1] row_mask:0xf bank_mask:0xf
  s_not_b64 vcc, vcc
  v_cndmask_b32_dpp v89, v94, v96, vcc quad_perm:[2,3,0,1] row_mask:0xf bank_mask:0xf
  v_and_or_b32 v88, v88, -2, s54
  s_cmp_lg_u32 s49, 0
  s_cbranch_scc1 wt_204
  buffer_store_dwordx2 v[88:89], v22, s[8:11], s53 offen
wb_205:
  s_min_u32 s60, s94, 63
gv_207:
  v_cmp_ge_i32 vcc, s60, v4
  s_nop 0
  s_cbranch_vccz gv_206
  buffer_load_dword v4, v3, s[8:11], s73 offen sc1
  s_waitcnt vmcnt(0)
  s_sleep 1
  s_sub_u32 s47, s47, 1
  s_cbranch_scc0 gv_207
  s_branch ABORT
gv_206:
  s_waitcnt vmcnt(1)
  v_bitop3_b32 v32, v184, v188, s52 bitop3:0x7e
  v_bitop3_b32 v33, v192, v196, s52 bitop3:0x7e
  v_bitop3_b32 v34, v200, v202, s52 bitop3:0x7e
  v_or3_b32 v32, v32, v33, v34
  v_and_b32 v32, 1, v32
  v_cmp_ne_u32 vcc, 0, v32
  s_nop 0
  s_cbranch_vccz po_209
pt_208:
  buffer_load_dwordx4 v[184:187], v17, s[8:11], s63 offen offset:0 sc1
  buffer_load_dwordx4 v[188:191], v17, s[8:11], s63 offen offset:1024 sc1
  buffer_load_dwordx4 v[192:195], v17, s[8:11], s63 offen offset:2048 sc1
  buffer_load_dwordx4 v[196:199], v17, s[8:11], s63 offen offset:3072 sc1
  buffer_load_dwordx4 v[200:203], v31, s[8:11], s63 offen sc1
  s_waitcnt vmcnt(0)
  v_bitop3_b32 v32, v184, v188, s52 bitop3:0x7e
  v_bitop3_b32 v33, v192, v196, s52 bitop3:0x7e
  v_bitop3_b32 v34, v200, v202, s52 bitop3:0x7e
  v_or3_b32 v32, v32, v33, v34
  v_and_b32 v32, 1, v32
  v_cmp_ne_u32 vcc, 0, v32
  s_nop 0
  s_cbranch_vccz po_209
  s_sub_u32 s47, s47, 1
  s_cbranch_scc0 pt_208
  s_branch ABORT
po_209:
  ds_write_b128 v17, v[184:187] offset:4096
  ds_write_b128 v17, v[188:191] offset:5120
  ds_write_b128 v17, v[192:195] offset:6144
  ds_write_b128 v17, v[196:199] offset:7168
  ds_write_b128 v31, v[200:203] offset:4096
  s_waitcnt lgkmcnt(0)
  s_barrier
  ds_read_b128 v[160:163], v17 offset:4096
  ds_read_b128 v[164:167], v17 offset:5120
  ds_read_b128 v[168:171], v17 offset:6144
  ds_read_b128 v[172:175], v17 offset:7168
  ds_read_b128 v[176:179], v18 offset:4096
  s_waitcnt lgkmcnt(4)
  v_mfma_f32_16x16x32_bf16 v[136:139], a[96:99], v[160:163], 0
  ds_read_b128 v[180:183], v18 offset:5120
  v_mfma_f32_16x16x32_bf16 v[144:147], a[128:131], v[160:163], 0
  s_add_u32 s65, s77, s78
  buffer_load_dwordx4 a[0:3], v8, s[8:11], s65 offen offset:0 sc1
  s_waitcnt lgkmcnt(4)
  v_mfma_f32_16x16x32_bf16 v[140:143], a[96:99], v[164:167], 0
  ds_read_b128 v[160:163], v18 offset:6144
  v_mfma_f32_16x16x32_bf16 v[148:151], a[128:131], v[164:167], 0
  buffer_load_dwordx4 a[4:7], v8, s[8:11], s65 offen offset:1024 sc1
  s_waitcnt lgkmcnt(4)
  v_mfma_f32_16x16x32_bf16 v[136:139], a[100:103], v[168:171], v[136:139]
  ds_read_b128 v[164:167], v18 offset:7168
  v_mfma_f32_16x16x32_bf16 v[144:147], a[132:135], v[168:171], v[144:147]
  buffer_load_dwordx4 a[32:35], v9, s[8:11], s65 offen offset:0 sc1
  s_waitcnt lgkmcnt(4)
  v_mfma_f32_16x16x32_bf16 v[140:143], a[100:103], v[172:175], v[140:143]
  ds_read_b128 v[168:171], v19 offset:4096
  v_mfma_f32_16x16x32_bf16 v[148:151], a[132:135], v[172:175], v[148:151]
  buffer_load_dwordx4 a[36:39], v9, s[8:11], s65 offen offset:1024 sc1
  s_waitcnt lgkmcnt(4)
  v_mfma_f32_16x16x32_bf16 v[136:139], a[104:107], v[176:179], v[136:139]
  ds_read_b128 v[172:175], v19 offset:5120
  v_mfma_f32_16x16x32_bf16 v[144:147], a[136:139], v[176:179], v[144:147]
  s_add_u32 s65, s77, s79
  buffer_load_dwordx4 a[8:11], v8, s[8:11], s65 offen offset:0 sc1
  s_waitcnt lgkmcnt(4)
  v_mfma_f32_16x16x32_bf16 v[140:143], a[104:107], v[180:183], v[140:143]
  ds_read_b128 v[176:179], v19 offset:6144
  v_mfma_f32_16x16x32_bf16 v[148:151], a[136:139], v[180:183], v[148:151]
  buffer_load_dwordx4 a[12:15], v8, s[8:11], s65 offen offset:1024 sc1
  s_waitcnt lgkmcnt(4)
  v_mfma_f32_16x16x32_bf16 v[136:139], a[108:111], v[160:163], v[136:139]
  ds_read_b128 v[180:183], v19 offset:7168
  v_mfma_f32_16x16x32_bf16 v[144:147], a[140:143], v[160:163], v[144:147]
  buffer_load_dwordx4 a[40:43], v9, s[8:11], s65 offen offset:0 sc1
  s_waitcnt lgkmcnt(4)
  v_mfma_f32_16x16x32_bf16 v[140:143], a[108:111], v[164:167], v[140:143]
  ds_read_b128 v[160:163], v20 offset:4096
  v_mfma_f32_16x16x32_bf16 v[148:151], a[140:143], v[164:167], v[148:151]
  buffer_load_dwordx4 a[44:47], v9, s[8:11], s65 offen offset:1024 sc1
  s_waitcnt lgkmcnt(4)
  v_mfma_f32_16x16x32_bf16 v[136:139], a[112:115], v[168:171], v[136:139]
  ds_read_b128 v[164:167], v20 offset:5120
  v_mfma_f32_16x16x32_bf16 v[144:147], a[144:147], v[168:171], v[144:147]
  s_add_u32 s65, s77, s80
  buffer_load_dwordx4 a[16:19], v8, s[8:11], s65 offen offset:0 sc1
  s_waitcnt lgkmcnt(4)
  v_mfma_f32_16x16x32_bf16 v[140:143], a[112:115], v[172:175], v[140:143]
  ds_read_b128 v[168:171], v20 offset:6144
  v_mfma_f32_16x16x32_bf16 v[148:151], a[144:147], v[172:175], v[148:151]
  buffer_load_dwordx4 a[20:23], v8, s[8:11], s65 offen offset:1024 sc1
  s_waitcnt lgkmcnt(4)
  v_mfma_f32_16x16x32_bf16 v[136:139], a[116:119], v[176:179], v[136:139]
  ds_read_b128 v[172:175], v20 offset:7168
  v_mfma_f32_16x16x32_bf16 v[144:147], a[148:151], v[176:179], v[144:147]
  buffer_load_dwordx4 a[48:51], v9, s[8:11], s65 offen offset:0 sc1
  s_waitcnt lgkmcnt(4)
  v_mfma_f32_16x16x32_bf16 v[140:143], a[116:119], v[180:183], v[140:143]
  ds_read_b128 v[176:179], v1 offset:20480
  v_mfma_f32_16x16x32_bf16 v[148:151], a[148:151], v[180:183], v[148:151]
  buffer_load_dwordx4 a[52:55], v9, s[8:11], s65 offen offset:1024 sc1
  s_waitcnt lgkmcnt(4)
  v_mfma_f32_16x16x32_bf16 v[136:139], a[120:123], v[160:163], v[136:139]
  ds_read_b128 v[180:183], v1 offset:21504
  v_mfma_f32_16x16x32_bf16 v[144:147], a[152:155], v[160:163], v[144:147]
  s_add_u32 s65, s77, s81
  buffer_load_dwordx4 a[24:27], v8, s[8:11], s65 offen offset:0 sc1
  s_waitcnt lgkmcnt(4)
  v_mfma_f32_16x16x32_bf16 v[140:143], a[120:123], v[164:167], v[140:143]
  ds_read_b128 v[160:163], v1 offset:22528
  v_mfma_f32_16x16x32_bf16 v[148:151], a[152:155], v[164:167], v[148:151]
  buffer_load_dwordx4 a[28:31], v8, s[8:11], s65 offen offset:1024 sc1
  s_waitcnt lgkmcnt(4)
  v_mfma_f32_16x16x32_bf16 v[136:139], a[124:127], v[168:171], v[136:139]
  ds_read_b128 v[164:167], v1 offset:23552
  v_mfma_f32_16x16x32_bf16 v[144:147], a[156:159], v[168:171], v[144:147]
  buffer_load_dwordx4 a[56:59], v9, s[8:11], s65 offen offset:0 sc1
  s_waitcnt lgkmcnt(4)
  v_mfma_f32_16x16x32_bf16 v[140:143], a[124:127], v[172:175], v[140:143]
  v_mfma_f32_16x16x32_bf16 v[148:151], a[156:159], v[172:175], v[148:151]
  buffer_load_dwordx4 a[60:63], v9, s[8:11], s65 offen offset:1024 sc1
  s_waitcnt lgkmcnt(3)
  v_mfma_f32_16x16x32_bf16 v[136:139], v[44:47], v[176:179], v[136:139]
  v_mfma_f32_16x16x32_bf16 v[144:147], v[52:55], v[176:179], v[144:147]
  s_waitcnt lgkmcnt(2)
  v_mfma_f32_16x16x32_bf16 v[140:143], v[44:47], v[180:183], v[140:143]
  v_mfma_f32_16x16x32_bf16 v[148:151], v[52:55], v[180:183], v[148:151]
  s_waitcnt lgkmcnt(1)
  v_mfma_f32_16x16x32_bf16 v[136:139], v[48:51], v[160:163], v[136:139]
  v_mfma_f32_16x16x32_bf16 v[144:147], v[56:59], v[160:163], v[144:147]
  s_waitcnt lgkmcnt(0)
  v_mfma_f32_16x16x32_bf16 v[140:143], v[48:51], v[164:167], v[140:143]
  v_mfma_f32_16x16x32_bf16 v[148:151], v[56:59], v[164:167], v[148:151]
  s_nop 3
  v_cvt_pk_bf16_f32 v204, v136, v137
  v_cvt_pk_bf16_f32 v205, v138, v139
  v_and_or_b32 v204, v204, -2, s72
  v_cvt_pk_bf16_f32 v206, v144, v145
  v_cvt_pk_bf16_f32 v207, v146, v147
  v_and_or_b32 v206, v206, -2, s72
  v_cvt_pk_bf16_f32 v208, v140, v141
  v_cvt_pk_bf16_f32 v209, v142, v143
  v_and_or_b32 v208, v208, -2, s72
  v_cvt_pk_bf16_f32 v210, v148, v149
  v_cvt_pk_bf16_f32 v211, v150, v151
  v_and_or_b32 v210, v210, -2, s72
  s_mov_b32 s93, s70
  buffer_store_dwordx4 v[204:207], v24, s[8:11], s93 offen offset:0 sc1
  buffer_store_dwordx4 v[208:211], v24, s[8:11], s93 offen offset:1024 sc1
  s_cmp_eq_u32 s50, 63
  s_cbranch_scc1 OW_END
  s_add_u32 s50, s50, 1
  s_and_b32 s60, s50, 1
  s_lshl_b32 s51, s60, 17
  s_add_u32 s51, s51, s55
  s_xor_b32 s53, s51, 131072
  s_bfe_u32 s52, s50, 0x10001
  s_xor_b32 s54, s52, s60
  s_mul_i32 s68, s60, 262144
  s_add_u32 s68, s68, s59
  s_and_b32 s60, s50, 3
  s_mul_i32 s70, s60, 327680
  s_add_u32 s70, s70, s69
  s_bfe_u32 s72, s50, 0x10002
  s_add_u32 s94, s50, 1
  s_and_b32 s60, s94, 1
  s_mul_i32 s77, s60, 327680
  s_add_u32 s77, s77, s71
  s_add_u32 s66, s51, 10240
  s_add_u32 s67, s51, 14336
  s_add_u32 s63, s51, 16384
  s_lshl_b32 s84, s56, 10
  s_add_u32 s84, s84, s68
  s_lshl_b32 s85, s56, 9
  s_add_u32 s85, s85, s68
  s_xor_b32 s86, s84, 1024
  s_xor_b32 s89, s85, 512
  s_xor_b32 s87, s84, 2048
  s_xor_b32 s90, s85, 1024
  s_xor_b32 s88, s84, 3072
  s_xor_b32 s91, s85, 1536
  s_branch OW_F2L0
OW_END:
  s_endpgm
wt_127:
  s_nop 7
  buffer_store_dword v32, v1, s[8:11], s76 offen sc1
  s_branch wb_128
wt_140:
  s_nop 7
  buffer_store_dwordx2 v[88:89], v22, s[8:11], s53 offen sc1
  s_branch wb_141
wt_142:
  s_nop 7
  buffer_store_dwordx2 v[98:99], v23, s[8:11], s53 offen sc1
  s_branch wb_143
wt_149:
  s_nop 7
  buffer_store_dword v32, v1, s[8:11], s76 offen sc1
  s_branch wb_150
wt_162:
  s_nop 7
  buffer_store_dwordx2 v[88:89], v22, s[8:11], s53 offen sc1
  s_branch wb_163
wt_164:
  s_nop 7
  buffer_store_dwordx2 v[98:99], v23, s[8:11], s53 offen sc1
  s_branch wb_165
wt_171:
  s_nop 7
  buffer_store_dword v32, v1, s[8:11], s76 offen sc1
  s_branch wb_172
wt_184:
  s_nop 7
  buffer_store_dwordx2 v[88:89], v22, s[8:11], s53 offen sc1
  s_branch wb_185
wt_191:
  s_nop 7
  buffer_store_dword v32, v1, s[8:11], s76 offen sc1
  s_branch wb_192
wt_204:
  s_nop 7
  buffer_store_dwordx2 v[88:89], v22, s[8:11], s53 offen sc1
  s_branch wb_205
GO_PO:
ROLE_PO:
  v_lshlrev_b32 v1, 4, v0
  v_lshlrev_b32 v6, 2, v0
  v_mov_b32 v4, 1
  v_mov_b32 v8, 24576
  s_mov_b32 s57, s48
  v_and_b32 v5, 15, v0
  v_lshlrev_b32 v5, 3, v5
  v_lshrrev_b32 v12, 4, v0
  v_lshl_add_u32 v5, v12, 8, v5
  v_and_b32 v2, 1, v0
  s_lshl_b32 s60, s57, 1
  v_add_lshl_u32 v2, v2, s60, 2
  s_lshr_b32 s58, s57, 1
  s_add_u32 s58, s58, 64
  s_andn2_b32 s73, s46, s57
  s_and_b32 s73, s73, 1
  s_add_u32 s60, s57, 32
  s_cmp_eq_u32 s46, 2
  s_cselect_b32 s58, s60, s58
  s_cmp_eq_u32 s46, 3
  s_cselect_b32 s58, s57, s58
  s_cmp_ge_u32 s46, 2
  s_cselect_b32 s73, 1, s73
  s_lshr_b32 s59, s58, 1
  s_lshl_b32 s59, s59, 10
  s_and_b32 s60, s58, 1
  s_lshl_b32 s60, s60, 7
  s_add_u32 s59, s59, s60
  s_and_b32 s60, s59, 0xffffe000
  s_add_u32 s83, s59, s60
  s_lshr_b32 s60, s57, 3
  s_mul_i32 s68, s60, 2621440
  s_and_b32 s60, s57, 7
  s_lshl_b32 s60, s60, 10
  s_add_u32 s68, s68, s60
  s_mul_i32 s60, s46, 81920
  s_add_u32 s68, s68, s60
  s_add_u32 s68, s68, 24117248
  s_mul_i32 s82, s46, 3072
  s_mul_i32 s69, s57, 36864
  s_add_u32 s69, s69, s82
  s_add_u32 s69, s69, 35676160
  s_lshl2_add_u32 s70, s57, s46
  s_lshl_b32 s70, s70, 2
  s_add_u32 s70, s70, 196608
  s_lshr_b32 s60, s57, 3
  s_lshl_b32 s60, s60, 5
  s_lshl2_add_u32 s60, s46, s60
  v_and_b32 v9, 3, v0
  v_add_lshl_u32 v9, v9, s60, 2
  s_mov_b32 s80, 0
  s_mov_b32 s81, 0
  s_mov_b32 s77, 0
  s_mov_b64 s[86:87], 0
  s_mov_b64 s[88:89], 0
  s_mov_b64 s[90:91], 0
  s_waitcnt vmcnt(0)
  s_barrier
  s_cmp_lg_u32 s46, 0
  s_cbranch_scc1 arr_211
  v_mov_b32 v12, 1
  s_lshl_b32 s3, s49, 2
  v_mov_b32 v13, s3
  s_mov_b64 exec, 1
  buffer_atomic_add v12, v13, s[12:15], 0 offen sc1
  s_mov_b64 exec, -1
arr_211:
  v_lshrrev_b32 v18, 2, v0
  v_mul_u32_u24 v18, 1280, v18
  v_and_b32 v19, 3, v0
  v_lshl_add_u32 v18, v19, 3, v18
  s_mul_i32 s60, s46, 320
  v_add_u32 v18, s60, v18
  s_mov_b32 s4, s26
  s_mov_b32 s5, s27
  s_mov_b32 s6, 7864320
  s_mov_b32 s7, 0x20000
  s_mul_i32 s60, s46, 10240
  s_mul_i32 s61, s57, 245760
  s_add_u32 s61, s60, s61
  s_mul_i32 s63, s46, 12288
  s_mul_i32 s65, s46, 10240
  s_add_u32 s64, s61, 0
  s_add_u32 m0, s65, 0
  s_nop 0
  buffer_load_dwordx4 v1, s[4:7], s64 offen offset:0 lds
  buffer_load_dwordx4 v1, s[4:7], s64 offen offset:1024 lds
  buffer_load_dwordx4 v1, s[4:7], s64 offen offset:2048 lds
  buffer_load_dwordx4 v1, s[4:7], s64 offen offset:3072 lds
  s_add_u32 s64, s61, 4096
  s_add_u32 m0, s65, 4096
  s_nop 0
  buffer_load_dwordx4 v1, s[4:7], s64 offen offset:0 lds
  buffer_load_dwordx4 v1, s[4:7], s64 offen offset:1024 lds
  buffer_load_dwordx4 v1, s[4:7], s64 offen offset:2048 lds
  buffer_load_dwordx4 v1, s[4:7], s64 offen offset:3072 lds
  s_add_u32 s64, s61, 8192
  s_add_u32 m0, s65, 8192
  s_nop 0
  buffer_load_dwordx4 v1, s[4:7], s64 offen offset:0 lds
  buffer_load_dwordx4 v1, s[4:7], s64 offen offset:1024 lds
  s_add_u32 s64, s61, 40960
  s_add_u32 m0, s65, 49152
  s_nop 0
  buffer_load_dwordx4 v1, s[4:7], s64 offen offset:0 lds
  buffer_load_dwordx4 v1, s[4:7], s64 offen offset:1024 lds
  buffer_load_dwordx4 v1, s[4:7], s64 offen offset:2048 lds
  buffer_load_dwordx4 v1, s[4:7], s64 offen offset:3072 lds
  s_add_u32 s64, s61, 45056
  s_add_u32 m0, s65, 53248
  s_nop 0
  buffer_load_dwordx4 v1, s[4:7], s64 offen offset:0 lds
  buffer_load_dwordx4 v1, s[4:7], s64 offen offset:1024 lds
  buffer_load_dwordx4 v1, s[4:7], s64 offen offset:2048 lds
  buffer_load_dwordx4 v1, s[4:7], s64 offen offset:3072 lds
  s_add_u32 s64, s61, 49152
  s_add_u32 m0, s65, 57344
  s_nop 0
  buffer_load_dwordx4 v1, s[4:7], s64 offen offset:0 lds
  buffer_load_dwordx4 v1, s[4:7], s64 offen offset:1024 lds
  s_add_u32 s64, s61, 81920
  s_add_u32 m0, s65, 98304
  s_nop 0
  buffer_load_dwordx4 v1, s[4:7], s64 offen offset:0 lds
  buffer_load_dwordx4 v1, s[4:7], s64 offen offset:1024 lds
  buffer_load_dwordx4 v1, s[4:7], s64 offen offset:2048 lds
  buffer_load_dwordx4 v1, s[4:7], s64 offen offset:3072 lds
  s_add_u32 s64, s61, 86016
  s_add_u32 m0, s65, 102400
  s_nop 0
  buffer_load_dwordx4 v1, s[4:7], s64 offen offset:0 lds
  buffer_load_dwordx4 v1, s[4:7], s64 offen offset:1024 lds
  buffer_load_dwordx4 v1, s[4:7], s64 offen offset:2048 lds
  buffer_load_dwordx4 v1, s[4:7], s64 offen offset:3072 lds
  s_add_u32 s64, s61, 90112
  s_add_u32 m0, s65, 106496
  s_nop 0
  buffer_load_dwordx4 v1, s[4:7], s64 offen offset:0 lds
  buffer_load_dwordx4 v1, s[4:7], s64 offen offset:1024 lds
  s_waitcnt vmcnt(20)
  s_barrier
  v_add_u32 v15, 0, v18
  ds_read_b64_tr_b16 a[0:1], v15 offset:0
  ds_read_b64_tr_b16 a[2:3], v15 offset:20480
  ds_read_b64_tr_b16 a[24:25], v15 offset:32
  ds_read_b64_tr_b16 a[26:27], v15 offset:20512
  ds_read_b64_tr_b16 a[48:49], v15 offset:64
  ds_read_b64_tr_b16 a[50:51], v15 offset:20544
  ds_read_b64_tr_b16 a[72:73], v15 offset:96
  ds_read_b64_tr_b16 a[74:75], v15 offset:20576
  ds_read_b64_tr_b16 a[96:97], v15 offset:128
  ds_read_b64_tr_b16 a[98:99], v15 offset:20608
  ds_read_b64_tr_b16 a[120:121], v15 offset:160
  ds_read_b64_tr_b16 a[122:123], v15 offset:20640
  s_waitcnt lgkmcnt(3)
  ds_read_b64_tr_b16 a[144:145], v15 offset:192
  ds_read_b64_tr_b16 a[146:147], v15 offset:20672
  ds_read_b64_tr_b16 a[168:169], v15 offset:224
  ds_read_b64_tr_b16 a[170:171], v15 offset:20704
  ds_read_b64_tr_b16 a[192:193], v15 offset:256
  ds_read_b64_tr_b16 a[194:195], v15 offset:20736
  ds_read_b64_tr_b16 a[216:217], v15 offset:288
  ds_read_b64_tr_b16 a[218:219], v15 offset:20768
  s_waitcnt lgkmcnt(0)
  s_barrier
  s_add_u32 s64, s61, 122880
  s_add_u32 m0, s65, 0
  s_nop 0
  buffer_load_dwordx4 v1, s[4:7], s64 offen offset:0 lds
  buffer_load_dwordx4 v1, s[4:7], s64 offen offset:1024 lds
  buffer_load_dwordx4 v1, s[4:7], s64 offen offset:2048 lds
  buffer_load_dwordx4 v1, s[4:7], s64 offen offset:3072 lds
  s_add_u32 s64, s61, 126976
  s_add_u32 m0, s65, 4096
  s_nop 0
  buffer_load_dwordx4 v1, s[4:7], s64 offen offset:0 lds
  buffer_load_dwordx4 v1, s[4:7], s64 offen offset:1024 lds
  buffer_load_dwordx4 v1, s[4:7], s64 offen offset:2048 lds
  buffer_load_dwordx4 v1, s[4:7], s64 offen offset:3072 lds
  s_add_u32 s64, s61, 131072
  s_add_u32 m0, s65, 8192
  s_nop 0
  buffer_load_dwordx4 v1, s[4:7], s64 offen offset:0 lds
  buffer_load_dwordx4 v1, s[4:7], s64 offen offset:1024 lds
  s_waitcnt vmcnt(20)
  s_barrier
  v_add_u32 v15, 49152, v18
  ds_read_b64_tr_b16 a[4:5], v15 offset:0
  ds_read_b64_tr_b16 a[6:7], v15 offset:20480
  ds_read_b64_tr_b16 a[28:29], v15 offset:32
  ds_read_b64_tr_b16 a[30:31], v15 offset:20512
  ds_read_b64_tr_b16 a[52:53], v15 offset:64
  ds_read_b64_tr_b16 a[54:55], v15 offset:20544
  ds_read_b64_tr_b16 a[76:77], v15 offset:96
  ds_read_b64_tr_b16 a[78:79], v15 offset:20576
  ds_read_b64_tr_b16 a[100:101], v15 offset:128
  ds_read_b64_tr_b16 a[102:103], v15 offset:20608
  ds_read_b64_tr_b16 a[124:125], v15 offset:160
  ds_read_b64_tr_b16 a[126:127], v15 offset:20640
  s_waitcnt lgkmcnt(3)
  ds_read_b64_tr_b16 a[148:149], v15 offset:192
  ds_read_b64_tr_b16 a[150:151], v15 offset:20672
  ds_read_b64_tr_b16 a[172:173], v15 offset:224
  ds_read_b64_tr_b16 a[174:175], v15 offset:20704
  ds_read_b64_tr_b16 a[196:197], v15 offset:256
  ds_read_b64_tr_b16 a[198:199], v15 offset:20736
  ds_read_b64_tr_b16 a[220:221], v15 offset:288
  ds_read_b64_tr_b16 a[222:223], v15 offset:20768
  s_waitcnt lgkmcnt(0)
  s_barrier
  s_add_u32 s64, s61, 163840
  s_add_u32 m0, s65, 49152
  s_nop 0
  buffer_load_dwordx4 v1, s[4:7], s64 offen offset:0 lds
  buffer_load_dwordx4 v1, s[4:7], s64 offen offset:1024 lds
  buffer_load_dwordx4 v1, s[4:7], s64 offen offset:2048 lds
  buffer_load_dwordx4 v1, s[4:7], s64 offen offset:3072 lds
  s_add_u32 s64, s61, 167936
  s_add_u32 m0, s65, 53248
  s_nop 0
  buffer_load_dwordx4 v1, s[4:7], s64 offen offset:0 lds
  buffer_load_dwordx4 v1, s[4:7], s64 offen offset:1024 lds
  buffer_load_dwordx4 v1, s[4:7], s64 offen offset:2048 lds
  buffer_load_dwordx4 v1, s[4:7], s64 offen offset:3072 lds
  s_add_u32 s64, s61, 172032
  s_add_u32 m0, s65, 57344
  s_nop 0
  buffer_load_dwordx4 v1, s[4:7], s64 offen offset:0 lds
  buffer_load_dwordx4 v1, s[4:7], s64 offen offset:1024 lds
  s_waitcnt vmcnt(20)
  s_barrier
  v_add_u32 v15, 98304, v18
  ds_read_b64_tr_b16 a[8:9], v15 offset:0
  ds_read_b64_tr_b16 a[10:11], v15 offset:20480
  ds_read_b64_tr_b16 a[32:33], v15 offset:32
  ds_read_b64_tr_b16 a[34:35], v15 offset:20512
  ds_read_b64_tr_b16 a[56:57], v15 offset:64
  ds_read_b64_tr_b16 a[58:59], v15 offset:20544
  ds_read_b64_tr_b16 a[80:81], v15 offset:96
  ds_read_b64_tr_b16 a[82:83], v15 offset:20576
  ds_read_b64_tr_b16 a[104:105], v15 offset:128
  ds_read_b64_tr_b16 a[106:107], v15 offset:20608
  ds_read_b64_tr_b16 a[128:129], v15 offset:160
  ds_read_b64_tr_b16 a[130:131], v15 offset:20640
  s_waitcnt lgkmcnt(3)
  ds_read_b64_tr_b16 a[152:153], v15 offset:192
  ds_read_b64_tr_b16 a[154:155], v15 offset:20672
  ds_read_b64_tr_b16 a[176:177], v15 offset:224
  ds_read_b64_tr_b16 a[178:179], v15 offset:20704
  ds_read_b64_tr_b16 a[200:201], v15 offset:256
  ds_read_b64_tr_b16 a[202:203], v15 offset:20736
  ds_read_b64_tr_b16 a[224:225], v15 offset:288
  ds_read_b64_tr_b16 a[226:227], v15 offset:20768
  s_waitcnt lgkmcnt(0)
  s_barrier
  s_add_u32 s64, s61, 204800
  s_add_u32 m0, s65, 98304
  s_nop 0
  buffer_load_dwordx4 v1, s[4:7], s64 offen offset:0 lds
  buffer_load_dwordx4 v1, s[4:7], s64 offen offset:1024 lds
  buffer_load_dwordx4 v1, s[4:7], s64 offen offset:2048 lds
  buffer_load_dwordx4 v1, s[4:7], s64 offen offset:3072 lds
  s_add_u32 s64, s61, 208896
  s_add_u32 m0, s65, 102400
  s_nop 0
  buffer_load_dwordx4 v1, s[4:7], s64 offen offset:0 lds
  buffer_load_dwordx4 v1, s[4:7], s64 offen offset:1024 lds
  buffer_load_dwordx4 v1, s[4:7], s64 offen offset:2048 lds
  buffer_load_dwordx4 v1, s[4:7], s64 offen offset:3072 lds
  s_add_u32 s64, s61, 212992
  s_add_u32 m0, s65, 106496
  s_nop 0
  buffer_load_dwordx4 v1, s[4:7], s64 offen offset:0 lds
  buffer_load_dwordx4 v1, s[4:7], s64 offen offset:1024 lds
  s_waitcnt vmcnt(20)
  s_barrier
  v_add_u32 v15, 0, v18
  ds_read_b64_tr_b16 a[12:13], v15 offset:0
  ds_read_b64_tr_b16 a[14:15], v15 offset:20480
  ds_read_b64_tr_b16 a[36:37], v15 offset:32
  ds_read_b64_tr_b16 a[38:39], v15 offset:20512
  ds_read_b64_tr_b16 a[60:61], v15 offset:64
  ds_read_b64_tr_b16 a[62:63], v15 offset:20544
  ds_read_b64_tr_b16 a[84:85], v15 offset:96
  ds_read_b64_tr_b16 a[86:87], v15 offset:20576
  ds_read_b64_tr_b16 a[108:109], v15 offset:128
  ds_read_b64_tr_b16 a[110:111], v15 offset:20608
  ds_read_b64_tr_b16 a[132:133], v15 offset:160
  ds_read_b64_tr_b16 a[134:135], v15 offset:20640
  s_waitcnt lgkmcnt(3)
  ds_read_b64_tr_b16 a[156:157], v15 offset:192
  ds_read_b64_tr_b16 a[158:159], v15 offset:20672
  ds_read_b64_tr_b16 a[180:181], v15 offset:224
  ds_read_b64_tr_b16 a[182:183], v15 offset:20704
  ds_read_b64_tr_b16 a[204:205], v15 offset:256
  ds_read_b64_tr_b16 a[206:207], v15 offset:20736
  ds_read_b64_tr_b16 a[228:229], v15 offset:288
  ds_read_b64_tr_b16 a[230:231], v15 offset:20768
  s_waitcnt lgkmcnt(0)
  s_barrier
  s_waitcnt vmcnt(10)
  s_barrier
  v_add_u32 v15, 49152, v18
  ds_read_b64_tr_b16 a[16:17], v15 offset:0
  ds_read_b64_tr_b16 a[18:19], v15 offset:20480
  ds_read_b64_tr_b16 a[40:41], v15 offset:32
  ds_read_b64_tr_b16 a[42:43], v15 offset:20512
  ds_read_b64_tr_b16 a[64:65], v15 offset:64
  ds_read_b64_tr_b16 a[66:67], v15 offset:20544
  ds_read_b64_tr_b16 a[88:89], v15 offset:96
  ds_read_b64_tr_b16 a[90:91], v15 offset:20576
  ds_read_b64_tr_b16 a[112:113], v15 offset:128
  ds_read_b64_tr_b16 a[114:115], v15 offset:20608
  ds_read_b64_tr_b16 a[136:137], v15 offset:160
  ds_read_b64_tr_b16 a[138:139], v15 offset:20640
  s_waitcnt lgkmcnt(3)
  ds_read_b64_tr_b16 a[160:161], v15 offset:192
  ds_read_b64_tr_b16 a[162:163], v15 offset:20672
  ds_read_b64_tr_b16 a[184:185], v15 offset:224
  ds_read_b64_tr_b16 a[186:187], v15 offset:20704
  ds_read_b64_tr_b16 a[208:209], v15 offset:256
  ds_read_b64_tr_b16 a[210:211], v15 offset:20736
  ds_read_b64_tr_b16 a[232:233], v15 offset:288
  ds_read_b64_tr_b16 a[234:235], v15 offset:20768
  s_waitcnt lgkmcnt(0)
  s_barrier
  s_waitcnt vmcnt(0)
  s_barrier
  v_add_u32 v15, 98304, v18
  ds_read_b64_tr_b16 a[20:21], v15 offset:0
  ds_read_b64_tr_b16 a[22:23], v15 offset:20480
  ds_read_b64_tr_b16 a[44:45], v15 offset:32
  ds_read_b64_tr_b16 a[46:47], v15 offset:20512
  ds_read_b64_tr_b16 a[68:69], v15 offset:64
  ds_read_b64_tr_b16 a[70:71], v15 offset:20544
  ds_read_b64_tr_b16 a[92:93], v15 offset:96
  ds_read_b64_tr_b16 a[94:95], v15 offset:20576
  ds_read_b64_tr_b16 a[116:117], v15 offset:128
  ds_read_b64_tr_b16 a[118:119], v15 offset:20608
  ds_read_b64_tr_b16 a[140:141], v15 offset:160
  ds_read_b64_tr_b16 a[142:143], v15 offset:20640
  s_waitcnt lgkmcnt(3)
  ds_read_b64_tr_b16 a[164:165], v15 offset:192
  ds_read_b64_tr_b16 a[166:167], v15 offset:20672
  ds_read_b64_tr_b16 a[188:189], v15 offset:224
  ds_read_b64_tr_b16 a[190:191], v15 offset:20704
  ds_read_b64_tr_b16 a[212:213], v15 offset:256
  ds_read_b64_tr_b16 a[214:215], v15 offset:20736
  ds_read_b64_tr_b16 a[236:237], v15 offset:288
  ds_read_b64_tr_b16 a[238:239], v15 offset:20768
  s_waitcnt lgkmcnt(0)
  s_barrier
  s_lshl_b32 s3, s49, 2
  v_mov_b32 v13, s3
  s_nop 1
ibw_212:
  buffer_load_dword v12, v13, s[12:15], 0 offen sc1
  s_waitcnt vmcnt(0)
  v_cmp_ne_u32 vcc, 256, v12
  s_nop 0
  s_cbranch_vccz ibw_213
  s_sleep 8
  s_sub_u32 s47, s47, 1
  s_cbranch_scc0 ibw_212
  s_branch ABORT
ibw_213:
  s_cmp_lg_u32 s49, 0
  s_cbranch_scc1 ibok_214
  v_and_b32 v13, 7, v0
  v_lshlrev_b32 v13, 2, v13
  buffer_load_dword v12, v13, s[12:15], 0 offen offset:32 sc1
  s_waitcnt vmcnt(0)
  v_cmp_ne_u32 vcc, 32, v12
  s_nop 0
  s_cbranch_vccz ibok_214
  s_barrier
  s_mov_b32 s49, 1
  s_mov_b32 s3, s2
  s_branch DISPATCH
ibok_214:
  v_mov_b32 v13, 196
  buffer_load_dword v12, v13, s[12:15], 0 offen sc1
  s_waitcnt vmcnt(0)
  v_readfirstlane_b32 s71, v12
  s_cmp_gt_i32 s71, 0
  s_cselect_b32 s71, 0x2000, 0
  s_add_u32 s71, s71, s83
  s_add_u32 s71, s71, 6291456
  v_mov_b32 v13, 200
  buffer_load_dword v12, v13, s[12:15], 0 offen sc1
  s_waitcnt vmcnt(0)
  v_readfirstlane_b32 s72, v12
  s_cmp_gt_i32 s72, 0
  s_cselect_b32 s72, 0x2000, 0
  s_add_u32 s72, s72, s83
  s_add_u32 s72, s72, 8388608
  s_mov_b32 s50, -1
  s_mov_b32 s51, 0
  s_mov_b32 s52, 0
  s_mov_b32 s38, 0
  s_mov_b32 s39, 0
  s_add_u32 s62, s50, 1
  s_min_u32 s62, s62, 133
  s_sub_i32 s60, s62, 13
  s_sub_i32 s53, s62, 12
  s_ashr_i32 s60, s60, 1
  s_ashr_i32 s53, s53, 1
  s_sub_i32 s61, s62, 67
  s_max_i32 s60, s60, s61
  s_add_i32 s61, s61, 1
  s_max_i32 s53, s53, s61
  s_max_i32 s60, s60, 0
  s_max_i32 s53, s53, 0
  s_sub_i32 s53, s53, s60
  s_sub_i32 s54, s62, s60
  s_sub_i32 s60, s60, s54
  s_mul_i32 s60, s60, s53
  s_add_i32 s54, s54, s60
  s_add_u32 s62, s50, 2
  s_min_u32 s62, s62, 133
  s_sub_i32 s60, s62, 13
  s_sub_i32 s55, s62, 12
  s_ashr_i32 s60, s60, 1
  s_ashr_i32 s55, s55, 1
  s_sub_i32 s61, s62, 67
  s_max_i32 s60, s60, s61
  s_add_i32 s61, s61, 1
  s_max_i32 s55, s55, s61
  s_max_i32 s60, s60, 0
  s_max_i32 s55, s55, 0
  s_sub_i32 s55, s55, s60
  s_sub_i32 s56, s62, s60
  s_sub_i32 s60, s60, s56
  s_mul_i32 s60, s60, s55
  s_add_i32 s56, s56, s60
  s_lshl_b32 s33, s51, 15
  s_add_u32 s33, s33, s70
  s_add_u32 s50, s50, 1
  s_mov_b32 s51, s53
  s_mov_b32 s52, s54
  s_mov_b32 s53, s55
  s_mov_b32 s54, s56
  s_sub_u32 s63, s52, 3
  s_cmp_lt_u32 s63, 64
  s_cselect_b32 s64, s73, 0
  s_cmp_lg_u32 s64, 0
  s_cselect_b64 s[34:35], -1, 0
  s_and_b32 s63, s63, 63
  s_bfe_u32 s31, s63, 0x10002
  s_lshl_b32 s32, s51, 6
  s_add_u32 s32, s32, s63
  s_and_b32 s63, s63, 3
  s_mul_i32 s63, s63, 327680
  s_cmp_eq_u32 s51, 0
  s_cselect_b32 s64, s71, s72
  s_add_u32 s26, s63, s64
  s_add_u32 s62, s50, 2
  s_min_u32 s62, s62, 133
  s_sub_i32 s60, s62, 13
  s_sub_i32 s55, s62, 12
  s_ashr_i32 s60, s60, 1
  s_ashr_i32 s55, s55, 1
  s_sub_i32 s61, s62, 67
  s_max_i32 s60, s60, s61
  s_add_i32 s61, s61, 1
  s_max_i32 s55, s55, s61
  s_max_i32 s60, s60, 0
  s_max_i32 s55, s55, 0
  s_sub_i32 s55, s55, s60
  s_sub_i32 s56, s62, s60
  s_sub_i32 s60, s60, s56
  s_mul_i32 s60, s60, s55
  s_add_i32 s56, s56, s60
  s_min_u32 s37, s56, 63
  s_lshl_b32 s64, s55, 6
  s_add_u32 s37, s37, s64
  s_lshl_b32 s37, s37, 9
  s_add_u32 s37, s37, 131072
  s_min_u32 s36, s54, 63
  s_mul_i32 s36, s36, 1179648
  s_add_u32 s36, s36, s69
  s_add_u32 s27, s26, 81920
  s_add_u32 s28, s26, 163840
  s_add_u32 s29, s26, 245760
  s_mul_i32 s30, s32, 46080
  s_add_u32 s30, s30, s59
  s_add_u32 s30, s30, 10485760
  s_mov_b64 s[16:17], s[26:27]
  s_mov_b64 s[18:19], s[28:29]
  s_mov_b64 s[20:21], s[30:31]
  s_mov_b64 s[22:23], s[32:33]
  s_mov_b64 s[24:25], s[34:35]
  s_mov_b32 s74, 0
  s_mov_b32 s75, 0
  s_mov_b32 s60, s73
  s_cmp_eq_u32 s60, 1
  s_cbranch_scc1 PO_FR0
PO_FN0:
  s_cmp_ge_u32 s52, 64
  s_cbranch_scc1 vi_216
  s_cmp_lg_u32 s74, 0
  s_mov_b32 s74, s75
  s_cbranch_scc1 go_215
  s_waitcnt vmcnt(0)
  v_mov_b32 v18, s77
  s_and_b64 exec, s[86:87], 1
  s_cmp_lg_u32 s49, 0
  s_cbranch_scc1 wt_219
  buffer_store_dword v18, v1, s[8:11], s23 offen
wb_220:
  s_mov_b64 exec, -1
  s_mov_b64 s[86:87], 0
  s_and_b64 exec, s[90:91], 1
  buffer_store_dword v4, v1, s[8:11], s81 offen sc1
  s_mov_b64 exec, -1
  s_mov_b64 s[90:91], 0
  s_mov_b64 exec, s[88:89]
  buffer_store_dwordx2 v[164:165], v5, s[8:11], s38 offen sc1
  s_and_b64 exec, s[88:89], 0x5555
  buffer_store_dwordx2 v[166:167], v6, s[8:11], s39 offen sc1
  s_mov_b64 exec, -1
  s_mov_b32 s81, s80
  s_mov_b64 s[90:91], s[88:89]
  s_mov_b64 s[88:89], 0
  s_waitcnt vmcnt(0)
  s_and_b64 exec, s[90:91], 1
  buffer_store_dword v4, v1, s[8:11], s81 offen sc1
  s_mov_b64 exec, -1
  s_mov_b64 s[90:91], 0
  s_min_u32 s66, s52, 63
  s_lshl_b32 s64, s51, 6
  s_add_u32 s66, s66, s64
  s_lshl_b32 s66, s66, 9
  s_add_u32 s66, s66, 131072
  s_min_u32 s65, s52, 63
  s_mul_i32 s65, s65, 1179648
  s_add_u32 s65, s65, s69
  s_cmp_lg_u32 s46, 0
  s_cbranch_scc1 w0_221
fl_222:
  buffer_load_dword v3, v2, s[8:11], s66 offen sc1
  s_waitcnt vmcnt(0)
  v_cmp_eq_u32 vcc, 0, v3
  s_nop 0
  s_cbranch_vccz fo_223
  s_sleep 4
  s_sub_u32 s47, s47, 1
  s_cbranch_scc0 fl_222
  s_branch ABORT
fo_223:
w0_221:
  s_barrier
  s_add_u32 m0, s82, 0
  s_nop 0
  buffer_load_dwordx4 v1, s[8:11], s65 offen offset:0 sc1 lds
  buffer_load_dwordx4 v1, s[8:11], s65 offen offset:1024 sc1 lds
  buffer_load_dwordx4 v1, s[8:11], s65 offen offset:2048 sc1 lds
  s_waitcnt vmcnt(0)
  s_barrier
  ds_read_b128 v[20:23], v1 offset:0
  ds_read_b128 v[24:27], v1 offset:1024
  ds_read_b128 v[28:31], v1 offset:2048
  ds_read_b128 v[32:35], v1 offset:3072
  ds_read_b128 v[36:39], v1 offset:4096
  ds_read_b128 v[40:43], v1 offset:5120
  ds_read_b128 v[44:47], v1 offset:6144
  ds_read_b128 v[48:51], v1 offset:7168
  ds_read_b128 v[52:55], v1 offset:8192
  ds_read_b128 v[56:59], v1 offset:9216
  ds_read_b128 v[60:63], v1 offset:10240
  ds_read_b128 v[64:67], v1 offset:11264
  s_waitcnt lgkmcnt(0)
go_215:
  v_mfma_f32_16x16x32_bf16 v[116:119], v[20:23], a[0:3], 0
  s_and_b32 s60, s52, 1
  s_lshl2_add_u32 s60, s51, s60
  s_mul_i32 s76, s60, 327680
  v_mfma_f32_16x16x32_bf16 v[120:123], v[24:27], a[0:3], 0
  s_add_u32 s76, s76, s68
  s_add_u32 m0, s82, 12288
  s_nop 0
  buffer_load_dwordx4 v1, s[8:11], s36 offen offset:0 sc1 lds
  v_mfma_f32_16x16x32_bf16 v[116:119], v[28:31], a[4:7], v[116:119]
  s_lshl_b32 s78, s51, 15
  s_add_u32 s78, s78, 197120
  s_sub_i32 s79, s52, 2
  v_mfma_f32_16x16x32_bf16 v[120:123], v[32:35], a[4:7], v[120:123]
  buffer_load_dwordx4 v1, s[8:11], s36 offen offset:1024 sc1 lds
  v_mfma_f32_16x16x32_bf16 v[116:119], v[36:39], a[8:11], v[116:119]
  v_mfma_f32_16x16x32_bf16 v[120:123], v[40:43], a[8:11], v[120:123]
  buffer_load_dwordx4 v1, s[8:11], s36 offen offset:2048 sc1 lds
  v_mfma_f32_16x16x32_bf16 v[116:119], v[44:47], a[12:15], v[116:119]
  v_mfma_f32_16x16x32_bf16 v[120:123], v[48:51], a[12:15], v[120:123]
  buffer_load_dword v3, v2, s[8:11], s37 offen sc1
  v_mfma_f32_16x16x32_bf16 v[116:119], v[52:55], a[16:19], v[116:119]
  v_mfma_f32_16x16x32_bf16 v[120:123], v[56:59], a[16:19], v[120:123]
  s_lshl_b32 s33, s51, 15
  s_add_u32 s33, s33, s70
  s_add_u32 s50, s50, 1
  v_mfma_f32_16x16x32_bf16 v[116:119], v[60:63], a[20:23], v[116:119]
  s_mov_b32 s51, s53
  s_mov_b32 s52, s54
  s_mov_b32 s53, s55
  v_mfma_f32_16x16x32_bf16 v[120:123], v[64:67], a[20:23], v[120:123]
  s_mov_b32 s54, s56
  s_sub_u32 s63, s52, 3
  v_mfma_f32_16x16x32_bf16 v[124:127], v[20:23], a[24:27], 0
  s_cmp_lt_u32 s63, 64
  s_cselect_b32 s64, s73, 0
  v_mfma_f32_16x16x32_bf16 v[128:131], v[24:27], a[24:27], 0
  s_cmp_lg_u32 s64, 0
  s_cselect_b64 s[34:35], -1, 0
  s_and_b32 s63, s63, 63
  v_mfma_f32_16x16x32_bf16 v[124:127], v[28:31], a[28:31], v[124:127]
  s_bfe_u32 s31, s63, 0x10002
  v_cvt_pk_bf16_f32 v168, v116, v117
  v_cvt_pk_bf16_f32 v169, v120, v121
  v_mfma_f32_16x16x32_bf16 v[128:131], v[32:35], a[28:31], v[128:131]
  s_lshl_b32 s32, s51, 6
  v_cvt_pk_bf16_f32 v170, v118, v119
  v_cvt_pk_bf16_f32 v171, v122, v123
  v_mfma_f32_16x16x32_bf16 v[124:127], v[36:39], a[32:35], v[124:127]
  s_add_u32 s32, s32, s63
  s_and_b32 s63, s63, 3
  s_mul_i32 s63, s63, 327680
  v_mfma_f32_16x16x32_bf16 v[128:131], v[40:43], a[32:35], v[128:131]
  s_cmp_eq_u32 s51, 0
  s_cselect_b32 s64, s71, s72
  s_add_u32 s26, s63, s64
  v_mfma_f32_16x16x32_bf16 v[124:127], v[44:47], a[36:39], v[124:127]
  s_add_u32 s62, s50, 2
  s_min_u32 s62, s62, 133
  s_sub_i32 s60, s62, 13
  v_mfma_f32_16x16x32_bf16 v[128:131], v[48:51], a[36:39], v[128:131]
  s_sub_i32 s55, s62, 12
  s_ashr_i32 s60, s60, 1
  s_ashr_i32 s55, s55, 1
  v_mfma_f32_16x16x32_bf16 v[124:127], v[52:55], a[40:43], v[124:127]
  s_sub_i32 s61, s62, 67
  s_max_i32 s60, s60, s61
  s_add_i32 s61, s61, 1
  v_mfma_f32_16x16x32_bf16 v[128:131], v[56:59], a[40:43], v[128:131]
  s_max_i32 s55, s55, s61
  s_max_i32 s60, s60, 0
  s_max_i32 s55, s55, 0
  v_mfma_f32_16x16x32_bf16 v[124:127], v[60:63], a[44:47], v[124:127]
  s_sub_i32 s55, s55, s60
  s_sub_i32 s56, s62, s60
  s_sub_i32 s60, s60, s56
  v_mfma_f32_16x16x32_bf16 v[128:131], v[64:67], a[44:47], v[128:131]
  s_mul_i32 s60, s60, s55
  s_add_i32 s56, s56, s60
  s_min_u32 s37, s56, 63
  v_mfma_f32_16x16x32_bf16 v[116:119], v[20:23], a[48:51], 0
  s_lshl_b32 s64, s55, 6
  s_add_u32 s37, s37, s64
  s_lshl_b32 s37, s37, 9
  v_mfma_f32_16x16x32_bf16 v[120:123], v[24:27], a[48:51], 0
  s_add_u32 s37, s37, 131072
  s_min_u32 s36, s54, 63
  s_mul_i32 s36, s36, 1179648
  v_mfma_f32_16x16x32_bf16 v[116:119], v[28:31], a[52:55], v[116:119]
  s_add_u32 s36, s36, s69
  v_cvt_pk_bf16_f32 v172, v124, v125
  v_cvt_pk_bf16_f32 v173, v128, v129
  v_mfma_f32_16x16x32_bf16 v[120:123], v[32:35], a[52:55], v[120:123]
  s_add_u32 s27, s26, 81920
  v_cvt_pk_bf16_f32 v174, v126, v127
  v_cvt_pk_bf16_f32 v175, v130, v131
  v_mfma_f32_16x16x32_bf16 v[116:119], v[36:39], a[56:59], v[116:119]
  s_add_u32 s28, s26, 163840
  s_add_u32 s29, s26, 245760
  s_mul_i32 s30, s32, 46080
  v_mfma_f32_16x16x32_bf16 v[120:123], v[40:43], a[56:59], v[120:123]
  s_add_u32 s30, s30, s59
  s_add_u32 s30, s30, 10485760
  v_mfma_f32_16x16x32_bf16 v[116:119], v[44:47], a[60:63], v[116:119]
  v_mfma_f32_16x16x32_bf16 v[120:123], v[48:51], a[60:63], v[120:123]
  v_mfma_f32_16x16x32_bf16 v[116:119], v[52:55], a[64:67], v[116:119]
  v_mfma_f32_16x16x32_bf16 v[120:123], v[56:59], a[64:67], v[120:123]
  v_mfma_f32_16x16x32_bf16 v[116:119], v[60:63], a[68:71], v[116:119]
  v_mfma_f32_16x16x32_bf16 v[120:123], v[64:67], a[68:71], v[120:123]
  v_mfma_f32_16x16x32_bf16 v[124:127], v[20:23], a[72:75], 0
  v_mfma_f32_16x16x32_bf16 v[128:131], v[24:27], a[72:75], 0
  v_mfma_f32_16x16x32_bf16 v[124:127], v[28:31], a[76:79], v[124:127]
  s_nop 3
  v_cvt_pk_bf16_f32 v176, v116, v117
  v_cvt_pk_bf16_f32 v177, v120, v121
  v_mfma_f32_16x16x32_bf16 v[128:131], v[32:35], a[76:79], v[128:131]
  v_cvt_pk_bf16_f32 v178, v118, v119
  v_cvt_pk_bf16_f32 v179, v122, v123
  v_mfma_f32_16x16x32_bf16 v[124:127], v[36:39], a[80:83], v[124:127]
  v_mfma_f32_16x16x32_bf16 v[128:131], v[40:43], a[80:83], v[128:131]
  v_mfma_f32_16x16x32_bf16 v[124:127], v[44:47], a[84:87], v[124:127]
  v_mfma_f32_16x16x32_bf16 v[128:131], v[48:51], a[84:87], v[128:131]
  v_mfma_f32_16x16x32_bf16 v[124:127], v[52:55], a[88:91], v[124:127]
  v_mfma_f32_16x16x32_bf16 v[128:131], v[56:59], a[88:91], v[128:131]
  v_mfma_f32_16x16x32_bf16 v[124:127], v[60:63], a[92:95], v[124:127]
  buffer_load_dword v10, v9, s[8:11], s78 offen sc1
  v_mfma_f32_16x16x32_bf16 v[128:131], v[64:67], a[92:95], v[128:131]
  v_mfma_f32_16x16x32_bf16 v[116:119], v[20:23], a[96:99], 0
  v_mfma_f32_16x16x32_bf16 v[120:123], v[24:27], a[96:99], 0
  v_mfma_f32_16x16x32_bf16 v[116:119], v[28:31], a[100:103], v[116:119]
  s_nop 2
  v_cvt_pk_bf16_f32 v180, v124, v125
  s_nop 0
  v_cvt_pk_bf16_f32 v181, v128, v129
  v_mfma_f32_16x16x32_bf16 v[120:123], v[32:35], a[100:103], v[120:123]
  v_cvt_pk_bf16_f32 v182, v126, v127
  v_cvt_pk_bf16_f32 v183, v130, v131
  v_mfma_f32_16x16x32_bf16 v[116:119], v[36:39], a[104:107], v[116:119]
  v_mfma_f32_16x16x32_bf16 v[120:123], v[40:43], a[104:107], v[120:123]
  v_mfma_f32_16x16x32_bf16 v[116:119], v[44:47], a[108:111], v[116:119]
  v_mfma_f32_16x16x32_bf16 v[120:123], v[48:51], a[108:111], v[120:123]
  v_mfma_f32_16x16x32_bf16 v[116:119], v[52:55], a[112:115], v[116:119]
  v_mfma_f32_16x16x32_bf16 v[120:123], v[56:59], a[112:115], v[120:123]
  v_mfma_f32_16x16x32_bf16 v[116:119], v[60:63], a[116:119], v[116:119]
  v_mfma_f32_16x16x32_bf16 v[120:123], v[64:67], a[116:119], v[120:123]
  v_mfma_f32_16x16x32_bf16 v[124:127], v[20:23], a[120:123], 0
  v_mfma_f32_16x16x32_bf16 v[128:131], v[24:27], a[120:123], 0
  v_mfma_f32_16x16x32_bf16 v[124:127], v[28:31], a[124:127], v[124:127]
  s_nop 3
  v_cvt_pk_bf16_f32 v184, v116, v117
  v_cvt_pk_bf16_f32 v185, v120, v121
  v_mfma_f32_16x16x32_bf16 v[128:131], v[32:35], a[124:127], v[128:131]
  v_cvt_pk_bf16_f32 v186, v118, v119
  v_cvt_pk_bf16_f32 v187, v122, v123
  v_mfma_f32_16x16x32_bf16 v[124:127], v[36:39], a[128:131], v[124:127]
  s_waitcnt vmcnt(0)
  v_mov_b32 v18, s77
  s_and_b64 exec, s[86:87], 1
  s_cmp_lg_u32 s49, 0
  s_cbranch_scc1 wt_224
  buffer_store_dword v18, v1, s[8:11], s23 offen
wb_225:
  s_mov_b64 exec, -1
  s_mov_b64 s[86:87], 0
  v_mfma_f32_16x16x32_bf16 v[128:131], v[40:43], a[128:131], v[128:131]
  v_min_u32_dpp v3, v3, v3 quad_perm:[1,0,3,2] row_mask:0xf bank_mask:0xf
  v_lshl_add_u32 v16, s46, 2, v8
  v_mfma_f32_16x16x32_bf16 v[124:127], v[44:47], a[132:135], v[124:127]
  ds_write_b32 v16, v3 offset:0
  v_cmp_ge_i32 vcc, s79, v10
  v_mfma_f32_16x16x32_bf16 v[128:131], v[48:51], a[132:135], v[128:131]
  v_mfma_f32_16x16x32_bf16 v[124:127], v[52:55], a[136:139], v[124:127]
  v_mfma_f32_16x16x32_bf16 v[128:131], v[56:59], a[136:139], v[128:131]
  v_mfma_f32_16x16x32_bf16 v[124:127], v[60:63], a[140:143], v[124:127]
  v_mfma_f32_16x16x32_bf16 v[128:131], v[64:67], a[140:143], v[128:131]
  s_cbranch_vccnz sl_217
bk_218:
  s_mov_b64 s[16:17], s[26:27]
  s_mov_b64 s[18:19], s[28:29]
  v_mfma_f32_16x16x32_bf16 v[116:119], v[20:23], a[144:147], 0
  s_mov_b64 s[20:21], s[30:31]
  s_cmp_lg_u32 s49, 0
  s_cbranch_scc1 wt_226
  buffer_store_dwordx4 v[168:171], v1, s[8:11], s76 offen
wb_227:
  v_mfma_f32_16x16x32_bf16 v[120:123], v[24:27], a[144:147], 0
  s_mov_b64 s[22:23], s[32:33]
  s_mov_b64 s[24:25], s[34:35]
  v_mfma_f32_16x16x32_bf16 v[116:119], v[28:31], a[148:151], v[116:119]
  v_cvt_pk_bf16_f32 v188, v124, v125
  v_cvt_pk_bf16_f32 v189, v128, v129
  v_mfma_f32_16x16x32_bf16 v[120:123], v[32:35], a[148:151], v[120:123]
  v_cvt_pk_bf16_f32 v190, v126, v127
  v_cvt_pk_bf16_f32 v191, v130, v131
  v_mfma_f32_16x16x32_bf16 v[116:119], v[36:39], a[152:155], v[116:119]
  v_mfma_f32_16x16x32_bf16 v[120:123], v[40:43], a[152:155], v[120:123]
  s_add_u32 s76, s76, 8192
  s_cmp_lg_u32 s49, 0
  s_cbranch_scc1 wt_228
  buffer_store_dwordx4 v[172:175], v1, s[8:11], s76 offen
wb_229:
  v_mfma_f32_16x16x32_bf16 v[116:119], v[44:47], a[156:159], v[116:119]
  v_mfma_f32_16x16x32_bf16 v[120:123], v[48:51], a[156:159], v[120:123]
  v_mfma_f32_16x16x32_bf16 v[116:119], v[52:55], a[160:163], v[116:119]
  v_mfma_f32_16x16x32_bf16 v[120:123], v[56:59], a[160:163], v[120:123]
  v_mfma_f32_16x16x32_bf16 v[116:119], v[60:63], a[164:167], v[116:119]
  s_add_u32 s76, s76, 8192
  s_cmp_lg_u32 s49, 0
  s_cbranch_scc1 wt_230
  buffer_store_dwordx4 v[176:179], v1, s[8:11], s76 offen
wb_231:
  v_mfma_f32_16x16x32_bf16 v[120:123], v[64:67], a[164:167], v[120:123]
  v_mfma_f32_16x16x32_bf16 v[124:127], v[20:23], a[168:171], 0
  v_mfma_f32_16x16x32_bf16 v[128:131], v[24:27], a[168:171], 0
  v_mfma_f32_16x16x32_bf16 v[124:127], v[28:31], a[172:175], v[124:127]
  v_cvt_pk_bf16_f32 v192, v116, v117
  s_nop 3
  v_cvt_pk_bf16_f32 v193, v120, v121
  v_mfma_f32_16x16x32_bf16 v[128:131], v[32:35], a[172:175], v[128:131]
  s_add_u32 s76, s76, 8192
  s_cmp_lg_u32 s49, 0
  s_cbranch_scc1 wt_232
  buffer_store_dwordx4 v[180:183], v1, s[8:11], s76 offen
wb_233:
  v_mfma_f32_16x16x32_bf16 v[124:127], v[36:39], a[176:179], v[124:127]
  v_cvt_pk_bf16_f32 v194, v118, v119
  v_cvt_pk_bf16_f32 v195, v122, v123
  v_mfma_f32_16x16x32_bf16 v[128:131], v[40:43], a[176:179], v[128:131]
  v_mfma_f32_16x16x32_bf16 v[124:127], v[44:47], a[180:183], v[124:127]
  v_mfma_f32_16x16x32_bf16 v[128:131], v[48:51], a[180:183], v[128:131]
  v_mfma_f32_16x16x32_bf16 v[124:127], v[52:55], a[184:187], v[124:127]
  s_waitcnt lgkmcnt(0)
  s_barrier
  ds_read_b32 v17, v8 offset:0
  s_add_u32 s76, s76, 8192
  s_cmp_lg_u32 s49, 0
  s_cbranch_scc1 wt_234
  buffer_store_dwordx4 v[184:187], v1, s[8:11], s76 offen
wb_235:
  v_mfma_f32_16x16x32_bf16 v[128:131], v[56:59], a[184:187], v[128:131]
  ds_read_b128 v[68:71], v1 offset:12288
  v_mfma_f32_16x16x32_bf16 v[124:127], v[60:63], a[188:191], v[124:127]
  v_mfma_f32_16x16x32_bf16 v[128:131], v[64:67], a[188:191], v[128:131]
  ds_read_b128 v[72:75], v1 offset:13312
  v_mfma_f32_16x16x32_bf16 v[116:119], v[20:23], a[192:195], 0
  v_mfma_f32_16x16x32_bf16 v[120:123], v[24:27], a[192:195], 0
  s_add_u32 s76, s76, 8192
  s_cmp_lg_u32 s49, 0
  s_cbranch_scc1 wt_236
  buffer_store_dwordx4 v[188:191], v1, s[8:11], s76 offen
wb_237:
  ds_read_b128 v[76:79], v1 offset:14336
  v_mfma_f32_16x16x32_bf16 v[116:119], v[28:31], a[196:199], v[116:119]
  v_cvt_pk_bf16_f32 v196, v124, v125
  v_cvt_pk_bf16_f32 v197, v128, v129
  v_mfma_f32_16x16x32_bf16 v[120:123], v[32:35], a[196:199], v[120:123]
  ds_read_b128 v[80:83], v1 offset:15360
  v_cvt_pk_bf16_f32 v198, v126, v127
  v_mfma_f32_16x16x32_bf16 v[116:119], v[36:39], a[200:203], v[116:119]
  v_cvt_pk_bf16_f32 v199, v130, v131
  v_mfma_f32_16x16x32_bf16 v[120:123], v[40:43], a[200:203], v[120:123]
  ds_read_b128 v[84:87], v1 offset:16384
  v_mfma_f32_16x16x32_bf16 v[116:119], v[44:47], a[204:207], v[116:119]
  s_add_u32 s76, s76, 8192
  s_cmp_lg_u32 s49, 0
  s_cbranch_scc1 wt_238
  buffer_store_dwordx4 v[192:195], v1, s[8:11], s76 offen
wb_239:
  v_mfma_f32_16x16x32_bf16 v[120:123], v[48:51], a[204:207], v[120:123]
  ds_read_b128 v[88:91], v1 offset:17408
  v_mfma_f32_16x16x32_bf16 v[116:119], v[52:55], a[208:211], v[116:119]
  v_mfma_f32_16x16x32_bf16 v[120:123], v[56:59], a[208:211], v[120:123]
  ds_read_b128 v[92:95], v1 offset:18432
  v_mfma_f32_16x16x32_bf16 v[116:119], v[60:63], a[212:215], v[116:119]
  v_mfma_f32_16x16x32_bf16 v[120:123], v[64:67], a[212:215], v[120:123]
  s_add_u32 s76, s76, 8192
  s_cmp_lg_u32 s49, 0
  s_cbranch_scc1 wt_240
  buffer_store_dwordx4 v[196:199], v1, s[8:11], s76 offen
wb_241:
  ds_read_b128 v[96:99], v1 offset:19456
  v_mfma_f32_16x16x32_bf16 v[124:127], v[20:23], a[216:219], 0
  v_mfma_f32_16x16x32_bf16 v[128:131], v[24:27], a[216:219], 0
  ds_read_b128 v[100:103], v1 offset:20480
  v_mfma_f32_16x16x32_bf16 v[124:127], v[28:31], a[220:223], v[124:127]
  v_cvt_pk_bf16_f32 v200, v116, v117
  v_cvt_pk_bf16_f32 v201, v120, v121
  v_mfma_f32_16x16x32_bf16 v[128:131], v[32:35], a[220:223], v[128:131]
  ds_read_b128 v[104:107], v1 offset:21504
  v_cvt_pk_bf16_f32 v202, v118, v119
  v_mfma_f32_16x16x32_bf16 v[124:127], v[36:39], a[224:227], v[124:127]
  v_cvt_pk_bf16_f32 v203, v122, v123
  v_mfma_f32_16x16x32_bf16 v[128:131], v[40:43], a[224:227], v[128:131]
  ds_read_b128 v[108:111], v1 offset:22528
  v_mfma_f32_16x16x32_bf16 v[124:127], v[44:47], a[228:231], v[124:127]
  s_add_u32 s76, s76, 8192
  s_cmp_lg_u32 s49, 0
  s_cbranch_scc1 wt_242
  buffer_store_dwordx4 v[200:203], v1, s[8:11], s76 offen
wb_243:
  v_mfma_f32_16x16x32_bf16 v[128:131], v[48:51], a[228:231], v[128:131]
  ds_read_b128 v[112:115], v1 offset:23552
  v_mfma_f32_16x16x32_bf16 v[124:127], v[52:55], a[232:235], v[124:127]
  v_mfma_f32_16x16x32_bf16 v[128:131], v[56:59], a[232:235], v[128:131]
  v_mfma_f32_16x16x32_bf16 v[124:127], v[60:63], a[236:239], v[124:127]
  v_mfma_f32_16x16x32_bf16 v[128:131], v[64:67], a[236:239], v[128:131]
  s_mov_b64 s[86:87], -1
  s_add_u32 s77, s79, 3
  s_waitcnt lgkmcnt(0)
  v_readfirstlane_b32 s75, v17
  s_nop 2
  v_cvt_pk_bf16_f32 v204, v124, v125
  v_cvt_pk_bf16_f32 v205, v128, v129
  v_cvt_pk_bf16_f32 v206, v126, v127
  v_cvt_pk_bf16_f32 v207, v130, v131
  s_add_u32 s76, s76, 8192
  s_cmp_lg_u32 s49, 0
  s_cbranch_scc1 wt_244
  buffer_store_dwordx4 v[204:207], v1, s[8:11], s76 offen
wb_245:
  s_nop 0
  s_branch PO_FN1
sl_217:
cg_246:
  buffer_load_dword v10, v9, s[8:11], s78 offen sc1
  s_waitcnt vmcnt(0)
  v_cmp_ge_i32 vcc, s79, v10
  s_nop 0
  s_cbranch_vccz bk_218
  s_sleep 1
  s_sub_u32 s47, s47, 1
  s_cbranch_scc0 cg_246
  s_branch ABORT
vi_216:
  s_waitcnt vmcnt(0)
  v_mov_b32 v18, s77
  s_and_b64 exec, s[86:87], 1
  s_cmp_lg_u32 s49, 0
  s_cbranch_scc1 wt_247
  buffer_store_dword v18, v1, s[8:11], s23 offen
wb_248:
  s_mov_b64 exec, -1
  s_mov_b64 s[86:87], 0
  s_and_b64 exec, s[90:91], 1
  buffer_store_dword v4, v1, s[8:11], s81 offen sc1
  s_mov_b64 exec, -1
  s_mov_b64 s[90:91], 0
  s_mov_b64 exec, s[88:89]
  buffer_store_dwordx2 v[164:165], v5, s[8:11], s38 offen sc1
  s_and_b64 exec, s[88:89], 0x5555
  buffer_store_dwordx2 v[166:167], v6, s[8:11], s39 offen sc1
  s_mov_b64 exec, -1
  s_mov_b32 s81, s80
  s_mov_b64 s[90:91], s[88:89]
  s_mov_b64 s[88:89], 0
  s_waitcnt vmcnt(0)
  s_and_b64 exec, s[90:91], 1
  buffer_store_dword v4, v1, s[8:11], s81 offen sc1
  s_mov_b64 exec, -1
  s_mov_b64 s[90:91], 0
  s_cmp_eq_u32 s50, 133
  s_cbranch_scc1 PO_END
  s_lshl_b32 s33, s51, 15
  s_add_u32 s33, s33, s70
  s_add_u32 s50, s50, 1
  s_mov_b32 s51, s53
  s_mov_b32 s52, s54
  s_mov_b32 s53, s55
  s_mov_b32 s54, s56
  s_sub_u32 s63, s52, 3
  s_cmp_lt_u32 s63, 64
  s_cselect_b32 s64, s73, 0
  s_cmp_lg_u32 s64, 0
  s_cselect_b64 s[34:35], -1, 0
  s_and_b32 s63, s63, 63
  s_bfe_u32 s31, s63, 0x10002
  s_lshl_b32 s32, s51, 6
  s_add_u32 s32, s32, s63
  s_and_b32 s63, s63, 3
  s_mul_i32 s63, s63, 327680
  s_cmp_eq_u32 s51, 0
  s_cselect_b32 s64, s71, s72
  s_add_u32 s26, s63, s64
  s_add_u32 s62, s50, 2
  s_min_u32 s62, s62, 133
  s_sub_i32 s60, s62, 13
  s_sub_i32 s55, s62, 12
  s_ashr_i32 s60, s60, 1
  s_ashr_i32 s55, s55, 1
  s_sub_i32 s61, s62, 67
  s_max_i32 s60, s60, s61
  s_add_i32 s61, s61, 1
  s_max_i32 s55, s55, s61
  s_max_i32 s60, s60, 0
  s_max_i32 s55, s55, 0
  s_sub_i32 s55, s55, s60
  s_sub_i32 s56, s62, s60
  s_sub_i32 s60, s60, s56
  s_mul_i32 s60, s60, s55
  s_add_i32 s56, s56, s60
  s_min_u32 s37, s56, 63
  s_lshl_b32 s64, s55, 6
  s_add_u32 s37, s37, s64
  s_lshl_b32 s37, s37, 9
  s_add_u32 s37, s37, 131072
  s_min_u32 s36, s54, 63
  s_mul_i32 s36, s36, 1179648
  s_add_u32 s36, s36, s69
  s_add_u32 s27, s26, 81920
  s_add_u32 s28, s26, 163840
  s_add_u32 s29, s26, 245760
  s_mul_i32 s30, s32, 46080
  s_add_u32 s30, s30, s59
  s_add_u32 s30, s30, 10485760
  s_mov_b64 s[16:17], s[26:27]
  s_mov_b64 s[18:19], s[28:29]
  s_mov_b64 s[20:21], s[30:31]
  s_mov_b64 s[22:23], s[32:33]
  s_mov_b64 s[24:25], s[34:35]
  s_mov_b32 s74, 0
  s_mov_b32 s75, 0
  s_branch PO_FN0
PO_FN1:
  s_cmp_ge_u32 s52, 64
  s_cbranch_scc1 vi_250
  s_cmp_lg_u32 s74, 0
  s_mov_b32 s74, s75
  s_cbranch_scc1 go_249
  s_waitcnt vmcnt(0)
  v_mov_b32 v18, s77
  s_and_b64 exec, s[86:87], 1
  s_cmp_lg_u32 s49, 0
  s_cbranch_scc1 wt_253
  buffer_store_dword v18, v1, s[8:11], s23 offen
wb_254:
  s_mov_b64 exec, -1
  s_mov_b64 s[86:87], 0
  s_and_b64 exec, s[90:91], 1
  buffer_store_dword v4, v1, s[8:11], s81 offen sc1
  s_mov_b64 exec, -1
  s_mov_b64 s[90:91], 0
  s_mov_b64 exec, s[88:89]
  buffer_store_dwordx2 v[164:165], v5, s[8:11], s38 offen sc1
  s_and_b64 exec, s[88:89], 0x5555
  buffer_store_dwordx2 v[166:167], v6, s[8:11], s39 offen sc1
  s_mov_b64 exec, -1
  s_mov_b32 s81, s80
  s_mov_b64 s[90:91], s[88:89]
  s_mov_b64 s[88:89], 0
  s_waitcnt vmcnt(0)
  s_and_b64 exec, s[90:91], 1
  buffer_store_dword v4, v1, s[8:11], s81 offen sc1
  s_mov_b64 exec, -1
  s_mov_b64 s[90:91], 0
  s_min_u32 s66, s52, 63
  s_lshl_b32 s64, s51, 6
  s_add_u32 s66, s66, s64
  s_lshl_b32 s66, s66, 9
  s_add_u32 s66, s66, 131072
  s_min_u32 s65, s52, 63
  s_mul_i32 s65, s65, 1179648
  s_add_u32 s65, s65, s69
  s_cmp_lg_u32 s46, 0
  s_cbranch_scc1 w0_255
fl_256:
  buffer_load_dword v3, v2, s[8:11], s66 offen sc1
  s_waitcnt vmcnt(0)
  v_cmp_eq_u32 vcc, 0, v3
  s_nop 0
  s_cbranch_vccz fo_257
  s_sleep 4
  s_sub_u32 s47, s47, 1
  s_cbranch_scc0 fl_256
  s_branch ABORT
fo_257:
w0_255:
  s_barrier
  s_add_u32 m0, s82, 12288
  s_nop 0
  buffer_load_dwordx4 v1, s[8:11], s65 offen offset:0 sc1 lds
  buffer_load_dwordx4 v1, s[8:11], s65 offen offset:1024 sc1 lds
  buffer_load_dwordx4 v1, s[8:11], s65 offen offset:2048 sc1 lds
  s_waitcnt vmcnt(0)
  s_barrier
  ds_read_b128 v[68:71], v1 offset:12288
  ds_read_b128 v[72:75], v1 offset:13312
  ds_read_b128 v[76:79], v1 offset:14336
  ds_read_b128 v[80:83], v1 offset:15360
  ds_read_b128 v[84:87], v1 offset:16384
  ds_read_b128 v[88:91], v1 offset:17408
  ds_read_b128 v[92:95], v1 offset:18432
  ds_read_b128 v[96:99], v1 offset:19456
  ds_read_b128 v[100:103], v1 offset:20480
  ds_read_b128 v[104:107], v1 offset:21504
  ds_read_b128 v[108:111], v1 offset:22528
  ds_read_b128 v[112:115], v1 offset:23552
  s_waitcnt lgkmcnt(0)
go_249:
  v_mfma_f32_16x16x32_bf16 v[116:119], v[68:71], a[0:3], 0
  s_and_b32 s60, s52, 1
  s_lshl2_add_u32 s60, s51, s60
  s_mul_i32 s76, s60, 327680
  v_mfma_f32_16x16x32_bf16 v[120:123], v[72:75], a[0:3], 0
  s_add_u32 s76, s76, s68
  s_add_u32 m0, s82, 0
  s_nop 0
  buffer_load_dwordx4 v1, s[8:11], s36 offen offset:0 sc1 lds
  v_mfma_f32_16x16x32_bf16 v[116:119], v[76:79], a[4:7], v[116:119]
  s_lshl_b32 s78, s51, 15
  s_add_u32 s78, s78, 197120
  s_sub_i32 s79, s52, 2
  v_mfma_f32_16x16x32_bf16 v[120:123], v[80:83], a[4:7], v[120:123]
  buffer_load_dwordx4 v1, s[8:11], s36 offen offset:1024 sc1 lds
  v_mfma_f32_16x16x32_bf16 v[116:119], v[84:87], a[8:11], v[116:119]
  v_mfma_f32_16x16x32_bf16 v[120:123], v[88:91], a[8:11], v[120:123]
  buffer_load_dwordx4 v1, s[8:11], s36 offen offset:2048 sc1 lds
  v_mfma_f32_16x16x32_bf16 v[116:119], v[92:95], a[12:15], v[116:119]
  v_mfma_f32_16x16x32_bf16 v[120:123], v[96:99], a[12:15], v[120:123]
  buffer_load_dword v3, v2, s[8:11], s37 offen sc1
  v_mfma_f32_16x16x32_bf16 v[116:119], v[100:103], a[16:19], v[116:119]
  v_mfma_f32_16x16x32_bf16 v[120:123], v[104:107], a[16:19], v[120:123]
  s_lshl_b32 s33, s51, 15
  s_add_u32 s33, s33, s70
  s_add_u32 s50, s50, 1
  v_mfma_f32_16x16x32_bf16 v[116:119], v[108:111], a[20:23], v[116:119]
  s_mov_b32 s51, s53
  s_mov_b32 s52, s54
  s_mov_b32 s53, s55
  v_mfma_f32_16x16x32_bf16 v[120:123], v[112:115], a[20:23], v[120:123]
  s_mov_b32 s54, s56
  s_sub_u32 s63, s52, 3
  v_mfma_f32_16x16x32_bf16 v[124:127], v[68:71], a[24:27], 0
  s_cmp_lt_u32 s63, 64
  s_cselect_b32 s64, s73, 0
  v_mfma_f32_16x16x32_bf16 v[128:131], v[72:75], a[24:27], 0
  s_cmp_lg_u32 s64, 0
  s_cselect_b64 s[34:35], -1, 0
  s_and_b32 s63, s63, 63
  v_mfma_f32_16x16x32_bf16 v[124:127], v[76:79], a[28:31], v[124:127]
  s_bfe_u32 s31, s63, 0x10002
  v_cvt_pk_bf16_f32 v168, v116, v117
  v_cvt_pk_bf16_f32 v169, v120, v121
  v_mfma_f32_16x16x32_bf16 v[128:131], v[80:83], a[28:31], v[128:131]
  s_lshl_b32 s32, s51, 6
  v_cvt_pk_bf16_f32 v170, v118, v119
  v_cvt_pk_bf16_f32 v171, v122, v123
  v_mfma_f32_16x16x32_bf16 v[124:127], v[84:87], a[32:35], v[124:127]
  s_add_u32 s32, s32, s63
  s_and_b32 s63, s63, 3
  s_mul_i32 s63, s63, 327680
  v_mfma_f32_16x16x32_bf16 v[128:131], v[88:91], a[32:35], v[128:131]
  s_cmp_eq_u32 s51, 0
  s_cselect_b32 s64, s71, s72
  s_add_u32 s26, s63, s64
  v_mfma_f32_16x16x32_bf16 v[124:127], v[92:95], a[36:39], v[124:127]
  s_add_u32 s62, s50, 2
  s_min_u32 s62, s62, 133
  s_sub_i32 s60, s62, 13
  v_mfma_f32_16x16x32_bf16 v[128:131], v[96:99], a[36:39], v[128:131]
  s_sub_i32 s55, s62, 12
  s_ashr_i32 s60, s60, 1
  s_ashr_i32 s55, s55, 1
  v_mfma_f32_16x16x32_bf16 v[124:127], v[100:103], a[40:43], v[124:127]
  s_sub_i32 s61, s62, 67
  s_max_i32 s60, s60, s61
  s_add_i32 s61, s61, 1
  v_mfma_f32_16x16x32_bf16 v[128:131], v[104:107], a[40:43], v[128:131]
  s_max_i32 s55, s55, s61
  s_max_i32 s60, s60, 0
  s_max_i32 s55, s55, 0
  v_mfma_f32_16x16x32_bf16 v[124:127], v[108:111], a[44:47], v[124:127]
  s_sub_i32 s55, s55, s60
  s_sub_i32 s56, s62, s60
  s_sub_i32 s60, s60, s56
  v_mfma_f32_16x16x32_bf16 v[128:131], v[112:115], a[44:47], v[128:131]
  s_mul_i32 s60, s60, s55
  s_add_i32 s56, s56, s60
  s_min_u32 s37, s56, 63
  v_mfma_f32_16x16x32_bf16 v[116:119], v[68:71], a[48:51], 0
  s_lshl_b32 s64, s55, 6
  s_add_u32 s37, s37, s64
  s_lshl_b32 s37, s37, 9
  v_mfma_f32_16x16x32_bf16 v[120:123], v[72:75], a[48:51], 0
  s_add_u32 s37, s37, 131072
  s_min_u32 s36, s54, 63
  s_mul_i32 s36, s36, 1179648
  v_mfma_f32_16x16x32_bf16 v[116:119], v[76:79], a[52:55], v[116:119]
  s_add_u32 s36, s36, s69
  v_cvt_pk_bf16_f32 v172, v124, v125
  v_cvt_pk_bf16_f32 v173, v128, v129
  v_mfma_f32_16x16x32_bf16 v[120:123], v[80:83], a[52:55], v[120:123]
  s_add_u32 s27, s26, 81920
  v_cvt_pk_bf16_f32 v174, v126, v127
  v_cvt_pk_bf16_f32 v175, v130, v131
  v_mfma_f32_16x16x32_bf16 v[116:119], v[84:87], a[56:59], v[116:119]
  s_add_u32 s28, s26, 163840
  s_add_u32 s29, s26, 245760
  s_mul_i32 s30, s32, 46080
  v_mfma_f32_16x16x32_bf16 v[120:123], v[88:91], a[56:59], v[120:123]
  s_add_u32 s30, s30, s59
  s_add_u32 s30, s30, 10485760
  v_mfma_f32_16x16x32_bf16 v[116:119], v[92:95], a[60:63], v[116:119]
  v_mfma_f32_16x16x32_bf16 v[120:123], v[96:99], a[60:63], v[120:123]
  v_mfma_f32_16x16x32_bf16 v[116:119], v[100:103], a[64:67], v[116:119]
  v_mfma_f32_16x16x32_bf16 v[120:123], v[104:107], a[64:67], v[120:123]
  v_mfma_f32_16x16x32_bf16 v[116:119], v[108:111], a[68:71], v[116:119]
  v_mfma_f32_16x16x32_bf16 v[120:123], v[112:115], a[68:71], v[120:123]
  v_mfma_f32_16x16x32_bf16 v[124:127], v[68:71], a[72:75], 0
  v_mfma_f32_16x16x32_bf16 v[128:131], v[72:75], a[72:75], 0
  v_mfma_f32_16x16x32_bf16 v[124:127], v[76:79], a[76:79], v[124:127]
  s_nop 3
  v_cvt_pk_bf16_f32 v176, v116, v117
  v_cvt_pk_bf16_f32 v177, v120, v121
  v_mfma_f32_16x16x32_bf16 v[128:131], v[80:83], a[76:79], v[128:131]
  v_cvt_pk_bf16_f32 v178, v118, v119
  v_cvt_pk_bf16_f32 v179, v122, v123
  v_mfma_f32_16x16x32_bf16 v[124:127], v[84:87], a[80:83], v[124:127]
  v_mfma_f32_16x16x32_bf16 v[128:131], v[88:91], a[80:83], v[128:131]
  v_mfma_f32_16x16x32_bf16 v[124:127], v[92:95], a[84:87], v[124:127]
  v_mfma_f32_16x16x32_bf16 v[128:131], v[96:99], a[84:87], v[128:131]
  v_mfma_f32_16x16x32_bf16 v[124:127], v[100:103], a[88:91], v[124:127]
  v_mfma_f32_16x16x32_bf16 v[128:131], v[104:107], a[88:91], v[128:131]
  v_mfma_f32_16x16x32_bf16 v[124:127], v[108:111], a[92:95], v[124:127]
  buffer_load_dword v10, v9, s[8:11], s78 offen sc1
  v_mfma_f32_16x16x32_bf16 v[128:131], v[112:115], a[92:95], v[128:131]
  v_mfma_f32_16x16x32_bf16 v[116:119], v[68:71], a[96:99], 0
  v_mfma_f32_16x16x32_bf16 v[120:123], v[72:75], a[96:99], 0
  v_mfma_f32_16x16x32_bf16 v[116:119], v[76:79], a[100:103], v[116:119]
  s_nop 2
  v_cvt_pk_bf16_f32 v180, v124, v125
  s_nop 0
  v_cvt_pk_bf16_f32 v181, v128, v129
  v_mfma_f32_16x16x32_bf16 v[120:123], v[80:83], a[100:103], v[120:123]
  v_cvt_pk_bf16_f32 v182, v126, v127
  v_cvt_pk_bf16_f32 v183, v130, v131
  v_mfma_f32_16x16x32_bf16 v[116:119], v[84:87], a[104:107], v[116:119]
  v_mfma_f32_16x16x32_bf16 v[120:123], v[88:91], a[104:107], v[120:123]
  v_mfma_f32_16x16x32_bf16 v[116:119], v[92:95], a[108:111], v[116:119]
  v_mfma_f32_16x16x32_bf16 v[120:123], v[96:99], a[108:111], v[120:123]
  v_mfma_f32_16x16x32_bf16 v[116:119], v[100:103], a[112:115], v[116:119]
  v_mfma_f32_16x16x32_bf16 v[120:123], v[104:107], a[112:115], v[120:123]
  v_mfma_f32_16x16x32_bf16 v[116:119], v[108:111], a[116:119], v[116:119]
  v_mfma_f32_16x16x32_bf16 v[120:123], v[112:115], a[116:119], v[120:123]
  v_mfma_f32_16x16x32_bf16 v[124:127], v[68:71], a[120:123], 0
  v_mfma_f32_16x16x32_bf16 v[128:131], v[72:75], a[120:123], 0
  v_mfma_f32_16x16x32_bf16 v[124:127], v[76:79], a[124:127], v[124:127]
  s_nop 3
  v_cvt_pk_bf16_f32 v184, v116, v117
  v_cvt_pk_bf16_f32 v185, v120, v121
  v_mfma_f32_16x16x32_bf16 v[128:131], v[80:83], a[124:127], v[128:131]
  v_cvt_pk_bf16_f32 v186, v118, v119
  v_cvt_pk_bf16_f32 v187, v122, v123
  v_mfma_f32_16x16x32_bf16 v[124:127], v[84:87], a[128:131], v[124:127]
  s_waitcnt vmcnt(0)
  v_mov_b32 v18, s77
  s_and_b64 exec, s[86:87], 1
  s_cmp_lg_u32 s49, 0
  s_cbranch_scc1 wt_258
  buffer_store_dword v18, v1, s[8:11], s23 offen
wb_259:
  s_mov_b64 exec, -1
  s_mov_b64 s[86:87], 0
  v_mfma_f32_16x16x32_bf16 v[128:131], v[88:91], a[128:131], v[128:131]
  v_min_u32_dpp v3, v3, v3 quad_perm:[1,0,3,2] row_mask:0xf bank_mask:0xf
  v_lshl_add_u32 v16, s46, 2, v8
  v_mfma_f32_16x16x32_bf16 v[124:127], v[92:95], a[132:135], v[124:127]
  ds_write_b32 v16, v3 offset:16
  v_cmp_ge_i32 vcc, s79, v10
  v_mfma_f32_16x16x32_bf16 v[128:131], v[96:99], a[132:135], v[128:131]
  v_mfma_f32_16x16x32_bf16 v[124:127], v[100:103], a[136:139], v[124:127]
  v_mfma_f32_16x16x32_bf16 v[128:131], v[104:107], a[136:139], v[128:131]
  v_mfma_f32_16x16x32_bf16 v[124:127], v[108:111], a[140:143], v[124:127]
  v_mfma_f32_16x16x32_bf16 v[128:131], v[112:115], a[140:143], v[128:131]
  s_cbranch_vccnz sl_251
bk_252:
  s_mov_b64 s[16:17], s[26:27]
  s_mov_b64 s[18:19], s[28:29]
  v_mfma_f32_16x16x32_bf16 v[116:119], v[68:71], a[144:147], 0
  s_mov_b64 s[20:21], s[30:31]
  s_cmp_lg_u32 s49, 0
  s_cbranch_scc1 wt_260
  buffer_store_dwordx4 v[168:171], v1, s[8:11], s76 offen
wb_261:
  v_mfma_f32_16x16x32_bf16 v[120:123], v[72:75], a[144:147], 0
  s_mov_b64 s[22:23], s[32:33]
  s_mov_b64 s[24:25], s[34:35]
  v_mfma_f32_16x16x32_bf16 v[116:119], v[76:79], a[148:151], v[116:119]
  v_cvt_pk_bf16_f32 v188, v124, v125
  v_cvt_pk_bf16_f32 v189, v128, v129
  v_mfma_f32_16x16x32_bf16 v[120:123], v[80:83], a[148:151], v[120:123]
  v_cvt_pk_bf16_f32 v190, v126, v127
  v_cvt_pk_bf16_f32 v191, v130, v131
  v_mfma_f32_16x16x32_bf16 v[116:119], v[84:87], a[152:155], v[116:119]
  v_mfma_f32_16x16x32_bf16 v[120:123], v[88:91], a[152:155], v[120:123]
  s_add_u32 s76, s76, 8192
  s_cmp_lg_u32 s49, 0
  s_cbranch_scc1 wt_262
  buffer_store_dwordx4 v[172:175], v1, s[8:11], s76 offen
wb_263:
  v_mfma_f32_16x16x32_bf16 v[116:119], v[92:95], a[156:159], v[116:119]
  v_mfma_f32_16x16x32_bf16 v[120:123], v[96:99], a[156:159], v[120:123]
  v_mfma_f32_16x16x32_bf16 v[116:119], v[100:103], a[160:163], v[116:119]
  v_mfma_f32_16x16x32_bf16 v[120:123], v[104:107], a[160:163], v[120:123]
  v_mfma_f32_16x16x32_bf16 v[116:119], v[108:111], a[164:167], v[116:119]
  s_add_u32 s76, s76, 8192
  s_cmp_lg_u32 s49, 0
  s_cbranch_scc1 wt_264
  buffer_store_dwordx4 v[176:179], v1, s[8:11], s76 offen
wb_265:
  v_mfma_f32_16x16x32_bf16 v[120:123], v[112:115], a[164:167], v[120:123]
  v_mfma_f32_16x16x32_bf16 v[124:127], v[68:71], a[168:171], 0
  v_mfma_f32_16x16x32_bf16 v[128:131], v[72:75], a[168:171], 0
  v_mfma_f32_16x16x32_bf16 v[124:127], v[76:79], a[172:175], v[124:127]
  v_cvt_pk_bf16_f32 v192, v116, v117
  s_nop 3
  v_cvt_pk_bf16_f32 v193, v120, v121
  v_mfma_f32_16x16x32_bf16 v[128:131], v[80:83], a[172:175], v[128:131]
  s_add_u32 s76, s76, 8192
  s_cmp_lg_u32 s49, 0
  s_cbranch_scc1 wt_266
  buffer_store_dwordx4 v[180:183], v1, s[8:11], s76 offen
wb_267:
  v_mfma_f32_16x16x32_bf16 v[124:127], v[84:87], a[176:179], v[124:127]
  v_cvt_pk_bf16_f32 v194, v118, v119
  v_cvt_pk_bf16_f32 v195, v122, v123
  v_mfma_f32_16x16x32_bf16 v[128:131], v[88:91], a[176:179], v[128:131]
  v_mfma_f32_16x16x32_bf16 v[124:127], v[92:95], a[180:183], v[124:127]
  v_mfma_f32_16x16x32_bf16 v[128:131], v[96:99], a[180:183], v[128:131]
  v_mfma_f32_16x16x32_bf16 v[124:127], v[100:103], a[184:187], v[124:127]
  s_waitcnt lgkmcnt(0)
  s_barrier
  ds_read_b32 v17, v8 offset:16
  s_add_u32 s76, s76, 8192
  s_cmp_lg_u32 s49, 0
  s_cbranch_scc1 wt_268
  buffer_store_dwordx4 v[184:187], v1, s[8:11], s76 offen
wb_269:
  v_mfma_f32_16x16x32_bf16 v[128:131], v[104:107], a[184:187], v[128:131]
  ds_read_b128 v[20:23], v1 offset:0
  v_mfma_f32_16x16x32_bf16 v[124:127], v[108:111], a[188:191], v[124:127]
  v_mfma_f32_16x16x32_bf16 v[128:131], v[112:115], a[188:191], v[128:131]
  ds_read_b128 v[24:27], v1 offset:1024
  v_mfma_f32_16x16x32_bf16 v[116:119], v[68:71], a[192:195], 0
  v_mfma_f32_16x16x32_bf16 v[120:123], v[72:75], a[192:195], 0
  s_add_u32 s76, s76, 8192
  s_cmp_lg_u32 s49, 0
  s_cbranch_scc1 wt_270
  buffer_store_dwordx4 v[188:191], v1, s[8:11], s76 offen
wb_271:
  ds_read_b128 v[28:31], v1 offset:2048
  v_mfma_f32_16x16x32_bf16 v[116:119], v[76:79], a[196:199], v[116:119]
  v_cvt_pk_bf16_f32 v196, v124, v125
  v_cvt_pk_bf16_f32 v197, v128, v129
  v_mfma_f32_16x16x32_bf16 v[120:123], v[80:83], a[196:199], v[120:123]
  ds_read_b128 v[32:35], v1 offset:3072
  v_cvt_pk_bf16_f32 v198, v126, v127
  v_mfma_f32_16x16x32_bf16 v[116:119], v[84:87], a[200:203], v[116:119]
  v_cvt_pk_bf16_f32 v199, v130, v131
  v_mfma_f32_16x16x32_bf16 v[120:123], v[88:91], a[200:203], v[120:123]
  ds_read_b128 v[36:39], v1 offset:4096
  v_mfma_f32_16x16x32_bf16 v[116:119], v[92:95], a[204:207], v[116:119]
  s_add_u32 s76, s76, 8192
  s_cmp_lg_u32 s49, 0
  s_cbranch_scc1 wt_272
  buffer_store_dwordx4 v[192:195], v1, s[8:11], s76 offen
wb_273:
  v_mfma_f32_16x16x32_bf16 v[120:123], v[96:99], a[204:207], v[120:123]
  ds_read_b128 v[40:43], v1 offset:5120
  v_mfma_f32_16x16x32_bf16 v[116:119], v[100:103], a[208:211], v[116:119]
  v_mfma_f32_16x16x32_bf16 v[120:123], v[104:107], a[208:211], v[120:123]
  ds_read_b128 v[44:47], v1 offset:6144
  v_mfma_f32_16x16x32_bf16 v[116:119], v[108:111], a[212:215], v[116:119]
  v_mfma_f32_16x16x32_bf16 v[120:123], v[112:115], a[212:215], v[120:123]
  s_add_u32 s76, s76, 8192
  s_cmp_lg_u32 s49, 0
  s_cbranch_scc1 wt_274
  buffer_store_dwordx4 v[196:199], v1, s[8:11], s76 offen
wb_275:
  ds_read_b128 v[48:51], v1 offset:7168
  v_mfma_f32_16x16x32_bf16 v[124:127], v[68:71], a[216:219], 0
  v_mfma_f32_16x16x32_bf16 v[128:131], v[72:75], a[216:219], 0
  ds_read_b128 v[52:55], v1 offset:8192
  v_mfma_f32_16x16x32_bf16 v[124:127], v[76:79], a[220:223], v[124:127]
  v_cvt_pk_bf16_f32 v200, v116, v117
  v_cvt_pk_bf16_f32 v201, v120, v121
  v_mfma_f32_16x16x32_bf16 v[128:131], v[80:83], a[220:223], v[128:131]
  ds_read_b128 v[56:59], v1 offset:9216
  v_cvt_pk_bf16_f32 v202, v118, v119
  v_mfma_f32_16x16x32_bf16 v[124:127], v[84:87], a[224:227], v[124:127]
  v_cvt_pk_bf16_f32 v203, v122, v123
  v_mfma_f32_16x16x32_bf16 v[128:131], v[88:91], a[224:227], v[128:131]
  ds_read_b128 v[60:63], v1 offset:10240
  v_mfma_f32_16x16x32_bf16 v[124:127], v[92:95], a[228:231], v[124:127]
  s_add_u32 s76, s76, 8192
  s_cmp_lg_u32 s49, 0
  s_cbranch_scc1 wt_276
  buffer_store_dwordx4 v[200:203], v1, s[8:11], s76 offen
wb_277:
  v_mfma_f32_16x16x32_bf16 v[128:131], v[96:99], a[228:231], v[128:131]
  ds_read_b128 v[64:67], v1 offset:11264
  v_mfma_f32_16x16x32_bf16 v[124:127], v[100:103], a[232:235], v[124:127]
  v_mfma_f32_16x16x32_bf16 v[128:131], v[104:107], a[232:235], v[128:131]
  v_mfma_f32_16x16x32_bf16 v[124:127], v[108:111], a[236:239], v[124:127]
  v_mfma_f32_16x16x32_bf16 v[128:131], v[112:115], a[236:239], v[128:131]
  s_mov_b64 s[86:87], -1
  s_add_u32 s77, s79, 3
  s_waitcnt lgkmcnt(0)
  v_readfirstlane_b32 s75, v17
  s_nop 2
  v_cvt_pk_bf16_f32 v204, v124, v125
  v_cvt_pk_bf16_f32 v205, v128, v129
  v_cvt_pk_bf16_f32 v206, v126, v127
  v_cvt_pk_bf16_f32 v207, v130, v131
  s_add_u32 s76, s76, 8192
  s_cmp_lg_u32 s49, 0
  s_cbranch_scc1 wt_278
  buffer_store_dwordx4 v[204:207], v1, s[8:11], s76 offen
wb_279:
  s_nop 0
  s_branch PO_FN0
sl_251:
cg_280:
  buffer_load_dword v10, v9, s[8:11], s78 offen sc1
  s_waitcnt vmcnt(0)
  v_cmp_ge_i32 vcc, s79, v10
  s_nop 0
  s_cbranch_vccz bk_252
  s_sleep 1
  s_sub_u32 s47, s47, 1
  s_cbranch_scc0 cg_280
  s_branch ABORT
vi_250:
  s_waitcnt vmcnt(0)
  v_mov_b32 v18, s77
  s_and_b64 exec, s[86:87], 1
  s_cmp_lg_u32 s49, 0
  s_cbranch_scc1 wt_281
  buffer_store_dword v18, v1, s[8:11], s23 offen
wb_282:
  s_mov_b64 exec, -1
  s_mov_b64 s[86:87], 0
  s_and_b64 exec, s[90:91], 1
  buffer_store_dword v4, v1, s[8:11], s81 offen sc1
  s_mov_b64 exec, -1
  s_mov_b64 s[90:91], 0
  s_mov_b64 exec, s[88:89]
  buffer_store_dwordx2 v[164:165], v5, s[8:11], s38 offen sc1
  s_and_b64 exec, s[88:89], 0x5555
  buffer_store_dwordx2 v[166:167], v6, s[8:11], s39 offen sc1
  s_mov_b64 exec, -1
  s_mov_b32 s81, s80
  s_mov_b64 s[90:91], s[88:89]
  s_mov_b64 s[88:89], 0
  s_waitcnt vmcnt(0)
  s_and_b64 exec, s[90:91], 1
  buffer_store_dword v4, v1, s[8:11], s81 offen sc1
  s_mov_b64 exec, -1
  s_mov_b64 s[90:91], 0
  s_cmp_eq_u32 s50, 133
  s_cbranch_scc1 PO_END
  s_lshl_b32 s33, s51, 15
  s_add_u32 s33, s33, s70
  s_add_u32 s50, s50, 1
  s_mov_b32 s51, s53
  s_mov_b32 s52, s54
  s_mov_b32 s53, s55
  s_mov_b32 s54, s56
  s_sub_u32 s63, s52, 3
  s_cmp_lt_u32 s63, 64
  s_cselect_b32 s64, s73, 0
  s_cmp_lg_u32 s64, 0
  s_cselect_b64 s[34:35], -1, 0
  s_and_b32 s63, s63, 63
  s_bfe_u32 s31, s63, 0x10002
  s_lshl_b32 s32, s51, 6
  s_add_u32 s32, s32, s63
  s_and_b32 s63, s63, 3
  s_mul_i32 s63, s63, 327680
  s_cmp_eq_u32 s51, 0
  s_cselect_b32 s64, s71, s72
  s_add_u32 s26, s63, s64
  s_add_u32 s62, s50, 2
  s_min_u32 s62, s62, 133
  s_sub_i32 s60, s62, 13
  s_sub_i32 s55, s62, 12
  s_ashr_i32 s60, s60, 1
  s_ashr_i32 s55, s55, 1
  s_sub_i32 s61, s62, 67
  s_max_i32 s60, s60, s61
  s_add_i32 s61, s61, 1
  s_max_i32 s55, s55, s61
  s_max_i32 s60, s60, 0
  s_max_i32 s55, s55, 0
  s_sub_i32 s55, s55, s60
  s_sub_i32 s56, s62, s60
  s_sub_i32 s60, s60, s56
  s_mul_i32 s60, s60, s55
  s_add_i32 s56, s56, s60
  s_min_u32 s37, s56, 63
  s_lshl_b32 s64, s55, 6
  s_add_u32 s37, s37, s64
  s_lshl_b32 s37, s37, 9
  s_add_u32 s37, s37, 131072
  s_min_u32 s36, s54, 63
  s_mul_i32 s36, s36, 1179648
  s_add_u32 s36, s36, s69
  s_add_u32 s27, s26, 81920
  s_add_u32 s28, s26, 163840
  s_add_u32 s29, s26, 245760
  s_mul_i32 s30, s32, 46080
  s_add_u32 s30, s30, s59
  s_add_u32 s30, s30, 10485760
  s_mov_b64 s[16:17], s[26:27]
  s_mov_b64 s[18:19], s[28:29]
  s_mov_b64 s[20:21], s[30:31]
  s_mov_b64 s[22:23], s[32:33]
  s_mov_b64 s[24:25], s[34:35]
  s_mov_b32 s74, 0
  s_mov_b32 s75, 0
  s_branch PO_FN1
PO_FR0:
  s_cmp_ge_u32 s52, 64
  s_cbranch_scc1 vi_284
  s_cmp_lg_u32 s74, 0
  s_mov_b32 s74, s75
  s_cbranch_scc1 go_283
  s_waitcnt vmcnt(0)
  v_mov_b32 v18, s77
  s_and_b64 exec, s[86:87], 1
  s_cmp_lg_u32 s49, 0
  s_cbranch_scc1 wt_287
  buffer_store_dword v18, v1, s[8:11], s23 offen
wb_288:
  s_mov_b64 exec, -1
  s_mov_b64 s[86:87], 0
  s_and_b64 exec, s[90:91], 1
  buffer_store_dword v4, v1, s[8:11], s81 offen sc1
  s_mov_b64 exec, -1
  s_mov_b64 s[90:91], 0
  s_mov_b64 exec, s[88:89]
  buffer_store_dwordx2 v[164:165], v5, s[8:11], s38 offen sc1
  s_and_b64 exec, s[88:89], 0x5555
  buffer_store_dwordx2 v[166:167], v6, s[8:11], s39 offen sc1
  s_mov_b64 exec, -1
  s_mov_b32 s81, s80
  s_mov_b64 s[90:91], s[88:89]
  s_mov_b64 s[88:89], 0
  s_waitcnt vmcnt(0)
  s_and_b64 exec, s[90:91], 1
  buffer_store_dword v4, v1, s[8:11], s81 offen sc1
  s_mov_b64 exec, -1
  s_mov_b64 s[90:91], 0
  s_min_u32 s66, s52, 63
  s_lshl_b32 s64, s51, 6
  s_add_u32 s66, s66, s64
  s_lshl_b32 s66, s66, 9
  s_add_u32 s66, s66, 131072
  s_min_u32 s65, s52, 63
  s_mul_i32 s65, s65, 1179648
  s_add_u32 s65, s65, s69
  s_cmp_lg_u32 s46, 0
  s_cbranch_scc1 w0_289
fl_290:
  buffer_load_dword v3, v2, s[8:11], s66 offen sc1
  s_waitcnt vmcnt(0)
  v_cmp_eq_u32 vcc, 0, v3
  s_nop 0
  s_cbranch_vccz fo_291
  s_sleep 4
  s_sub_u32 s47, s47, 1
  s_cbranch_scc0 fl_290
  s_branch ABORT
fo_291:
w0_289:
  s_barrier
  s_add_u32 m0, s82, 0
  s_nop 0
  buffer_load_dwordx4 v1, s[8:11], s65 offen offset:0 sc1 lds
  buffer_load_dwordx4 v1, s[8:11], s65 offen offset:1024 sc1 lds
  buffer_load_dwordx4 v1, s[8:11], s65 offen offset:2048 sc1 lds
  s_waitcnt vmcnt(0)
  s_barrier
  ds_read_b128 v[20:23], v1 offset:0
  ds_read_b128 v[24:27], v1 offset:1024
  ds_read_b128 v[28:31], v1 offset:2048
  ds_read_b128 v[32:35], v1 offset:3072
  ds_read_b128 v[36:39], v1 offset:4096
  ds_read_b128 v[40:43], v1 offset:5120
  ds_read_b128 v[44:47], v1 offset:6144
  ds_read_b128 v[48:51], v1 offset:7168
  ds_read_b128 v[52:55], v1 offset:8192
  ds_read_b128 v[56:59], v1 offset:9216
  ds_read_b128 v[60:63], v1 offset:10240
  ds_read_b128 v[64:67], v1 offset:11264
  s_waitcnt lgkmcnt(0)
go_283:
  v_mfma_f32_16x16x32_bf16 v[116:119], v[20:23], a[0:3], 0
  s_and_b32 s60, s52, 1
  s_lshl2_add_u32 s60, s51, s60
  s_mul_i32 s76, s60, 327680
  v_mfma_f32_16x16x32_bf16 v[120:123], v[24:27], a[0:3], 0
  s_add_u32 s76, s76, s68
  s_add_u32 m0, s82, 12288
  s_nop 0
  buffer_load_dwordx4 v1, s[8:11], s36 offen offset:0 sc1 lds
  v_mfma_f32_16x16x32_bf16 v[116:119], v[28:31], a[4:7], v[116:119]
  s_lshl_b32 s78, s51, 15
  s_add_u32 s78, s78, 197120
  s_sub_i32 s79, s52, 2
  v_mfma_f32_16x16x32_bf16 v[120:123], v[32:35], a[4:7], v[120:123]
  s_and_b64 exec, s[90:91], 1
  buffer_store_dword v4, v1, s[8:11], s81 offen sc1
  s_mov_b64 exec, -1
  s_mov_b64 s[90:91], 0
  v_mfma_f32_16x16x32_bf16 v[116:119], v[36:39], a[8:11], v[116:119]
  v_mfma_f32_16x16x32_bf16 v[120:123], v[40:43], a[8:11], v[120:123]
  s_mov_b64 exec, s[88:89]
  buffer_store_dwordx2 v[164:165], v5, s[8:11], s38 offen sc1
  s_and_b64 exec, s[88:89], 0x5555
  buffer_store_dwordx2 v[166:167], v6, s[8:11], s39 offen sc1
  s_mov_b64 exec, -1
  s_mov_b32 s81, s80
  s_mov_b64 s[90:91], s[88:89]
  s_mov_b64 s[88:89], 0
  v_mfma_f32_16x16x32_bf16 v[116:119], v[44:47], a[12:15], v[116:119]
  v_mfma_f32_16x16x32_bf16 v[120:123], v[48:51], a[12:15], v[120:123]
  buffer_load_dwordx4 v1, s[8:11], s36 offen offset:1024 sc1 lds
  v_mfma_f32_16x16x32_bf16 v[116:119], v[52:55], a[16:19], v[116:119]
  v_mfma_f32_16x16x32_bf16 v[120:123], v[56:59], a[16:19], v[120:123]
  buffer_load_dwordx4 v1, s[8:11], s36 offen offset:2048 sc1 lds
  v_mfma_f32_16x16x32_bf16 v[116:119], v[60:63], a[20:23], v[116:119]
  v_mfma_f32_16x16x32_bf16 v[120:123], v[64:67], a[20:23], v[120:123]
  buffer_load_dwordx2 v[140:141], v5, s[8:11], s20 offen sc1
  v_mfma_f32_16x16x32_bf16 v[124:127], v[20:23], a[24:27], 0
  v_mfma_f32_16x16x32_bf16 v[128:131], v[24:27], a[24:27], 0
  buffer_load_dwordx2 v[132:133], v5, s[8:11], s16 offen sc1
  v_mfma_f32_16x16x32_bf16 v[124:127], v[28:31], a[28:31], v[124:127]
  s_nop 1
  v_cvt_pk_bf16_f32 v168, v116, v117
  v_cvt_pk_bf16_f32 v169, v120, v121
  v_mfma_f32_16x16x32_bf16 v[128:131], v[32:35], a[28:31], v[128:131]
  buffer_load_dwordx2 v[134:135], v5, s[8:11], s17 offen sc1
  v_cvt_pk_bf16_f32 v170, v118, v119
  v_mfma_f32_16x16x32_bf16 v[124:127], v[36:39], a[32:35], v[124:127]
  v_cvt_pk_bf16_f32 v171, v122, v123
  v_mfma_f32_16x16x32_bf16 v[128:131], v[40:43], a[32:35], v[128:131]
  buffer_load_dwordx2 v[136:137], v5, s[8:11], s18 offen sc1
  v_mfma_f32_16x16x32_bf16 v[124:127], v[44:47], a[36:39], v[124:127]
  v_mfma_f32_16x16x32_bf16 v[128:131], v[48:51], a[36:39], v[128:131]
  buffer_load_dwordx2 v[138:139], v5, s[8:11], s19 offen sc1
  v_mfma_f32_16x16x32_bf16 v[124:127], v[52:55], a[40:43], v[124:127]
  v_mfma_f32_16x16x32_bf16 v[128:131], v[56:59], a[40:43], v[128:131]
  s_mov_b64 s[88:89], s[24:25]
  s_add_u32 s38, s20, 5898240
  s_lshl_b32 s39, s58, 6
  v_mfma_f32_16x16x32_bf16 v[124:127], v[60:63], a[44:47], v[124:127]
  s_sub_u32 s39, s39, s59
  s_add_u32 s39, s39, s38
  s_add_u32 s39, s39, 40960
  v_mfma_f32_16x16x32_bf16 v[128:131], v[64:67], a[44:47], v[128:131]
  s_lshl_b32 s80, s22, 9
  s_lshl2_add_u32 s80, s58, s80
  s_add_u32 s80, s80, 262144
  v_mfma_f32_16x16x32_bf16 v[116:119], v[20:23], a[48:51], 0
  s_lshl_b32 s33, s51, 15
  s_add_u32 s33, s33, s70
  s_add_u32 s50, s50, 1
  v_mfma_f32_16x16x32_bf16 v[120:123], v[24:27], a[48:51], 0
  s_mov_b32 s51, s53
  s_mov_b32 s52, s54
  s_mov_b32 s53, s55
  v_mfma_f32_16x16x32_bf16 v[116:119], v[28:31], a[52:55], v[116:119]
  s_mov_b32 s54, s56
  v_cvt_pk_bf16_f32 v172, v124, v125
  v_cvt_pk_bf16_f32 v173, v128, v129
  v_mfma_f32_16x16x32_bf16 v[120:123], v[32:35], a[52:55], v[120:123]
  s_sub_u32 s63, s52, 3
  v_cvt_pk_bf16_f32 v174, v126, v127
  v_cvt_pk_bf16_f32 v175, v130, v131
  v_mfma_f32_16x16x32_bf16 v[116:119], v[36:39], a[56:59], v[116:119]
  s_cmp_lt_u32 s63, 64
  s_cselect_b32 s64, s73, 0
  v_mfma_f32_16x16x32_bf16 v[120:123], v[40:43], a[56:59], v[120:123]
  s_cmp_lg_u32 s64, 0
  s_cselect_b64 s[34:35], -1, 0
  s_and_b32 s63, s63, 63
  v_mfma_f32_16x16x32_bf16 v[116:119], v[44:47], a[60:63], v[116:119]
  s_bfe_u32 s31, s63, 0x10002
  s_lshl_b32 s32, s51, 6
  s_add_u32 s32, s32, s63
  v_mfma_f32_16x16x32_bf16 v[120:123], v[48:51], a[60:63], v[120:123]
  s_and_b32 s63, s63, 3
  s_mul_i32 s63, s63, 327680
  v_mfma_f32_16x16x32_bf16 v[116:119], v[52:55], a[64:67], v[116:119]
  s_cmp_eq_u32 s51, 0
  s_cselect_b32 s64, s71, s72
  s_add_u32 s26, s63, s64
  v_mfma_f32_16x16x32_bf16 v[120:123], v[56:59], a[64:67], v[120:123]
  s_add_u32 s62, s50, 2
  s_min_u32 s62, s62, 133
  s_sub_i32 s60, s62, 13
  v_mfma_f32_16x16x32_bf16 v[116:119], v[60:63], a[68:71], v[116:119]
  s_sub_i32 s55, s62, 12
  s_ashr_i32 s60, s60, 1
  s_ashr_i32 s55, s55, 1
  v_mfma_f32_16x16x32_bf16 v[120:123], v[64:67], a[68:71], v[120:123]
  s_sub_i32 s61, s62, 67
  s_max_i32 s60, s60, s61
  s_add_i32 s61, s61, 1
  v_mfma_f32_16x16x32_bf16 v[124:127], v[20:23], a[72:75], 0
  s_max_i32 s55, s55, s61
  s_max_i32 s60, s60, 0
  s_max_i32 s55, s55, 0
  v_mfma_f32_16x16x32_bf16 v[128:131], v[24:27], a[72:75], 0
  s_sub_i32 s55, s55, s60
  s_sub_i32 s56, s62, s60
  s_sub_i32 s60, s60, s56
  v_mfma_f32_16x16x32_bf16 v[124:127], v[28:31], a[76:79], v[124:127]
  s_mul_i32 s60, s60, s55
  v_cvt_pk_bf16_f32 v176, v116, v117
  v_cvt_pk_bf16_f32 v177, v120, v121
  v_mfma_f32_16x16x32_bf16 v[128:131], v[32:35], a[76:79], v[128:131]
  s_add_i32 s56, s56, s60
  v_cvt_pk_bf16_f32 v178, v118, v119
  v_cvt_pk_bf16_f32 v179, v122, v123
  v_mfma_f32_16x16x32_bf16 v[124:127], v[36:39], a[80:83], v[124:127]
  s_min_u32 s37, s56, 63
  s_lshl_b32 s64, s55, 6
  s_add_u32 s37, s37, s64
  v_mfma_f32_16x16x32_bf16 v[128:131], v[40:43], a[80:83], v[128:131]
  s_lshl_b32 s37, s37, 9
  s_add_u32 s37, s37, 131072
  s_min_u32 s36, s54, 63
  v_mfma_f32_16x16x32_bf16 v[124:127], v[44:47], a[84:87], v[124:127]
  s_mul_i32 s36, s36, 1179648
  s_add_u32 s36, s36, s69
  s_add_u32 s27, s26, 81920
  v_mfma_f32_16x16x32_bf16 v[128:131], v[48:51], a[84:87], v[128:131]
  s_add_u32 s28, s26, 163840
  s_add_u32 s29, s26, 245760
  s_mul_i32 s30, s32, 46080
  v_mfma_f32_16x16x32_bf16 v[124:127], v[52:55], a[88:91], v[124:127]
  s_add_u32 s30, s30, s59
  s_add_u32 s30, s30, 10485760
  v_mfma_f32_16x16x32_bf16 v[128:131], v[56:59], a[88:91], v[128:131]
  v_mfma_f32_16x16x32_bf16 v[124:127], v[60:63], a[92:95], v[124:127]
  buffer_load_dword v10, v9, s[8:11], s78 offen sc1
  v_mfma_f32_16x16x32_bf16 v[128:131], v[64:67], a[92:95], v[128:131]
  v_mfma_f32_16x16x32_bf16 v[116:119], v[20:23], a[96:99], 0
  v_mfma_f32_16x16x32_bf16 v[120:123], v[24:27], a[96:99], 0
  v_mfma_f32_16x16x32_bf16 v[116:119], v[28:31], a[100:103], v[116:119]
  s_nop 2
  v_cvt_pk_bf16_f32 v180, v124, v125
  s_nop 0
  v_cvt_pk_bf16_f32 v181, v128, v129
  v_mfma_f32_16x16x32_bf16 v[120:123], v[32:35], a[100:103], v[120:123]
  v_cvt_pk_bf16_f32 v182, v126, v127
  v_cvt_pk_bf16_f32 v183, v130, v131
  v_mfma_f32_16x16x32_bf16 v[116:119], v[36:39], a[104:107], v[116:119]
  v_mfma_f32_16x16x32_bf16 v[120:123], v[40:43], a[104:107], v[120:123]
  v_mfma_f32_16x16x32_bf16 v[116:119], v[44:47], a[108:111], v[116:119]
  v_mfma_f32_16x16x32_bf16 v[120:123], v[48:51], a[108:111], v[120:123]
  v_mfma_f32_16x16x32_bf16 v[116:119], v[52:55], a[112:115], v[116:119]
  v_mfma_f32_16x16x32_bf16 v[120:123], v[56:59], a[112:115], v[120:123]
  v_mfma_f32_16x16x32_bf16 v[116:119], v[60:63], a[116:119], v[116:119]
  v_mfma_f32_16x16x32_bf16 v[120:123], v[64:67], a[116:119], v[120:123]
  v_mfma_f32_16x16x32_bf16 v[124:127], v[20:23], a[120:123], 0
  v_mfma_f32_16x16x32_bf16 v[128:131], v[24:27], a[120:123], 0
  v_mfma_f32_16x16x32_bf16 v[124:127], v[28:31], a[124:127], v[124:127]
  s_nop 3
  v_cvt_pk_bf16_f32 v184, v116, v117
  v_cvt_pk_bf16_f32 v185, v120, v121
  v_mfma_f32_16x16x32_bf16 v[128:131], v[32:35], a[124:127], v[128:131]
  v_cvt_pk_bf16_f32 v186, v118, v119
  v_cvt_pk_bf16_f32 v187, v122, v123
  v_mfma_f32_16x16x32_bf16 v[124:127], v[36:39], a[128:131], v[124:127]
  s_waitcnt vmcnt(0)
  v_mov_b32 v18, s77
  s_and_b64 exec, s[86:87], 1
  s_cmp_lg_u32 s49, 0
  s_cbranch_scc1 wt_292
  buffer_store_dword v18, v1, s[8:11], s23 offen
wb_293:
  s_mov_b64 exec, -1
  s_mov_b64 s[86:87], 0
  v_mfma_f32_16x16x32_bf16 v[128:131], v[40:43], a[128:131], v[128:131]
  v_bitop3_b32 v12, v132, v134, s21 bitop3:0x7e
  v_bitop3_b32 v13, v136, v138, s21 bitop3:0x7e
  v_mfma_f32_16x16x32_bf16 v[124:127], v[44:47], a[132:135], v[124:127]
  v_bitop3_b32 v12, v12, v13, 1 bitop3:0xa8
  v_and_b32 v12, s24, v12
  v_mfma_f32_16x16x32_bf16 v[128:131], v[48:51], a[132:135], v[128:131]
  v_lshlrev_b32 v13, 31, v12
  v_or_b32 v13, v13, v10
  v_mfma_f32_16x16x32_bf16 v[124:127], v[52:55], a[136:139], v[124:127]
  v_cmp_ge_i32 vcc, s79, v13
  v_mfma_f32_16x16x32_bf16 v[128:131], v[56:59], a[136:139], v[128:131]
  v_mfma_f32_16x16x32_bf16 v[124:127], v[60:63], a[140:143], v[124:127]
  v_mfma_f32_16x16x32_bf16 v[128:131], v[64:67], a[140:143], v[128:131]
  s_cbranch_vccnz sl_285
bk_286:
  v_lshlrev_b32 v144, 16, v132
  v_and_b32 v145, 0xffff0000, v132
  v_mfma_f32_16x16x32_bf16 v[116:119], v[20:23], a[144:147], 0
  s_mov_b64 s[16:17], s[26:27]
  s_cmp_lg_u32 s49, 0
  s_cbranch_scc1 wt_294
  buffer_store_dwordx4 v[168:171], v1, s[8:11], s76 offen
wb_295:
  v_mfma_f32_16x16x32_bf16 v[120:123], v[24:27], a[144:147], 0
  s_mov_b64 s[18:19], s[28:29]
  v_lshlrev_b32 v146, 16, v133
  v_and_b32 v147, 0xffff0000, v133
  v_mfma_f32_16x16x32_bf16 v[116:119], v[28:31], a[148:151], v[116:119]
  s_mov_b64 s[20:21], s[30:31]
  v_cvt_pk_bf16_f32 v188, v124, v125
  v_cvt_pk_bf16_f32 v189, v128, v129
  v_mfma_f32_16x16x32_bf16 v[120:123], v[32:35], a[148:151], v[120:123]
  s_mov_b64 s[22:23], s[32:33]
  v_cvt_pk_bf16_f32 v190, v126, v127
  v_cvt_pk_bf16_f32 v191, v130, v131
  v_mfma_f32_16x16x32_bf16 v[116:119], v[36:39], a[152:155], v[116:119]
  s_mov_b64 s[24:25], s[34:35]
  v_lshlrev_b32 v148, 16, v134
  v_and_b32 v149, 0xffff0000, v134
  v_mfma_f32_16x16x32_bf16 v[120:123], v[40:43], a[152:155], v[120:123]
  s_add_u32 s76, s76, 8192
  s_cmp_lg_u32 s49, 0
  s_cbranch_scc1 wt_296
  buffer_store_dwordx4 v[172:175], v1, s[8:11], s76 offen
wb_297:
  v_mfma_f32_16x16x32_bf16 v[116:119], v[44:47], a[156:159], v[116:119]
  v_lshlrev_b32 v150, 16, v135
  v_and_b32 v151, 0xffff0000, v135
  v_mfma_f32_16x16x32_bf16 v[120:123], v[48:51], a[156:159], v[120:123]
  v_lshlrev_b32 v152, 16, v136
  v_and_b32 v153, 0xffff0000, v136
  v_mfma_f32_16x16x32_bf16 v[116:119], v[52:55], a[160:163], v[116:119]
  v_lshlrev_b32 v154, 16, v137
  v_and_b32 v155, 0xffff0000, v137
  v_mfma_f32_16x16x32_bf16 v[120:123], v[56:59], a[160:163], v[120:123]
  v_lshlrev_b32 v156, 16, v138
  v_and_b32 v157, 0xffff0000, v138
  v_mfma_f32_16x16x32_bf16 v[116:119], v[60:63], a[164:167], v[116:119]
  s_add_u32 s76, s76, 8192
  s_cmp_lg_u32 s49, 0
  s_cbranch_scc1 wt_298
  buffer_store_dwordx4 v[176:179], v1, s[8:11], s76 offen
wb_299:
  v_mfma_f32_16x16x32_bf16 v[120:123], v[64:67], a[164:167], v[120:123]
  v_lshlrev_b32 v158, 16, v139
  v_and_b32 v159, 0xffff0000, v139
  v_mfma_f32_16x16x32_bf16 v[124:127], v[20:23], a[168:171], 0
  v_lshlrev_b32 v160, 16, v140
  v_and_b32 v161, 0xffff0000, v140
  v_mfma_f32_16x16x32_bf16 v[128:131], v[24:27], a[168:171], 0
  v_lshlrev_b32 v162, 16, v141
  v_and_b32 v163, 0xffff0000, v141
  v_mfma_f32_16x16x32_bf16 v[124:127], v[28:31], a[172:175], v[124:127]
  v_cvt_pk_bf16_f32 v192, v116, v117
  v_cvt_pk_bf16_f32 v193, v120, v121
  v_mfma_f32_16x16x32_bf16 v[128:131], v[32:35], a[172:175], v[128:131]
  s_add_u32 s76, s76, 8192
  s_cmp_lg_u32 s49, 0
  s_cbranch_scc1 wt_300
  buffer_store_dwordx4 v[180:183], v1, s[8:11], s76 offen
wb_301:
  v_mfma_f32_16x16x32_bf16 v[124:127], v[36:39], a[176:179], v[124:127]
  v_cvt_pk_bf16_f32 v194, v118, v119
  v_cvt_pk_bf16_f32 v195, v122, v123
  v_mfma_f32_16x16x32_bf16 v[128:131], v[40:43], a[176:179], v[128:131]
  v_add_f32 v144, v144, v148
  v_add_f32 v152, v152, v156
  v_mfma_f32_16x16x32_bf16 v[124:127], v[44:47], a[180:183], v[124:127]
  v_add_f32 v145, v145, v149
  v_add_f32 v153, v153, v157
  v_mfma_f32_16x16x32_bf16 v[128:131], v[48:51], a[180:183], v[128:131]
  v_add_f32 v146, v146, v150
  v_add_f32 v154, v154, v158
  v_mfma_f32_16x16x32_bf16 v[124:127], v[52:55], a[184:187], v[124:127]
  s_barrier
  ds_read_b32 v17, v8 offset:0
  s_add_u32 s76, s76, 8192
  s_cmp_lg_u32 s49, 0
  s_cbranch_scc1 wt_302
  buffer_store_dwordx4 v[184:187], v1, s[8:11], s76 offen
wb_303:
  v_mfma_f32_16x16x32_bf16 v[128:131], v[56:59], a[184:187], v[128:131]
  ds_read_b128 v[68:71], v1 offset:12288
  v_add_f32 v147, v147, v151
  v_mfma_f32_16x16x32_bf16 v[124:127], v[60:63], a[188:191], v[124:127]
  v_add_f32 v155, v155, v159
  v_add_f32 v144, v144, v152
  v_mfma_f32_16x16x32_bf16 v[128:131], v[64:67], a[188:191], v[128:131]
  ds_read_b128 v[72:75], v1 offset:13312
  v_add_f32 v145, v145, v153
  v_mfma_f32_16x16x32_bf16 v[116:119], v[20:23], a[192:195], 0
  v_add_f32 v146, v146, v154
  v_add_f32 v147, v147, v155
  v_mfma_f32_16x16x32_bf16 v[120:123], v[24:27], a[192:195], 0
  s_add_u32 s76, s76, 8192
  s_cmp_lg_u32 s49, 0
  s_cbranch_scc1 wt_304
  buffer_store_dwordx4 v[188:191], v1, s[8:11], s76 offen
wb_305:
  ds_read_b128 v[76:79], v1 offset:14336
  v_mfma_f32_16x16x32_bf16 v[116:119], v[28:31], a[196:199], v[116:119]
  v_cvt_pk_bf16_f32 v196, v124, v125
  v_cvt_pk_bf16_f32 v197, v128, v129
  v_mfma_f32_16x16x32_bf16 v[120:123], v[32:35], a[196:199], v[120:123]
  ds_read_b128 v[80:83], v1 offset:15360
  v_cvt_pk_bf16_f32 v198, v126, v127
  v_mfma_f32_16x16x32_bf16 v[116:119], v[36:39], a[200:203], v[116:119]
  v_cvt_pk_bf16_f32 v199, v130, v131
  v_add_f32 v144, v144, v160
  v_mfma_f32_16x16x32_bf16 v[120:123], v[40:43], a[200:203], v[120:123]
  ds_read_b128 v[84:87], v1 offset:16384
  v_add_f32 v145, v145, v161
  v_mfma_f32_16x16x32_bf16 v[116:119], v[44:47], a[204:207], v[116:119]
  s_add_u32 s76, s76, 8192
  s_cmp_lg_u32 s49, 0
  s_cbranch_scc1 wt_306
  buffer_store_dwordx4 v[192:195], v1, s[8:11], s76 offen
wb_307:
  v_mfma_f32_16x16x32_bf16 v[120:123], v[48:51], a[204:207], v[120:123]
  ds_read_b128 v[88:91], v1 offset:17408
  v_add_f32 v146, v146, v162
  v_mfma_f32_16x16x32_bf16 v[116:119], v[52:55], a[208:211], v[116:119]
  v_add_f32 v147, v147, v163
  v_cvt_pk_bf16_f32 v164, v144, v145
  v_mfma_f32_16x16x32_bf16 v[120:123], v[56:59], a[208:211], v[120:123]
  ds_read_b128 v[92:95], v1 offset:18432
  v_lshlrev_b32 v144, 16, v164
  v_mfma_f32_16x16x32_bf16 v[116:119], v[60:63], a[212:215], v[116:119]
  v_and_b32 v145, 0xffff0000, v164
  v_cvt_pk_bf16_f32 v165, v146, v147
  v_mfma_f32_16x16x32_bf16 v[120:123], v[64:67], a[212:215], v[120:123]
  s_add_u32 s76, s76, 8192
  s_cmp_lg_u32 s49, 0
  s_cbranch_scc1 wt_308
  buffer_store_dwordx4 v[196:199], v1, s[8:11], s76 offen
wb_309:
  ds_read_b128 v[96:99], v1 offset:19456
  v_mfma_f32_16x16x32_bf16 v[124:127], v[20:23], a[216:219], 0
  v_lshlrev_b32 v146, 16, v165
  v_and_b32 v147, 0xffff0000, v165
  v_mfma_f32_16x16x32_bf16 v[128:131], v[24:27], a[216:219], 0
  ds_read_b128 v[100:103], v1 offset:20480
  v_add_f32 v148, v144, v145
  v_mfma_f32_16x16x32_bf16 v[124:127], v[28:31], a[220:223], v[124:127]
  v_cvt_pk_bf16_f32 v200, v116, v117
  v_cvt_pk_bf16_f32 v201, v120, v121
  v_mfma_f32_16x16x32_bf16 v[128:131], v[32:35], a[220:223], v[128:131]
  ds_read_b128 v[104:107], v1 offset:21504
  v_cvt_pk_bf16_f32 v202, v118, v119
  v_mfma_f32_16x16x32_bf16 v[124:127], v[36:39], a[224:227], v[124:127]
  v_cvt_pk_bf16_f32 v203, v122, v123
  v_mul_f32 v149, v144, v144
  v_mfma_f32_16x16x32_bf16 v[128:131], v[40:43], a[224:227], v[128:131]
  ds_read_b128 v[108:111], v1 offset:22528
  v_fmac_f32 v149, v145, v145
  v_mfma_f32_16x16x32_bf16 v[124:127], v[44:47], a[228:231], v[124:127]
  s_add_u32 s76, s76, 8192
  s_cmp_lg_u32 s49, 0
  s_cbranch_scc1 wt_310
  buffer_store_dwordx4 v[200:203], v1, s[8:11], s76 offen
wb_311:
  v_mfma_f32_16x16x32_bf16 v[128:131], v[48:51], a[228:231], v[128:131]
  ds_read_b128 v[112:115], v1 offset:23552
  v_add_f32 v148, v148, v146
  v_mfma_f32_16x16x32_bf16 v[124:127], v[52:55], a[232:235], v[124:127]
  v_fmac_f32 v149, v146, v146
  v_add_f32 v148, v148, v147
  v_mfma_f32_16x16x32_bf16 v[128:131], v[56:59], a[232:235], v[128:131]
  v_fmac_f32 v149, v147, v147
  v_mov_b32 v150, v148
  v_mfma_f32_16x16x32_bf16 v[124:127], v[60:63], a[236:239], v[124:127]
  v_mov_b32 v151, v149
  v_mfma_f32_16x16x32_bf16 v[128:131], v[64:67], a[236:239], v[128:131]
  v_permlane32_swap_b32 v148, v150
  s_mov_b64 s[86:87], -1
  s_add_u32 s77, s79, 3
  s_waitcnt lgkmcnt(0)
  v_readfirstlane_b32 s75, v17
  v_permlane32_swap_b32 v149, v151
  v_add_f32 v148, v148, v150
  v_add_f32 v149, v149, v151
  v_mov_b32 v150, v148
  v_mov_b32 v151, v149
  s_nop 0
  v_permlane16_swap_b32 v148, v150
  v_permlane16_swap_b32 v149, v151
  v_add_f32 v148, v148, v150
  v_add_f32 v149, v149, v151
  s_nop 0
  v_add_f32_dpp v166, v148, v148 quad_perm:[1,0,3,2] row_mask:0xf bank_mask:0xf
  v_add_f32_dpp v167, v149, v149 quad_perm:[1,0,3,2] row_mask:0xf bank_mask:0xf
  v_cvt_pk_bf16_f32 v204, v124, v125
  v_cvt_pk_bf16_f32 v205, v128, v129
  v_cvt_pk_bf16_f32 v206, v126, v127
  v_cvt_pk_bf16_f32 v207, v130, v131
  s_add_u32 s76, s76, 8192
  s_cmp_lg_u32 s49, 0
  s_cbranch_scc1 wt_312
  buffer_store_dwordx4 v[204:207], v1, s[8:11], s76 offen
wb_313:
  s_nop 0
  s_branch PO_FR1
sl_285:
  s_and_b64 exec, s[90:91], 1
  buffer_store_dword v4, v1, s[8:11], s81 offen sc1
  s_mov_b64 exec, -1
  s_mov_b64 s[90:91], 0
  v_cmp_ne_u32 vcc, 0, v12
  s_nop 0
  s_cbranch_vccz cg_314
  s_cmp_eq_u64 s[24:25], 0
  s_cbranch_scc1 gk_315
pt_316:
  buffer_load_dwordx2 v[140:141], v5, s[8:11], s20 offen sc1
  buffer_load_dwordx2 v[132:133], v5, s[8:11], s16 offen sc1
  buffer_load_dwordx2 v[134:135], v5, s[8:11], s17 offen sc1
  buffer_load_dwordx2 v[136:137], v5, s[8:11], s18 offen sc1
  buffer_load_dwordx2 v[138:139], v5, s[8:11], s19 offen sc1
  s_waitcnt vmcnt(0)
  v_bitop3_b32 v12, v132, v134, s21 bitop3:0x7e
  v_bitop3_b32 v13, v136, v138, s21 bitop3:0x7e
  v_bitop3_b32 v12, v12, v13, 1 bitop3:0xa8
  v_cmp_ne_u32 vcc, 0, v12
  s_nop 0
  s_cbranch_vccz po_317
  s_sleep 4
  s_sub_u32 s47, s47, 1
  s_cbranch_scc0 pt_316
  s_branch ABORT
po_317:
gk_315:
cg_314:
cg_319:
  buffer_load_dword v10, v9, s[8:11], s78 offen sc1
  s_waitcnt vmcnt(0)
  v_cmp_ge_i32 vcc, s79, v10
  s_nop 0
  s_cbranch_vccz bk_286
  s_sleep 1
  s_sub_u32 s47, s47, 1
  s_cbranch_scc0 cg_319
  s_branch ABORT
vi_284:
  s_waitcnt vmcnt(0)
  v_mov_b32 v18, s77
  s_and_b64 exec, s[86:87], 1
  s_cmp_lg_u32 s49, 0
  s_cbranch_scc1 wt_320
  buffer_store_dword v18, v1, s[8:11], s23 offen
wb_321:
  s_mov_b64 exec, -1
  s_mov_b64 s[86:87], 0
  s_and_b64 exec, s[90:91], 1
  buffer_store_dword v4, v1, s[8:11], s81 offen sc1
  s_mov_b64 exec, -1
  s_mov_b64 s[90:91], 0
  s_mov_b64 exec, s[88:89]
  buffer_store_dwordx2 v[164:165], v5, s[8:11], s38 offen sc1
  s_and_b64 exec, s[88:89], 0x5555
  buffer_store_dwordx2 v[166:167], v6, s[8:11], s39 offen sc1
  s_mov_b64 exec, -1
  s_mov_b32 s81, s80
  s_mov_b64 s[90:91], s[88:89]
  s_mov_b64 s[88:89], 0
  s_waitcnt vmcnt(0)
  s_and_b64 exec, s[90:91], 1
  buffer_store_dword v4, v1, s[8:11], s81 offen sc1
  s_mov_b64 exec, -1
  s_mov_b64 s[90:91], 0
  s_cmp_eq_u64 s[24:25], 0
  s_cbranch_scc1 gk_322
pt_323:
  buffer_load_dwordx2 v[140:141], v5, s[8:11], s20 offen sc1
  buffer_load_dwordx2 v[132:133], v5, s[8:11], s16 offen sc1
  buffer_load_dwordx2 v[134:135], v5, s[8:11], s17 offen sc1
  buffer_load_dwordx2 v[136:137], v5, s[8:11], s18 offen sc1
  buffer_load_dwordx2 v[138:139], v5, s[8:11], s19 offen sc1
  s_waitcnt vmcnt(0)
  v_bitop3_b32 v12, v132, v134, s21 bitop3:0x7e
  v_bitop3_b32 v13, v136, v138, s21 bitop3:0x7e
  v_bitop3_b32 v12, v12, v13, 1 bitop3:0xa8
  v_cmp_ne_u32 vcc, 0, v12
  s_nop 0
  s_cbranch_vccz po_324
  s_sleep 4
  s_sub_u32 s47, s47, 1
  s_cbranch_scc0 pt_323
  s_branch ABORT
po_324:
gk_322:
  v_lshlrev_b32 v144, 16, v132
  v_and_b32 v145, 0xffff0000, v132
  v_lshlrev_b32 v146, 16, v133
  v_and_b32 v147, 0xffff0000, v133
  v_lshlrev_b32 v148, 16, v134
  v_and_b32 v149, 0xffff0000, v134
  v_lshlrev_b32 v150, 16, v135
  v_and_b32 v151, 0xffff0000, v135
  v_lshlrev_b32 v152, 16, v136
  v_and_b32 v153, 0xffff0000, v136
  v_lshlrev_b32 v154, 16, v137
  v_and_b32 v155, 0xffff0000, v137
  v_lshlrev_b32 v156, 16, v138
  v_and_b32 v157, 0xffff0000, v138
  v_lshlrev_b32 v158, 16, v139
  v_and_b32 v159, 0xffff0000, v139
  v_lshlrev_b32 v160, 16, v140
  v_and_b32 v161, 0xffff0000, v140
  v_lshlrev_b32 v162, 16, v141
  v_and_b32 v163, 0xffff0000, v141
  v_add_f32 v144, v144, v148
  v_add_f32 v152, v152, v156
  v_add_f32 v145, v145, v149
  v_add_f32 v153, v153, v157
  v_add_f32 v146, v146, v150
  v_add_f32 v154, v154, v158
  v_add_f32 v147, v147, v151
  v_add_f32 v155, v155, v159
  v_add_f32 v144, v144, v152
  v_add_f32 v145, v145, v153
  v_add_f32 v146, v146, v154
  v_add_f32 v147, v147, v155
  v_add_f32 v144, v144, v160
  v_add_f32 v145, v145, v161
  v_add_f32 v146, v146, v162
  v_add_f32 v147, v147, v163
  v_cvt_pk_bf16_f32 v164, v144, v145
  v_lshlrev_b32 v144, 16, v164
  v_and_b32 v145, 0xffff0000, v164
  v_cvt_pk_bf16_f32 v165, v146, v147
  v_lshlrev_b32 v146, 16, v165
  v_and_b32 v147, 0xffff0000, v165
  v_add_f32 v148, v144, v145
  v_mul_f32 v149, v144, v144
  v_fmac_f32 v149, v145, v145
  v_add_f32 v148, v148, v146
  v_fmac_f32 v149, v146, v146
  v_add_f32 v148, v148, v147
  v_fmac_f32 v149, v147, v147
  v_mov_b32 v150, v148
  v_mov_b32 v151, v149
  s_nop 0
  v_permlane32_swap_b32 v148, v150
  v_permlane32_swap_b32 v149, v151
  v_add_f32 v148, v148, v150
  v_add_f32 v149, v149, v151
  v_mov_b32 v150, v148
  v_mov_b32 v151, v149
  s_nop 0
  v_permlane16_swap_b32 v148, v150
  v_permlane16_swap_b32 v149, v151
  v_add_f32 v148, v148, v150
  v_add_f32 v149, v149, v151
  s_nop 0
  v_add_f32_dpp v166, v148, v148 quad_perm:[1,0,3,2] row_mask:0xf bank_mask:0xf
  v_add_f32_dpp v167, v149, v149 quad_perm:[1,0,3,2] row_mask:0xf bank_mask:0xf
  s_mov_b64 s[88:89], s[24:25]
  s_add_u32 s38, s20, 5898240
  s_lshl_b32 s39, s58, 6
  s_sub_u32 s39, s39, s59
  s_add_u32 s39, s39, s38
  s_add_u32 s39, s39, 40960
  s_lshl_b32 s80, s22, 9
  s_lshl2_add_u32 s80, s58, s80
  s_add_u32 s80, s80, 262144
  s_waitcnt vmcnt(0)
  v_mov_b32 v18, s77
  s_and_b64 exec, s[86:87], 1
  s_cmp_lg_u32 s49, 0
  s_cbranch_scc1 wt_326
  buffer_store_dword v18, v1, s[8:11], s23 offen
wb_327:
  s_mov_b64 exec, -1
  s_mov_b64 s[86:87], 0
  s_and_b64 exec, s[90:91], 1
  buffer_store_dword v4, v1, s[8:11], s81 offen sc1
  s_mov_b64 exec, -1
  s_mov_b64 s[90:91], 0
  s_mov_b64 exec, s[88:89]
  buffer_store_dwordx2 v[164:165], v5, s[8:11], s38 offen sc1
  s_and_b64 exec, s[88:89], 0x5555
  buffer_store_dwordx2 v[166:167], v6, s[8:11], s39 offen sc1
  s_mov_b64 exec, -1
  s_mov_b32 s81, s80
  s_mov_b64 s[90:91], s[88:89]
  s_mov_b64 s[88:89], 0
  s_waitcnt vmcnt(0)
  s_and_b64 exec, s[90:91], 1
  buffer_store_dword v4, v1, s[8:11], s81 offen sc1
  s_mov_b64 exec, -1
  s_mov_b64 s[90:91], 0
  s_cmp_eq_u32 s50, 133
  s_cbranch_scc1 PO_END
  s_lshl_b32 s33, s51, 15
  s_add_u32 s33, s33, s70
  s_add_u32 s50, s50, 1
  s_mov_b32 s51, s53
  s_mov_b32 s52, s54
  s_mov_b32 s53, s55
  s_mov_b32 s54, s56
  s_sub_u32 s63, s52, 3
  s_cmp_lt_u32 s63, 64
  s_cselect_b32 s64, s73, 0
  s_cmp_lg_u32 s64, 0
  s_cselect_b64 s[34:35], -1, 0
  s_and_b32 s63, s63, 63
  s_bfe_u32 s31, s63, 0x10002
  s_lshl_b32 s32, s51, 6
  s_add_u32 s32, s32, s63
  s_and_b32 s63, s63, 3
  s_mul_i32 s63, s63, 327680
  s_cmp_eq_u32 s51, 0
  s_cselect_b32 s64, s71, s72
  s_add_u32 s26, s63, s64
  s_add_u32 s62, s50, 2
  s_min_u32 s62, s62, 133
  s_sub_i32 s60, s62, 13
  s_sub_i32 s55, s62, 12
  s_ashr_i32 s60, s60, 1
  s_ashr_i32 s55, s55, 1
  s_sub_i32 s61, s62, 67
  s_max_i32 s60, s60, s61
  s_add_i32 s61, s61, 1
  s_max_i32 s55, s55, s61
  s_max_i32 s60, s60, 0
  s_max_i32 s55, s55, 0
  s_sub_i32 s55, s55, s60
  s_sub_i32 s56, s62, s60
  s_sub_i32 s60, s60, s56
  s_mul_i32 s60, s60, s55
  s_add_i32 s56, s56, s60
  s_min_u32 s37, s56, 63
  s_lshl_b32 s64, s55, 6
  s_add_u32 s37, s37, s64
  s_lshl_b32 s37, s37, 9
  s_add_u32 s37, s37, 131072
  s_min_u32 s36, s54, 63
  s_mul_i32 s36, s36, 1179648
  s_add_u32 s36, s36, s69
  s_add_u32 s27, s26, 81920
  s_add_u32 s28, s26, 163840
  s_add_u32 s29, s26, 245760
  s_mul_i32 s30, s32, 46080
  s_add_u32 s30, s30, s59
  s_add_u32 s30, s30, 10485760
  s_mov_b64 s[16:17], s[26:27]
  s_mov_b64 s[18:19], s[28:29]
  s_mov_b64 s[20:21], s[30:31]
  s_mov_b64 s[22:23], s[32:33]
  s_mov_b64 s[24:25], s[34:35]
  s_mov_b32 s74, 0
  s_mov_b32 s75, 0
  s_branch PO_FR0
PO_FR1:
  s_cmp_ge_u32 s52, 64
  s_cbranch_scc1 vi_329
  s_cmp_lg_u32 s74, 0
  s_mov_b32 s74, s75
  s_cbranch_scc1 go_328
  s_waitcnt vmcnt(0)
  v_mov_b32 v18, s77
  s_and_b64 exec, s[86:87], 1
  s_cmp_lg_u32 s49, 0
  s_cbranch_scc1 wt_332
  buffer_store_dword v18, v1, s[8:11], s23 offen
wb_333:
  s_mov_b64 exec, -1
  s_mov_b64 s[86:87], 0
  s_and_b64 exec, s[90:91], 1
  buffer_store_dword v4, v1, s[8:11], s81 offen sc1
  s_mov_b64 exec, -1
  s_mov_b64 s[90:91], 0
  s_mov_b64 exec, s[88:89]
  buffer_store_dwordx2 v[164:165], v5, s[8:11], s38 offen sc1
  s_and_b64 exec, s[88:89], 0x5555
  buffer_store_dwordx2 v[166:167], v6, s[8:11], s39 offen sc1
  s_mov_b64 exec, -1
  s_mov_b32 s81, s80
  s_mov_b64 s[90:91], s[88:89]
  s_mov_b64 s[88:89], 0
  s_waitcnt vmcnt(0)
  s_and_b64 exec, s[90:91], 1
  buffer_store_dword v4, v1, s[8:11], s81 offen sc1
  s_mov_b64 exec, -1
  s_mov_b64 s[90:91], 0
  s_min_u32 s66, s52, 63
  s_lshl_b32 s64, s51, 6
  s_add_u32 s66, s66, s64
  s_lshl_b32 s66, s66, 9
  s_add_u32 s66, s66, 131072
  s_min_u32 s65, s52, 63
  s_mul_i32 s65, s65, 1179648
  s_add_u32 s65, s65, s69
  s_cmp_lg_u32 s46, 0
  s_cbranch_scc1 w0_334
fl_335:
  buffer_load_dword v3, v2, s[8:11], s66 offen sc1
  s_waitcnt vmcnt(0)
  v_cmp_eq_u32 vcc, 0, v3
  s_nop 0
  s_cbranch_vccz fo_336
  s_sleep 4
  s_sub_u32 s47, s47, 1
  s_cbranch_scc0 fl_335
  s_branch ABORT
fo_336:
w0_334:
  s_barrier
  s_add_u32 m0, s82, 12288
  s_nop 0
  buffer_load_dwordx4 v1, s[8:11], s65 offen offset:0 sc1 lds
  buffer_load_dwordx4 v1, s[8:11], s65 offen offset:1024 sc1 lds
  buffer_load_dwordx4 v1, s[8:11], s65 offen offset:2048 sc1 lds
  s_waitcnt vmcnt(0)
  s_barrier
  ds_read_b128 v[68:71], v1 offset:12288
  ds_read_b128 v[72:75], v1 offset:13312
  ds_read_b128 v[76:79], v1 offset:14336
  ds_read_b128 v[80:83], v1 offset:15360
  ds_read_b128 v[84:87], v1 offset:16384
  ds_read_b128 v[88:91], v1 offset:17408
  ds_read_b128 v[92:95], v1 offset:18432
  ds_read_b128 v[96:99], v1 offset:19456
  ds_read_b128 v[100:103], v1 offset:20480
  ds_read_b128 v[104:107], v1 offset:21504
  ds_read_b128 v[108:111], v1 offset:22528
  ds_read_b128 v[112:115], v1 offset:23552
  s_waitcnt lgkmcnt(0)
go_328:
  v_mfma_f32_16x16x32_bf16 v[116:119], v[68:71], a[0:3], 0
  s_and_b32 s60, s52, 1
  s_lshl2_add_u32 s60, s51, s60
  s_mul_i32 s76, s60, 327680
  v_mfma_f32_16x16x32_bf16 v[120:123], v[72:75], a[0:3], 0
  s_add_u32 s76, s76, s68
  s_add_u32 m0, s82, 0
  s_nop 0
  buffer_load_dwordx4 v1, s[8:11], s36 offen offset:0 sc1 lds
  v_mfma_f32_16x16x32_bf16 v[116:119], v[76:79], a[4:7], v[116:119]
  s_lshl_b32 s78, s51, 15
  s_add_u32 s78, s78, 197120
  s_sub_i32 s79, s52, 2
  v_mfma_f32_16x16x32_bf16 v[120:123], v[80:83], a[4:7], v[120:123]
  s_and_b64 exec, s[90:91], 1
  buffer_store_dword v4, v1, s[8:11], s81 offen sc1
  s_mov_b64 exec, -1
  s_mov_b64 s[90:91], 0
  v_mfma_f32_16x16x32_bf16 v[116:119], v[84:87], a[8:11], v[116:119]
  v_mfma_f32_16x16x32_bf16 v[120:123], v[88:91], a[8:11], v[120:123]
  s_mov_b64 exec, s[88:89]
  buffer_store_dwordx2 v[164:165], v5, s[8:11], s38 offen sc1
  s_and_b64 exec, s[88:89], 0x5555
  buffer_store_dwordx2 v[166:167], v6, s[8:11], s39 offen sc1
  s_mov_b64 exec, -1
  s_mov_b32 s81, s80
  s_mov_b64 s[90:91], s[88:89]
  s_mov_b64 s[88:89], 0
  v_mfma_f32_16x16x32_bf16 v[116:119], v[92:95], a[12:15], v[116:119]
  v_mfma_f32_16x16x32_bf16 v[120:123], v[96:99], a[12:15], v[120:123]
  buffer_load_dwordx4 v1, s[8:11], s36 offen offset:1024 sc1 lds
  v_mfma_f32_16x16x32_bf16 v[116:119], v[100:103], a[16:19], v[116:119]
  v_mfma_f32_16x16x32_bf16 v[120:123], v[104:107], a[16:19], v[120:123]
  buffer_load_dwordx4 v1, s[8:11], s36 offen offset:2048 sc1 lds
  v_mfma_f32_16x16x32_bf16 v[116:119], v[108:111], a[20:23], v[116:119]
  v_mfma_f32_16x16x32_bf16 v[120:123], v[112:115], a[20:23], v[120:123]
  buffer_load_dwordx2 v[140:141], v5, s[8:11], s20 offen sc1
  v_mfma_f32_16x16x32_bf16 v[124:127], v[68:71], a[24:27], 0
  v_mfma_f32_16x16x32_bf16 v[128:131], v[72:75], a[24:27], 0
  buffer_load_dwordx2 v[132:133], v5, s[8:11], s16 offen sc1
  v_mfma_f32_16x16x32_bf16 v[124:127], v[76:79], a[28:31], v[124:127]
  s_nop 1
  v_cvt_pk_bf16_f32 v168, v116, v117
  v_cvt_pk_bf16_f32 v169, v120, v121
  v_mfma_f32_16x16x32_bf16 v[128:131], v[80:83], a[28:31], v[128:131]
  buffer_load_dwordx2 v[134:135], v5, s[8:11], s17 offen sc1
  v_cvt_pk_bf16_f32 v170, v118, v119
  v_mfma_f32_16x16x32_bf16 v[124:127], v[84:87], a[32:35], v[124:127]
  v_cvt_pk_bf16_f32 v171, v122, v123
  v_mfma_f32_16x16x32_bf16 v[128:131], v[88:91], a[32:35], v[128:131]
  buffer_load_dwordx2 v[136:137], v5, s[8:11], s18 offen sc1
  v_mfma_f32_16x16x32_bf16 v[124:127], v[92:95], a[36:39], v[124:127]
  v_mfma_f32_16x16x32_bf16 v[128:131], v[96:99], a[36:39], v[128:131]
  buffer_load_dwordx2 v[138:139], v5, s[8:11], s19 offen sc1
  v_mfma_f32_16x16x32_bf16 v[124:127], v[100:103], a[40:43], v[124:127]
  v_mfma_f32_16x16x32_bf16 v[128:131], v[104:107], a[40:43], v[128:131]
  s_mov_b64 s[88:89], s[24:25]
  s_add_u32 s38, s20, 5898240
  s_lshl_b32 s39, s58, 6
  v_mfma_f32_16x16x32_bf16 v[124:127], v[108:111], a[44:47], v[124:127]
  s_sub_u32 s39, s39, s59
  s_add_u32 s39, s39, s38
  s_add_u32 s39, s39, 40960
  v_mfma_f32_16x16x32_bf16 v[128:131], v[112:115], a[44:47], v[128:131]
  s_lshl_b32 s80, s22, 9
  s_lshl2_add_u32 s80, s58, s80
  s_add_u32 s80, s80, 262144
  v_mfma_f32_16x16x32_bf16 v[116:119], v[68:71], a[48:51], 0
  s_lshl_b32 s33, s51, 15
  s_add_u32 s33, s33, s70
  s_add_u32 s50, s50, 1
  v_mfma_f32_16x16x32_bf16 v[120:123], v[72:75], a[48:51], 0
  s_mov_b32 s51, s53
  s_mov_b32 s52, s54
  s_mov_b32 s53, s55
  v_mfma_f32_16x16x32_bf16 v[116:119], v[76:79], a[52:55], v[116:119]
  s_mov_b32 s54, s56
  v_cvt_pk_bf16_f32 v172, v124, v125
  v_cvt_pk_bf16_f32 v173, v128, v129
  v_mfma_f32_16x16x32_bf16 v[120:123], v[80:83], a[52:55], v[120:123]
  s_sub_u32 s63, s52, 3
  v_cvt_pk_bf16_f32 v174, v126, v127
  v_cvt_pk_bf16_f32 v175, v130, v131
  v_mfma_f32_16x16x32_bf16 v[116:119], v[84:87], a[56:59], v[116:119]
  s_cmp_lt_u32 s63, 64
  s_cselect_b32 s64, s73, 0
  v_mfma_f32_16x16x32_bf16 v[120:123], v[88:91], a[56:59], v[120:123]
  s_cmp_lg_u32 s64, 0
  s_cselect_b64 s[34:35], -1, 0
  s_and_b32 s63, s63, 63
  v_mfma_f32_16x16x32_bf16 v[116:119], v[92:95], a[60:63], v[116:119]
  s_bfe_u32 s31, s63, 0x10002
  s_lshl_b32 s32, s51, 6
  s_add_u32 s32, s32, s63
  v_mfma_f32_16x16x32_bf16 v[120:123], v[96:99], a[60:63], v[120:123]
  s_and_b32 s63, s63, 3
  s_mul_i32 s63, s63, 327680
  v_mfma_f32_16x16x32_bf16 v[116:119], v[100:103], a[64:67], v[116:119]
  s_cmp_eq_u32 s51, 0
  s_cselect_b32 s64, s71, s72
  s_add_u32 s26, s63, s64
  v_mfma_f32_16x16x32_bf16 v[120:123], v[104:107], a[64:67], v[120:123]
  s_add_u32 s62, s50, 2
  s_min_u32 s62, s62, 133
  s_sub_i32 s60, s62, 13
  v_mfma_f32_16x16x32_bf16 v[116:119], v[108:111], a[68:71], v[116:119]
  s_sub_i32 s55, s62, 12
  s_ashr_i32 s60, s60, 1
  s_ashr_i32 s55, s55, 1
  v_mfma_f32_16x16x32_bf16 v[120:123], v[112:115], a[68:71], v[120:123]
  s_sub_i32 s61, s62, 67
  s_max_i32 s60, s60, s61
  s_add_i32 s61, s61, 1
  v_mfma_f32_16x16x32_bf16 v[124:127], v[68:71], a[72:75], 0
  s_max_i32 s55, s55, s61
  s_max_i32 s60, s60, 0
  s_max_i32 s55, s55, 0
  v_mfma_f32_16x16x32_bf16 v[128:131], v[72:75], a[72:75], 0
  s_sub_i32 s55, s55, s60
  s_sub_i32 s56, s62, s60
  s_sub_i32 s60, s60, s56
  v_mfma_f32_16x16x32_bf16 v[124:127], v[76:79], a[76:79], v[124:127]
  s_mul_i32 s60, s60, s55
  v_cvt_pk_bf16_f32 v176, v116, v117
  v_cvt_pk_bf16_f32 v177, v120, v121
  v_mfma_f32_16x16x32_bf16 v[128:131], v[80:83], a[76:79], v[128:131]
  s_add_i32 s56, s56, s60
  v_cvt_pk_bf16_f32 v178, v118, v119
  v_cvt_pk_bf16_f32 v179, v122, v123
  v_mfma_f32_16x16x32_bf16 v[124:127], v[84:87], a[80:83], v[124:127]
  s_min_u32 s37, s56, 63
  s_lshl_b32 s64, s55, 6
  s_add_u32 s37, s37, s64
  v_mfma_f32_16x16x32_bf16 v[128:131], v[88:91], a[80:83], v[128:131]
  s_lshl_b32 s37, s37, 9
  s_add_u32 s37, s37, 131072
  s_min_u32 s36, s54, 63
  v_mfma_f32_16x16x32_bf16 v[124:127], v[92:95], a[84:87], v[124:127]
  s_mul_i32 s36, s36, 1179648
  s_add_u32 s36, s36, s69
  s_add_u32 s27, s26, 81920
  v_mfma_f32_16x16x32_bf16 v[128:131], v[96:99], a[84:87], v[128:131]
  s_add_u32 s28, s26, 163840
  s_add_u32 s29, s26, 245760
  s_mul_i32 s30, s32, 46080
  v_mfma_f32_16x16x32_bf16 v[124:127], v[100:103], a[88:91], v[124:127]
  s_add_u32 s30, s30, s59
  s_add_u32 s30, s30, 10485760
  v_mfma_f32_16x16x32_bf16 v[128:131], v[104:107], a[88:91], v[128:131]
  v_mfma_f32_16x16x32_bf16 v[124:127], v[108:111], a[92:95], v[124:127]
  buffer_load_dword v10, v9, s[8:11], s78 offen sc1
  v_mfma_f32_16x16x32_bf16 v[128:131], v[112:115], a[92:95], v[128:131]
  v_mfma_f32_16x16x32_bf16 v[116:119], v[68:71], a[96:99], 0
  v_mfma_f32_16x16x32_bf16 v[120:123], v[72:75], a[96:99], 0
  v_mfma_f32_16x16x32_bf16 v[116:119], v[76:79], a[100:103], v[116:119]
  s_nop 2
  v_cvt_pk_bf16_f32 v180, v124, v125
  s_nop 0
  v_cvt_pk_bf16_f32 v181, v128, v129
  v_mfma_f32_16x16x32_bf16 v[120:123], v[80:83], a[100:103], v[120:123]
  v_cvt_pk_bf16_f32 v182, v126, v127
  v_cvt_pk_bf16_f32 v183, v130, v131
  v_mfma_f32_16x16x32_bf16 v[116:119], v[84:87], a[104:107], v[116:119]
  v_mfma_f32_16x16x32_bf16 v[120:123], v[88:91], a[104:107], v[120:123]
  v_mfma_f32_16x16x32_bf16 v[116:119], v[92:95], a[108:111], v[116:119]
  v_mfma_f32_16x16x32_bf16 v[120:123], v[96:99], a[108:111], v[120:123]
  v_mfma_f32_16x16x32_bf16 v[116:119], v[100:103], a[112:115], v[116:119]
  v_mfma_f32_16x16x32_bf16 v[120:123], v[104:107], a[112:115], v[120:123]
  v_mfma_f32_16x16x32_bf16 v[116:119], v[108:111], a[116:119], v[116:119]
  v_mfma_f32_16x16x32_bf16 v[120:123], v[112:115], a[116:119], v[120:123]
  v_mfma_f32_16x16x32_bf16 v[124:127], v[68:71], a[120:123], 0
  v_mfma_f32_16x16x32_bf16 v[128:131], v[72:75], a[120:123], 0
  v_mfma_f32_16x16x32_bf16 v[124:127], v[76:79], a[124:127], v[124:127]
  s_nop 3
  v_cvt_pk_bf16_f32 v184, v116, v117
  v_cvt_pk_bf16_f32 v185, v120, v121
  v_mfma_f32_16x16x32_bf16 v[128:131], v[80:83], a[124:127], v[128:131]
  v_cvt_pk_bf16_f32 v186, v118, v119
  v_cvt_pk_bf16_f32 v187, v122, v123
  v_mfma_f32_16x16x32_bf16 v[124:127], v[84:87], a[128:131], v[124:127]
  s_waitcnt vmcnt(0)
  v_mov_b32 v18, s77
  s_and_b64 exec, s[86:87], 1
  s_cmp_lg_u32 s49, 0
  s_cbranch_scc1 wt_337
  buffer_store_dword v18, v1, s[8:11], s23 offen
wb_338:
  s_mov_b64 exec, -1
  s_mov_b64 s[86:87], 0
  v_mfma_f32_16x16x32_bf16 v[128:131], v[88:91], a[128:131], v[128:131]
  v_bitop3_b32 v12, v132, v134, s21 bitop3:0x7e
  v_bitop3_b32 v13, v136, v138, s21 bitop3:0x7e
  v_mfma_f32_16x16x32_bf16 v[124:127], v[92:95], a[132:135], v[124:127]
  v_bitop3_b32 v12, v12, v13, 1 bitop3:0xa8
  v_and_b32 v12, s24, v12
  v_mfma_f32_16x16x32_bf16 v[128:131], v[96:99], a[132:135], v[128:131]
  v_lshlrev_b32 v13, 31, v12
  v_or_b32 v13, v13, v10
  v_mfma_f32_16x16x32_bf16 v[124:127], v[100:103], a[136:139], v[124:127]
  v_cmp_ge_i32 vcc, s79, v13
  v_mfma_f32_16x16x32_bf16 v[128:131], v[104:107], a[136:139], v[128:131]
  v_mfma_f32_16x16x32_bf16 v[124:127], v[108:111], a[140:143], v[124:127]
  v_mfma_f32_16x16x32_bf16 v[128:131], v[112:115], a[140:143], v[128:131]
  s_cbranch_vccnz sl_330
bk_331:
  v_lshlrev_b32 v144, 16, v132
  v_and_b32 v145, 0xffff0000, v132
  v_mfma_f32_16x16x32_bf16 v[116:119], v[68:71], a[144:147], 0
  s_mov_b64 s[16:17], s[26:27]
  s_cmp_lg_u32 s49, 0
  s_cbranch_scc1 wt_339
  buffer_store_dwordx4 v[168:171], v1, s[8:11], s76 offen
wb_340:
  v_mfma_f32_16x16x32_bf16 v[120:123], v[72:75], a[144:147], 0
  s_mov_b64 s[18:19], s[28:29]
  v_lshlrev_b32 v146, 16, v133
  v_and_b32 v147, 0xffff0000, v133
  v_mfma_f32_16x16x32_bf16 v[116:119], v[76:79], a[148:151], v[116:119]
  s_mov_b64 s[20:21], s[30:31]
  v_cvt_pk_bf16_f32 v188, v124, v125
  v_cvt_pk_bf16_f32 v189, v128, v129
  v_mfma_f32_16x16x32_bf16 v[120:123], v[80:83], a[148:151], v[120:123]
  s_mov_b64 s[22:23], s[32:33]
  v_cvt_pk_bf16_f32 v190, v126, v127
  v_cvt_pk_bf16_f32 v191, v130, v131
  v_mfma_f32_16x16x32_bf16 v[116:119], v[84:87], a[152:155], v[116:119]
  s_mov_b64 s[24:25], s[34:35]
  v_lshlrev_b32 v148, 16, v134
  v_and_b32 v149, 0xffff0000, v134
  v_mfma_f32_16x16x32_bf16 v[120:123], v[88:91], a[152:155], v[120:123]
  s_add_u32 s76, s76, 8192
  s_cmp_lg_u32 s49, 0
  s_cbranch_scc1 wt_341
  buffer_store_dwordx4 v[172:175], v1, s[8:11], s76 offen
wb_342:
  v_mfma_f32_16x16x32_bf16 v[116:119], v[92:95], a[156:159], v[116:119]
  v_lshlrev_b32 v150, 16, v135
  v_and_b32 v151, 0xffff0000, v135
  v_mfma_f32_16x16x32_bf16 v[120:123], v[96:99], a[156:159], v[120:123]
  v_lshlrev_b32 v152, 16, v136
  v_and_b32 v153, 0xffff0000, v136
  v_mfma_f32_16x16x32_bf16 v[116:119], v[100:103], a[160:163], v[116:119]
  v_lshlrev_b32 v154, 16, v137
  v_and_b32 v155, 0xffff0000, v137
  v_mfma_f32_16x16x32_bf16 v[120:123], v[104:107], a[160:163], v[120:123]
  v_lshlrev_b32 v156, 16, v138
  v_and_b32 v157, 0xffff0000, v138
  v_mfma_f32_16x16x32_bf16 v[116:119], v[108:111], a[164:167], v[116:119]
  s_add_u32 s76, s76, 8192
  s_cmp_lg_u32 s49, 0
  s_cbranch_scc1 wt_343
  buffer_store_dwordx4 v[176:179], v1, s[8:11], s76 offen
wb_344:
  v_mfma_f32_16x16x32_bf16 v[120:123], v[112:115], a[164:167], v[120:123]
  v_lshlrev_b32 v158, 16, v139
  v_and_b32 v159, 0xffff0000, v139
  v_mfma_f32_16x16x32_bf16 v[124:127], v[68:71], a[168:171], 0
  v_lshlrev_b32 v160, 16, v140
  v_and_b32 v161, 0xffff0000, v140
  v_mfma_f32_16x16x32_bf16 v[128:131], v[72:75], a[168:171], 0
  v_lshlrev_b32 v162, 16, v141
  v_and_b32 v163, 0xffff0000, v141
  v_mfma_f32_16x16x32_bf16 v[124:127], v[76:79], a[172:175], v[124:127]
  v_cvt_pk_bf16_f32 v192, v116, v117
  v_cvt_pk_bf16_f32 v193, v120, v121
  v_mfma_f32_16x16x32_bf16 v[128:131], v[80:83], a[172:175], v[128:131]
  s_add_u32 s76, s76, 8192
  s_cmp_lg_u32 s49, 0
  s_cbranch_scc1 wt_345
  buffer_store_dwordx4 v[180:183], v1, s[8:11], s76 offen
wb_346:
  v_mfma_f32_16x16x32_bf16 v[124:127], v[84:87], a[176:179], v[124:127]
  v_cvt_pk_bf16_f32 v194, v118, v119
  v_cvt_pk_bf16_f32 v195, v122, v123
  v_mfma_f32_16x16x32_bf16 v[128:131], v[88:91], a[176:179], v[128:131]
  v_add_f32 v144, v144, v148
  v_add_f32 v152, v152, v156
  v_mfma_f32_16x16x32_bf16 v[124:127], v[92:95], a[180:183], v[124:127]
  v_add_f32 v145, v145, v149
  v_add_f32 v153, v153, v157
  v_mfma_f32_16x16x32_bf16 v[128:131], v[96:99], a[180:183], v[128:131]
  v_add_f32 v146, v146, v150
  v_add_f32 v154, v154, v158
  v_mfma_f32_16x16x32_bf16 v[124:127], v[100:103], a[184:187], v[124:127]
  s_barrier
  ds_read_b32 v17, v8 offset:16
  s_add_u32 s76, s76, 8192
  s_cmp_lg_u32 s49, 0
  s_cbranch_scc1 wt_347
  buffer_store_dwordx4 v[184:187], v1, s[8:11], s76 offen
wb_348:
  v_mfma_f32_16x16x32_bf16 v[128:131], v[104:107], a[184:187], v[128:131]
  ds_read_b128 v[20:23], v1 offset:0
  v_add_f32 v147, v147, v151
  v_mfma_f32_16x16x32_bf16 v[124:127], v[108:111], a[188:191], v[124:127]
  v_add_f32 v155, v155, v159
  v_add_f32 v144, v144, v152
  v_mfma_f32_16x16x32_bf16 v[128:131], v[112:115], a[188:191], v[128:131]
  ds_read_b128 v[24:27], v1 offset:1024
  v_add_f32 v145, v145, v153
  v_mfma_f32_16x16x32_bf16 v[116:119], v[68:71], a[192:195], 0
  v_add_f32 v146, v146, v154
  v_add_f32 v147, v147, v155
  v_mfma_f32_16x16x32_bf16 v[120:123], v[72:75], a[192:195], 0
  s_add_u32 s76, s76, 8192
  s_cmp_lg_u32 s49, 0
  s_cbranch_scc1 wt_349
  buffer_store_dwordx4 v[188:191], v1, s[8:11], s76 offen
wb_350:
  ds_read_b128 v[28:31], v1 offset:2048
  v_mfma_f32_16x16x32_bf16 v[116:119], v[76:79], a[196:199], v[116:119]
  v_cvt_pk_bf16_f32 v196, v124, v125
  v_cvt_pk_bf16_f32 v197, v128, v129
  v_mfma_f32_16x16x32_bf16 v[120:123], v[80:83], a[196:199], v[120:123]
  ds_read_b128 v[32:35], v1 offset:3072
  v_cvt_pk_bf16_f32 v198, v126, v127
  v_mfma_f32_16x16x32_bf16 v[116:119], v[84:87], a[200:203], v[116:119]
  v_cvt_pk_bf16_f32 v199, v130, v131
  v_add_f32 v144, v144, v160
  v_mfma_f32_16x16x32_bf16 v[120:123], v[88:91], a[200:203], v[120:123]
  ds_read_b128 v[36:39], v1 offset:4096
  v_add_f32 v145, v145, v161
  v_mfma_f32_16x16x32_bf16 v[116:119], v[92:95], a[204:207], v[116:119]
  s_add_u32 s76, s76, 8192
  s_cmp_lg_u32 s49, 0
  s_cbranch_scc1 wt_351
  buffer_store_dwordx4 v[192:195], v1, s[8:11], s76 offen
wb_352:
  v_mfma_f32_16x16x32_bf16 v[120:123], v[96:99], a[204:207], v[120:123]
  ds_read_b128 v[40:43], v1 offset:5120
  v_add_f32 v146, v146, v162
  v_mfma_f32_16x16x32_bf16 v[116:119], v[100:103], a[208:211], v[116:119]
  v_add_f32 v147, v147, v163
  v_cvt_pk_bf16_f32 v164, v144, v145
  v_mfma_f32_16x16x32_bf16 v[120:123], v[104:107], a[208:211], v[120:123]
  ds_read_b128 v[44:47], v1 offset:6144
  v_lshlrev_b32 v144, 16, v164
  v_mfma_f32_16x16x32_bf16 v[116:119], v[108:111], a[212:215], v[116:119]
  v_and_b32 v145, 0xffff0000, v164
  v_cvt_pk_bf16_f32 v165, v146, v147
  v_mfma_f32_16x16x32_bf16 v[120:123], v[112:115], a[212:215], v[120:123]
  s_add_u32 s76, s76, 8192
  s_cmp_lg_u32 s49, 0
  s_cbranch_scc1 wt_353
  buffer_store_dwordx4 v[196:199], v1, s[8:11], s76 offen
wb_354:
  ds_read_b128 v[48:51], v1 offset:7168
  v_mfma_f32_16x16x32_bf16 v[124:127], v[68:71], a[216:219], 0
  v_lshlrev_b32 v146, 16, v165
  v_and_b32 v147, 0xffff0000, v165
  v_mfma_f32_16x16x32_bf16 v[128:131], v[72:75], a[216:219], 0
  ds_read_b128 v[52:55], v1 offset:8192
  v_add_f32 v148, v144, v145
  v_mfma_f32_16x16x32_bf16 v[124:127], v[76:79], a[220:223], v[124:127]
  v_cvt_pk_bf16_f32 v200, v116, v117
  v_cvt_pk_bf16_f32 v201, v120, v121
  v_mfma_f32_16x16x32_bf16 v[128:131], v[80:83], a[220:223], v[128:131]
  ds_read_b128 v[56:59], v1 offset:9216
  v_cvt_pk_bf16_f32 v202, v118, v119
  v_mfma_f32_16x16x32_bf16 v[124:127], v[84:87], a[224:227], v[124:127]
  v_cvt_pk_bf16_f32 v203, v122, v123
  v_mul_f32 v149, v144, v144
  v_mfma_f32_16x16x32_bf16 v[128:131], v[88:91], a[224:227], v[128:131]
  ds_read_b128 v[60:63], v1 offset:10240
  v_fmac_f32 v149, v145, v145
  v_mfma_f32_16x16x32_bf16 v[124:127], v[92:95], a[228:231], v[124:127]
  s_add_u32 s76, s76, 8192
  s_cmp_lg_u32 s49, 0
  s_cbranch_scc1 wt_355
  buffer_store_dwordx4 v[200:203], v1, s[8:11], s76 offen
wb_356:
  v_mfma_f32_16x16x32_bf16 v[128:131], v[96:99], a[228:231], v[128:131]
  ds_read_b128 v[64:67], v1 offset:11264
  v_add_f32 v148, v148, v146
  v_mfma_f32_16x16x32_bf16 v[124:127], v[100:103], a[232:235], v[124:127]
  v_fmac_f32 v149, v146, v146
  v_add_f32 v148, v148, v147
  v_mfma_f32_16x16x32_bf16 v[128:131], v[104:107], a[232:235], v[128:131]
  v_fmac_f32 v149, v147, v147
  v_mov_b32 v150, v148
  v_mfma_f32_16x16x32_bf16 v[124:127], v[108:111], a[236:239], v[124:127]
  v_mov_b32 v151, v149
  v_mfma_f32_16x16x32_bf16 v[128:131], v[112:115], a[236:239], v[128:131]
  v_permlane32_swap_b32 v148, v150
  s_mov_b64 s[86:87], -1
  s_add_u32 s77, s79, 3
  s_waitcnt lgkmcnt(0)
  v_readfirstlane_b32 s75, v17
  v_permlane32_swap_b32 v149, v151
  v_add_f32 v148, v148, v150
  v_add_f32 v149, v149, v151
  v_mov_b32 v150, v148
  v_mov_b32 v151, v149
  s_nop 0
  v_permlane16_swap_b32 v148, v150
  v_permlane16_swap_b32 v149, v151
  v_add_f32 v148, v148, v150
  v_add_f32 v149, v149, v151
  s_nop 0
  v_add_f32_dpp v166, v148, v148 quad_perm:[1,0,3,2] row_mask:0xf bank_mask:0xf
  v_add_f32_dpp v167, v149, v149 quad_perm:[1,0,3,2] row_mask:0xf bank_mask:0xf
  v_cvt_pk_bf16_f32 v204, v124, v125
  v_cvt_pk_bf16_f32 v205, v128, v129
  v_cvt_pk_bf16_f32 v206, v126, v127
  v_cvt_pk_bf16_f32 v207, v130, v131
  s_add_u32 s76, s76, 8192
  s_cmp_lg_u32 s49, 0
  s_cbranch_scc1 wt_357
  buffer_store_dwordx4 v[204:207], v1, s[8:11], s76 offen
wb_358:
  s_nop 0
  s_branch PO_FR0
sl_330:
  s_and_b64 exec, s[90:91], 1
  buffer_store_dword v4, v1, s[8:11], s81 offen sc1
  s_mov_b64 exec, -1
  s_mov_b64 s[90:91], 0
  v_cmp_ne_u32 vcc, 0, v12
  s_nop 0
  s_cbranch_vccz cg_359
  s_cmp_eq_u64 s[24:25], 0
  s_cbranch_scc1 gk_360
pt_361:
  buffer_load_dwordx2 v[140:141], v5, s[8:11], s20 offen sc1
  buffer_load_dwordx2 v[132:133], v5, s[8:11], s16 offen sc1
  buffer_load_dwordx2 v[134:135], v5, s[8:11], s17 offen sc1
  buffer_load_dwordx2 v[136:137], v5, s[8:11], s18 offen sc1
  buffer_load_dwordx2 v[138:139], v5, s[8:11], s19 offen sc1
  s_waitcnt vmcnt(0)
  v_bitop3_b32 v12, v132, v134, s21 bitop3:0x7e
  v_bitop3_b32 v13, v136, v138, s21 bitop3:0x7e
  v_bitop3_b32 v12, v12, v13, 1 bitop3:0xa8
  v_cmp_ne_u32 vcc, 0, v12
  s_nop 0
  s_cbranch_vccz po_362
  s_sleep 4
  s_sub_u32 s47, s47, 1
  s_cbranch_scc0 pt_361
  s_branch ABORT
po_362:
gk_360:
cg_359:
cg_364:
  buffer_load_dword v10, v9, s[8:11], s78 offen sc1
  s_waitcnt vmcnt(0)
  v_cmp_ge_i32 vcc, s79, v10
  s_nop 0
  s_cbranch_vccz bk_331
  s_sleep 1
  s_sub_u32 s47, s47, 1
  s_cbranch_scc0 cg_364
  s_branch ABORT
vi_329:
  s_waitcnt vmcnt(0)
  v_mov_b32 v18, s77
  s_and_b64 exec, s[86:87], 1
  s_cmp_lg_u32 s49, 0
  s_cbranch_scc1 wt_365
  buffer_store_dword v18, v1, s[8:11], s23 offen
wb_366:
  s_mov_b64 exec, -1
  s_mov_b64 s[86:87], 0
  s_and_b64 exec, s[90:91], 1
  buffer_store_dword v4, v1, s[8:11], s81 offen sc1
  s_mov_b64 exec, -1
  s_mov_b64 s[90:91], 0
  s_mov_b64 exec, s[88:89]
  buffer_store_dwordx2 v[164:165], v5, s[8:11], s38 offen sc1
  s_and_b64 exec, s[88:89], 0x5555
  buffer_store_dwordx2 v[166:167], v6, s[8:11], s39 offen sc1
  s_mov_b64 exec, -1
  s_mov_b32 s81, s80
  s_mov_b64 s[90:91], s[88:89]
  s_mov_b64 s[88:89], 0
  s_waitcnt vmcnt(0)
  s_and_b64 exec, s[90:91], 1
  buffer_store_dword v4, v1, s[8:11], s81 offen sc1
  s_mov_b64 exec, -1
  s_mov_b64 s[90:91], 0
  s_cmp_eq_u64 s[24:25], 0
  s_cbranch_scc1 gk_367
pt_368:
  buffer_load_dwordx2 v[140:141], v5, s[8:11], s20 offen sc1
  buffer_load_dwordx2 v[132:133], v5, s[8:11], s16 offen sc1
  buffer_load_dwordx2 v[134:135], v5, s[8:11], s17 offen sc1
  buffer_load_dwordx2 v[136:137], v5, s[8:11], s18 offen sc1
  buffer_load_dwordx2 v[138:139], v5, s[8:11], s19 offen sc1
  s_waitcnt vmcnt(0)
  v_bitop3_b32 v12, v132, v134, s21 bitop3:0x7e
  v_bitop3_b32 v13, v136, v138, s21 bitop3:0x7e
  v_bitop3_b32 v12, v12, v13, 1 bitop3:0xa8
  v_cmp_ne_u32 vcc, 0, v12
  s_nop 0
  s_cbranch_vccz po_369
  s_sleep 4
  s_sub_u32 s47, s47, 1
  s_cbranch_scc0 pt_368
  s_branch ABORT
po_369:
gk_367:
  v_lshlrev_b32 v144, 16, v132
  v_and_b32 v145, 0xffff0000, v132
  v_lshlrev_b32 v146, 16, v133
  v_and_b32 v147, 0xffff0000, v133
  v_lshlrev_b32 v148, 16, v134
  v_and_b32 v149, 0xffff0000, v134
  v_lshlrev_b32 v150, 16, v135
  v_and_b32 v151, 0xffff0000, v135
  v_lshlrev_b32 v152, 16, v136
  v_and_b32 v153, 0xffff0000, v136
  v_lshlrev_b32 v154, 16, v137
  v_and_b32 v155, 0xffff0000, v137
  v_lshlrev_b32 v156, 16, v138
  v_and_b32 v157, 0xffff0000, v138
  v_lshlrev_b32 v158, 16, v139
  v_and_b32 v159, 0xffff0000, v139
  v_lshlrev_b32 v160, 16, v140
  v_and_b32 v161, 0xffff0000, v140
  v_lshlrev_b32 v162, 16, v141
  v_and_b32 v163, 0xffff0000, v141
  v_add_f32 v144, v144, v148
  v_add_f32 v152, v152, v156
  v_add_f32 v145, v145, v149
  v_add_f32 v153, v153, v157
  v_add_f32 v146, v146, v150
  v_add_f32 v154, v154, v158
  v_add_f32 v147, v147, v151
  v_add_f32 v155, v155, v159
  v_add_f32 v144, v144, v152
  v_add_f32 v145, v145, v153
  v_add_f32 v146, v146, v154
  v_add_f32 v147, v147, v155
  v_add_f32 v144, v144, v160
  v_add_f32 v145, v145, v161
  v_add_f32 v146, v146, v162
  v_add_f32 v147, v147, v163
  v_cvt_pk_bf16_f32 v164, v144, v145
  v_lshlrev_b32 v144, 16, v164
  v_and_b32 v145, 0xffff0000, v164
  v_cvt_pk_bf16_f32 v165, v146, v147
  v_lshlrev_b32 v146, 16, v165
  v_and_b32 v147, 0xffff0000, v165
  v_add_f32 v148, v144, v145
  v_mul_f32 v149, v144, v144
  v_fmac_f32 v149, v145, v145
  v_add_f32 v148, v148, v146
  v_fmac_f32 v149, v146, v146
  v_add_f32 v148, v148, v147
  v_fmac_f32 v149, v147, v147
  v_mov_b32 v150, v148
  v_mov_b32 v151, v149
  s_nop 0
  v_permlane32_swap_b32 v148, v150
  v_permlane32_swap_b32 v149, v151
  v_add_f32 v148, v148, v150
  v_add_f32 v149, v149, v151
  v_mov_b32 v150, v148
  v_mov_b32 v151, v149
  s_nop 0
  v_permlane16_swap_b32 v148, v150
  v_permlane16_swap_b32 v149, v151
  v_add_f32 v148, v148, v150
  v_add_f32 v149, v149, v151
  s_nop 0
  v_add_f32_dpp v166, v148, v148 quad_perm:[1,0,3,2] row_mask:0xf bank_mask:0xf
  v_add_f32_dpp v167, v149, v149 quad_perm:[1,0,3,2] row_mask:0xf bank_mask:0xf
  s_mov_b64 s[88:89], s[24:25]
  s_add_u32 s38, s20, 5898240
  s_lshl_b32 s39, s58, 6
  s_sub_u32 s39, s39, s59
  s_add_u32 s39, s39, s38
  s_add_u32 s39, s39, 40960
  s_lshl_b32 s80, s22, 9
  s_lshl2_add_u32 s80, s58, s80
  s_add_u32 s80, s80, 262144
  s_waitcnt vmcnt(0)
  v_mov_b32 v18, s77
  s_and_b64 exec, s[86:87], 1
  s_cmp_lg_u32 s49, 0
  s_cbranch_scc1 wt_371
  buffer_store_dword v18, v1, s[8:11], s23 offen
wb_372:
  s_mov_b64 exec, -1
  s_mov_b64 s[86:87], 0
  s_and_b64 exec, s[90:91], 1
  buffer_store_dword v4, v1, s[8:11], s81 offen sc1
  s_mov_b64 exec, -1
  s_mov_b64 s[90:91], 0
  s_mov_b64 exec, s[88:89]
  buffer_store_dwordx2 v[164:165], v5, s[8:11], s38 offen sc1
  s_and_b64 exec, s[88:89], 0x5555
  buffer_store_dwordx2 v[166:167], v6, s[8:11], s39 offen sc1
  s_mov_b64 exec, -1
  s_mov_b32 s81, s80
  s_mov_b64 s[90:91], s[88:89]
  s_mov_b64 s[88:89], 0
  s_waitcnt vmcnt(0)
  s_and_b64 exec, s[90:91], 1
  buffer_store_dword v4, v1, s[8:11], s81 offen sc1
  s_mov_b64 exec, -1
  s_mov_b64 s[90:91], 0
  s_cmp_eq_u32 s50, 133
  s_cbranch_scc1 PO_END
  s_lshl_b32 s33, s51, 15
  s_add_u32 s33, s33, s70
  s_add_u32 s50, s50, 1
  s_mov_b32 s51, s53
  s_mov_b32 s52, s54
  s_mov_b32 s53, s55
  s_mov_b32 s54, s56
  s_sub_u32 s63, s52, 3
  s_cmp_lt_u32 s63, 64
  s_cselect_b32 s64, s73, 0
  s_cmp_lg_u32 s64, 0
  s_cselect_b64 s[34:35], -1, 0
  s_and_b32 s63, s63, 63
  s_bfe_u32 s31, s63, 0x10002
  s_lshl_b32 s32, s51, 6
  s_add_u32 s32, s32, s63
  s_and_b32 s63, s63, 3
  s_mul_i32 s63, s63, 327680
  s_cmp_eq_u32 s51, 0
  s_cselect_b32 s64, s71, s72
  s_add_u32 s26, s63, s64
  s_add_u32 s62, s50, 2
  s_min_u32 s62, s62, 133
  s_sub_i32 s60, s62, 13
  s_sub_i32 s55, s62, 12
  s_ashr_i32 s60, s60, 1
  s_ashr_i32 s55, s55, 1
  s_sub_i32 s61, s62, 67
  s_max_i32 s60, s60, s61
  s_add_i32 s61, s61, 1
  s_max_i32 s55, s55, s61
  s_max_i32 s60, s60, 0
  s_max_i32 s55, s55, 0
  s_sub_i32 s55, s55, s60
  s_sub_i32 s56, s62, s60
  s_sub_i32 s60, s60, s56
  s_mul_i32 s60, s60, s55
  s_add_i32 s56, s56, s60
  s_min_u32 s37, s56, 63
  s_lshl_b32 s64, s55, 6
  s_add_u32 s37, s37, s64
  s_lshl_b32 s37, s37, 9
  s_add_u32 s37, s37, 131072
  s_min_u32 s36, s54, 63
  s_mul_i32 s36, s36, 1179648
  s_add_u32 s36, s36, s69
  s_add_u32 s27, s26, 81920
  s_add_u32 s28, s26, 163840
  s_add_u32 s29, s26, 245760
  s_mul_i32 s30, s32, 46080
  s_add_u32 s30, s30, s59
  s_add_u32 s30, s30, 10485760
  s_mov_b64 s[16:17], s[26:27]
  s_mov_b64 s[18:19], s[28:29]
  s_mov_b64 s[20:21], s[30:31]
  s_mov_b64 s[22:23], s[32:33]
  s_mov_b64 s[24:25], s[34:35]
  s_mov_b32 s74, 0
  s_mov_b32 s75, 0
  s_branch PO_FR1
PO_END:
  s_endpgm
wt_219:
  s_nop 7
  buffer_store_dword v18, v1, s[8:11], s23 offen sc1
  s_branch wb_220
wt_224:
  s_nop 7
  buffer_store_dword v18, v1, s[8:11], s23 offen sc1
  s_branch wb_225
wt_226:
  s_nop 7
  buffer_store_dwordx4 v[168:171], v1, s[8:11], s76 offen sc1
  s_branch wb_227
wt_228:
  s_nop 7
  buffer_store_dwordx4 v[172:175], v1, s[8:11], s76 offen sc1
  s_branch wb_229
wt_230:
  s_nop 7
  buffer_store_dwordx4 v[176:179], v1, s[8:11], s76 offen sc1
  s_branch wb_231
wt_232:
  s_nop 7
  buffer_store_dwordx4 v[180:183], v1, s[8:11], s76 offen sc1
  s_branch wb_233
wt_234:
  s_nop 7
  buffer_store_dwordx4 v[184:187], v1, s[8:11], s76 offen sc1
  s_branch wb_235
wt_236:
  s_nop 7
  buffer_store_dwordx4 v[188:191], v1, s[8:11], s76 offen sc1
  s_branch wb_237
wt_238:
  s_nop 7
  buffer_store_dwordx4 v[192:195], v1, s[8:11], s76 offen sc1
  s_branch wb_239
wt_240:
  s_nop 7
  buffer_store_dwordx4 v[196:199], v1, s[8:11], s76 offen sc1
  s_branch wb_241
wt_242:
  s_nop 7
  buffer_store_dwordx4 v[200:203], v1, s[8:11], s76 offen sc1
  s_branch wb_243
wt_244:
  s_nop 7
  buffer_store_dwordx4 v[204:207], v1, s[8:11], s76 offen sc1
  s_branch wb_245
wt_247:
  s_nop 7
  buffer_store_dword v18, v1, s[8:11], s23 offen sc1
  s_branch wb_248
wt_253:
  s_nop 7
  buffer_store_dword v18, v1, s[8:11], s23 offen sc1
  s_branch wb_254
wt_258:
  s_nop 7
  buffer_store_dword v18, v1, s[8:11], s23 offen sc1
  s_branch wb_259
wt_260:
  s_nop 7
  buffer_store_dwordx4 v[168:171], v1, s[8:11], s76 offen sc1
  s_branch wb_261
wt_262:
  s_nop 7
  buffer_store_dwordx4 v[172:175], v1, s[8:11], s76 offen sc1
  s_branch wb_263
wt_264:
  s_nop 7
  buffer_store_dwordx4 v[176:179], v1, s[8:11], s76 offen sc1
  s_branch wb_265
wt_266:
  s_nop 7
  buffer_store_dwordx4 v[180:183], v1, s[8:11], s76 offen sc1
  s_branch wb_267
wt_268:
  s_nop 7
  buffer_store_dwordx4 v[184:187], v1, s[8:11], s76 offen sc1
  s_branch wb_269
wt_270:
  s_nop 7
  buffer_store_dwordx4 v[188:191], v1, s[8:11], s76 offen sc1
  s_branch wb_271
wt_272:
  s_nop 7
  buffer_store_dwordx4 v[192:195], v1, s[8:11], s76 offen sc1
  s_branch wb_273
wt_274:
  s_nop 7
  buffer_store_dwordx4 v[196:199], v1, s[8:11], s76 offen sc1
  s_branch wb_275
wt_276:
  s_nop 7
  buffer_store_dwordx4 v[200:203], v1, s[8:11], s76 offen sc1
  s_branch wb_277
wt_278:
  s_nop 7
  buffer_store_dwordx4 v[204:207], v1, s[8:11], s76 offen sc1
  s_branch wb_279
wt_281:
  s_nop 7
  buffer_store_dword v18, v1, s[8:11], s23 offen sc1
  s_branch wb_282
wt_287:
  s_nop 7
  buffer_store_dword v18, v1, s[8:11], s23 offen sc1
  s_branch wb_288
wt_292:
  s_nop 7
  buffer_store_dword v18, v1, s[8:11], s23 offen sc1
  s_branch wb_293
wt_294:
  s_nop 7
  buffer_store_dwordx4 v[168:171], v1, s[8:11], s76 offen sc1
  s_branch wb_295
wt_296:
  s_nop 7
  buffer_store_dwordx4 v[172:175], v1, s[8:11], s76 offen sc1
  s_branch wb_297
wt_298:
  s_nop 7
  buffer_store_dwordx4 v[176:179], v1, s[8:11], s76 offen sc1
  s_branch wb_299
wt_300:
  s_nop 7
  buffer_store_dwordx4 v[180:183], v1, s[8:11], s76 offen sc1
  s_branch wb_301
wt_302:
  s_nop 7
  buffer_store_dwordx4 v[184:187], v1, s[8:11], s76 offen sc1
  s_branch wb_303
wt_304:
  s_nop 7
  buffer_store_dwordx4 v[188:191], v1, s[8:11], s76 offen sc1
  s_branch wb_305
wt_306:
  s_nop 7
  buffer_store_dwordx4 v[192:195], v1, s[8:11], s76 offen sc1
  s_branch wb_307
wt_308:
  s_nop 7
  buffer_store_dwordx4 v[196:199], v1, s[8:11], s76 offen sc1
  s_branch wb_309
wt_310:
  s_nop 7
  buffer_store_dwordx4 v[200:203], v1, s[8:11], s76 offen sc1
  s_branch wb_311
wt_312:
  s_nop 7
  buffer_store_dwordx4 v[204:207], v1, s[8:11], s76 offen sc1
  s_branch wb_313
wt_320:
  s_nop 7
  buffer_store_dword v18, v1, s[8:11], s23 offen sc1
  s_branch wb_321
wt_326:
  s_nop 7
  buffer_store_dword v18, v1, s[8:11], s23 offen sc1
  s_branch wb_327
wt_332:
  s_nop 7
  buffer_store_dword v18, v1, s[8:11], s23 offen sc1
  s_branch wb_333
wt_337:
  s_nop 7
  buffer_store_dword v18, v1, s[8:11], s23 offen sc1
  s_branch wb_338
wt_339:
  s_nop 7
  buffer_store_dwordx4 v[168:171], v1, s[8:11], s76 offen sc1
  s_branch wb_340
wt_341:
  s_nop 7
  buffer_store_dwordx4 v[172:175], v1, s[8:11], s76 offen sc1
  s_branch wb_342
wt_343:
  s_nop 7
  buffer_store_dwordx4 v[176:179], v1, s[8:11], s76 offen sc1
  s_branch wb_344
wt_345:
  s_nop 7
  buffer_store_dwordx4 v[180:183], v1, s[8:11], s76 offen sc1
  s_branch wb_346
wt_347:
  s_nop 7
  buffer_store_dwordx4 v[184:187], v1, s[8:11], s76 offen sc1
  s_branch wb_348
wt_349:
  s_nop 7
  buffer_store_dwordx4 v[188:191], v1, s[8:11], s76 offen sc1
  s_branch wb_350
wt_351:
  s_nop 7
  buffer_store_dwordx4 v[192:195], v1, s[8:11], s76 offen sc1
  s_branch wb_352
wt_353:
  s_nop 7
  buffer_store_dwordx4 v[196:199], v1, s[8:11], s76 offen sc1
  s_branch wb_354
wt_355:
  s_nop 7
  buffer_store_dwordx4 v[200:203], v1, s[8:11], s76 offen sc1
  s_branch wb_356
wt_357:
  s_nop 7
  buffer_store_dwordx4 v[204:207], v1, s[8:11], s76 offen sc1
  s_branch wb_358
wt_365:
  s_nop 7
  buffer_store_dword v18, v1, s[8:11], s23 offen sc1
  s_branch wb_366
wt_371:
  s_nop 7
  buffer_store_dword v18, v1, s[8:11], s23 offen sc1
  s_branch wb_372
GO_P1:
ROLE_P1:
  v_lshlrev_b32 v1, 4, v0
  v_mov_b32 v4, 1
  s_cmp_ge_u32 s48, 48
  s_cselect_b32 s51, 1, 0
  s_mul_i32 s60, s51, 48
  s_sub_u32 s52, s48, s60
  s_lshr_b32 s60, s46, 1
  s_sub_u32 s61, s52, 32
  s_lshl1_add_u32 s61, s61, s60
  s_cmp_lt_u32 s52, 32
  s_cselect_b32 s66, s60, 2
  s_cselect_b32 s67, s52, s61
  s_cselect_b32 s54, 0, 65024
  s_lshl2_add_u32 s60, s52, s46
  s_lshl2_add_u32 s54, s60, s54
  s_lshl_b32 s60, s51, 15
  s_add_u32 s54, s54, s60
  s_add_u32 s54, s54, 65536
  s_add_u32 s56, s60, 0
  s_mul_i32 s53, s67, 36864
  s_mul_i32 s60, s66, 12288
  s_add_u32 s53, s53, s60
  s_and_b32 s60, s46, 1
  s_mul_i32 s60, s60, 6144
  s_add_u32 s53, s53, s60
  s_add_u32 s53, s53, 35651584
  s_mul_i32 s58, s46, 11264
  s_mul_i32 s55, s51, 2949120
  s_add_u32 s55, s55, s58
  s_add_u32 s55, s55, 10485760
  s_mul_i32 s60, s51, 16
  s_add_u32 s60, s60, 3
  v_min_u32 v2, s60, v0
  v_lshlrev_b32 v2, 2, v2
  s_lshl_b32 s60, s46, 14
  v_add_u32 v6, s60, v1
  v_bfe_u32 v12, v0, 4, 1
  v_mul_u32_u24 v7, 2560, v12
  v_lshrrev_b32 v12, 5, v0
  v_lshl_add_u32 v7, v12, 7, v7
  v_and_b32 v12, 15, v0
  v_lshl_add_u32 v7, v12, 3, v7
  v_add_u32 v7, 0xa000, v7
  s_mul_i32 s60, s46, 384
  s_add_u32 s60, s60, 157696
  v_and_b32 v9, 48, v0
  v_add_u32 v9, s60, v9
  v_mov_b32 v10, 159232
  s_mov_b64 s[72:73], 0
  s_mov_b32 s70, 0
  s_waitcnt vmcnt(0)
  s_barrier
  s_cmp_lg_u32 s46, 0
  s_cbranch_scc1 arr_373
  v_mov_b32 v12, 1
  s_lshl_b32 s3, s49, 2
  v_mov_b32 v13, s3
  s_mov_b64 exec, 1
  buffer_atomic_add v12, v13, s[12:15], 0 offen sc1
  s_mov_b64 exec, -1
arr_373:
  s_cmp_eq_u32 s51, 0
  s_cbranch_scc1 lt_374
  s_lshl_b32 s3, s49, 2
  v_mov_b32 v13, s3
  s_nop 1
ibw_375:
  buffer_load_dword v12, v13, s[12:15], 0 offen sc1
  s_waitcnt vmcnt(0)
  v_cmp_ne_u32 vcc, 256, v12
  s_nop 0
  s_cbranch_vccz ibw_376
  s_sleep 8
  s_sub_u32 s47, s47, 1
  s_cbranch_scc0 ibw_375
  s_branch ABORT
ibw_376:
  s_cmp_lg_u32 s49, 0
  s_cbranch_scc1 ibok_377
  v_and_b32 v13, 7, v0
  v_lshlrev_b32 v13, 2, v13
  buffer_load_dword v12, v13, s[12:15], 0 offen offset:32 sc1
  s_waitcnt vmcnt(0)
  v_cmp_ne_u32 vcc, 32, v12
  s_nop 0
  s_cbranch_vccz ibok_377
  s_barrier
  s_mov_b32 s49, 1
  s_mov_b32 s3, s2
  s_branch DISPATCH
ibok_377:
  s_mov_b32 s60, 65536
  v_mov_b32 v13, 0
  s_cmp_lg_u32 s46, 0
  s_cbranch_scc1 w0_378
fl_379:
  buffer_load_dword v12, v13, s[8:11], s60 offen sc1
  s_waitcnt vmcnt(0)
  v_cmp_eq_u32 vcc, 0, v12
  s_nop 0
  s_cbranch_vccz fo_380
  s_sleep 32
  s_sub_u32 s47, s47, 1
  s_cbranch_scc0 fl_379
  s_branch ABORT
fo_380:
w0_378:
  s_barrier
lt_374:
  v_add_u32 v16, 0, v0
  v_mul_u32_u24 v17, 2731, v16
  v_lshrrev_b32 v17, 16, v17
  v_mul_u32_u24 v12, 11904, v17
  v_lshl_add_u32 v12, v16, 4, v12
  v_add_u32 v16, 64, v0
  v_mul_u32_u24 v17, 2731, v16
  v_lshrrev_b32 v17, 16, v17
  v_mul_u32_u24 v13, 11904, v17
  v_lshl_add_u32 v13, v16, 4, v13
  v_add_u32 v16, 128, v0
  v_mul_u32_u24 v17, 2731, v16
  v_lshrrev_b32 v17, 16, v17
  v_mul_u32_u24 v14, 11904, v17
  v_lshl_add_u32 v14, v16, 4, v14
  v_lshrrev_b32 v18, 2, v0
  v_mul_u32_u24 v18, 384, v18
  v_and_b32 v19, 3, v0
  v_lshl_add_u32 v18, v19, 3, v18
  s_lshr_b32 s60, s46, 1
  s_mul_i32 s60, s60, 24576
  s_and_b32 s61, s46, 1
  s_mul_i32 s62, s61, 192
  s_add_u32 s60, s60, s62
  v_add_u32 v18, s60, v18
  s_cmp_eq_u32 s66, 0
  s_cselect_b32 s4, s20, s22
  s_cselect_b32 s5, s21, s23
  s_cmp_eq_u32 s66, 2
  s_cselect_b32 s4, s24, s4
  s_cselect_b32 s5, s25, s5
  s_mov_b32 s6, 7864320
  s_mov_b32 s7, 0x20000
  s_mul_i32 s61, s61, 393216
  s_mul_i32 s62, s67, 384
  s_add_u32 s62, s62, s61
  s_mul_i32 s63, s46, 12288
  s_mul_i32 s65, s46, 10240
  s_add_u32 s64, s62, 0
  s_add_u32 m0, s63, 0
  s_nop 0
  buffer_load_dwordx4 v12, s[4:7], s64 offen lds
  s_add_u32 m0, s63, 1024
  s_nop 0
  buffer_load_dwordx4 v13, s[4:7], s64 offen lds
  s_add_u32 m0, s63, 2048
  s_nop 0
  buffer_load_dwordx4 v14, s[4:7], s64 offen lds
  s_add_u32 s64, s62, 98304
  s_add_u32 m0, s63, 3072
  s_nop 0
  buffer_load_dwordx4 v12, s[4:7], s64 offen lds
  s_add_u32 m0, s63, 4096
  s_nop 0
  buffer_load_dwordx4 v13, s[4:7], s64 offen lds
  s_add_u32 m0, s63, 5120
  s_nop 0
  buffer_load_dwordx4 v14, s[4:7], s64 offen lds
  s_add_u32 s64, s62, 196608
  s_add_u32 m0, s63, 6144
  s_nop 0
  buffer_load_dwordx4 v12, s[4:7], s64 offen lds
  s_add_u32 m0, s63, 7168
  s_nop 0
  buffer_load_dwordx4 v13, s[4:7], s64 offen lds
  s_add_u32 m0, s63, 8192
  s_nop 0
  buffer_load_dwordx4 v14, s[4:7], s64 offen lds
  s_add_u32 s64, s62, 294912
  s_add_u32 m0, s63, 9216
  s_nop 0
  buffer_load_dwordx4 v12, s[4:7], s64 offen lds
  s_add_u32 m0, s63, 10240
  s_nop 0
  buffer_load_dwordx4 v13, s[4:7], s64 offen lds
  s_add_u32 m0, s63, 11264
  s_nop 0
  buffer_load_dwordx4 v14, s[4:7], s64 offen lds
  s_add_u32 s64, s62, 786432
  s_add_u32 m0, s63, 49152
  s_nop 0
  buffer_load_dwordx4 v12, s[4:7], s64 offen lds
  s_add_u32 m0, s63, 50176
  s_nop 0
  buffer_load_dwordx4 v13, s[4:7], s64 offen lds
  s_add_u32 m0, s63, 51200
  s_nop 0
  buffer_load_dwordx4 v14, s[4:7], s64 offen lds
  s_add_u32 s64, s62, 884736
  s_add_u32 m0, s63, 52224
  s_nop 0
  buffer_load_dwordx4 v12, s[4:7], s64 offen lds
  s_add_u32 m0, s63, 53248
  s_nop 0
  buffer_load_dwordx4 v13, s[4:7], s64 offen lds
  s_add_u32 m0, s63, 54272
  s_nop 0
  buffer_load_dwordx4 v14, s[4:7], s64 offen lds
  s_add_u32 s64, s62, 983040
  s_add_u32 m0, s63, 55296
  s_nop 0
  buffer_load_dwordx4 v12, s[4:7], s64 offen lds
  s_add_u32 m0, s63, 56320
  s_nop 0
  buffer_load_dwordx4 v13, s[4:7], s64 offen lds
  s_add_u32 m0, s63, 57344
  s_nop 0
  buffer_load_dwordx4 v14, s[4:7], s64 offen lds
  s_add_u32 s64, s62, 1081344
  s_add_u32 m0, s63, 58368
  s_nop 0
  buffer_load_dwordx4 v12, s[4:7], s64 offen lds
  s_add_u32 m0, s63, 59392
  s_nop 0
  buffer_load_dwordx4 v13, s[4:7], s64 offen lds
  s_add_u32 m0, s63, 60416
  s_nop 0
  buffer_load_dwordx4 v14, s[4:7], s64 offen lds
  s_add_u32 s64, s62, 1572864
  s_add_u32 m0, s63, 98304
  s_nop 0
  buffer_load_dwordx4 v12, s[4:7], s64 offen lds
  s_add_u32 m0, s63, 99328
  s_nop 0
  buffer_load_dwordx4 v13, s[4:7], s64 offen lds
  s_add_u32 m0, s63, 100352
  s_nop 0
  buffer_load_dwordx4 v14, s[4:7], s64 offen lds
  s_add_u32 s64, s62, 1671168
  s_add_u32 m0, s63, 101376
  s_nop 0
  buffer_load_dwordx4 v12, s[4:7], s64 offen lds
  s_add_u32 m0, s63, 102400
  s_nop 0
  buffer_load_dwordx4 v13, s[4:7], s64 offen lds
  s_add_u32 m0, s63, 103424
  s_nop 0
  buffer_load_dwordx4 v14, s[4:7], s64 offen lds
  s_add_u32 s64, s62, 1769472
  s_add_u32 m0, s63, 104448
  s_nop 0
  buffer_load_dwordx4 v12, s[4:7], s64 offen lds
  s_add_u32 m0, s63, 105472
  s_nop 0
  buffer_load_dwordx4 v13, s[4:7], s64 offen lds
  s_add_u32 m0, s63, 106496
  s_nop 0
  buffer_load_dwordx4 v14, s[4:7], s64 offen lds
  s_add_u32 s64, s62, 1867776
  s_add_u32 m0, s63, 107520
  s_nop 0
  buffer_load_dwordx4 v12, s[4:7], s64 offen lds
  s_add_u32 m0, s63, 108544
  s_nop 0
  buffer_load_dwordx4 v13, s[4:7], s64 offen lds
  s_add_u32 m0, s63, 109568
  s_nop 0
  buffer_load_dwordx4 v14, s[4:7], s64 offen lds
  s_waitcnt vmcnt(24)
  s_barrier
  v_add_u32 v15, 0, v18
  ds_read_b64_tr_b16 a[0:1], v15 offset:0
  ds_read_b64_tr_b16 a[2:3], v15 offset:6144
  ds_read_b64_tr_b16 a[68:69], v15 offset:32
  ds_read_b64_tr_b16 a[70:71], v15 offset:6176
  ds_read_b64_tr_b16 a[140:141], v15 offset:64
  ds_read_b64_tr_b16 a[142:143], v15 offset:6208
  ds_read_b64_tr_b16 a[208:209], v15 offset:96
  ds_read_b64_tr_b16 a[210:211], v15 offset:6240
  ds_read_b64_tr_b16 v[116:117], v15 offset:128
  ds_read_b64_tr_b16 v[118:119], v15 offset:6272
  ds_read_b64_tr_b16 v[188:189], v15 offset:160
  ds_read_b64_tr_b16 v[190:191], v15 offset:6304
  s_waitcnt lgkmcnt(3)
  ds_read_b64_tr_b16 a[4:5], v15 offset:12288
  ds_read_b64_tr_b16 a[6:7], v15 offset:18432
  ds_read_b64_tr_b16 a[72:73], v15 offset:12320
  ds_read_b64_tr_b16 a[74:75], v15 offset:18464
  ds_read_b64_tr_b16 v[40:41], v15 offset:12352
  ds_read_b64_tr_b16 v[42:43], v15 offset:18496
  ds_read_b64_tr_b16 a[212:213], v15 offset:12384
  ds_read_b64_tr_b16 a[214:215], v15 offset:18528
  ds_read_b64_tr_b16 v[120:121], v15 offset:12416
  ds_read_b64_tr_b16 v[122:123], v15 offset:18560
  ds_read_b64_tr_b16 v[72:73], v15 offset:12448
  ds_read_b64_tr_b16 v[74:75], v15 offset:18592
  s_waitcnt lgkmcnt(3)
  s_waitcnt lgkmcnt(0)
  s_barrier
  s_add_u32 s64, s62, 2359296
  s_add_u32 m0, s63, 0
  s_nop 0
  buffer_load_dwordx4 v12, s[4:7], s64 offen lds
  s_add_u32 m0, s63, 1024
  s_nop 0
  buffer_load_dwordx4 v13, s[4:7], s64 offen lds
  s_add_u32 m0, s63, 2048
  s_nop 0
  buffer_load_dwordx4 v14, s[4:7], s64 offen lds
  s_add_u32 s64, s62, 2457600
  s_add_u32 m0, s63, 3072
  s_nop 0
  buffer_load_dwordx4 v12, s[4:7], s64 offen lds
  s_add_u32 m0, s63, 4096
  s_nop 0
  buffer_load_dwordx4 v13, s[4:7], s64 offen lds
  s_add_u32 m0, s63, 5120
  s_nop 0
  buffer_load_dwordx4 v14, s[4:7], s64 offen lds
  s_add_u32 s64, s62, 2555904
  s_add_u32 m0, s63, 6144
  s_nop 0
  buffer_load_dwordx4 v12, s[4:7], s64 offen lds
  s_add_u32 m0, s63, 7168
  s_nop 0
  buffer_load_dwordx4 v13, s[4:7], s64 offen lds
  s_add_u32 m0, s63, 8192
  s_nop 0
  buffer_load_dwordx4 v14, s[4:7], s64 offen lds
  s_add_u32 s64, s62, 2654208
  s_add_u32 m0, s63, 9216
  s_nop 0
  buffer_load_dwordx4 v12, s[4:7], s64 offen lds
  s_add_u32 m0, s63, 10240
  s_nop 0
  buffer_load_dwordx4 v13, s[4:7], s64 offen lds
  s_add_u32 m0, s63, 11264
  s_nop 0
  buffer_load_dwordx4 v14, s[4:7], s64 offen lds
  s_waitcnt vmcnt(24)
  s_barrier
  v_add_u32 v15, 49152, v18
  ds_read_b64_tr_b16 a[8:9], v15 offset:0
  ds_read_b64_tr_b16 a[10:11], v15 offset:6144
  ds_read_b64_tr_b16 a[76:77], v15 offset:32
  ds_read_b64_tr_b16 a[78:79], v15 offset:6176
  ds_read_b64_tr_b16 a[144:145], v15 offset:64
  ds_read_b64_tr_b16 a[146:147], v15 offset:6208
  ds_read_b64_tr_b16 a[216:217], v15 offset:96
  ds_read_b64_tr_b16 a[218:219], v15 offset:6240
  ds_read_b64_tr_b16 v[124:125], v15 offset:128
  ds_read_b64_tr_b16 v[126:127], v15 offset:6272
  ds_read_b64_tr_b16 v[192:193], v15 offset:160
  ds_read_b64_tr_b16 v[194:195], v15 offset:6304
  s_waitcnt lgkmcnt(3)
  ds_read_b64_tr_b16 v[20:21], v15 offset:12288
  ds_read_b64_tr_b16 v[22:23], v15 offset:18432
  ds_read_b64_tr_b16 a[80:81], v15 offset:12320
  ds_read_b64_tr_b16 a[82:83], v15 offset:18464
  ds_read_b64_tr_b16 a[148:149], v15 offset:12352
  ds_read_b64_tr_b16 a[150:151], v15 offset:18496
  ds_read_b64_tr_b16 v[52:53], v15 offset:12384
  ds_read_b64_tr_b16 v[54:55], v15 offset:18528
  ds_read_b64_tr_b16 v[128:129], v15 offset:12416
  ds_read_b64_tr_b16 v[130:131], v15 offset:18560
  ds_read_b64_tr_b16 v[196:197], v15 offset:12448
  ds_read_b64_tr_b16 v[198:199], v15 offset:18592
  s_waitcnt lgkmcnt(3)
  s_waitcnt lgkmcnt(0)
  s_barrier
  s_add_u32 s64, s62, 3145728
  s_add_u32 m0, s63, 49152
  s_nop 0
  buffer_load_dwordx4 v12, s[4:7], s64 offen lds
  s_add_u32 m0, s63, 50176
  s_nop 0
  buffer_load_dwordx4 v13, s[4:7], s64 offen lds
  s_add_u32 m0, s63, 51200
  s_nop 0
  buffer_load_dwordx4 v14, s[4:7], s64 offen lds
  s_add_u32 s64, s62, 3244032
  s_add_u32 m0, s63, 52224
  s_nop 0
  buffer_load_dwordx4 v12, s[4:7], s64 offen lds
  s_add_u32 m0, s63, 53248
  s_nop 0
  buffer_load_dwordx4 v13, s[4:7], s64 offen lds
  s_add_u32 m0, s63, 54272
  s_nop 0
  buffer_load_dwordx4 v14, s[4:7], s64 offen lds
  s_add_u32 s64, s62, 3342336
  s_add_u32 m0, s63, 55296
  s_nop 0
  buffer_load_dwordx4 v12, s[4:7], s64 offen lds
  s_add_u32 m0, s63, 56320
  s_nop 0
  buffer_load_dwordx4 v13, s[4:7], s64 offen lds
  s_add_u32 m0, s63, 57344
  s_nop 0
  buffer_load_dwordx4 v14, s[4:7], s64 offen lds
  s_add_u32 s64, s62, 3440640
  s_add_u32 m0, s63, 58368
  s_nop 0
  buffer_load_dwordx4 v12, s[4:7], s64 offen lds
  s_add_u32 m0, s63, 59392
  s_nop 0
  buffer_load_dwordx4 v13, s[4:7], s64 offen lds
  s_add_u32 m0, s63, 60416
  s_nop 0
  buffer_load_dwordx4 v14, s[4:7], s64 offen lds
  s_waitcnt vmcnt(24)
  s_barrier
  v_add_u32 v15, 98304, v18
  ds_read_b64_tr_b16 a[12:13], v15 offset:0
  ds_read_b64_tr_b16 a[14:15], v15 offset:6144
  ds_read_b64_tr_b16 a[84:85], v15 offset:32
  ds_read_b64_tr_b16 a[86:87], v15 offset:6176
  ds_read_b64_tr_b16 a[152:153], v15 offset:64
  ds_read_b64_tr_b16 a[154:155], v15 offset:6208
  ds_read_b64_tr_b16 a[220:221], v15 offset:96
  ds_read_b64_tr_b16 a[222:223], v15 offset:6240
  ds_read_b64_tr_b16 v[132:133], v15 offset:128
  ds_read_b64_tr_b16 v[134:135], v15 offset:6272
  ds_read_b64_tr_b16 v[200:201], v15 offset:160
  ds_read_b64_tr_b16 v[202:203], v15 offset:6304
  s_waitcnt lgkmcnt(3)
  ds_read_b64_tr_b16 a[16:17], v15 offset:12288
  ds_read_b64_tr_b16 a[18:19], v15 offset:18432
  ds_read_b64_tr_b16 a[88:89], v15 offset:12320
  ds_read_b64_tr_b16 a[90:91], v15 offset:18464
  ds_read_b64_tr_b16 a[156:157], v15 offset:12352
  ds_read_b64_tr_b16 a[158:159], v15 offset:18496
  ds_read_b64_tr_b16 a[224:225], v15 offset:12384
  ds_read_b64_tr_b16 a[226:227], v15 offset:18528
  ds_read_b64_tr_b16 v[136:137], v15 offset:12416
  ds_read_b64_tr_b16 v[138:139], v15 offset:18560
  ds_read_b64_tr_b16 v[204:205], v15 offset:12448
  ds_read_b64_tr_b16 v[206:207], v15 offset:18592
  s_waitcnt lgkmcnt(3)
  s_waitcnt lgkmcnt(0)
  s_barrier
  s_add_u32 s64, s62, 3932160
  s_add_u32 m0, s63, 98304
  s_nop 0
  buffer_load_dwordx4 v12, s[4:7], s64 offen lds
  s_add_u32 m0, s63, 99328
  s_nop 0
  buffer_load_dwordx4 v13, s[4:7], s64 offen lds
  s_add_u32 m0, s63, 100352
  s_nop 0
  buffer_load_dwordx4 v14, s[4:7], s64 offen lds
  s_add_u32 s64, s62, 4030464
  s_add_u32 m0, s63, 101376
  s_nop 0
  buffer_load_dwordx4 v12, s[4:7], s64 offen lds
  s_add_u32 m0, s63, 102400
  s_nop 0
  buffer_load_dwordx4 v13, s[4:7], s64 offen lds
  s_add_u32 m0, s63, 103424
  s_nop 0
  buffer_load_dwordx4 v14, s[4:7], s64 offen lds
  s_add_u32 s64, s62, 4128768
  s_add_u32 m0, s63, 104448
  s_nop 0
  buffer_load_dwordx4 v12, s[4:7], s64 offen lds
  s_add_u32 m0, s63, 105472
  s_nop 0
  buffer_load_dwordx4 v13, s[4:7], s64 offen lds
  s_add_u32 m0, s63, 106496
  s_nop 0
  buffer_load_dwordx4 v14, s[4:7], s64 offen lds
  s_add_u32 s64, s62, 4227072
  s_add_u32 m0, s63, 107520
  s_nop 0
  buffer_load_dwordx4 v12, s[4:7], s64 offen lds
  s_add_u32 m0, s63, 108544
  s_nop 0
  buffer_load_dwordx4 v13, s[4:7], s64 offen lds
  s_add_u32 m0, s63, 109568
  s_nop 0
  buffer_load_dwordx4 v14, s[4:7], s64 offen lds
  s_waitcnt vmcnt(24)
  s_barrier
  v_add_u32 v15, 0, v18
  ds_read_b64_tr_b16 a[20:21], v15 offset:0
  ds_read_b64_tr_b16 a[22:23], v15 offset:6144
  ds_read_b64_tr_b16 v[32:33], v15 offset:32
  ds_read_b64_tr_b16 v[34:35], v15 offset:6176
  ds_read_b64_tr_b16 a[160:161], v15 offset:64
  ds_read_b64_tr_b16 a[162:163], v15 offset:6208
  ds_read_b64_tr_b16 a[228:229], v15 offset:96
  ds_read_b64_tr_b16 a[230:231], v15 offset:6240
  ds_read_b64_tr_b16 v[64:65], v15 offset:128
  ds_read_b64_tr_b16 v[66:67], v15 offset:6272
  ds_read_b64_tr_b16 v[208:209], v15 offset:160
  ds_read_b64_tr_b16 v[210:211], v15 offset:6304
  s_waitcnt lgkmcnt(3)
  ds_read_b64_tr_b16 a[24:25], v15 offset:12288
  ds_read_b64_tr_b16 a[26:27], v15 offset:18432
  ds_read_b64_tr_b16 a[92:93], v15 offset:12320
  ds_read_b64_tr_b16 a[94:95], v15 offset:18464
  ds_read_b64_tr_b16 a[164:165], v15 offset:12352
  ds_read_b64_tr_b16 a[166:167], v15 offset:18496
  ds_read_b64_tr_b16 a[232:233], v15 offset:12384
  ds_read_b64_tr_b16 a[234:235], v15 offset:18528
  ds_read_b64_tr_b16 v[140:141], v15 offset:12416
  ds_read_b64_tr_b16 v[142:143], v15 offset:18560
  ds_read_b64_tr_b16 v[212:213], v15 offset:12448
  ds_read_b64_tr_b16 v[214:215], v15 offset:18592
  s_waitcnt lgkmcnt(3)
  s_waitcnt lgkmcnt(0)
  s_barrier
  s_add_u32 s64, s62, 4718592
  s_add_u32 m0, s63, 0
  s_nop 0
  buffer_load_dwordx4 v12, s[4:7], s64 offen lds
  s_add_u32 m0, s63, 1024
  s_nop 0
  buffer_load_dwordx4 v13, s[4:7], s64 offen lds
  s_add_u32 m0, s63, 2048
  s_nop 0
  buffer_load_dwordx4 v14, s[4:7], s64 offen lds
  s_add_u32 s64, s62, 4816896
  s_add_u32 m0, s63, 3072
  s_nop 0
  buffer_load_dwordx4 v12, s[4:7], s64 offen lds
  s_add_u32 m0, s63, 4096
  s_nop 0
  buffer_load_dwordx4 v13, s[4:7], s64 offen lds
  s_add_u32 m0, s63, 5120
  s_nop 0
  buffer_load_dwordx4 v14, s[4:7], s64 offen lds
  s_add_u32 s64, s62, 4915200
  s_add_u32 m0, s63, 6144
  s_nop 0
  buffer_load_dwordx4 v12, s[4:7], s64 offen lds
  s_add_u32 m0, s63, 7168
  s_nop 0
  buffer_load_dwordx4 v13, s[4:7], s64 offen lds
  s_add_u32 m0, s63, 8192
  s_nop 0
  buffer_load_dwordx4 v14, s[4:7], s64 offen lds
  s_add_u32 s64, s62, 5013504
  s_add_u32 m0, s63, 9216
  s_nop 0
  buffer_load_dwordx4 v12, s[4:7], s64 offen lds
  s_add_u32 m0, s63, 10240
  s_nop 0
  buffer_load_dwordx4 v13, s[4:7], s64 offen lds
  s_add_u32 m0, s63, 11264
  s_nop 0
  buffer_load_dwordx4 v14, s[4:7], s64 offen lds
  s_waitcnt vmcnt(24)
  s_barrier
  v_add_u32 v15, 49152, v18
  ds_read_b64_tr_b16 a[28:29], v15 offset:0
  ds_read_b64_tr_b16 a[30:31], v15 offset:6144
  ds_read_b64_tr_b16 a[96:97], v15 offset:32
  ds_read_b64_tr_b16 a[98:99], v15 offset:6176
  ds_read_b64_tr_b16 v[44:45], v15 offset:64
  ds_read_b64_tr_b16 v[46:47], v15 offset:6208
  ds_read_b64_tr_b16 a[236:237], v15 offset:96
  ds_read_b64_tr_b16 a[238:239], v15 offset:6240
  ds_read_b64_tr_b16 v[144:145], v15 offset:128
  ds_read_b64_tr_b16 v[146:147], v15 offset:6272
  ds_read_b64_tr_b16 v[76:77], v15 offset:160
  ds_read_b64_tr_b16 v[78:79], v15 offset:6304
  s_waitcnt lgkmcnt(3)
  ds_read_b64_tr_b16 a[32:33], v15 offset:12288
  ds_read_b64_tr_b16 a[34:35], v15 offset:18432
  ds_read_b64_tr_b16 a[100:101], v15 offset:12320
  ds_read_b64_tr_b16 a[102:103], v15 offset:18464
  ds_read_b64_tr_b16 a[168:169], v15 offset:12352
  ds_read_b64_tr_b16 a[170:171], v15 offset:18496
  ds_read_b64_tr_b16 a[240:241], v15 offset:12384
  ds_read_b64_tr_b16 a[242:243], v15 offset:18528
  ds_read_b64_tr_b16 v[148:149], v15 offset:12416
  ds_read_b64_tr_b16 v[150:151], v15 offset:18560
  ds_read_b64_tr_b16 v[216:217], v15 offset:12448
  ds_read_b64_tr_b16 v[218:219], v15 offset:18592
  s_waitcnt lgkmcnt(3)
  s_waitcnt lgkmcnt(0)
  s_barrier
  s_add_u32 s64, s62, 5505024
  s_add_u32 m0, s63, 49152
  s_nop 0
  buffer_load_dwordx4 v12, s[4:7], s64 offen lds
  s_add_u32 m0, s63, 50176
  s_nop 0
  buffer_load_dwordx4 v13, s[4:7], s64 offen lds
  s_add_u32 m0, s63, 51200
  s_nop 0
  buffer_load_dwordx4 v14, s[4:7], s64 offen lds
  s_add_u32 s64, s62, 5603328
  s_add_u32 m0, s63, 52224
  s_nop 0
  buffer_load_dwordx4 v12, s[4:7], s64 offen lds
  s_add_u32 m0, s63, 53248
  s_nop 0
  buffer_load_dwordx4 v13, s[4:7], s64 offen lds
  s_add_u32 m0, s63, 54272
  s_nop 0
  buffer_load_dwordx4 v14, s[4:7], s64 offen lds
  s_add_u32 s64, s62, 5701632
  s_add_u32 m0, s63, 55296
  s_nop 0
  buffer_load_dwordx4 v12, s[4:7], s64 offen lds
  s_add_u32 m0, s63, 56320
  s_nop 0
  buffer_load_dwordx4 v13, s[4:7], s64 offen lds
  s_add_u32 m0, s63, 57344
  s_nop 0
  buffer_load_dwordx4 v14, s[4:7], s64 offen lds
  s_add_u32 s64, s62, 5799936
  s_add_u32 m0, s63, 58368
  s_nop 0
  buffer_load_dwordx4 v12, s[4:7], s64 offen lds
  s_add_u32 m0, s63, 59392
  s_nop 0
  buffer_load_dwordx4 v13, s[4:7], s64 offen lds
  s_add_u32 m0, s63, 60416
  s_nop 0
  buffer_load_dwordx4 v14, s[4:7], s64 offen lds
  s_waitcnt vmcnt(24)
  s_barrier
  v_add_u32 v15, 98304, v18
  ds_read_b64_tr_b16 a[36:37], v15 offset:0
  ds_read_b64_tr_b16 a[38:39], v15 offset:6144
  ds_read_b64_tr_b16 a[104:105], v15 offset:32
  ds_read_b64_tr_b16 a[106:107], v15 offset:6176
  ds_read_b64_tr_b16 a[172:173], v15 offset:64
  ds_read_b64_tr_b16 a[174:175], v15 offset:6208
  ds_read_b64_tr_b16 a[244:245], v15 offset:96
  ds_read_b64_tr_b16 a[246:247], v15 offset:6240
  ds_read_b64_tr_b16 v[152:153], v15 offset:128
  ds_read_b64_tr_b16 v[154:155], v15 offset:6272
  ds_read_b64_tr_b16 v[220:221], v15 offset:160
  ds_read_b64_tr_b16 v[222:223], v15 offset:6304
  s_waitcnt lgkmcnt(3)
  ds_read_b64_tr_b16 v[24:25], v15 offset:12288
  ds_read_b64_tr_b16 v[26:27], v15 offset:18432
  ds_read_b64_tr_b16 a[108:109], v15 offset:12320
  ds_read_b64_tr_b16 a[110:111], v15 offset:18464
  ds_read_b64_tr_b16 a[176:177], v15 offset:12352
  ds_read_b64_tr_b16 a[178:179], v15 offset:18496
  ds_read_b64_tr_b16 v[56:57], v15 offset:12384
  ds_read_b64_tr_b16 v[58:59], v15 offset:18528
  ds_read_b64_tr_b16 v[156:157], v15 offset:12416
  ds_read_b64_tr_b16 v[158:159], v15 offset:18560
  ds_read_b64_tr_b16 v[224:225], v15 offset:12448
  ds_read_b64_tr_b16 v[226:227], v15 offset:18592
  s_waitcnt lgkmcnt(3)
  s_waitcnt lgkmcnt(0)
  s_barrier
  s_add_u32 s64, s62, 6291456
  s_add_u32 m0, s63, 98304
  s_nop 0
  buffer_load_dwordx4 v12, s[4:7], s64 offen lds
  s_add_u32 m0, s63, 99328
  s_nop 0
  buffer_load_dwordx4 v13, s[4:7], s64 offen lds
  s_add_u32 m0, s63, 100352
  s_nop 0
  buffer_load_dwordx4 v14, s[4:7], s64 offen lds
  s_add_u32 s64, s62, 6389760
  s_add_u32 m0, s63, 101376
  s_nop 0
  buffer_load_dwordx4 v12, s[4:7], s64 offen lds
  s_add_u32 m0, s63, 102400
  s_nop 0
  buffer_load_dwordx4 v13, s[4:7], s64 offen lds
  s_add_u32 m0, s63, 103424
  s_nop 0
  buffer_load_dwordx4 v14, s[4:7], s64 offen lds
  s_add_u32 s64, s62, 6488064
  s_add_u32 m0, s63, 104448
  s_nop 0
  buffer_load_dwordx4 v12, s[4:7], s64 offen lds
  s_add_u32 m0, s63, 105472
  s_nop 0
  buffer_load_dwordx4 v13, s[4:7], s64 offen lds
  s_add_u32 m0, s63, 106496
  s_nop 0
  buffer_load_dwordx4 v14, s[4:7], s64 offen lds
  s_add_u32 s64, s62, 6586368
  s_add_u32 m0, s63, 107520
  s_nop 0
  buffer_load_dwordx4 v12, s[4:7], s64 offen lds
  s_add_u32 m0, s63, 108544
  s_nop 0
  buffer_load_dwordx4 v13, s[4:7], s64 offen lds
  s_add_u32 m0, s63, 109568
  s_nop 0
  buffer_load_dwordx4 v14, s[4:7], s64 offen lds
  s_waitcnt vmcnt(24)
  s_barrier
  v_add_u32 v15, 0, v18
  ds_read_b64_tr_b16 a[40:41], v15 offset:0
  ds_read_b64_tr_b16 a[42:43], v15 offset:6144
  ds_read_b64_tr_b16 a[112:113], v15 offset:32
  ds_read_b64_tr_b16 a[114:115], v15 offset:6176
  ds_read_b64_tr_b16 a[180:181], v15 offset:64
  ds_read_b64_tr_b16 a[182:183], v15 offset:6208
  ds_read_b64_tr_b16 a[248:249], v15 offset:96
  ds_read_b64_tr_b16 a[250:251], v15 offset:6240
  ds_read_b64_tr_b16 v[160:161], v15 offset:128
  ds_read_b64_tr_b16 v[162:163], v15 offset:6272
  ds_read_b64_tr_b16 v[228:229], v15 offset:160
  ds_read_b64_tr_b16 v[230:231], v15 offset:6304
  s_waitcnt lgkmcnt(3)
  ds_read_b64_tr_b16 a[44:45], v15 offset:12288
  ds_read_b64_tr_b16 a[46:47], v15 offset:18432
  ds_read_b64_tr_b16 v[36:37], v15 offset:12320
  ds_read_b64_tr_b16 v[38:39], v15 offset:18464
  ds_read_b64_tr_b16 a[184:185], v15 offset:12352
  ds_read_b64_tr_b16 a[186:187], v15 offset:18496
  ds_read_b64_tr_b16 a[252:253], v15 offset:12384
  ds_read_b64_tr_b16 a[254:255], v15 offset:18528
  ds_read_b64_tr_b16 v[68:69], v15 offset:12416
  ds_read_b64_tr_b16 v[70:71], v15 offset:18560
  ds_read_b64_tr_b16 v[232:233], v15 offset:12448
  ds_read_b64_tr_b16 v[234:235], v15 offset:18592
  s_waitcnt lgkmcnt(3)
  s_waitcnt lgkmcnt(0)
  s_barrier
  s_add_u32 s64, s62, 7077888
  s_add_u32 m0, s63, 0
  s_nop 0
  buffer_load_dwordx4 v12, s[4:7], s64 offen lds
  s_add_u32 m0, s63, 1024
  s_nop 0
  buffer_load_dwordx4 v13, s[4:7], s64 offen lds
  s_add_u32 m0, s63, 2048
  s_nop 0
  buffer_load_dwordx4 v14, s[4:7], s64 offen lds
  s_add_u32 s64, s62, 7176192
  s_add_u32 m0, s63, 3072
  s_nop 0
  buffer_load_dwordx4 v12, s[4:7], s64 offen lds
  s_add_u32 m0, s63, 4096
  s_nop 0
  buffer_load_dwordx4 v13, s[4:7], s64 offen lds
  s_add_u32 m0, s63, 5120
  s_nop 0
  buffer_load_dwordx4 v14, s[4:7], s64 offen lds
  s_add_u32 s64, s62, 7274496
  s_add_u32 m0, s63, 6144
  s_nop 0
  buffer_load_dwordx4 v12, s[4:7], s64 offen lds
  s_add_u32 m0, s63, 7168
  s_nop 0
  buffer_load_dwordx4 v13, s[4:7], s64 offen lds
  s_add_u32 m0, s63, 8192
  s_nop 0
  buffer_load_dwordx4 v14, s[4:7], s64 offen lds
  s_add_u32 s64, s62, 7372800
  s_add_u32 m0, s63, 9216
  s_nop 0
  buffer_load_dwordx4 v12, s[4:7], s64 offen lds
  s_add_u32 m0, s63, 10240
  s_nop 0
  buffer_load_dwordx4 v13, s[4:7], s64 offen lds
  s_add_u32 m0, s63, 11264
  s_nop 0
  buffer_load_dwordx4 v14, s[4:7], s64 offen lds
  s_waitcnt vmcnt(24)
  s_barrier
  v_add_u32 v15, 49152, v18
  ds_read_b64_tr_b16 a[48:49], v15 offset:0
  ds_read_b64_tr_b16 a[50:51], v15 offset:6144
  ds_read_b64_tr_b16 a[116:117], v15 offset:32
  ds_read_b64_tr_b16 a[118:119], v15 offset:6176
  ds_read_b64_tr_b16 a[188:189], v15 offset:64
  ds_read_b64_tr_b16 a[190:191], v15 offset:6208
  ds_read_b64_tr_b16 v[96:97], v15 offset:96
  ds_read_b64_tr_b16 v[98:99], v15 offset:6240
  ds_read_b64_tr_b16 v[164:165], v15 offset:128
  ds_read_b64_tr_b16 v[166:167], v15 offset:6272
  ds_read_b64_tr_b16 v[236:237], v15 offset:160
  ds_read_b64_tr_b16 v[238:239], v15 offset:6304
  s_waitcnt lgkmcnt(3)
  ds_read_b64_tr_b16 a[52:53], v15 offset:12288
  ds_read_b64_tr_b16 a[54:55], v15 offset:18432
  ds_read_b64_tr_b16 a[120:121], v15 offset:12320
  ds_read_b64_tr_b16 a[122:123], v15 offset:18464
  ds_read_b64_tr_b16 a[192:193], v15 offset:12352
  ds_read_b64_tr_b16 a[194:195], v15 offset:18496
  ds_read_b64_tr_b16 v[100:101], v15 offset:12384
  ds_read_b64_tr_b16 v[102:103], v15 offset:18528
  ds_read_b64_tr_b16 v[168:169], v15 offset:12416
  ds_read_b64_tr_b16 v[170:171], v15 offset:18560
  ds_read_b64_tr_b16 v[240:241], v15 offset:12448
  ds_read_b64_tr_b16 v[242:243], v15 offset:18592
  s_waitcnt lgkmcnt(3)
  s_waitcnt lgkmcnt(0)
  s_barrier
  s_waitcnt vmcnt(12)
  s_barrier
  v_add_u32 v15, 98304, v18
  ds_read_b64_tr_b16 a[56:57], v15 offset:0
  ds_read_b64_tr_b16 a[58:59], v15 offset:6144
  ds_read_b64_tr_b16 a[124:125], v15 offset:32
  ds_read_b64_tr_b16 a[126:127], v15 offset:6176
  ds_read_b64_tr_b16 v[48:49], v15 offset:64
  ds_read_b64_tr_b16 v[50:51], v15 offset:6208
  ds_read_b64_tr_b16 v[104:105], v15 offset:96
  ds_read_b64_tr_b16 v[106:107], v15 offset:6240
  ds_read_b64_tr_b16 v[172:173], v15 offset:128
  ds_read_b64_tr_b16 v[174:175], v15 offset:6272
  ds_read_b64_tr_b16 v[80:81], v15 offset:160
  ds_read_b64_tr_b16 v[82:83], v15 offset:6304
  s_waitcnt lgkmcnt(3)
  ds_read_b64_tr_b16 a[60:61], v15 offset:12288
  ds_read_b64_tr_b16 a[62:63], v15 offset:18432
  ds_read_b64_tr_b16 a[128:129], v15 offset:12320
  ds_read_b64_tr_b16 a[130:131], v15 offset:18464
  ds_read_b64_tr_b16 a[196:197], v15 offset:12352
  ds_read_b64_tr_b16 a[198:199], v15 offset:18496
  ds_read_b64_tr_b16 v[108:109], v15 offset:12384
  ds_read_b64_tr_b16 v[110:111], v15 offset:18528
  ds_read_b64_tr_b16 v[176:177], v15 offset:12416
  ds_read_b64_tr_b16 v[178:179], v15 offset:18560
  ds_read_b64_tr_b16 v[244:245], v15 offset:12448
  ds_read_b64_tr_b16 v[246:247], v15 offset:18592
  s_waitcnt lgkmcnt(3)
  s_waitcnt lgkmcnt(0)
  s_barrier
  s_waitcnt vmcnt(0)
  s_barrier
  v_add_u32 v15, 0, v18
  ds_read_b64_tr_b16 v[28:29], v15 offset:0
  ds_read_b64_tr_b16 v[30:31], v15 offset:6144
  ds_read_b64_tr_b16 a[132:133], v15 offset:32
  ds_read_b64_tr_b16 a[134:135], v15 offset:6176
  ds_read_b64_tr_b16 a[200:201], v15 offset:64
  ds_read_b64_tr_b16 a[202:203], v15 offset:6208
  ds_read_b64_tr_b16 v[60:61], v15 offset:96
  ds_read_b64_tr_b16 v[62:63], v15 offset:6240
  ds_read_b64_tr_b16 v[180:181], v15 offset:128
  ds_read_b64_tr_b16 v[182:183], v15 offset:6272
  ds_read_b64_tr_b16 v[248:249], v15 offset:160
  ds_read_b64_tr_b16 v[250:251], v15 offset:6304
  s_waitcnt lgkmcnt(3)
  ds_read_b64_tr_b16 a[64:65], v15 offset:12288
  ds_read_b64_tr_b16 a[66:67], v15 offset:18432
  ds_read_b64_tr_b16 a[136:137], v15 offset:12320
  ds_read_b64_tr_b16 a[138:139], v15 offset:18464
  ds_read_b64_tr_b16 a[204:205], v15 offset:12352
  ds_read_b64_tr_b16 a[206:207], v15 offset:18496
  ds_read_b64_tr_b16 v[112:113], v15 offset:12384
  ds_read_b64_tr_b16 v[114:115], v15 offset:18528
  ds_read_b64_tr_b16 v[184:185], v15 offset:12416
  ds_read_b64_tr_b16 v[186:187], v15 offset:18560
  ds_read_b64_tr_b16 v[252:253], v15 offset:12448
  ds_read_b64_tr_b16 v[254:255], v15 offset:18592
  s_waitcnt lgkmcnt(3)
  s_waitcnt lgkmcnt(0)
  s_barrier
  ds_write_b128 v6, v[20:23] offset:0
  ds_write_b128 v6, v[24:27] offset:1024
  ds_write_b128 v6, v[28:31] offset:2048
  ds_write_b128 v6, v[32:35] offset:3072
  ds_write_b128 v6, v[36:39] offset:4096
  ds_write_b128 v6, v[40:43] offset:5120
  ds_write_b128 v6, v[44:47] offset:6144
  ds_write_b128 v6, v[48:51] offset:7168
  s_waitcnt lgkmcnt(2)
  ds_write_b128 v6, v[52:55] offset:8192
  ds_write_b128 v6, v[56:59] offset:9216
  ds_write_b128 v6, v[60:63] offset:10240
  ds_write_b128 v6, v[64:67] offset:11264
  ds_write_b128 v6, v[68:71] offset:12288
  ds_write_b128 v6, v[72:75] offset:13312
  ds_write_b128 v6, v[76:79] offset:14336
  ds_write_b128 v6, v[80:83] offset:15360
  s_waitcnt lgkmcnt(2)
  v_mov_b32 v12, 0x3f803f80
  v_mov_b32 v13, 0x3f803f80
  v_mov_b32 v14, 0x3f803f80
  v_mov_b32 v15, 0x3f803f80
  s_nop 1
  v_mfma_f32_16x16x32_bf16 v[84:87], a[0:3], v[12:15], 0
  v_mfma_f32_16x16x32_bf16 v[84:87], a[4:7], v[12:15], v[84:87]
  v_mfma_f32_16x16x32_bf16 v[84:87], a[8:11], v[12:15], v[84:87]
  v_mfma_f32_16x16x32_bf16 v[84:87], v[20:23], v[12:15], v[84:87]
  v_mfma_f32_16x16x32_bf16 v[84:87], a[12:15], v[12:15], v[84:87]
  v_mfma_f32_16x16x32_bf16 v[84:87], a[16:19], v[12:15], v[84:87]
  v_mfma_f32_16x16x32_bf16 v[84:87], a[20:23], v[12:15], v[84:87]
  v_mfma_f32_16x16x32_bf16 v[84:87], a[24:27], v[12:15], v[84:87]
  v_mfma_f32_16x16x32_bf16 v[84:87], a[28:31], v[12:15], v[84:87]
  v_mfma_f32_16x16x32_bf16 v[84:87], a[32:35], v[12:15], v[84:87]
  v_mfma_f32_16x16x32_bf16 v[84:87], a[36:39], v[12:15], v[84:87]
  v_mfma_f32_16x16x32_bf16 v[84:87], v[24:27], v[12:15], v[84:87]
  v_mfma_f32_16x16x32_bf16 v[84:87], a[40:43], v[12:15], v[84:87]
  v_mfma_f32_16x16x32_bf16 v[84:87], a[44:47], v[12:15], v[84:87]
  v_mfma_f32_16x16x32_bf16 v[84:87], a[48:51], v[12:15], v[84:87]
  v_mfma_f32_16x16x32_bf16 v[84:87], a[52:55], v[12:15], v[84:87]
  v_mfma_f32_16x16x32_bf16 v[84:87], a[56:59], v[12:15], v[84:87]
  v_mfma_f32_16x16x32_bf16 v[84:87], a[60:63], v[12:15], v[84:87]
  v_mfma_f32_16x16x32_bf16 v[84:87], v[28:31], v[12:15], v[84:87]
  v_mfma_f32_16x16x32_bf16 v[84:87], a[64:67], v[12:15], v[84:87]
  s_nop 7
  ds_write_b128 v9, v[84:87] offset:0
  v_mfma_f32_16x16x32_bf16 v[88:91], a[68:71], v[12:15], 0
  v_mfma_f32_16x16x32_bf16 v[88:91], a[72:75], v[12:15], v[88:91]
  v_mfma_f32_16x16x32_bf16 v[88:91], a[76:79], v[12:15], v[88:91]
  v_mfma_f32_16x16x32_bf16 v[88:91], a[80:83], v[12:15], v[88:91]
  v_mfma_f32_16x16x32_bf16 v[88:91], a[84:87], v[12:15], v[88:91]
  v_mfma_f32_16x16x32_bf16 v[88:91], a[88:91], v[12:15], v[88:91]
  v_mfma_f32_16x16x32_bf16 v[88:91], v[32:35], v[12:15], v[88:91]
  v_mfma_f32_16x16x32_bf16 v[88:91], a[92:95], v[12:15], v[88:91]
  v_mfma_f32_16x16x32_bf16 v[88:91], a[96:99], v[12:15], v[88:91]
  v_mfma_f32_16x16x32_bf16 v[88:91], a[100:103], v[12:15], v[88:91]
  v_mfma_f32_16x16x32_bf16 v[88:91], a[104:107], v[12:15], v[88:91]
  v_mfma_f32_16x16x32_bf16 v[88:91], a[108:111], v[12:15], v[88:91]
  v_mfma_f32_16x16x32_bf16 v[88:91], a[112:115], v[12:15], v[88:91]
  v_mfma_f32_16x16x32_bf16 v[88:91], v[36:39], v[12:15], v[88:91]
  v_mfma_f32_16x16x32_bf16 v[88:91], a[116:119], v[12:15], v[88:91]
  v_mfma_f32_16x16x32_bf16 v[88:91], a[120:123], v[12:15], v[88:91]
  v_mfma_f32_16x16x32_bf16 v[88:91], a[124:127], v[12:15], v[88:91]
  v_mfma_f32_16x16x32_bf16 v[88:91], a[128:131], v[12:15], v[88:91]
  v_mfma_f32_16x16x32_bf16 v[88:91], a[132:135], v[12:15], v[88:91]
  v_mfma_f32_16x16x32_bf16 v[88:91], a[136:139], v[12:15], v[88:91]
  s_nop 7
  ds_write_b128 v9, v[88:91] offset:64
  v_mfma_f32_16x16x32_bf16 v[92:95], a[140:143], v[12:15], 0
  v_mfma_f32_16x16x32_bf16 v[92:95], v[40:43], v[12:15], v[92:95]
  v_mfma_f32_16x16x32_bf16 v[92:95], a[144:147], v[12:15], v[92:95]
  v_mfma_f32_16x16x32_bf16 v[92:95], a[148:151], v[12:15], v[92:95]
  v_mfma_f32_16x16x32_bf16 v[92:95], a[152:155], v[12:15], v[92:95]
  v_mfma_f32_16x16x32_bf16 v[92:95], a[156:159], v[12:15], v[92:95]
  v_mfma_f32_16x16x32_bf16 v[92:95], a[160:163], v[12:15], v[92:95]
  v_mfma_f32_16x16x32_bf16 v[92:95], a[164:167], v[12:15], v[92:95]
  v_mfma_f32_16x16x32_bf16 v[92:95], v[44:47], v[12:15], v[92:95]
  v_mfma_f32_16x16x32_bf16 v[92:95], a[168:171], v[12:15], v[92:95]
  v_mfma_f32_16x16x32_bf16 v[92:95], a[172:175], v[12:15], v[92:95]
  v_mfma_f32_16x16x32_bf16 v[92:95], a[176:179], v[12:15], v[92:95]
  v_mfma_f32_16x16x32_bf16 v[92:95], a[180:183], v[12:15], v[92:95]
  v_mfma_f32_16x16x32_bf16 v[92:95], a[184:187], v[12:15], v[92:95]
  v_mfma_f32_16x16x32_bf16 v[92:95], a[188:191], v[12:15], v[92:95]
  v_mfma_f32_16x16x32_bf16 v[92:95], a[192:195], v[12:15], v[92:95]
  v_mfma_f32_16x16x32_bf16 v[92:95], v[48:51], v[12:15], v[92:95]
  v_mfma_f32_16x16x32_bf16 v[92:95], a[196:199], v[12:15], v[92:95]
  v_mfma_f32_16x16x32_bf16 v[92:95], a[200:203], v[12:15], v[92:95]
  v_mfma_f32_16x16x32_bf16 v[92:95], a[204:207], v[12:15], v[92:95]
  s_nop 7
  ds_write_b128 v9, v[92:95] offset:128
  v_mfma_f32_16x16x32_bf16 v[84:87], a[208:211], v[12:15], 0
  v_mfma_f32_16x16x32_bf16 v[84:87], a[212:215], v[12:15], v[84:87]
  v_mfma_f32_16x16x32_bf16 v[84:87], a[216:219], v[12:15], v[84:87]
  v_mfma_f32_16x16x32_bf16 v[84:87], v[52:55], v[12:15], v[84:87]
  v_mfma_f32_16x16x32_bf16 v[84:87], a[220:223], v[12:15], v[84:87]
  v_mfma_f32_16x16x32_bf16 v[84:87], a[224:227], v[12:15], v[84:87]
  v_mfma_f32_16x16x32_bf16 v[84:87], a[228:231], v[12:15], v[84:87]
  v_mfma_f32_16x16x32_bf16 v[84:87], a[232:235], v[12:15], v[84:87]
  v_mfma_f32_16x16x32_bf16 v[84:87], a[236:239], v[12:15], v[84:87]
  v_mfma_f32_16x16x32_bf16 v[84:87], a[240:243], v[12:15], v[84:87]
  v_mfma_f32_16x16x32_bf16 v[84:87], a[244:247], v[12:15], v[84:87]
  v_mfma_f32_16x16x32_bf16 v[84:87], v[56:59], v[12:15], v[84:87]
  v_mfma_f32_16x16x32_bf16 v[84:87], a[248:251], v[12:15], v[84:87]
  v_mfma_f32_16x16x32_bf16 v[84:87], a[252:255], v[12:15], v[84:87]
  v_mfma_f32_16x16x32_bf16 v[84:87], v[96:99], v[12:15], v[84:87]
  v_mfma_f32_16x16x32_bf16 v[84:87], v[100:103], v[12:15], v[84:87]
  v_mfma_f32_16x16x32_bf16 v[84:87], v[104:107], v[12:15], v[84:87]
  v_mfma_f32_16x16x32_bf16 v[84:87], v[108:111], v[12:15], v[84:87]
  v_mfma_f32_16x16x32_bf16 v[84:87], v[60:63], v[12:15], v[84:87]
  v_mfma_f32_16x16x32_bf16 v[84:87], v[112:115], v[12:15], v[84:87]
  s_nop 7
  ds_write_b128 v9, v[84:87] offset:192
  v_mfma_f32_16x16x32_bf16 v[88:91], v[116:119], v[12:15], 0
  v_mfma_f32_16x16x32_bf16 v[88:91], v[120:123], v[12:15], v[88:91]
  v_mfma_f32_16x16x32_bf16 v[88:91], v[124:127], v[12:15], v[88:91]
  v_mfma_f32_16x16x32_bf16 v[88:91], v[128:131], v[12:15], v[88:91]
  v_mfma_f32_16x16x32_bf16 v[88:91], v[132:135], v[12:15], v[88:91]
  v_mfma_f32_16x16x32_bf16 v[88:91], v[136:139], v[12:15], v[88:91]
  v_mfma_f32_16x16x32_bf16 v[88:91], v[64:67], v[12:15], v[88:91]
  v_mfma_f32_16x16x32_bf16 v[88:91], v[140:143], v[12:15], v[88:91]
  v_mfma_f32_16x16x32_bf16 v[88:91], v[144:147], v[12:15], v[88:91]
  v_mfma_f32_16x16x32_bf16 v[88:91], v[148:151], v[12:15], v[88:91]
  v_mfma_f32_16x16x32_bf16 v[88:91], v[152:155], v[12:15], v[88:91]
  v_mfma_f32_16x16x32_bf16 v[88:91], v[156:159], v[12:15], v[88:91]
  v_mfma_f32_16x16x32_bf16 v[88:91], v[160:163], v[12:15], v[88:91]
  v_mfma_f32_16x16x32_bf16 v[88:91], v[68:71], v[12:15], v[88:91]
  v_mfma_f32_16x16x32_bf16 v[88:91], v[164:167], v[12:15], v[88:91]
  v_mfma_f32_16x16x32_bf16 v[88:91], v[168:171], v[12:15], v[88:91]
  v_mfma_f32_16x16x32_bf16 v[88:91], v[172:175], v[12:15], v[88:91]
  v_mfma_f32_16x16x32_bf16 v[88:91], v[176:179], v[12:15], v[88:91]
  v_mfma_f32_16x16x32_bf16 v[88:91], v[180:183], v[12:15], v[88:91]
  v_mfma_f32_16x16x32_bf16 v[88:91], v[184:187], v[12:15], v[88:91]
  s_nop 7
  ds_write_b128 v9, v[88:91] offset:256
  v_mfma_f32_16x16x32_bf16 v[92:95], v[188:191], v[12:15], 0
  v_mfma_f32_16x16x32_bf16 v[92:95], v[72:75], v[12:15], v[92:95]
  v_mfma_f32_16x16x32_bf16 v[92:95], v[192:195], v[12:15], v[92:95]
  v_mfma_f32_16x16x32_bf16 v[92:95], v[196:199], v[12:15], v[92:95]
  v_mfma_f32_16x16x32_bf16 v[92:95], v[200:203], v[12:15], v[92:95]
  v_mfma_f32_16x16x32_bf16 v[92:95], v[204:207], v[12:15], v[92:95]
  v_mfma_f32_16x16x32_bf16 v[92:95], v[208:211], v[12:15], v[92:95]
  v_mfma_f32_16x16x32_bf16 v[92:95], v[212:215], v[12:15], v[92:95]
  v_mfma_f32_16x16x32_bf16 v[92:95], v[76:79], v[12:15], v[92:95]
  v_mfma_f32_16x16x32_bf16 v[92:95], v[216:219], v[12:15], v[92:95]
  v_mfma_f32_16x16x32_bf16 v[92:95], v[220:223], v[12:15], v[92:95]
  v_mfma_f32_16x16x32_bf16 v[92:95], v[224:227], v[12:15], v[92:95]
  v_mfma_f32_16x16x32_bf16 v[92:95], v[228:231], v[12:15], v[92:95]
  v_mfma_f32_16x16x32_bf16 v[92:95], v[232:235], v[12:15], v[92:95]
  v_mfma_f32_16x16x32_bf16 v[92:95], v[236:239], v[12:15], v[92:95]
  v_mfma_f32_16x16x32_bf16 v[92:95], v[240:243], v[12:15], v[92:95]
  v_mfma_f32_16x16x32_bf16 v[92:95], v[80:83], v[12:15], v[92:95]
  v_mfma_f32_16x16x32_bf16 v[92:95], v[244:247], v[12:15], v[92:95]
  v_mfma_f32_16x16x32_bf16 v[92:95], v[248:251], v[12:15], v[92:95]
  v_mfma_f32_16x16x32_bf16 v[92:95], v[252:255], v[12:15], v[92:95]
  s_nop 7
  ds_write_b128 v9, v[92:95] offset:320
  s_waitcnt lgkmcnt(0)
  s_lshl_b32 s3, s49, 2
  v_mov_b32 v13, s3
  s_nop 1
ibw_381:
  buffer_load_dword v12, v13, s[12:15], 0 offen sc1
  s_waitcnt vmcnt(0)
  v_cmp_ne_u32 vcc, 256, v12
  s_nop 0
  s_cbranch_vccz ibw_382
  s_sleep 8
  s_sub_u32 s47, s47, 1
  s_cbranch_scc0 ibw_381
  s_branch ABORT
ibw_382:
  s_cmp_lg_u32 s49, 0
  s_cbranch_scc1 ibok_383
  v_and_b32 v13, 7, v0
  v_lshlrev_b32 v13, 2, v13
  buffer_load_dword v12, v13, s[12:15], 0 offen offset:32 sc1
  s_waitcnt vmcnt(0)
  v_cmp_ne_u32 vcc, 32, v12
  s_nop 0
  s_cbranch_vccz ibok_383
  s_barrier
  s_mov_b32 s49, 1
  s_mov_b32 s3, s2
  s_branch DISPATCH
ibok_383:
  s_mov_b32 s50, 0
  s_mov_b32 s57, 65536
P1_WAIT:
  s_cmp_lg_u32 s46, 0
  s_cbranch_scc1 w0_384
fl_385:
  buffer_load_dword v3, v2, s[8:11], s56 offen sc1
  s_waitcnt vmcnt(0)
  v_cmp_eq_u32 vcc, 0, v3
  s_nop 0
  s_cbranch_vccz fo_386
  s_sleep 4
  s_sub_u32 s47, s47, 1
  s_cbranch_scc0 fl_385
  s_branch ABORT
fo_386:
w0_384:
  s_barrier
  s_add_u32 s69, s57, s58
  s_add_u32 m0, s69, 0
  s_add_u32 s65, s55, 0
  buffer_load_dwordx4 v1, s[8:11], s65 offen offset:0 sc1 lds
  buffer_load_dwordx4 v1, s[8:11], s65 offen offset:1024 sc1 lds
  buffer_load_dwordx4 v1, s[8:11], s65 offen offset:2048 sc1 lds
  buffer_load_dwordx4 v1, s[8:11], s65 offen offset:3072 sc1 lds
  s_add_u32 m0, s69, 4096
  s_add_u32 s65, s55, 4096
  buffer_load_dwordx4 v1, s[8:11], s65 offen offset:0 sc1 lds
  buffer_load_dwordx4 v1, s[8:11], s65 offen offset:1024 sc1 lds
  buffer_load_dwordx4 v1, s[8:11], s65 offen offset:2048 sc1 lds
  buffer_load_dwordx4 v1, s[8:11], s65 offen offset:3072 sc1 lds
  s_add_u32 m0, s69, 8192
  s_add_u32 s65, s55, 8192
  buffer_load_dwordx4 v1, s[8:11], s65 offen offset:0 sc1 lds
  buffer_load_dwordx4 v1, s[8:11], s65 offen offset:1024 sc1 lds
  buffer_load_dwordx4 v1, s[8:11], s65 offen offset:2048 sc1 lds
  buffer_load_dwordx4 v1, s[8:11], s65 offen offset:3072 sc1 lds
  s_waitcnt vmcnt(0)
P1_LOOP:
  v_add_u32 v5, s57, v1
  v_add_u32 v8, s57, v7
  s_xor_b32 s57, s57, 46080
  s_barrier
  ds_read_b128 v[20:23], v5 offset:0
  ds_read_b128 v[24:27], v5 offset:1024
  ds_read_b128 v[28:31], v5 offset:2048
  ds_read_b128 v[32:35], v5 offset:3072
  ds_read_b128 v[36:39], v5 offset:4096
  ds_read_b128 v[40:43], v5 offset:5120
  s_waitcnt lgkmcnt(5)
  v_mfma_f32_16x16x32_bf16 v[56:59], a[0:3], v[20:23], 0
  ds_read_b128 v[44:47], v6 offset:0
  v_mfma_f32_16x16x32_bf16 v[60:63], a[68:71], v[20:23], 0
  s_waitcnt lgkmcnt(5)
  ds_read_b128 v[20:23], v5 offset:6144
  v_mfma_f32_16x16x32_bf16 v[64:67], a[0:3], v[24:27], 0
  ds_read_b128 v[48:51], v6 offset:3072
  v_mfma_f32_16x16x32_bf16 v[68:71], a[68:71], v[24:27], 0
  s_waitcnt lgkmcnt(6)
  ds_read_b128 v[24:27], v5 offset:7168
  v_mfma_f32_16x16x32_bf16 v[56:59], a[4:7], v[28:31], v[56:59]
  ds_read_b128 v[52:55], v6 offset:1024
  v_add_u32 v12, 0x800, v8
  v_mfma_f32_16x16x32_bf16 v[60:63], a[72:75], v[28:31], v[60:63]
  s_waitcnt lgkmcnt(7)
  ds_read_b128 v[28:31], v5 offset:8192
  ds_read2_b64 v[72:75], v8 offset0:0 offset1:32
  v_mfma_f32_16x16x32_bf16 v[64:67], a[4:7], v[32:35], v[64:67]
  ds_read2_b64 v[76:79], v8 offset0:64 offset1:96
  ds_read2_b64 v[80:83], v8 offset0:128 offset1:160
  v_mfma_f32_16x16x32_bf16 v[68:71], a[72:75], v[32:35], v[68:71]
  s_waitcnt lgkmcnt(10)
  ds_read_b128 v[32:35], v5 offset:9216
  ds_read2_b64 v[84:87], v8 offset0:192 offset1:224
  v_mfma_f32_16x16x32_bf16 v[56:59], a[8:11], v[36:39], v[56:59]
  ds_read2_b64 v[88:91], v12 offset0:0 offset1:32
  v_mfma_f32_16x16x32_bf16 v[60:63], a[76:79], v[36:39], v[60:63]
  s_waitcnt lgkmcnt(12)
  ds_read_b128 v[36:39], v5 offset:10240
  v_mfma_f32_16x16x32_bf16 v[64:67], a[8:11], v[40:43], v[64:67]
  v_mfma_f32_16x16x32_bf16 v[68:71], a[76:79], v[40:43], v[68:71]
  s_waitcnt lgkmcnt(11)
  ds_read_b128 v[40:43], v5 offset:11264
  v_mfma_f32_16x16x32_bf16 v[56:59], v[44:47], v[20:23], v[56:59]
  v_mfma_f32_16x16x32_bf16 v[60:63], a[80:83], v[20:23], v[60:63]
  s_waitcnt lgkmcnt(10)
  ds_read_b128 v[20:23], v5 offset:12288
  v_mfma_f32_16x16x32_bf16 v[64:67], v[44:47], v[24:27], v[64:67]
  ds_read_b128 v[44:47], v6 offset:4096
  v_mfma_f32_16x16x32_bf16 v[68:71], a[80:83], v[24:27], v[68:71]
  s_waitcnt lgkmcnt(10)
  ds_read_b128 v[24:27], v5 offset:13312
  v_mfma_f32_16x16x32_bf16 v[56:59], a[12:15], v[28:31], v[56:59]
  v_mfma_f32_16x16x32_bf16 v[60:63], a[84:87], v[28:31], v[60:63]
  s_waitcnt lgkmcnt(7)
  ds_read_b128 v[28:31], v5 offset:14336
  v_mfma_f32_16x16x32_bf16 v[64:67], a[12:15], v[32:35], v[64:67]
  v_mfma_f32_16x16x32_bf16 v[68:71], a[84:87], v[32:35], v[68:71]
  s_waitcnt lgkmcnt(5)
  ds_read_b128 v[32:35], v5 offset:15360
  v_mfma_f32_16x16x32_bf16 v[56:59], a[16:19], v[36:39], v[56:59]
  v_mfma_f32_16x16x32_bf16 v[60:63], a[88:91], v[36:39], v[60:63]
  s_waitcnt lgkmcnt(5)
  ds_read_b128 v[36:39], v5 offset:16384
  v_mfma_f32_16x16x32_bf16 v[64:67], a[16:19], v[40:43], v[64:67]
  v_mfma_f32_16x16x32_bf16 v[68:71], a[88:91], v[40:43], v[68:71]
  s_waitcnt lgkmcnt(5)
  ds_read_b128 v[40:43], v5 offset:17408
  v_mfma_f32_16x16x32_bf16 v[56:59], a[20:23], v[20:23], v[56:59]
  v_add_f32 v72, v72, v82
  v_add_f32 v73, v73, v83
  v_mfma_f32_16x16x32_bf16 v[60:63], v[48:51], v[20:23], v[60:63]
  s_waitcnt lgkmcnt(4)
  ds_read_b128 v[20:23], v5 offset:18432
  v_add_f32 v74, v74, v84
  v_mfma_f32_16x16x32_bf16 v[64:67], a[20:23], v[24:27], v[64:67]
  v_add_f32 v75, v75, v85
  v_add_f32 v76, v76, v86
  v_mfma_f32_16x16x32_bf16 v[68:71], v[48:51], v[24:27], v[68:71]
  s_waitcnt lgkmcnt(4)
  ds_read_b128 v[24:27], v5 offset:19456
  v_add_f32 v77, v77, v87
  v_mfma_f32_16x16x32_bf16 v[56:59], a[24:27], v[28:31], v[56:59]
  ds_read_b128 v[48:51], v6 offset:2048
  v_add_f32 v78, v78, v88
  v_mfma_f32_16x16x32_bf16 v[60:63], a[92:95], v[28:31], v[60:63]
  s_waitcnt lgkmcnt(5)
  ds_read_b128 v[28:31], v5 offset:20480
  v_add_f32 v79, v79, v89
  v_mfma_f32_16x16x32_bf16 v[64:67], a[24:27], v[32:35], v[64:67]
  v_add_f32 v80, v80, v90
  v_add_f32 v81, v81, v91
  v_mfma_f32_16x16x32_bf16 v[68:71], a[92:95], v[32:35], v[68:71]
  s_waitcnt lgkmcnt(5)
  ds_read_b128 v[32:35], v5 offset:21504
  v_add_f32 v72, v72, v74
  v_mfma_f32_16x16x32_bf16 v[56:59], a[28:31], v[36:39], v[56:59]
  v_add_f32 v73, v73, v75
  v_add_f32 v76, v76, v78
  v_mfma_f32_16x16x32_bf16 v[60:63], a[96:99], v[36:39], v[60:63]
  s_waitcnt lgkmcnt(5)
  ds_read_b128 v[36:39], v5 offset:22528
  v_add_f32 v77, v77, v79
  v_mfma_f32_16x16x32_bf16 v[64:67], a[28:31], v[40:43], v[64:67]
  v_add_f32 v72, v72, v76
  v_add_f32 v73, v73, v77
  v_mfma_f32_16x16x32_bf16 v[68:71], a[96:99], v[40:43], v[68:71]
  s_waitcnt lgkmcnt(5)
  ds_read_b128 v[40:43], v5 offset:23552
  v_add_f32 v72, v72, v80
  v_mfma_f32_16x16x32_bf16 v[56:59], a[32:35], v[20:23], v[56:59]
  v_add_f32 v73, v73, v81
  v_mov_b32 v74, v72
  v_mfma_f32_16x16x32_bf16 v[60:63], a[100:103], v[20:23], v[60:63]
  s_waitcnt lgkmcnt(5)
  ds_read_b128 v[20:23], v5 offset:24576
  v_mov_b32 v75, v73
  v_mfma_f32_16x16x32_bf16 v[64:67], a[32:35], v[24:27], v[64:67]
  v_permlane16_swap_b32 v72, v74
  v_mfma_f32_16x16x32_bf16 v[68:71], a[100:103], v[24:27], v[68:71]
  s_waitcnt lgkmcnt(4)
  ds_read_b128 v[24:27], v5 offset:25600
  v_mfma_f32_16x16x32_bf16 v[56:59], a[36:39], v[28:31], v[56:59]
  v_permlane16_swap_b32 v73, v75
  v_mfma_f32_16x16x32_bf16 v[60:63], a[104:107], v[28:31], v[60:63]
  s_waitcnt lgkmcnt(4)
  ds_read_b128 v[28:31], v5 offset:26624
  v_add_f32 v16, v72, v74
  v_mfma_f32_16x16x32_bf16 v[64:67], a[36:39], v[32:35], v[64:67]
  v_add_f32 v17, v73, v75
  v_mul_f32 v16, 0x3acccccd, v16
  v_mfma_f32_16x16x32_bf16 v[68:71], a[104:107], v[32:35], v[68:71]
  s_waitcnt lgkmcnt(4)
  ds_read_b128 v[32:35], v5 offset:27648
  v_mul_f32 v17, 0x3acccccd, v17
  v_mfma_f32_16x16x32_bf16 v[56:59], v[52:55], v[36:39], v[56:59]
  v_fma_f32 v17, -v16, v16, v17
  v_max_f32 v17, 0, v17
  v_mfma_f32_16x16x32_bf16 v[60:63], a[108:111], v[36:39], v[60:63]
  s_waitcnt lgkmcnt(4)
  ds_read_b128 v[36:39], v5 offset:28672
  v_add_f32 v17, 0x3727c5ac, v17
  v_mfma_f32_16x16x32_bf16 v[64:67], v[52:55], v[40:43], v[64:67]
  ds_read_b128 v[52:55], v6 offset:5120
  v_mfma_f32_16x16x32_bf16 v[68:71], a[108:111], v[40:43], v[68:71]
  s_waitcnt lgkmcnt(5)
  ds_read_b128 v[40:43], v5 offset:29696
  v_mfma_f32_16x16x32_bf16 v[56:59], a[40:43], v[20:23], v[56:59]
  v_rsq_f32 v17, v17
  v_mfma_f32_16x16x32_bf16 v[60:63], a[112:115], v[20:23], v[60:63]
  s_waitcnt lgkmcnt(5)
  ds_read_b128 v[20:23], v5 offset:30720
  v_mov_b32 v18, v16
  v_mfma_f32_16x16x32_bf16 v[64:67], a[40:43], v[24:27], v[64:67]
  v_mov_b32 v19, v17
  v_mfma_f32_16x16x32_bf16 v[68:71], a[112:115], v[24:27], v[68:71]
  s_waitcnt lgkmcnt(5)
  ds_read_b128 v[24:27], v5 offset:31744
  v_mfma_f32_16x16x32_bf16 v[56:59], a[44:47], v[28:31], v[56:59]
  v_permlane32_swap_b32 v16, v18
  v_mfma_f32_16x16x32_bf16 v[60:63], v[44:47], v[28:31], v[60:63]
  s_waitcnt lgkmcnt(5)
  ds_read_b128 v[28:31], v5 offset:32768
  v_mfma_f32_16x16x32_bf16 v[64:67], a[44:47], v[32:35], v[64:67]
  v_permlane32_swap_b32 v17, v19
  v_mfma_f32_16x16x32_bf16 v[68:71], v[44:47], v[32:35], v[68:71]
  s_waitcnt lgkmcnt(5)
  ds_read_b128 v[32:35], v5 offset:33792
  ds_read_b128 v[88:91], v9 offset:0
  v_mfma_f32_16x16x32_bf16 v[56:59], a[48:51], v[36:39], v[56:59]
  s_waitcnt vmcnt(0)
  s_and_b64 exec, s[72:73], 1
  buffer_store_dword v4, v1, s[8:11], s70 offen sc1
  s_mov_b64 exec, -1
  v_mfma_f32_16x16x32_bf16 v[60:63], a[116:119], v[36:39], v[60:63]
  s_waitcnt lgkmcnt(5)
  ds_read_b128 v[36:39], v5 offset:34816
  ds_read_b128 v[92:95], v9 offset:64
  v_mfma_f32_16x16x32_bf16 v[64:67], a[48:51], v[40:43], v[64:67]
  ds_read_b128 v[44:47], v6 offset:8192
  v_mfma_f32_16x16x32_bf16 v[68:71], a[116:119], v[40:43], v[68:71]
  s_waitcnt lgkmcnt(7)
  ds_read_b128 v[40:43], v5 offset:35840
  v_mfma_f32_16x16x32_bf16 v[56:59], a[52:55], v[20:23], v[56:59]
  v_mfma_f32_16x16x32_bf16 v[60:63], a[120:123], v[20:23], v[60:63]
  s_waitcnt lgkmcnt(7)
  ds_read_b128 v[20:23], v5 offset:36864
  v_mfma_f32_16x16x32_bf16 v[64:67], a[52:55], v[24:27], v[64:67]
  v_mfma_f32_16x16x32_bf16 v[68:71], a[120:123], v[24:27], v[68:71]
  s_waitcnt lgkmcnt(7)
  ds_read_b128 v[24:27], v5 offset:37888
  v_mfma_f32_16x16x32_bf16 v[56:59], a[56:59], v[28:31], v[56:59]
  v_mfma_f32_16x16x32_bf16 v[60:63], a[124:127], v[28:31], v[60:63]
  s_waitcnt lgkmcnt(7)
  ds_read_b128 v[28:31], v5 offset:38912
  v_mfma_f32_16x16x32_bf16 v[64:67], a[56:59], v[32:35], v[64:67]
  v_mfma_f32_16x16x32_bf16 v[68:71], a[124:127], v[32:35], v[68:71]
  s_waitcnt lgkmcnt(6)
  ds_read_b128 v[32:35], v5 offset:39936
  v_mfma_f32_16x16x32_bf16 v[56:59], a[60:63], v[36:39], v[56:59]
  v_mfma_f32_16x16x32_bf16 v[60:63], a[128:131], v[36:39], v[60:63]
  s_waitcnt lgkmcnt(4)
  ds_read_b128 v[36:39], v5 offset:0
  v_mfma_f32_16x16x32_bf16 v[64:67], a[60:63], v[40:43], v[64:67]
  v_mfma_f32_16x16x32_bf16 v[68:71], a[128:131], v[40:43], v[68:71]
  s_waitcnt lgkmcnt(4)
  ds_read_b128 v[40:43], v5 offset:1024
  v_mfma_f32_16x16x32_bf16 v[56:59], v[48:51], v[20:23], v[56:59]
  v_mfma_f32_16x16x32_bf16 v[60:63], a[132:135], v[20:23], v[60:63]
  s_waitcnt lgkmcnt(4)
  ds_read_b128 v[20:23], v5 offset:2048
  v_mfma_f32_16x16x32_bf16 v[64:67], v[48:51], v[24:27], v[64:67]
  ds_read_b128 v[48:51], v6 offset:6144
  v_mfma_f32_16x16x32_bf16 v[68:71], a[132:135], v[24:27], v[68:71]
  s_waitcnt lgkmcnt(5)
  ds_read_b128 v[24:27], v5 offset:3072
  v_mfma_f32_16x16x32_bf16 v[56:59], a[64:67], v[28:31], v[56:59]
  v_mfma_f32_16x16x32_bf16 v[60:63], a[136:139], v[28:31], v[60:63]
  s_waitcnt lgkmcnt(5)
  ds_read_b128 v[28:31], v5 offset:4096
  v_mfma_f32_16x16x32_bf16 v[64:67], a[64:67], v[32:35], v[64:67]
  v_mfma_f32_16x16x32_bf16 v[68:71], a[136:139], v[32:35], v[68:71]
  s_waitcnt lgkmcnt(5)
  ds_read_b128 v[32:35], v5 offset:5120
  v_mfma_f32_16x16x32_bf16 v[72:75], a[140:143], v[36:39], 0
  s_add_u32 s56, s56, 512
  s_add_u32 s55, s55, 46080
  buffer_load_dword v3, v2, s[8:11], s56 offen sc1
  v_mfma_f32_16x16x32_bf16 v[76:79], a[208:211], v[36:39], 0
  s_waitcnt lgkmcnt(5)
  ds_read_b128 v[36:39], v5 offset:6144
  v_mfma_f32_16x16x32_bf16 v[80:83], a[140:143], v[40:43], 0
  v_mfma_f32_16x16x32_bf16 v[84:87], a[208:211], v[40:43], 0
  s_waitcnt lgkmcnt(5)
  ds_read_b128 v[40:43], v5 offset:7168
  v_fma_f32 v56, -v16, v88, v56
  v_mfma_f32_16x16x32_bf16 v[72:75], v[52:55], v[20:23], v[72:75]
  v_fma_f32 v57, -v16, v89, v57
  v_fma_f32 v58, -v16, v90, v58
  v_mfma_f32_16x16x32_bf16 v[76:79], a[212:215], v[20:23], v[76:79]
  s_waitcnt lgkmcnt(4)
  ds_read_b128 v[20:23], v5 offset:8192
  v_fma_f32 v59, -v16, v91, v59
  v_mfma_f32_16x16x32_bf16 v[80:83], v[52:55], v[24:27], v[80:83]
  ds_read_b128 v[52:55], v6 offset:9216
  v_fma_f32 v60, -v16, v92, v60
  v_mfma_f32_16x16x32_bf16 v[84:87], a[212:215], v[24:27], v[84:87]
  s_waitcnt lgkmcnt(5)
  ds_read_b128 v[24:27], v5 offset:9216
  v_fma_f32 v61, -v16, v93, v61
  v_mfma_f32_16x16x32_bf16 v[72:75], a[144:147], v[28:31], v[72:75]
  v_fma_f32 v62, -v16, v94, v62
  v_fma_f32 v63, -v16, v95, v63
  v_mfma_f32_16x16x32_bf16 v[76:79], a[216:219], v[28:31], v[76:79]
  s_waitcnt lgkmcnt(5)
  ds_read_b128 v[28:31], v5 offset:10240
  v_mul_f32 v56, v56, v17
  v_mfma_f32_16x16x32_bf16 v[80:83], a[144:147], v[32:35], v[80:83]
  v_mul_f32 v57, v57, v17
  v_mul_f32 v58, v58, v17
  v_mfma_f32_16x16x32_bf16 v[84:87], a[216:219], v[32:35], v[84:87]
  s_waitcnt lgkmcnt(5)
  ds_read_b128 v[32:35], v5 offset:11264
  v_mul_f32 v59, v59, v17
  v_mfma_f32_16x16x32_bf16 v[72:75], a[148:151], v[36:39], v[72:75]
  v_mul_f32 v60, v60, v17
  v_mul_f32 v61, v61, v17
  v_mfma_f32_16x16x32_bf16 v[76:79], v[44:47], v[36:39], v[76:79]
  s_waitcnt lgkmcnt(5)
  ds_read_b128 v[36:39], v5 offset:12288
  v_mul_f32 v62, v62, v17
  v_mfma_f32_16x16x32_bf16 v[80:83], a[148:151], v[40:43], v[80:83]
  v_mul_f32 v63, v63, v17
  v_cvt_pk_bf16_f32 v56, v56, v57
  v_mfma_f32_16x16x32_bf16 v[84:87], v[44:47], v[40:43], v[84:87]
  s_waitcnt lgkmcnt(5)
  ds_read_b128 v[40:43], v5 offset:13312
  v_cvt_pk_bf16_f32 v57, v58, v59
  v_mfma_f32_16x16x32_bf16 v[72:75], a[152:155], v[20:23], v[72:75]
  ds_read_b128 v[44:47], v6 offset:7168
  v_cvt_pk_bf16_f32 v58, v60, v61
  v_mfma_f32_16x16x32_bf16 v[76:79], a[220:223], v[20:23], v[76:79]
  s_waitcnt lgkmcnt(5)
  ds_read_b128 v[20:23], v5 offset:14336
  v_cvt_pk_bf16_f32 v59, v62, v63
  v_mfma_f32_16x16x32_bf16 v[80:83], a[152:155], v[24:27], v[80:83]
  buffer_store_dwordx4 v[56:59], v1, s[8:11], s53 offen offset:0 sc1
  v_fma_f32 v64, -v18, v88, v64
  v_mfma_f32_16x16x32_bf16 v[84:87], a[220:223], v[24:27], v[84:87]
  s_waitcnt lgkmcnt(5)
  ds_read_b128 v[24:27], v5 offset:15360
  v_fma_f32 v65, -v18, v89, v65
  v_mfma_f32_16x16x32_bf16 v[72:75], a[156:159], v[28:31], v[72:75]
  v_fma_f32 v66, -v18, v90, v66
  v_fma_f32 v67, -v18, v91, v67
  v_mfma_f32_16x16x32_bf16 v[76:79], a[224:227], v[28:31], v[76:79]
  s_waitcnt lgkmcnt(5)
  ds_read_b128 v[28:31], v5 offset:16384
  v_fma_f32 v68, -v18, v92, v68
  v_mfma_f32_16x16x32_bf16 v[80:83], a[156:159], v[32:35], v[80:83]
  v_fma_f32 v69, -v18, v93, v69
  v_fma_f32 v70, -v18, v94, v70
  v_mfma_f32_16x16x32_bf16 v[84:87], a[224:227], v[32:35], v[84:87]
  s_waitcnt lgkmcnt(5)
  ds_read_b128 v[32:35], v5 offset:17408
  v_fma_f32 v71, -v18, v95, v71
  v_mfma_f32_16x16x32_bf16 v[72:75], a[160:163], v[36:39], v[72:75]
  v_mul_f32 v64, v64, v19
  v_mul_f32 v65, v65, v19
  v_mfma_f32_16x16x32_bf16 v[76:79], a[228:231], v[36:39], v[76:79]
  s_waitcnt lgkmcnt(5)
  ds_read_b128 v[36:39], v5 offset:18432
  v_mul_f32 v66, v66, v19
  v_mfma_f32_16x16x32_bf16 v[80:83], a[160:163], v[40:43], v[80:83]
  v_mul_f32 v67, v67, v19
  v_mul_f32 v68, v68, v19
  v_mfma_f32_16x16x32_bf16 v[84:87], a[228:231], v[40:43], v[84:87]
  s_waitcnt lgkmcnt(4)
  ds_read_b128 v[40:43], v5 offset:19456
  v_mul_f32 v69, v69, v19
  v_mfma_f32_16x16x32_bf16 v[72:75], a[164:167], v[20:23], v[72:75]
  v_mul_f32 v70, v70, v19
  v_mul_f32 v71, v71, v19
  v_mfma_f32_16x16x32_bf16 v[76:79], a[232:235], v[20:23], v[76:79]
  s_waitcnt lgkmcnt(4)
  ds_read_b128 v[20:23], v5 offset:20480
  v_cvt_pk_bf16_f32 v64, v64, v65
  v_mfma_f32_16x16x32_bf16 v[80:83], a[164:167], v[24:27], v[80:83]
  v_cvt_pk_bf16_f32 v65, v66, v67
  v_cvt_pk_bf16_f32 v66, v68, v69
  v_mfma_f32_16x16x32_bf16 v[84:87], a[232:235], v[24:27], v[84:87]
  s_waitcnt lgkmcnt(4)
  ds_read_b128 v[24:27], v5 offset:21504
  v_cvt_pk_bf16_f32 v67, v70, v71
  v_mfma_f32_16x16x32_bf16 v[72:75], v[48:51], v[28:31], v[72:75]
  buffer_store_dwordx4 v[64:67], v1, s[8:11], s53 offen offset:1024 sc1
  ds_read_b128 v[88:91], v9 offset:128
  v_mfma_f32_16x16x32_bf16 v[76:79], a[236:239], v[28:31], v[76:79]
  s_waitcnt lgkmcnt(5)
  ds_read_b128 v[28:31], v5 offset:22528
  ds_read_b128 v[92:95], v9 offset:192
  v_mfma_f32_16x16x32_bf16 v[80:83], v[48:51], v[32:35], v[80:83]
  ds_read_b128 v[48:51], v6 offset:10240
  v_mfma_f32_16x16x32_bf16 v[84:87], a[236:239], v[32:35], v[84:87]
  s_waitcnt lgkmcnt(7)
  ds_read_b128 v[32:35], v5 offset:23552
  v_mfma_f32_16x16x32_bf16 v[72:75], a[168:171], v[36:39], v[72:75]
  v_mfma_f32_16x16x32_bf16 v[76:79], a[240:243], v[36:39], v[76:79]
  s_waitcnt lgkmcnt(7)
  ds_read_b128 v[36:39], v5 offset:24576
  v_mfma_f32_16x16x32_bf16 v[80:83], a[168:171], v[40:43], v[80:83]
  v_mfma_f32_16x16x32_bf16 v[84:87], a[240:243], v[40:43], v[84:87]
  s_waitcnt lgkmcnt(7)
  ds_read_b128 v[40:43], v5 offset:25600
  v_mfma_f32_16x16x32_bf16 v[72:75], a[172:175], v[20:23], v[72:75]
  v_mfma_f32_16x16x32_bf16 v[76:79], a[244:247], v[20:23], v[76:79]
  s_waitcnt lgkmcnt(7)
  ds_read_b128 v[20:23], v5 offset:26624
  v_mfma_f32_16x16x32_bf16 v[80:83], a[172:175], v[24:27], v[80:83]
  v_mfma_f32_16x16x32_bf16 v[84:87], a[244:247], v[24:27], v[84:87]
  s_waitcnt lgkmcnt(6)
  ds_read_b128 v[24:27], v5 offset:27648
  v_mfma_f32_16x16x32_bf16 v[72:75], a[176:179], v[28:31], v[72:75]
  v_mfma_f32_16x16x32_bf16 v[76:79], v[52:55], v[28:31], v[76:79]
  s_waitcnt lgkmcnt(4)
  ds_read_b128 v[28:31], v5 offset:28672
  v_mfma_f32_16x16x32_bf16 v[80:83], a[176:179], v[32:35], v[80:83]
  v_mfma_f32_16x16x32_bf16 v[84:87], v[52:55], v[32:35], v[84:87]
  s_waitcnt lgkmcnt(4)
  ds_read_b128 v[32:35], v5 offset:29696
  v_mfma_f32_16x16x32_bf16 v[72:75], a[180:183], v[36:39], v[72:75]
  ds_read_b128 v[52:55], v6 offset:13312
  v_mfma_f32_16x16x32_bf16 v[76:79], a[248:251], v[36:39], v[76:79]
  s_waitcnt lgkmcnt(5)
  ds_read_b128 v[36:39], v5 offset:30720
  v_mfma_f32_16x16x32_bf16 v[80:83], a[180:183], v[40:43], v[80:83]
  v_mfma_f32_16x16x32_bf16 v[84:87], a[248:251], v[40:43], v[84:87]
  s_waitcnt lgkmcnt(5)
  ds_read_b128 v[40:43], v5 offset:31744
  v_mfma_f32_16x16x32_bf16 v[72:75], a[184:187], v[20:23], v[72:75]
  v_mfma_f32_16x16x32_bf16 v[76:79], a[252:255], v[20:23], v[76:79]
  s_waitcnt lgkmcnt(5)
  ds_read_b128 v[20:23], v5 offset:32768
  v_mfma_f32_16x16x32_bf16 v[80:83], a[184:187], v[24:27], v[80:83]
  v_mfma_f32_16x16x32_bf16 v[84:87], a[252:255], v[24:27], v[84:87]
  s_waitcnt lgkmcnt(5)
  ds_read_b128 v[24:27], v5 offset:33792
  v_mfma_f32_16x16x32_bf16 v[72:75], a[188:191], v[28:31], v[72:75]
  s_waitcnt vmcnt(2)
  v_cmp_eq_u32 vcc, 0, v3
  v_lshl_add_u32 v14, s46, 2, v10
  s_or_b32 vcc_lo, vcc_lo, vcc_hi
  v_mov_b32 v13, vcc_lo
  ds_write_b32 v14, v13 offset:0
  v_mfma_f32_16x16x32_bf16 v[76:79], v[96:99], v[28:31], v[76:79]
  s_waitcnt lgkmcnt(6)
  ds_read_b128 v[28:31], v5 offset:34816
  v_mfma_f32_16x16x32_bf16 v[80:83], a[188:191], v[32:35], v[80:83]
  v_mfma_f32_16x16x32_bf16 v[84:87], v[96:99], v[32:35], v[84:87]
  s_waitcnt lgkmcnt(5)
  ds_read_b128 v[32:35], v5 offset:35840
  v_mfma_f32_16x16x32_bf16 v[72:75], a[192:195], v[36:39], v[72:75]
  s_waitcnt lgkmcnt(2)
  s_barrier
  ds_read_b32 v13, v10
  v_mfma_f32_16x16x32_bf16 v[76:79], v[100:103], v[36:39], v[76:79]
  ds_read_b128 v[36:39], v5 offset:36864
  v_mfma_f32_16x16x32_bf16 v[80:83], a[192:195], v[40:43], v[80:83]
  v_mfma_f32_16x16x32_bf16 v[84:87], v[100:103], v[40:43], v[84:87]
  ds_read_b128 v[40:43], v5 offset:37888
  v_mfma_f32_16x16x32_bf16 v[72:75], v[44:47], v[20:23], v[72:75]
  v_mfma_f32_16x16x32_bf16 v[76:79], v[104:107], v[20:23], v[76:79]
  ds_read_b128 v[20:23], v5 offset:38912
  v_mfma_f32_16x16x32_bf16 v[80:83], v[44:47], v[24:27], v[80:83]
  ds_read_b128 v[44:47], v6 offset:11264
  v_mfma_f32_16x16x32_bf16 v[84:87], v[104:107], v[24:27], v[84:87]
  s_waitcnt lgkmcnt(6)
  ds_read_b128 v[24:27], v5 offset:39936
  v_mfma_f32_16x16x32_bf16 v[72:75], a[196:199], v[28:31], v[72:75]
  v_mfma_f32_16x16x32_bf16 v[76:79], v[108:111], v[28:31], v[76:79]
  s_waitcnt lgkmcnt(6)
  ds_read_b128 v[28:31], v5 offset:0
  v_mfma_f32_16x16x32_bf16 v[80:83], a[196:199], v[32:35], v[80:83]
  s_waitcnt lgkmcnt(6)
  v_readfirstlane_b32 s59, v13
  s_add_u32 s69, s57, s58
  v_mfma_f32_16x16x32_bf16 v[84:87], v[108:111], v[32:35], v[84:87]
  s_waitcnt lgkmcnt(5)
  ds_read_b128 v[32:35], v5 offset:1024
  s_cmp_eq_u32 s59, 0
  s_cselect_b32 s68, s55, 536870912
  v_mfma_f32_16x16x32_bf16 v[72:75], a[200:203], v[36:39], v[72:75]
  s_add_u32 m0, s69, 0
  s_add_u32 s65, s68, 0
  buffer_load_dwordx4 v1, s[8:11], s65 offen offset:0 sc1 lds
  v_mfma_f32_16x16x32_bf16 v[76:79], v[48:51], v[36:39], v[76:79]
  s_waitcnt lgkmcnt(5)
  ds_read_b128 v[36:39], v5 offset:2048
  v_mfma_f32_16x16x32_bf16 v[80:83], a[200:203], v[40:43], v[80:83]
  v_mfma_f32_16x16x32_bf16 v[84:87], v[48:51], v[40:43], v[84:87]
  s_waitcnt lgkmcnt(5)
  ds_read_b128 v[40:43], v5 offset:3072
  v_mfma_f32_16x16x32_bf16 v[72:75], a[204:207], v[20:23], v[72:75]
  ds_read_b128 v[48:51], v6 offset:14336
  v_mfma_f32_16x16x32_bf16 v[76:79], v[112:115], v[20:23], v[76:79]
  s_waitcnt lgkmcnt(5)
  ds_read_b128 v[20:23], v5 offset:4096
  buffer_load_dwordx4 v1, s[8:11], s65 offen offset:1024 sc1 lds
  v_mfma_f32_16x16x32_bf16 v[80:83], a[204:207], v[24:27], v[80:83]
  v_mfma_f32_16x16x32_bf16 v[84:87], v[112:115], v[24:27], v[84:87]
  s_waitcnt lgkmcnt(5)
  ds_read_b128 v[24:27], v5 offset:5120
  v_mfma_f32_16x16x32_bf16 v[56:59], v[116:119], v[28:31], 0
  v_mfma_f32_16x16x32_bf16 v[60:63], v[188:191], v[28:31], 0
  s_waitcnt lgkmcnt(5)
  ds_read_b128 v[28:31], v5 offset:6144
  v_mfma_f32_16x16x32_bf16 v[64:67], v[116:119], v[32:35], 0
  buffer_load_dwordx4 v1, s[8:11], s65 offen offset:2048 sc1 lds
  v_mfma_f32_16x16x32_bf16 v[68:71], v[188:191], v[32:35], 0
  s_waitcnt lgkmcnt(5)
  ds_read_b128 v[32:35], v5 offset:7168
  v_fma_f32 v72, -v16, v88, v72
  v_mfma_f32_16x16x32_bf16 v[56:59], v[120:123], v[36:39], v[56:59]
  v_fma_f32 v73, -v16, v89, v73
  v_fma_f32 v74, -v16, v90, v74
  v_mfma_f32_16x16x32_bf16 v[60:63], v[52:55], v[36:39], v[60:63]
  s_waitcnt lgkmcnt(5)
  ds_read_b128 v[36:39], v5 offset:8192
  v_fma_f32 v75, -v16, v91, v75
  v_mfma_f32_16x16x32_bf16 v[64:67], v[120:123], v[40:43], v[64:67]
  v_fma_f32 v76, -v16, v92, v76
  v_fma_f32 v77, -v16, v93, v77
  v_mfma_f32_16x16x32_bf16 v[68:71], v[52:55], v[40:43], v[68:71]
  s_waitcnt lgkmcnt(4)
  ds_read_b128 v[40:43], v5 offset:9216
  buffer_load_dwordx4 v1, s[8:11], s65 offen offset:3072 sc1 lds
  v_mfma_f32_16x16x32_bf16 v[56:59], v[124:127], v[20:23], v[56:59]
  ds_read_b128 v[52:55], v6 offset:12288
  v_fma_f32 v78, -v16, v94, v78
  v_mfma_f32_16x16x32_bf16 v[60:63], v[192:195], v[20:23], v[60:63]
  s_waitcnt lgkmcnt(5)
  ds_read_b128 v[20:23], v5 offset:10240
  v_fma_f32 v79, -v16, v95, v79
  v_mfma_f32_16x16x32_bf16 v[64:67], v[124:127], v[24:27], v[64:67]
  v_mul_f32 v72, v72, v17
  v_mul_f32 v73, v73, v17
  v_mfma_f32_16x16x32_bf16 v[68:71], v[192:195], v[24:27], v[68:71]
  s_waitcnt lgkmcnt(5)
  ds_read_b128 v[24:27], v5 offset:11264
  v_mul_f32 v74, v74, v17
  v_mfma_f32_16x16x32_bf16 v[56:59], v[128:131], v[28:31], v[56:59]
  s_add_u32 m0, s69, 4096
  s_add_u32 s65, s68, 4096
  buffer_load_dwordx4 v1, s[8:11], s65 offen offset:0 sc1 lds
  v_mfma_f32_16x16x32_bf16 v[60:63], v[196:199], v[28:31], v[60:63]
  s_waitcnt lgkmcnt(5)
  ds_read_b128 v[28:31], v5 offset:12288
  v_mul_f32 v75, v75, v17
  v_mfma_f32_16x16x32_bf16 v[64:67], v[128:131], v[32:35], v[64:67]
  v_mul_f32 v76, v76, v17
  v_mul_f32 v77, v77, v17
  v_mfma_f32_16x16x32_bf16 v[68:71], v[196:199], v[32:35], v[68:71]
  s_waitcnt lgkmcnt(5)
  ds_read_b128 v[32:35], v5 offset:13312
  v_mul_f32 v78, v78, v17
  v_mfma_f32_16x16x32_bf16 v[56:59], v[132:135], v[36:39], v[56:59]
  v_mul_f32 v79, v79, v17
  v_cvt_pk_bf16_f32 v72, v72, v73
  v_mfma_f32_16x16x32_bf16 v[60:63], v[200:203], v[36:39], v[60:63]
  s_waitcnt lgkmcnt(5)
  ds_read_b128 v[36:39], v5 offset:14336
  buffer_load_dwordx4 v1, s[8:11], s65 offen offset:1024 sc1 lds
  v_mfma_f32_16x16x32_bf16 v[64:67], v[132:135], v[40:43], v[64:67]
  v_cvt_pk_bf16_f32 v73, v74, v75
  v_cvt_pk_bf16_f32 v74, v76, v77
  v_mfma_f32_16x16x32_bf16 v[68:71], v[200:203], v[40:43], v[68:71]
  s_waitcnt lgkmcnt(4)
  ds_read_b128 v[40:43], v5 offset:15360
  v_cvt_pk_bf16_f32 v75, v78, v79
  v_mfma_f32_16x16x32_bf16 v[56:59], v[136:139], v[20:23], v[56:59]
  buffer_store_dwordx4 v[72:75], v1, s[8:11], s53 offen offset:2048 sc1
  v_fma_f32 v80, -v18, v88, v80
  v_mfma_f32_16x16x32_bf16 v[60:63], v[204:207], v[20:23], v[60:63]
  s_waitcnt lgkmcnt(4)
  ds_read_b128 v[20:23], v5 offset:16384
  v_fma_f32 v81, -v18, v89, v81
  v_mfma_f32_16x16x32_bf16 v[64:67], v[136:139], v[24:27], v[64:67]
  buffer_load_dwordx4 v1, s[8:11], s65 offen offset:2048 sc1 lds
  v_fma_f32 v82, -v18, v90, v82
  v_mfma_f32_16x16x32_bf16 v[68:71], v[204:207], v[24:27], v[68:71]
  s_waitcnt lgkmcnt(4)
  ds_read_b128 v[24:27], v5 offset:17408
  v_fma_f32 v83, -v18, v91, v83
  v_mfma_f32_16x16x32_bf16 v[56:59], v[44:47], v[28:31], v[56:59]
  v_fma_f32 v84, -v18, v92, v84
  v_fma_f32 v85, -v18, v93, v85
  v_mfma_f32_16x16x32_bf16 v[60:63], v[208:211], v[28:31], v[60:63]
  s_waitcnt lgkmcnt(4)
  ds_read_b128 v[28:31], v5 offset:18432
  v_fma_f32 v86, -v18, v94, v86
  v_mfma_f32_16x16x32_bf16 v[64:67], v[44:47], v[32:35], v[64:67]
  ds_read_b128 v[44:47], v6 offset:15360
  v_fma_f32 v87, -v18, v95, v87
  v_mfma_f32_16x16x32_bf16 v[68:71], v[208:211], v[32:35], v[68:71]
  s_waitcnt lgkmcnt(5)
  ds_read_b128 v[32:35], v5 offset:19456
  buffer_load_dwordx4 v1, s[8:11], s65 offen offset:3072 sc1 lds
  v_mfma_f32_16x16x32_bf16 v[56:59], v[140:143], v[36:39], v[56:59]
  v_mul_f32 v80, v80, v19
  v_mul_f32 v81, v81, v19
  v_mfma_f32_16x16x32_bf16 v[60:63], v[212:215], v[36:39], v[60:63]
  s_waitcnt lgkmcnt(5)
  ds_read_b128 v[36:39], v5 offset:20480
  v_mul_f32 v82, v82, v19
  v_mfma_f32_16x16x32_bf16 v[64:67], v[140:143], v[40:43], v[64:67]
  v_mul_f32 v83, v83, v19
  v_mul_f32 v84, v84, v19
  v_mfma_f32_16x16x32_bf16 v[68:71], v[212:215], v[40:43], v[68:71]
  s_waitcnt lgkmcnt(5)
  ds_read_b128 v[40:43], v5 offset:21504
  v_mul_f32 v85, v85, v19
  v_mfma_f32_16x16x32_bf16 v[56:59], v[144:147], v[20:23], v[56:59]
  s_add_u32 m0, s69, 8192
  s_add_u32 s65, s68, 8192
  buffer_load_dwordx4 v1, s[8:11], s65 offen offset:0 sc1 lds
  v_mfma_f32_16x16x32_bf16 v[60:63], v[48:51], v[20:23], v[60:63]
  s_waitcnt lgkmcnt(5)
  ds_read_b128 v[20:23], v5 offset:22528
  v_mul_f32 v86, v86, v19
  v_mfma_f32_16x16x32_bf16 v[64:67], v[144:147], v[24:27], v[64:67]
  v_mul_f32 v87, v87, v19
  v_cvt_pk_bf16_f32 v80, v80, v81
  v_mfma_f32_16x16x32_bf16 v[68:71], v[48:51], v[24:27], v[68:71]
  s_waitcnt lgkmcnt(5)
  ds_read_b128 v[24:27], v5 offset:23552
  v_cvt_pk_bf16_f32 v81, v82, v83
  v_mfma_f32_16x16x32_bf16 v[56:59], v[148:151], v[28:31], v[56:59]
  v_cvt_pk_bf16_f32 v82, v84, v85
  v_cvt_pk_bf16_f32 v83, v86, v87
  v_mfma_f32_16x16x32_bf16 v[60:63], v[216:219], v[28:31], v[60:63]
  s_waitcnt lgkmcnt(4)
  ds_read_b128 v[28:31], v5 offset:24576
  buffer_load_dwordx4 v1, s[8:11], s65 offen offset:1024 sc1 lds
  v_mfma_f32_16x16x32_bf16 v[64:67], v[148:151], v[32:35], v[64:67]
  buffer_store_dwordx4 v[80:83], v1, s[8:11], s53 offen offset:3072 sc1
  ds_read_b128 v[88:91], v9 offset:256
  v_mfma_f32_16x16x32_bf16 v[68:71], v[216:219], v[32:35], v[68:71]
  s_waitcnt lgkmcnt(5)
  ds_read_b128 v[32:35], v5 offset:25600
  ds_read_b128 v[92:95], v9 offset:320
  v_mfma_f32_16x16x32_bf16 v[56:59], v[152:155], v[36:39], v[56:59]
  s_add_u32 s64, s53, 4096
  v_mfma_f32_16x16x32_bf16 v[60:63], v[220:223], v[36:39], v[60:63]
  s_waitcnt lgkmcnt(6)
  ds_read_b128 v[36:39], v5 offset:26624
  v_mfma_f32_16x16x32_bf16 v[64:67], v[152:155], v[40:43], v[64:67]
  buffer_load_dwordx4 v1, s[8:11], s65 offen offset:2048 sc1 lds
  v_mfma_f32_16x16x32_bf16 v[68:71], v[220:223], v[40:43], v[68:71]
  s_waitcnt lgkmcnt(6)
  ds_read_b128 v[40:43], v5 offset:27648
  v_mfma_f32_16x16x32_bf16 v[56:59], v[156:159], v[20:23], v[56:59]
  v_mfma_f32_16x16x32_bf16 v[60:63], v[224:227], v[20:23], v[60:63]
  s_waitcnt lgkmcnt(6)
  ds_read_b128 v[20:23], v5 offset:28672
  v_mfma_f32_16x16x32_bf16 v[64:67], v[156:159], v[24:27], v[64:67]
  v_mfma_f32_16x16x32_bf16 v[68:71], v[224:227], v[24:27], v[68:71]
  s_waitcnt lgkmcnt(6)
  ds_read_b128 v[24:27], v5 offset:29696
  buffer_load_dwordx4 v1, s[8:11], s65 offen offset:3072 sc1 lds
  v_mfma_f32_16x16x32_bf16 v[56:59], v[160:163], v[28:31], v[56:59]
  v_mfma_f32_16x16x32_bf16 v[60:63], v[228:231], v[28:31], v[60:63]
  s_waitcnt lgkmcnt(5)
  ds_read_b128 v[28:31], v5 offset:30720
  v_mfma_f32_16x16x32_bf16 v[64:67], v[160:163], v[32:35], v[64:67]
  v_mfma_f32_16x16x32_bf16 v[68:71], v[228:231], v[32:35], v[68:71]
  s_waitcnt lgkmcnt(4)
  ds_read_b128 v[32:35], v5 offset:31744
  v_mfma_f32_16x16x32_bf16 v[56:59], v[52:55], v[36:39], v[56:59]
  v_mfma_f32_16x16x32_bf16 v[60:63], v[232:235], v[36:39], v[60:63]
  s_waitcnt lgkmcnt(4)
  ds_read_b128 v[36:39], v5 offset:32768
  v_mfma_f32_16x16x32_bf16 v[64:67], v[52:55], v[40:43], v[64:67]
  v_mfma_f32_16x16x32_bf16 v[68:71], v[232:235], v[40:43], v[68:71]
  s_waitcnt lgkmcnt(4)
  ds_read_b128 v[40:43], v5 offset:33792
  v_mfma_f32_16x16x32_bf16 v[56:59], v[164:167], v[20:23], v[56:59]
  v_mfma_f32_16x16x32_bf16 v[60:63], v[236:239], v[20:23], v[60:63]
  s_waitcnt lgkmcnt(4)
  ds_read_b128 v[20:23], v5 offset:34816
  v_mfma_f32_16x16x32_bf16 v[64:67], v[164:167], v[24:27], v[64:67]
  v_mfma_f32_16x16x32_bf16 v[68:71], v[236:239], v[24:27], v[68:71]
  s_waitcnt lgkmcnt(4)
  ds_read_b128 v[24:27], v5 offset:35840
  v_mfma_f32_16x16x32_bf16 v[56:59], v[168:171], v[28:31], v[56:59]
  v_mfma_f32_16x16x32_bf16 v[60:63], v[240:243], v[28:31], v[60:63]
  s_waitcnt lgkmcnt(4)
  ds_read_b128 v[28:31], v5 offset:36864
  v_mfma_f32_16x16x32_bf16 v[64:67], v[168:171], v[32:35], v[64:67]
  v_mfma_f32_16x16x32_bf16 v[68:71], v[240:243], v[32:35], v[68:71]
  s_waitcnt lgkmcnt(4)
  ds_read_b128 v[32:35], v5 offset:37888
  v_mfma_f32_16x16x32_bf16 v[56:59], v[172:175], v[36:39], v[56:59]
  v_mfma_f32_16x16x32_bf16 v[60:63], v[44:47], v[36:39], v[60:63]
  s_waitcnt lgkmcnt(4)
  ds_read_b128 v[36:39], v5 offset:38912
  v_mfma_f32_16x16x32_bf16 v[64:67], v[172:175], v[40:43], v[64:67]
  v_mfma_f32_16x16x32_bf16 v[68:71], v[44:47], v[40:43], v[68:71]
  s_waitcnt lgkmcnt(4)
  ds_read_b128 v[40:43], v5 offset:39936
  v_mfma_f32_16x16x32_bf16 v[56:59], v[176:179], v[20:23], v[56:59]
  v_mfma_f32_16x16x32_bf16 v[60:63], v[244:247], v[20:23], v[60:63]
  s_waitcnt lgkmcnt(4)
  v_mfma_f32_16x16x32_bf16 v[64:67], v[176:179], v[24:27], v[64:67]
  v_mfma_f32_16x16x32_bf16 v[68:71], v[244:247], v[24:27], v[68:71]
  s_waitcnt lgkmcnt(3)
  v_mfma_f32_16x16x32_bf16 v[56:59], v[180:183], v[28:31], v[56:59]
  v_mfma_f32_16x16x32_bf16 v[60:63], v[248:251], v[28:31], v[60:63]
  s_waitcnt lgkmcnt(2)
  v_mfma_f32_16x16x32_bf16 v[64:67], v[180:183], v[32:35], v[64:67]
  v_mfma_f32_16x16x32_bf16 v[68:71], v[248:251], v[32:35], v[68:71]
  s_waitcnt lgkmcnt(1)
  v_mfma_f32_16x16x32_bf16 v[56:59], v[184:187], v[36:39], v[56:59]
  v_mfma_f32_16x16x32_bf16 v[60:63], v[252:255], v[36:39], v[60:63]
  s_waitcnt lgkmcnt(0)
  v_mfma_f32_16x16x32_bf16 v[64:67], v[184:187], v[40:43], v[64:67]
  v_mfma_f32_16x16x32_bf16 v[68:71], v[252:255], v[40:43], v[68:71]
  s_nop 3
  v_fma_f32 v56, -v16, v88, v56
  v_fma_f32 v57, -v16, v89, v57
  v_fma_f32 v58, -v16, v90, v58
  v_fma_f32 v59, -v16, v91, v59
  v_fma_f32 v60, -v16, v92, v60
  v_fma_f32 v61, -v16, v93, v61
  v_fma_f32 v62, -v16, v94, v62
  v_fma_f32 v63, -v16, v95, v63
  v_mul_f32 v56, v56, v17
  v_mul_f32 v57, v57, v17
  v_mul_f32 v58, v58, v17
  v_mul_f32 v59, v59, v17
  v_mul_f32 v60, v60, v17
  v_mul_f32 v61, v61, v17
  v_mul_f32 v62, v62, v17
  v_mul_f32 v63, v63, v17
  v_cvt_pk_bf16_f32 v56, v56, v57
  v_cvt_pk_bf16_f32 v57, v58, v59
  v_cvt_pk_bf16_f32 v58, v60, v61
  v_cvt_pk_bf16_f32 v59, v62, v63
  buffer_store_dwordx4 v[56:59], v1, s[8:11], s64 offen offset:0 sc1
  v_fma_f32 v64, -v18, v88, v64
  v_fma_f32 v65, -v18, v89, v65
  v_fma_f32 v66, -v18, v90, v66
  v_fma_f32 v67, -v18, v91, v67
  v_fma_f32 v68, -v18, v92, v68
  v_fma_f32 v69, -v18, v93, v69
  v_fma_f32 v70, -v18, v94, v70
  v_fma_f32 v71, -v18, v95, v71
  v_mul_f32 v64, v64, v19
  v_mul_f32 v65, v65, v19
  v_mul_f32 v66, v66, v19
  v_mul_f32 v67, v67, v19
  v_mul_f32 v68, v68, v19
  v_mul_f32 v69, v69, v19
  v_mul_f32 v70, v70, v19
  v_mul_f32 v71, v71, v19
  v_cvt_pk_bf16_f32 v64, v64, v65
  v_cvt_pk_bf16_f32 v65, v66, v67
  v_cvt_pk_bf16_f32 v66, v68, v69
  v_cvt_pk_bf16_f32 v67, v70, v71
  buffer_store_dwordx4 v[64:67], v1, s[8:11], s64 offen offset:1024 sc1
  s_mov_b32 s70, s54
  s_mov_b64 s[72:73], -1
  s_add_u32 s54, s54, 512
  s_add_u32 s53, s53, 1179648
  s_add_u32 s50, s50, 1
  s_cmp_eq_u32 s50, 64
  s_cselect_b32 s59, 1, s59
  s_cmp_lt_u32 s50, 3
  s_cselect_b32 s60, 1, s59
  s_waitcnt vmcnt(2)
  s_cmp_eq_u32 s60, 0
  s_cbranch_scc1 P1_LOOP
  s_waitcnt vmcnt(0)
  s_and_b64 exec, s[72:73], 1
  buffer_store_dword v4, v1, s[8:11], s70 offen sc1
  s_mov_b64 exec, -1
  s_mov_b64 s[72:73], 0
  s_cmp_eq_u32 s59, 0
  s_cbranch_scc1 P1_LOOP
  s_cmp_lt_u32 s50, 64
  s_cbranch_scc1 P1_WAIT
  s_endpgm
GO_W1:
ROLE_W1:
  v_lshlrev_b32 v1, 4, v0
  s_lshl2_add_u32 s55, s48, s46
  v_min_u32 v2, 39, v0
  v_lshlrev_b32 v2, 3, v2
  v_min_u32 v8, 19, v0
  v_mov_b32 v9, 3
  v_add_lshl_u32 v8, v8, 20, 2
  v_bfe_u32 v12, v0, 4, 1
  v_mul_u32_u24 v3, 2560, v12
  v_lshrrev_b32 v12, 5, v0
  v_lshl_add_u32 v3, v12, 7, v3
  v_and_b32 v6, 15, v0
  v_lshlrev_b32 v6, 3, v6
  v_add_u32 v3, v3, v6
  v_add_u32 v3, 0xa000, v3
  s_mul_i32 s58, s46, 10240
  s_lshl_b32 s75, s46, 10
  s_add_u32 s75, s75, 40960
  s_mov_b64 s[76:77], 0
  s_mov_b32 s59, 0
  s_mov_b32 s83, 0
  s_mov_b32 s84, 0
  v_mov_b32 v20, v1
  v_add_u32 v21, 0x400, v1
  s_waitcnt vmcnt(0)
  s_barrier
  s_cmp_lg_u32 s46, 0
  s_cbranch_scc1 arr_387
  v_mov_b32 v12, 1
  s_lshl_b32 s3, s49, 2
  v_mov_b32 v13, s3
  s_mov_b64 exec, 1
  buffer_atomic_add v12, v13, s[12:15], 0 offen sc1
  s_mov_b64 exec, -1
arr_387:
  s_lshl_b32 s3, s49, 2
  v_mov_b32 v13, s3
  s_nop 1
ibw_388:
  buffer_load_dword v12, v13, s[12:15], 0 offen sc1
  s_waitcnt vmcnt(0)
  v_cmp_ne_u32 vcc, 256, v12
  s_nop 0
  s_cbranch_vccz ibw_389
  s_sleep 8
  s_sub_u32 s47, s47, 1
  s_cbranch_scc0 ibw_388
  s_branch ABORT
ibw_389:
  s_cmp_lg_u32 s49, 0
  s_cbranch_scc1 ibok_390
  v_and_b32 v13, 7, v0
  v_lshlrev_b32 v13, 2, v13
  buffer_load_dword v12, v13, s[12:15], 0 offen offset:32 sc1
  s_waitcnt vmcnt(0)
  v_cmp_ne_u32 vcc, 32, v12
  s_nop 0
  s_cbranch_vccz ibok_390
  s_barrier
  s_mov_b32 s49, 1
  s_mov_b32 s3, s2
  s_branch DISPATCH
ibok_390:
  s_mov_b32 s60, 0
  v_mov_b32 v13, 0
  s_cmp_lg_u32 s46, 0
  s_cbranch_scc1 w0_391
fl_392:
  buffer_load_dword v12, v13, s[8:11], s60 offen sc1
  s_waitcnt vmcnt(0)
  v_cmp_eq_u32 vcc, 0, v12
  s_nop 0
  s_cbranch_vccz fo_393
  s_sleep 32
  s_sub_u32 s47, s47, 1
  s_cbranch_scc0 fl_392
  s_branch ABORT
fo_393:
w0_391:
  s_barrier
  s_mov_b32 s4, s32
  s_mov_b32 s5, s33
  s_mov_b32 s6, 819200
  s_mov_b32 s7, 0x20000
  s_lshl_b32 s60, s55, 6
  s_mul_i32 s63, s46, 40960
  v_lshrrev_b32 v15, 2, v0
  v_mul_u32_u24 v15, 1280, v15
  v_and_b32 v16, 3, v0
  v_lshl_add_u32 v12, v16, 4, v15
  v_lshrrev_b32 v15, 2, v0
  v_mul_u32_u24 v15, 64, v15
  v_and_b32 v16, 3, v0
  v_lshl_add_u32 v15, v16, 3, v15
  v_add_u32 v13, s63, v15
  s_add_u32 m0, s63, 0
  s_add_u32 s65, s60, 0
  buffer_load_dwordx4 v12, s[4:7], s65 offen lds
  s_add_u32 m0, s63, 1024
  s_add_u32 s65, s60, 20480
  buffer_load_dwordx4 v12, s[4:7], s65 offen lds
  s_add_u32 m0, s63, 2048
  s_add_u32 s65, s60, 40960
  buffer_load_dwordx4 v12, s[4:7], s65 offen lds
  s_add_u32 m0, s63, 3072
  s_add_u32 s65, s60, 61440
  buffer_load_dwordx4 v12, s[4:7], s65 offen lds
  s_add_u32 m0, s63, 4096
  s_add_u32 s65, s60, 81920
  buffer_load_dwordx4 v12, s[4:7], s65 offen lds
  s_add_u32 m0, s63, 5120
  s_add_u32 s65, s60, 102400
  buffer_load_dwordx4 v12, s[4:7], s65 offen lds
  s_add_u32 m0, s63, 6144
  s_add_u32 s65, s60, 122880
  buffer_load_dwordx4 v12, s[4:7], s65 offen lds
  s_add_u32 m0, s63, 7168
  s_add_u32 s65, s60, 143360
  buffer_load_dwordx4 v12, s[4:7], s65 offen lds
  s_add_u32 m0, s63, 8192
  s_add_u32 s65, s60, 163840
  buffer_load_dwordx4 v12, s[4:7], s65 offen lds
  s_add_u32 m0, s63, 9216
  s_add_u32 s65, s60, 184320
  buffer_load_dwordx4 v12, s[4:7], s65 offen lds
  s_add_u32 m0, s63, 10240
  s_add_u32 s65, s60, 204800
  buffer_load_dwordx4 v12, s[4:7], s65 offen lds
  s_add_u32 m0, s63, 11264
  s_add_u32 s65, s60, 225280
  buffer_load_dwordx4 v12, s[4:7], s65 offen lds
  s_add_u32 m0, s63, 12288
  s_add_u32 s65, s60, 245760
  buffer_load_dwordx4 v12, s[4:7], s65 offen lds
  s_add_u32 m0, s63, 13312
  s_add_u32 s65, s60, 266240
  buffer_load_dwordx4 v12, s[4:7], s65 offen lds
  s_add_u32 m0, s63, 14336
  s_add_u32 s65, s60, 286720
  buffer_load_dwordx4 v12, s[4:7], s65 offen lds
  s_add_u32 m0, s63, 15360
  s_add_u32 s65, s60, 307200
  buffer_load_dwordx4 v12, s[4:7], s65 offen lds
  s_add_u32 m0, s63, 16384
  s_add_u32 s65, s60, 327680
  buffer_load_dwordx4 v12, s[4:7], s65 offen lds
  s_add_u32 m0, s63, 17408
  s_add_u32 s65, s60, 348160
  buffer_load_dwordx4 v12, s[4:7], s65 offen lds
  s_add_u32 m0, s63, 18432
  s_add_u32 s65, s60, 368640
  buffer_load_dwordx4 v12, s[4:7], s65 offen lds
  s_add_u32 m0, s63, 19456
  s_add_u32 s65, s60, 389120
  buffer_load_dwordx4 v12, s[4:7], s65 offen lds
  s_add_u32 m0, s63, 20480
  s_add_u32 s65, s60, 409600
  buffer_load_dwordx4 v12, s[4:7], s65 offen lds
  s_add_u32 m0, s63, 21504
  s_add_u32 s65, s60, 430080
  buffer_load_dwordx4 v12, s[4:7], s65 offen lds
  s_add_u32 m0, s63, 22528
  s_add_u32 s65, s60, 450560
  buffer_load_dwordx4 v12, s[4:7], s65 offen lds
  s_add_u32 m0, s63, 23552
  s_add_u32 s65, s60, 471040
  buffer_load_dwordx4 v12, s[4:7], s65 offen lds
  s_add_u32 m0, s63, 24576
  s_add_u32 s65, s60, 491520
  buffer_load_dwordx4 v12, s[4:7], s65 offen lds
  s_add_u32 m0, s63, 25600
  s_add_u32 s65, s60, 512000
  buffer_load_dwordx4 v12, s[4:7], s65 offen lds
  s_add_u32 m0, s63, 26624
  s_add_u32 s65, s60, 532480
  buffer_load_dwordx4 v12, s[4:7], s65 offen lds
  s_add_u32 m0, s63, 27648
  s_add_u32 s65, s60, 552960
  buffer_load_dwordx4 v12, s[4:7], s65 offen lds
  s_add_u32 m0, s63, 28672
  s_add_u32 s65, s60, 573440
  buffer_load_dwordx4 v12, s[4:7], s65 offen lds
  s_add_u32 m0, s63, 29696
  s_add_u32 s65, s60, 593920
  buffer_load_dwordx4 v12, s[4:7], s65 offen lds
  s_add_u32 m0, s63, 30720
  s_add_u32 s65, s60, 614400
  buffer_load_dwordx4 v12, s[4:7], s65 offen lds
  s_add_u32 m0, s63, 31744
  s_add_u32 s65, s60, 634880
  buffer_load_dwordx4 v12, s[4:7], s65 offen lds
  s_add_u32 m0, s63, 32768
  s_add_u32 s65, s60, 655360
  buffer_load_dwordx4 v12, s[4:7], s65 offen lds
  s_add_u32 m0, s63, 33792
  s_add_u32 s65, s60, 675840
  buffer_load_dwordx4 v12, s[4:7], s65 offen lds
  s_add_u32 m0, s63, 34816
  s_add_u32 s65, s60, 696320
  buffer_load_dwordx4 v12, s[4:7], s65 offen lds
  s_add_u32 m0, s63, 35840
  s_add_u32 s65, s60, 716800
  buffer_load_dwordx4 v12, s[4:7], s65 offen lds
  s_add_u32 m0, s63, 36864
  s_add_u32 s65, s60, 737280
  buffer_load_dwordx4 v12, s[4:7], s65 offen lds
  s_add_u32 m0, s63, 37888
  s_add_u32 s65, s60, 757760
  buffer_load_dwordx4 v12, s[4:7], s65 offen lds
  s_add_u32 m0, s63, 38912
  s_add_u32 s65, s60, 778240
  buffer_load_dwordx4 v12, s[4:7], s65 offen lds
  s_add_u32 m0, s63, 39936
  s_add_u32 s65, s60, 798720
  buffer_load_dwordx4 v12, s[4:7], s65 offen lds
  s_waitcnt vmcnt(20)
  ds_read_b64_tr_b16 a[0:1], v13 offset:0
  ds_read_b64_tr_b16 a[2:3], v13 offset:1024
  ds_read_b64_tr_b16 a[4:5], v13 offset:32
  ds_read_b64_tr_b16 a[6:7], v13 offset:1056
  ds_read_b64_tr_b16 a[8:9], v13 offset:2048
  ds_read_b64_tr_b16 a[10:11], v13 offset:3072
  ds_read_b64_tr_b16 a[12:13], v13 offset:2080
  ds_read_b64_tr_b16 a[14:15], v13 offset:3104
  ds_read_b64_tr_b16 a[16:17], v13 offset:4096
  ds_read_b64_tr_b16 a[18:19], v13 offset:5120
  ds_read_b64_tr_b16 a[20:21], v13 offset:4128
  ds_read_b64_tr_b16 a[22:23], v13 offset:5152
  s_waitcnt lgkmcnt(4)
  ds_read_b64_tr_b16 a[24:25], v13 offset:6144
  ds_read_b64_tr_b16 a[26:27], v13 offset:7168
  ds_read_b64_tr_b16 a[28:29], v13 offset:6176
  ds_read_b64_tr_b16 a[30:31], v13 offset:7200
  ds_read_b64_tr_b16 a[32:33], v13 offset:8192
  ds_read_b64_tr_b16 a[34:35], v13 offset:9216
  ds_read_b64_tr_b16 a[36:37], v13 offset:8224
  ds_read_b64_tr_b16 a[38:39], v13 offset:9248
  ds_read_b64_tr_b16 a[40:41], v13 offset:10240
  ds_read_b64_tr_b16 a[42:43], v13 offset:11264
  ds_read_b64_tr_b16 a[44:45], v13 offset:10272
  ds_read_b64_tr_b16 a[46:47], v13 offset:11296
  s_waitcnt lgkmcnt(4)
  ds_read_b64_tr_b16 a[48:49], v13 offset:12288
  ds_read_b64_tr_b16 a[50:51], v13 offset:13312
  ds_read_b64_tr_b16 a[52:53], v13 offset:12320
  ds_read_b64_tr_b16 a[54:55], v13 offset:13344
  ds_read_b64_tr_b16 a[56:57], v13 offset:14336
  ds_read_b64_tr_b16 a[58:59], v13 offset:15360
  ds_read_b64_tr_b16 a[60:61], v13 offset:14368
  ds_read_b64_tr_b16 a[62:63], v13 offset:15392
  ds_read_b64_tr_b16 a[64:65], v13 offset:16384
  ds_read_b64_tr_b16 a[66:67], v13 offset:17408
  ds_read_b64_tr_b16 a[68:69], v13 offset:16416
  ds_read_b64_tr_b16 a[70:71], v13 offset:17440
  s_waitcnt lgkmcnt(4)
  ds_read_b64_tr_b16 a[72:73], v13 offset:18432
  ds_read_b64_tr_b16 a[74:75], v13 offset:19456
  ds_read_b64_tr_b16 a[76:77], v13 offset:18464
  ds_read_b64_tr_b16 a[78:79], v13 offset:19488
  s_waitcnt lgkmcnt(0)
  s_waitcnt vmcnt(0)
  ds_read_b64_tr_b16 a[80:81], v13 offset:20480
  ds_read_b64_tr_b16 a[82:83], v13 offset:21504
  ds_read_b64_tr_b16 a[84:85], v13 offset:20512
  ds_read_b64_tr_b16 a[86:87], v13 offset:21536
  ds_read_b64_tr_b16 a[88:89], v13 offset:22528
  ds_read_b64_tr_b16 a[90:91], v13 offset:23552
  ds_read_b64_tr_b16 a[92:93], v13 offset:22560
  ds_read_b64_tr_b16 a[94:95], v13 offset:23584
  ds_read_b64_tr_b16 a[96:97], v13 offset:24576
  ds_read_b64_tr_b16 a[98:99], v13 offset:25600
  ds_read_b64_tr_b16 a[100:101], v13 offset:24608
  ds_read_b64_tr_b16 a[102:103], v13 offset:25632
  s_waitcnt lgkmcnt(4)
  ds_read_b64_tr_b16 a[104:105], v13 offset:26624
  ds_read_b64_tr_b16 a[106:107], v13 offset:27648
  ds_read_b64_tr_b16 a[108:109], v13 offset:26656
  ds_read_b64_tr_b16 a[110:111], v13 offset:27680
  ds_read_b64_tr_b16 a[112:113], v13 offset:28672
  ds_read_b64_tr_b16 a[114:115], v13 offset:29696
  ds_read_b64_tr_b16 a[116:117], v13 offset:28704
  ds_read_b64_tr_b16 a[118:119], v13 offset:29728
  ds_read_b64_tr_b16 a[120:121], v13 offset:30720
  ds_read_b64_tr_b16 a[122:123], v13 offset:31744
  ds_read_b64_tr_b16 a[124:125], v13 offset:30752
  ds_read_b64_tr_b16 a[126:127], v13 offset:31776
  s_waitcnt lgkmcnt(4)
  ds_read_b64_tr_b16 a[128:129], v13 offset:32768
  ds_read_b64_tr_b16 a[130:131], v13 offset:33792
  ds_read_b64_tr_b16 a[132:133], v13 offset:32800
  ds_read_b64_tr_b16 a[134:135], v13 offset:33824
  ds_read_b64_tr_b16 a[136:137], v13 offset:34816
  ds_read_b64_tr_b16 a[138:139], v13 offset:35840
  ds_read_b64_tr_b16 a[140:141], v13 offset:34848
  ds_read_b64_tr_b16 a[142:143], v13 offset:35872
  ds_read_b64_tr_b16 a[144:145], v13 offset:36864
  ds_read_b64_tr_b16 a[146:147], v13 offset:37888
  ds_read_b64_tr_b16 a[148:149], v13 offset:36896
  ds_read_b64_tr_b16 a[150:151], v13 offset:37920
  s_waitcnt lgkmcnt(4)
  ds_read_b64_tr_b16 a[152:153], v13 offset:38912
  ds_read_b64_tr_b16 a[154:155], v13 offset:39936
  ds_read_b64_tr_b16 a[156:157], v13 offset:38944
  ds_read_b64_tr_b16 a[158:159], v13 offset:39968
  s_waitcnt lgkmcnt(0)
  v_mov_b32 v32, 0x3f803f80
  v_mov_b32 v33, 0x3f803f80
  v_mov_b32 v34, 0x3f803f80
  v_mov_b32 v35, 0x3f803f80
  s_nop 1
  v_mfma_f32_16x16x32_bf16 v[80:83], a[0:3], v[32:35], 0
  v_mfma_f32_16x16x32_bf16 v[84:87], a[4:7], v[32:35], 0
  v_mfma_f32_16x16x32_bf16 v[80:83], a[8:11], v[32:35], v[80:83]
  v_mfma_f32_16x16x32_bf16 v[84:87], a[12:15], v[32:35], v[84:87]
  v_mfma_f32_16x16x32_bf16 v[80:83], a[16:19], v[32:35], v[80:83]
  v_mfma_f32_16x16x32_bf16 v[84:87], a[20:23], v[32:35], v[84:87]
  v_mfma_f32_16x16x32_bf16 v[80:83], a[24:27], v[32:35], v[80:83]
  v_mfma_f32_16x16x32_bf16 v[84:87], a[28:31], v[32:35], v[84:87]
  v_mfma_f32_16x16x32_bf16 v[80:83], a[32:35], v[32:35], v[80:83]
  v_mfma_f32_16x16x32_bf16 v[84:87], a[36:39], v[32:35], v[84:87]
  v_mfma_f32_16x16x32_bf16 v[80:83], a[40:43], v[32:35], v[80:83]
  v_mfma_f32_16x16x32_bf16 v[84:87], a[44:47], v[32:35], v[84:87]
  v_mfma_f32_16x16x32_bf16 v[80:83], a[48:51], v[32:35], v[80:83]
  v_mfma_f32_16x16x32_bf16 v[84:87], a[52:55], v[32:35], v[84:87]
  v_mfma_f32_16x16x32_bf16 v[80:83], a[56:59], v[32:35], v[80:83]
  v_mfma_f32_16x16x32_bf16 v[84:87], a[60:63], v[32:35], v[84:87]
  v_mfma_f32_16x16x32_bf16 v[80:83], a[64:67], v[32:35], v[80:83]
  v_mfma_f32_16x16x32_bf16 v[84:87], a[68:71], v[32:35], v[84:87]
  v_mfma_f32_16x16x32_bf16 v[80:83], a[72:75], v[32:35], v[80:83]
  v_mfma_f32_16x16x32_bf16 v[84:87], a[76:79], v[32:35], v[84:87]
  v_mfma_f32_16x16x32_bf16 v[80:83], a[80:83], v[32:35], v[80:83]
  v_mfma_f32_16x16x32_bf16 v[84:87], a[84:87], v[32:35], v[84:87]
  v_mfma_f32_16x16x32_bf16 v[80:83], a[88:91], v[32:35], v[80:83]
  v_mfma_f32_16x16x32_bf16 v[84:87], a[92:95], v[32:35], v[84:87]
  v_mfma_f32_16x16x32_bf16 v[80:83], a[96:99], v[32:35], v[80:83]
  v_mfma_f32_16x16x32_bf16 v[84:87], a[100:103], v[32:35], v[84:87]
  v_mfma_f32_16x16x32_bf16 v[80:83], a[104:107], v[32:35], v[80:83]
  v_mfma_f32_16x16x32_bf16 v[84:87], a[108:111], v[32:35], v[84:87]
  v_mfma_f32_16x16x32_bf16 v[80:83], a[112:115], v[32:35], v[80:83]
  v_mfma_f32_16x16x32_bf16 v[84:87], a[116:119], v[32:35], v[84:87]
  v_mfma_f32_16x16x32_bf16 v[80:83], a[120:123], v[32:35], v[80:83]
  v_mfma_f32_16x16x32_bf16 v[84:87], a[124:127], v[32:35], v[84:87]
  v_mfma_f32_16x16x32_bf16 v[80:83], a[128:131], v[32:35], v[80:83]
  v_mfma_f32_16x16x32_bf16 v[84:87], a[132:135], v[32:35], v[84:87]
  v_mfma_f32_16x16x32_bf16 v[80:83], a[136:139], v[32:35], v[80:83]
  v_mfma_f32_16x16x32_bf16 v[84:87], a[140:143], v[32:35], v[84:87]
  v_mfma_f32_16x16x32_bf16 v[80:83], a[144:147], v[32:35], v[80:83]
  v_mfma_f32_16x16x32_bf16 v[84:87], a[148:151], v[32:35], v[84:87]
  v_mfma_f32_16x16x32_bf16 v[80:83], a[152:155], v[32:35], v[80:83]
  v_mfma_f32_16x16x32_bf16 v[84:87], a[156:159], v[32:35], v[84:87]
  v_lshrrev_b32 v12, 4, v0
  v_mul_u32_u24 v12, 40960, v12
  v_lshl_add_u32 v12, v6, 4, v12
  s_lshl_b32 s60, s55, 11
  s_add_u32 s61, s60, 22650880
  buffer_load_dword v13, v12, s[8:11], s61 offen sc1
  s_add_u32 s61, s60, 22814720
  buffer_load_dword v13, v12, s[8:11], s61 offen sc1
  s_waitcnt vmcnt(0)
  s_barrier
  s_mov_b32 s50, 0
  s_mov_b32 s56, 0
  s_add_u32 s62, s50, 0
  s_min_u32 s62, s62, 127
  s_sub_i32 s60, s62, 13
  s_sub_i32 s53, s62, 12
  s_ashr_i32 s60, s60, 1
  s_ashr_i32 s53, s53, 1
  s_sub_i32 s61, s62, 64
  s_max_i32 s60, s60, s61
  s_add_i32 s61, s61, 1
  s_max_i32 s53, s53, s61
  s_max_i32 s60, s60, 0
  s_max_i32 s53, s53, 0
  s_sub_i32 s53, s53, s60
  s_sub_i32 s54, s62, s60
  s_sub_i32 s60, s60, s54
  s_mul_i32 s60, s60, s53
  s_add_i32 s54, s54, s60
  s_lshl_b32 s82, s53, 15
  s_add_u32 s82, s82, 327680
  s_lshl_b32 s60, s53, 6
  s_add_u32 s60, s60, s54
  s_lshl_b32 s70, s60, 9
  s_add_u32 s70, s70, 262144
  s_mul_i32 s69, s60, 46080
  s_add_u32 s69, s69, 16384000
  s_add_u32 s68, s69, s58
  s_add_u32 s71, s56, s58
W1_F_WAIT:
su_394:
  buffer_load_dword v156, v8, s[8:11], s82 offen sc1
  buffer_load_dwordx2 v[10:11], v2, s[8:11], s70 offen sc1
  s_waitcnt vmcnt(0)
  v_add_u32 v156, v156, v9
  v_min3_u32 v10, v10, v11, 1
  v_mul_u32_u24 v156, v156, v10
  v_cmp_ge_i32 vcc, s54, v156
  s_nop 0
  s_cbranch_vccz so_395
  s_sleep 2
  s_sub_u32 s47, s47, 1
  s_cbranch_scc0 su_394
  s_branch ABORT
so_395:
  s_add_u32 m0, s71, 0
  s_add_u32 s65, s68, 0
  buffer_load_dwordx4 v20, s[8:11], s65 offen offset:0 sc1 lds
  buffer_load_dwordx4 v20, s[8:11], s65 offen offset:2048 sc1 lds
  s_add_u32 m0, s71, 4096
  s_add_u32 s65, s68, 4096
  buffer_load_dwordx4 v20, s[8:11], s65 offen offset:0 sc1 lds
  buffer_load_dwordx4 v20, s[8:11], s65 offen offset:2048 sc1 lds
  s_add_u32 m0, s71, 8192
  s_add_u32 s65, s68, 8192
  buffer_load_dwordx4 v20, s[8:11], s65 offen offset:0 sc1 lds
  s_add_u32 m0, s56, s75
  s_add_u32 s65, s69, s75
  buffer_load_dwordx4 v1, s[8:11], s65 offen sc1 lds
  buffer_load_dwordx4 v1, s[8:11], s65 offen offset:1024 sc1 lds
  s_add_u32 m0, s71, 1024
  s_add_u32 s65, s68, 0
  buffer_load_dwordx4 v21, s[8:11], s65 offen offset:0 sc1 lds
  buffer_load_dwordx4 v21, s[8:11], s65 offen offset:2048 sc1 lds
  s_add_u32 m0, s71, 5120
  s_add_u32 s65, s68, 4096
  buffer_load_dwordx4 v21, s[8:11], s65 offen offset:0 sc1 lds
  buffer_load_dwordx4 v21, s[8:11], s65 offen offset:2048 sc1 lds
  s_add_u32 m0, s71, 9216
  s_add_u32 s65, s68, 8192
  buffer_load_dwordx4 v21, s[8:11], s65 offen offset:0 sc1 lds
  s_waitcnt vmcnt(5)
W1_F_LOOP:
  v_add_u32 v7, s56, v1
  v_add_u32 v4, s56, v3
  s_barrier
  ds_read_b128 v[32:35], v7 offset:0
  ds_read_b128 v[36:39], v7 offset:2048
  ds_read_b128 v[40:43], v7 offset:4096
  ds_read_b128 v[44:47], v7 offset:6144
  s_xor_b32 s56, s56, 46080
  s_mov_b32 s51, s53
  s_mov_b32 s52, s54
  s_lshl2_add_u32 s74, s55, s82
  s_add_u32 s74, s74, 0
  s_add_u32 s62, s50, 1
  s_min_u32 s62, s62, 127
  s_sub_i32 s60, s62, 13
  s_sub_i32 s53, s62, 12
  s_ashr_i32 s60, s60, 1
  s_ashr_i32 s53, s53, 1
  s_sub_i32 s61, s62, 64
  s_max_i32 s60, s60, s61
  s_waitcnt lgkmcnt(3)
  v_mfma_f32_16x16x32_bf16 v[64:67], a[0:3], v[32:35], 0
  s_add_i32 s61, s61, 1
  ds_read_b128 v[48:51], v7 offset:8192
  v_add_u32 v12, 0x800, v4
  v_mfma_f32_16x16x32_bf16 v[68:71], a[4:7], v[32:35], 0
  s_waitcnt lgkmcnt(3)
  ds_read_b128 v[52:55], v7 offset:10240
  s_max_i32 s53, s53, s61
  v_mfma_f32_16x16x32_bf16 v[64:67], a[8:11], v[36:39], v[64:67]
  s_max_i32 s60, s60, 0
  ds_read_b128 v[56:59], v7 offset:12288
  s_max_i32 s53, s53, 0
  v_mfma_f32_16x16x32_bf16 v[68:71], a[12:15], v[36:39], v[68:71]
  s_waitcnt lgkmcnt(4)
  ds_read_b128 v[60:63], v7 offset:14336
  s_sub_i32 s53, s53, s60
  v_mfma_f32_16x16x32_bf16 v[64:67], a[16:19], v[40:43], v[64:67]
  s_sub_i32 s54, s62, s60
  ds_read_b128 v[32:35], v7 offset:16384
  s_sub_i32 s60, s60, s54
  v_mfma_f32_16x16x32_bf16 v[68:71], a[20:23], v[40:43], v[68:71]
  s_waitcnt lgkmcnt(5)
  ds_read_b128 v[36:39], v7 offset:18432
  ds_read2_b64 v[88:91], v4 offset0:0 offset1:32
  v_mfma_f32_16x16x32_bf16 v[64:67], a[24:27], v[44:47], v[64:67]
  s_mul_i32 s60, s60, s53
  ds_read_b128 v[40:43], v7 offset:20480
  s_add_i32 s54, s54, s60
  v_mfma_f32_16x16x32_bf16 v[68:71], a[28:31], v[44:47], v[68:71]
  s_waitcnt lgkmcnt(6)
  ds_read2_b64 v[92:95], v4 offset0:64 offset1:96
  s_lshl_b32 s82, s53, 15
  v_mfma_f32_16x16x32_bf16 v[64:67], a[32:35], v[48:51], v[64:67]
  s_add_u32 s82, s82, 327680
  ds_read_b128 v[44:47], v7 offset:22528
  ds_read2_b64 v[96:99], v4 offset0:128 offset1:160
  v_mfma_f32_16x16x32_bf16 v[68:71], a[36:39], v[48:51], v[68:71]
  s_lshl_b32 s60, s53, 6
  ds_read2_b64 v[100:103], v4 offset0:192 offset1:224
  s_add_u32 s60, s60, s54
  v_mfma_f32_16x16x32_bf16 v[64:67], a[40:43], v[52:55], v[64:67]
  s_lshl_b32 s70, s60, 9
  ds_read_b128 v[48:51], v7 offset:24576
  s_add_u32 s70, s70, 262144
  v_mfma_f32_16x16x32_bf16 v[68:71], a[44:47], v[52:55], v[68:71]
  s_waitcnt lgkmcnt(9)
  ds_read2_b64 v[104:107], v12 offset0:0 offset1:32
  v_mfma_f32_16x16x32_bf16 v[64:67], a[48:51], v[56:59], v[64:67]
  ds_read_b128 v[52:55], v7 offset:26624
  v_mfma_f32_16x16x32_bf16 v[68:71], a[52:55], v[56:59], v[68:71]
  v_mfma_f32_16x16x32_bf16 v[64:67], a[56:59], v[60:63], v[64:67]
  ds_read_b128 v[56:59], v7 offset:28672
  v_mfma_f32_16x16x32_bf16 v[68:71], a[60:63], v[60:63], v[68:71]
  s_waitcnt lgkmcnt(10)
  s_waitcnt lgkmcnt(2)
  v_add_f32 v88, v88, v98
  v_mfma_f32_16x16x32_bf16 v[64:67], a[64:67], v[32:35], v[64:67]
  ds_read_b128 v[60:63], v7 offset:30720
  v_add_f32 v89, v89, v99
  v_mfma_f32_16x16x32_bf16 v[68:71], a[68:71], v[32:35], v[68:71]
  v_add_f32 v90, v90, v100
  v_add_f32 v91, v91, v101
  v_mfma_f32_16x16x32_bf16 v[64:67], a[72:75], v[36:39], v[64:67]
  ds_read_b128 v[32:35], v7 offset:32768
  v_add_f32 v92, v92, v102
  v_mfma_f32_16x16x32_bf16 v[68:71], a[76:79], v[36:39], v[68:71]
  v_add_f32 v93, v93, v103
  v_add_f32 v94, v94, v104
  v_mfma_f32_16x16x32_bf16 v[64:67], a[80:83], v[40:43], v[64:67]
  ds_read_b128 v[36:39], v7 offset:34816
  v_add_f32 v95, v95, v105
  v_mfma_f32_16x16x32_bf16 v[68:71], a[84:87], v[40:43], v[68:71]
  v_add_f32 v96, v96, v106
  v_add_f32 v97, v97, v107
  v_mfma_f32_16x16x32_bf16 v[64:67], a[88:91], v[44:47], v[64:67]
  ds_read_b128 v[40:43], v7 offset:36864
  v_add_f32 v88, v88, v90
  v_mfma_f32_16x16x32_bf16 v[68:71], a[92:95], v[44:47], v[68:71]
  s_waitcnt lgkmcnt(5)
  v_add_f32 v89, v89, v91
  v_add_f32 v92, v92, v94
  v_mfma_f32_16x16x32_bf16 v[64:67], a[96:99], v[48:51], v[64:67]
  ds_read_b128 v[44:47], v7 offset:38912
  v_add_f32 v93, v93, v95
  v_mfma_f32_16x16x32_bf16 v[68:71], a[100:103], v[48:51], v[68:71]
  s_waitcnt vmcnt(0)
  v_mov_b32 v19, s83
  s_and_b64 exec, s[76:77], 1
  s_cmp_lg_u32 s49, 0
  s_cbranch_scc1 wt_396
  buffer_store_dword v19, v1, s[8:11], s59 offen
wb_397:
  s_mov_b64 exec, -1
  s_barrier
  v_mfma_f32_16x16x32_bf16 v[64:67], a[104:107], v[52:55], v[64:67]
  s_and_b32 s63, s52, 3
  ds_read_b128 v[48:51], v7 offset:1024
  v_add_f32 v88, v88, v92
  v_mfma_f32_16x16x32_bf16 v[68:71], a[108:111], v[52:55], v[68:71]
  s_waitcnt lgkmcnt(5)
  buffer_load_dword v156, v8, s[8:11], s82 offen sc1
  v_add_f32 v89, v89, v93
  v_mfma_f32_16x16x32_bf16 v[64:67], a[112:115], v[56:59], v[64:67]
  s_lshl2_add_u32 s63, s51, s63
  ds_read_b128 v[52:55], v7 offset:3072
  v_add_f32 v88, v88, v96
  v_mfma_f32_16x16x32_bf16 v[68:71], a[116:119], v[56:59], v[68:71]
  s_mul_i32 s72, s63, 40960
  buffer_load_dwordx2 v[10:11], v2, s[8:11], s70 offen sc1
  v_add_f32 v89, v89, v97
  v_mfma_f32_16x16x32_bf16 v[64:67], a[120:123], v[60:63], v[64:67]
  s_add_u32 s72, s72, 22650880
  ds_read_b128 v[56:59], v7 offset:5120
  v_mov_b32 v90, v88
  v_mfma_f32_16x16x32_bf16 v[68:71], a[124:127], v[60:63], v[68:71]
  s_waitcnt lgkmcnt(5)
  v_mov_b32 v91, v89
  s_lshl_b32 s63, s55, 11
  v_mfma_f32_16x16x32_bf16 v[64:67], a[128:131], v[32:35], v[64:67]
  s_add_u32 s72, s72, s63
  ds_read_b128 v[60:63], v7 offset:7168
  s_mul_i32 s69, s60, 46080
  v_mfma_f32_16x16x32_bf16 v[68:71], a[132:135], v[32:35], v[68:71]
  s_add_u32 s69, s69, 16384000
  v_permlane16_swap_b32 v88, v90
  v_mfma_f32_16x16x32_bf16 v[64:67], a[136:139], v[36:39], v[64:67]
  s_add_u32 s68, s69, s58
  ds_read_b128 v[32:35], v7 offset:9216
  s_add_u32 s71, s56, s58
  v_mfma_f32_16x16x32_bf16 v[68:71], a[140:143], v[36:39], v[68:71]
  s_waitcnt lgkmcnt(5)
  v_permlane16_swap_b32 v89, v91
  v_mfma_f32_16x16x32_bf16 v[64:67], a[144:147], v[40:43], v[64:67]
  ds_read_b128 v[36:39], v7 offset:11264
  v_add_f32 v27, v88, v90
  v_mfma_f32_16x16x32_bf16 v[68:71], a[148:151], v[40:43], v[68:71]
  v_add_f32 v28, v89, v91
  v_mul_f32 v27, 0x3acccccd, v27
  v_mfma_f32_16x16x32_bf16 v[64:67], a[152:155], v[44:47], v[64:67]
  ds_read_b128 v[40:43], v7 offset:13312
  v_mul_f32 v28, 0x3acccccd, v28
  v_mfma_f32_16x16x32_bf16 v[68:71], a[156:159], v[44:47], v[68:71]
  s_waitcnt lgkmcnt(5)
  v_fma_f32 v28, -v27, v27, v28
  v_max_f32 v28, 0, v28
  v_mfma_f32_16x16x32_bf16 v[72:75], a[0:3], v[48:51], 0
  ds_read_b128 v[44:47], v7 offset:15360
  v_mul_f32 v28, 0x3f800054, v28
  v_mfma_f32_16x16x32_bf16 v[76:79], a[4:7], v[48:51], 0
  v_add_f32 v28, 0x2edbe6ff, v28
  v_mfma_f32_16x16x32_bf16 v[72:75], a[8:11], v[52:55], v[72:75]
  ds_read_b128 v[48:51], v7 offset:17408
  v_mfma_f32_16x16x32_bf16 v[76:79], a[12:15], v[52:55], v[76:79]
  s_waitcnt lgkmcnt(5)
  v_rsq_f32 v28, v28
  v_mfma_f32_16x16x32_bf16 v[72:75], a[16:19], v[56:59], v[72:75]
  ds_read_b128 v[52:55], v7 offset:19456
  v_mul_f32 v25, v28, v28
  v_mfma_f32_16x16x32_bf16 v[76:79], a[20:23], v[56:59], v[76:79]
  v_mul_f32 v24, 0xc0135761, v28
  v_mfma_f32_16x16x32_bf16 v[72:75], a[24:27], v[60:63], v[72:75]
  ds_read_b128 v[56:59], v7 offset:21504
  v_mfma_f32_16x16x32_bf16 v[76:79], a[28:31], v[60:63], v[76:79]
  s_waitcnt lgkmcnt(5)
  v_rcp_f32 v26, v28
  v_mfma_f32_16x16x32_bf16 v[72:75], a[32:35], v[32:35], v[72:75]
  ds_read_b128 v[60:63], v7 offset:23552
  v_mul_f32 v25, 0x3d372713, v25
  v_mfma_f32_16x16x32_bf16 v[76:79], a[36:39], v[32:35], v[76:79]
  v_mul_f32 v25, v25, v24
  v_mov_b32 v28, v24
  v_mfma_f32_16x16x32_bf16 v[72:75], a[40:43], v[36:39], v[72:75]
  ds_read_b128 v[32:35], v7 offset:25600
  v_mov_b32 v29, v25
  v_mfma_f32_16x16x32_bf16 v[76:79], a[44:47], v[36:39], v[76:79]
  s_waitcnt lgkmcnt(5)
  v_mov_b32 v30, v26
  v_mov_b32 v31, v27
  v_mfma_f32_16x16x32_bf16 v[72:75], a[48:51], v[40:43], v[72:75]
  ds_read_b128 v[36:39], v7 offset:27648
  v_mfma_f32_16x16x32_bf16 v[76:79], a[52:55], v[40:43], v[76:79]
  v_permlane32_swap_b32 v24, v28
  v_mfma_f32_16x16x32_bf16 v[72:75], a[56:59], v[44:47], v[72:75]
  ds_read_b128 v[40:43], v7 offset:29696
  v_mfma_f32_16x16x32_bf16 v[76:79], a[60:63], v[44:47], v[76:79]
  s_waitcnt lgkmcnt(5)
  v_permlane32_swap_b32 v25, v29
  v_mfma_f32_16x16x32_bf16 v[72:75], a[64:67], v[48:51], v[72:75]
  ds_read_b128 v[44:47], v7 offset:31744
  v_mfma_f32_16x16x32_bf16 v[76:79], a[68:71], v[48:51], v[76:79]
  v_permlane32_swap_b32 v26, v30
  v_mfma_f32_16x16x32_bf16 v[72:75], a[72:75], v[52:55], v[72:75]
  s_waitcnt vmcnt(0)
  ds_read_b128 v[48:51], v7 offset:33792
  v_add_u32 v156, v156, v9
  v_mfma_f32_16x16x32_bf16 v[76:79], a[76:79], v[52:55], v[76:79]
  s_waitcnt lgkmcnt(5)
  v_min3_u32 v10, v10, v11, 1
  v_mul_u32_u24 v156, v156, v10
  v_mfma_f32_16x16x32_bf16 v[72:75], a[80:83], v[56:59], v[72:75]
  ds_read_b128 v[52:55], v7 offset:35840
  v_cmp_ge_i32 vcc, s54, v156
  v_mfma_f32_16x16x32_bf16 v[76:79], a[84:87], v[56:59], v[76:79]
  s_cmp_lg_u64 vcc, 0
  s_cselect_b32 s57, 536870912, 0
  s_or_b32 s66, s68, s57
  v_mfma_f32_16x16x32_bf16 v[72:75], a[88:91], v[60:63], v[72:75]
  s_or_b32 s67, s69, s57
  ds_read_b128 v[56:59], v7 offset:37888
  v_mfma_f32_16x16x32_bf16 v[76:79], a[92:95], v[60:63], v[76:79]
  s_waitcnt lgkmcnt(5)
  s_add_u32 m0, s71, 0
  s_add_u32 s65, s66, 0
  buffer_load_dwordx4 v20, s[8:11], s65 offen offset:0 sc1 lds
  v_mfma_f32_16x16x32_bf16 v[72:75], a[96:99], v[32:35], v[72:75]
  ds_read_b128 v[60:63], v7 offset:39936
  v_mfma_f32_16x16x32_bf16 v[76:79], a[100:103], v[32:35], v[76:79]
  v_permlane32_swap_b32 v27, v31
  v_mfma_f32_16x16x32_bf16 v[72:75], a[104:107], v[36:39], v[72:75]
  v_fma_f32 v64, -v27, v80, v64
  v_fma_f32 v65, -v27, v81, v65
  v_mfma_f32_16x16x32_bf16 v[76:79], a[108:111], v[36:39], v[76:79]
  s_waitcnt lgkmcnt(4)
  buffer_load_dwordx4 v20, s[8:11], s65 offen offset:2048 sc1 lds
  v_fma_f32 v66, -v27, v82, v66
  v_mfma_f32_16x16x32_bf16 v[72:75], a[112:115], v[40:43], v[72:75]
  v_fma_f32 v67, -v27, v83, v67
  v_fma_f32 v68, -v27, v84, v68
  v_mfma_f32_16x16x32_bf16 v[76:79], a[116:119], v[40:43], v[76:79]
  v_fma_f32 v69, -v27, v85, v69
  v_fma_f32 v70, -v27, v86, v70
  v_mfma_f32_16x16x32_bf16 v[72:75], a[120:123], v[44:47], v[72:75]
  v_fma_f32 v71, -v27, v87, v71
  v_mul_f32 v116, v64, v64
  v_mfma_f32_16x16x32_bf16 v[76:79], a[124:127], v[44:47], v[76:79]
  s_waitcnt lgkmcnt(2)
  s_add_u32 m0, s71, 4096
  s_add_u32 s65, s66, 4096
  buffer_load_dwordx4 v20, s[8:11], s65 offen offset:0 sc1 lds
  v_mfma_f32_16x16x32_bf16 v[72:75], a[128:131], v[48:51], v[72:75]
  v_mul_f32 v117, v65, v65
  v_mul_f32 v118, v66, v66
  v_mfma_f32_16x16x32_bf16 v[76:79], a[132:135], v[48:51], v[76:79]
  v_mul_f32 v119, v67, v67
  v_mul_f32 v120, v68, v68
  v_mfma_f32_16x16x32_bf16 v[72:75], a[136:139], v[52:55], v[72:75]
  v_mul_f32 v121, v69, v69
  v_mul_f32 v122, v70, v70
  v_mfma_f32_16x16x32_bf16 v[76:79], a[140:143], v[52:55], v[76:79]
  s_waitcnt lgkmcnt(0)
  buffer_load_dwordx4 v20, s[8:11], s65 offen offset:2048 sc1 lds
  v_mul_f32 v123, v71, v71
  v_mfma_f32_16x16x32_bf16 v[72:75], a[144:147], v[56:59], v[72:75]
  v_fma_f32 v116, v116, v25, v24
  v_fma_f32 v117, v117, v25, v24
  v_mfma_f32_16x16x32_bf16 v[76:79], a[148:151], v[56:59], v[76:79]
  v_fma_f32 v118, v118, v25, v24
  v_fma_f32 v119, v119, v25, v24
  v_mfma_f32_16x16x32_bf16 v[72:75], a[152:155], v[60:63], v[72:75]
  v_fma_f32 v120, v120, v25, v24
  v_fma_f32 v121, v121, v25, v24
  v_mfma_f32_16x16x32_bf16 v[76:79], a[156:159], v[60:63], v[76:79]
  s_add_u32 m0, s71, 8192
  s_add_u32 s65, s66, 8192
  buffer_load_dwordx4 v20, s[8:11], s65 offen offset:0 sc1 lds
  s_add_u32 m0, s56, s75
  s_add_u32 s65, s67, s75
  buffer_load_dwordx4 v1, s[8:11], s65 offen sc1 lds
  v_fma_f32 v122, v122, v25, v24
  v_fma_f32 v123, v123, v25, v24
  v_mul_f32 v116, v116, v64
  v_mul_f32 v117, v117, v65
  v_mul_f32 v118, v118, v66
  v_mul_f32 v119, v119, v67
  v_mul_f32 v120, v120, v68
  v_mul_f32 v121, v121, v69
  v_mul_f32 v122, v122, v70
  v_mul_f32 v123, v123, v71
  v_exp_f32 v116, v116
  v_exp_f32 v117, v117
  buffer_load_dwordx4 v1, s[8:11], s65 offen offset:1024 sc1 lds
  v_exp_f32 v118, v118
  v_exp_f32 v119, v119
  v_exp_f32 v120, v120
  v_exp_f32 v121, v121
  v_exp_f32 v122, v122
  v_exp_f32 v123, v123
  v_fma_f32 v116, v116, v26, v26
  v_fma_f32 v117, v117, v26, v26
  v_fma_f32 v118, v118, v26, v26
  v_fma_f32 v119, v119, v26, v26
  v_fma_f32 v120, v120, v26, v26
  v_fma_f32 v121, v121, v26, v26
  s_add_u32 m0, s71, 1024
  s_add_u32 s65, s66, 0
  buffer_load_dwordx4 v21, s[8:11], s65 offen offset:0 sc1 lds
  v_fma_f32 v122, v122, v26, v26
  v_fma_f32 v123, v123, v26, v26
  v_rcp_f32 v116, v116
  v_rcp_f32 v117, v117
  v_rcp_f32 v118, v118
  v_rcp_f32 v119, v119
  v_rcp_f32 v120, v120
  v_rcp_f32 v121, v121
  v_rcp_f32 v122, v122
  v_rcp_f32 v123, v123
  v_mul_f32 v64, v64, v116
  v_mul_f32 v65, v65, v117
  buffer_load_dwordx4 v21, s[8:11], s65 offen offset:2048 sc1 lds
  v_mul_f32 v66, v66, v118
  v_mul_f32 v67, v67, v119
  v_mul_f32 v68, v68, v120
  v_mul_f32 v69, v69, v121
  v_mul_f32 v70, v70, v122
  v_mul_f32 v71, v71, v123
  v_cvt_pk_bf16_f32 v108, v64, v65
  v_cvt_pk_bf16_f32 v109, v66, v67
  v_cvt_pk_bf16_f32 v110, v68, v69
  v_cvt_pk_bf16_f32 v111, v70, v71
  s_cmp_lg_u32 s49, 0
  s_cbranch_scc1 wt_398
  buffer_store_dwordx4 v[108:111], v1, s[8:11], s72 offen offset:0
wb_399:
  v_pk_fma_f32 v[72:73], v[80:81], v[30:31], v[72:73] op_sel:[0,1,0] op_sel_hi:[1,1,1] neg_lo:[0,1,0] neg_hi:[0,1,0]
  s_add_u32 m0, s71, 5120
  s_add_u32 s65, s66, 4096
  buffer_load_dwordx4 v21, s[8:11], s65 offen offset:0 sc1 lds
  v_pk_fma_f32 v[74:75], v[82:83], v[30:31], v[74:75] op_sel:[0,1,0] op_sel_hi:[1,1,1] neg_lo:[0,1,0] neg_hi:[0,1,0]
  v_pk_fma_f32 v[76:77], v[84:85], v[30:31], v[76:77] op_sel:[0,1,0] op_sel_hi:[1,1,1] neg_lo:[0,1,0] neg_hi:[0,1,0]
  v_pk_fma_f32 v[78:79], v[86:87], v[30:31], v[78:79] op_sel:[0,1,0] op_sel_hi:[1,1,1] neg_lo:[0,1,0] neg_hi:[0,1,0]
  v_pk_mul_f32 v[116:117], v[72:73], v[72:73]
  v_pk_mul_f32 v[118:119], v[74:75], v[74:75]
  v_pk_mul_f32 v[120:121], v[76:77], v[76:77]
  v_pk_mul_f32 v[122:123], v[78:79], v[78:79]
  v_pk_fma_f32 v[116:117], v[116:117], v[28:29], v[28:29] op_sel:[0,1,0] op_sel_hi:[1,1,0]
  v_pk_fma_f32 v[118:119], v[118:119], v[28:29], v[28:29] op_sel:[0,1,0] op_sel_hi:[1,1,0]
  v_pk_fma_f32 v[120:121], v[120:121], v[28:29], v[28:29] op_sel:[0,1,0] op_sel_hi:[1,1,0]
  v_pk_fma_f32 v[122:123], v[122:123], v[28:29], v[28:29] op_sel:[0,1,0] op_sel_hi:[1,1,0]
  v_pk_mul_f32 v[116:117], v[116:117], v[72:73]
  buffer_load_dwordx4 v21, s[8:11], s65 offen offset:2048 sc1 lds
  v_pk_mul_f32 v[118:119], v[118:119], v[74:75]
  v_pk_mul_f32 v[120:121], v[120:121], v[76:77]
  v_pk_mul_f32 v[122:123], v[122:123], v[78:79]
  v_exp_f32 v116, v116
  v_exp_f32 v117, v117
  v_exp_f32 v118, v118
  v_exp_f32 v119, v119
  v_exp_f32 v120, v120
  v_exp_f32 v121, v121
  v_exp_f32 v122, v122
  v_exp_f32 v123, v123
  v_pk_fma_f32 v[116:117], v[116:117], v[30:31], v[30:31] op_sel_hi:[1,0,0]
  s_add_u32 m0, s71, 9216
  s_add_u32 s65, s66, 8192
  buffer_load_dwordx4 v21, s[8:11], s65 offen offset:0 sc1 lds
  v_pk_fma_f32 v[118:119], v[118:119], v[30:31], v[30:31] op_sel_hi:[1,0,0]
  v_pk_fma_f32 v[120:121], v[120:121], v[30:31], v[30:31] op_sel_hi:[1,0,0]
  v_pk_fma_f32 v[122:123], v[122:123], v[30:31], v[30:31] op_sel_hi:[1,0,0]
  v_rcp_f32 v116, v116
  v_rcp_f32 v117, v117
  v_rcp_f32 v118, v118
  v_rcp_f32 v119, v119
  v_rcp_f32 v120, v120
  v_rcp_f32 v121, v121
  v_rcp_f32 v122, v122
  v_rcp_f32 v123, v123
  v_pk_mul_f32 v[72:73], v[72:73], v[116:117]
  v_pk_mul_f32 v[74:75], v[74:75], v[118:119]
  v_pk_mul_f32 v[76:77], v[76:77], v[120:121]
  v_pk_mul_f32 v[78:79], v[78:79], v[122:123]
  v_cvt_pk_bf16_f32 v112, v72, v73
  v_cvt_pk_bf16_f32 v113, v74, v75
  v_cvt_pk_bf16_f32 v114, v76, v77
  v_cvt_pk_bf16_f32 v115, v78, v79
  s_cmp_lg_u32 s49, 0
  s_cbranch_scc1 wt_400
  buffer_store_dwordx4 v[112:115], v1, s[8:11], s72 offen offset:1024
wb_401:
  s_mov_b32 s59, s74
  s_add_u32 s83, s52, 1
  s_cmp_eq_u32 s52, 63
  s_cselect_b32 s83, 65, s83
  s_mov_b64 s[76:77], -1
  s_add_u32 s50, s50, 1
  s_cmp_eq_u32 s50, 128
  s_cselect_b32 s57, 1, s57
  s_waitcnt vmcnt(7)
  s_cmp_eq_u32 s57, 0
  s_cbranch_scc1 W1_F_LOOP
  s_waitcnt vmcnt(0)
  v_mov_b32 v19, s83
  s_and_b64 exec, s[76:77], 1
  s_cmp_lg_u32 s49, 0
  s_cbranch_scc1 wt_402
  buffer_store_dword v19, v1, s[8:11], s59 offen
wb_403:
  s_mov_b64 exec, -1
  s_mov_b64 s[76:77], 0
  s_cmp_lt_u32 s50, 128
  s_cbranch_scc1 W1_F_WAIT
  s_endpgm
wt_396:
  s_nop 7
  buffer_store_dword v19, v1, s[8:11], s59 offen sc1
  s_branch wb_397
wt_398:
  s_nop 7
  buffer_store_dwordx4 v[108:111], v1, s[8:11], s72 offen offset:0 sc1
  s_branch wb_399
wt_400:
  s_nop 7
  buffer_store_dwordx4 v[112:115], v1, s[8:11], s72 offen offset:1024 sc1
  s_branch wb_401
wt_402:
  s_nop 7
  buffer_store_dword v19, v1, s[8:11], s59 offen sc1
  s_branch wb_403
GO_W2:
ROLE_W2:
  v_lshlrev_b32 v1, 4, v0
  s_lshl2_add_u32 s55, s48, s46
  v_min_u32 v2, 39, v0
  v_lshlrev_b32 v2, 3, v2
  v_min_u32 v8, 39, v0
  v_mov_b32 v9, -1
  v_cmp_le_u32 vcc, 20, v8
  v_mov_b32 v12, 4
  s_nop 0
  v_cndmask_b32 v9, v9, v12, vcc
  v_mov_b32 v12, 68
  v_cndmask_b32 v12, 0, v12, vcc
  v_add_u32 v8, v8, v12
  v_add_lshl_u32 v8, v8, 0, 2
  v_bfe_u32 v12, v0, 4, 1
  v_mul_u32_u24 v3, 2560, v12
  v_lshrrev_b32 v12, 5, v0
  v_lshl_add_u32 v3, v12, 7, v3
  v_and_b32 v6, 15, v0
  v_lshlrev_b32 v6, 3, v6
  v_add_u32 v3, v3, v6
  v_add_u32 v3, 0xa000, v3
  s_mul_i32 s58, s46, 10240
  s_lshl_b32 s75, s46, 10
  s_add_u32 s75, s75, 40960
  s_mov_b64 s[76:77], 0
  s_mov_b32 s59, 0
  s_mov_b32 s83, 0
  s_mov_b32 s84, 0
  s_lshr_b32 s60, s46, 1
  s_add_u32 s60, s60, 1
  s_sub_u32 s61, 32, s60
  s_add_u32 s60, s60, 32
  s_bitcmp1_b32 s46, 0
  s_cselect_b32 s60, s60, s61
  v_and_b32 v12, 15, v0
  v_add_u32 v12, s60, v12
  v_lshrrev_b32 v13, 5, v12
  v_cmp_ne_u32 s[78:79], 1, v13
  v_bfe_u32 v13, v12, 4, 1
  v_lshlrev_b32 v22, 10, v13
  v_and_b32 v13, 15, v12
  v_lshl_add_u32 v22, v13, 4, v22
  v_lshrrev_b32 v13, 4, v0
  v_lshl_add_u32 v22, v13, 8, v22
  v_and_b32 v12, 15, v0
  v_add_u32 v12, s60, v12
  v_add_u32 v12, 16, v12
  v_lshrrev_b32 v13, 5, v12
  v_cmp_ne_u32 s[80:81], 1, v13
  v_bfe_u32 v13, v12, 4, 1
  v_lshlrev_b32 v23, 10, v13
  v_and_b32 v13, 15, v12
  v_lshl_add_u32 v23, v13, 4, v23
  v_lshrrev_b32 v13, 4, v0
  v_lshl_add_u32 v23, v13, 8, v23
  s_waitcnt vmcnt(0)
  s_barrier
  s_cmp_lg_u32 s46, 0
  s_cbranch_scc1 arr_404
  v_mov_b32 v12, 1
  s_lshl_b32 s3, s49, 2
  v_mov_b32 v13, s3
  s_mov_b64 exec, 1
  buffer_atomic_add v12, v13, s[12:15], 0 offen sc1
  s_mov_b64 exec, -1
arr_404:
  s_lshl_b32 s3, s49, 2
  v_mov_b32 v13, s3
  s_nop 1
ibw_405:
  buffer_load_dword v12, v13, s[12:15], 0 offen sc1
  s_waitcnt vmcnt(0)
  v_cmp_ne_u32 vcc, 256, v12
  s_nop 0
  s_cbranch_vccz ibw_406
  s_sleep 8
  s_sub_u32 s47, s47, 1
  s_cbranch_scc0 ibw_405
  s_branch ABORT
ibw_406:
  s_cmp_lg_u32 s49, 0
  s_cbranch_scc1 ibok_407
  v_and_b32 v13, 7, v0
  v_lshlrev_b32 v13, 2, v13
  buffer_load_dword v12, v13, s[12:15], 0 offen offset:32 sc1
  s_waitcnt vmcnt(0)
  v_cmp_ne_u32 vcc, 32, v12
  s_nop 0
  s_cbranch_vccz ibok_407
  s_barrier
  s_mov_b32 s49, 1
  s_mov_b32 s3, s2
  s_branch DISPATCH
ibok_407:
  s_mov_b32 s60, 0
  v_mov_b32 v13, 0
  s_cmp_lg_u32 s46, 0
  s_cbranch_scc1 w0_408
fl_409:
  buffer_load_dword v12, v13, s[8:11], s60 offen sc1
  s_waitcnt vmcnt(0)
  v_cmp_eq_u32 vcc, 0, v12
  s_nop 0
  s_cbranch_vccz fo_410
  s_sleep 32
  s_sub_u32 s47, s47, 1
  s_cbranch_scc0 fl_409
  s_branch ABORT
fo_410:
w0_408:
  s_barrier
  s_mov_b32 s4, s34
  s_mov_b32 s5, s35
  s_mov_b32 s6, 819200
  s_mov_b32 s7, 0x20000
  s_lshl_b32 s60, s55, 6
  s_mul_i32 s63, s46, 40960
  v_lshrrev_b32 v15, 2, v0
  v_mul_u32_u24 v15, 1280, v15
  v_and_b32 v16, 3, v0
  v_lshl_add_u32 v12, v16, 4, v15
  v_lshrrev_b32 v15, 2, v0
  v_mul_u32_u24 v15, 64, v15
  v_and_b32 v16, 3, v0
  v_lshl_add_u32 v15, v16, 3, v15
  v_add_u32 v13, s63, v15
  s_add_u32 m0, s63, 0
  s_add_u32 s65, s60, 0
  buffer_load_dwordx4 v12, s[4:7], s65 offen lds
  s_add_u32 m0, s63, 1024
  s_add_u32 s65, s60, 20480
  buffer_load_dwordx4 v12, s[4:7], s65 offen lds
  s_add_u32 m0, s63, 2048
  s_add_u32 s65, s60, 40960
  buffer_load_dwordx4 v12, s[4:7], s65 offen lds
  s_add_u32 m0, s63, 3072
  s_add_u32 s65, s60, 61440
  buffer_load_dwordx4 v12, s[4:7], s65 offen lds
  s_add_u32 m0, s63, 4096
  s_add_u32 s65, s60, 81920
  buffer_load_dwordx4 v12, s[4:7], s65 offen lds
  s_add_u32 m0, s63, 5120
  s_add_u32 s65, s60, 102400
  buffer_load_dwordx4 v12, s[4:7], s65 offen lds
  s_add_u32 m0, s63, 6144
  s_add_u32 s65, s60, 122880
  buffer_load_dwordx4 v12, s[4:7], s65 offen lds
  s_add_u32 m0, s63, 7168
  s_add_u32 s65, s60, 143360
  buffer_load_dwordx4 v12, s[4:7], s65 offen lds
  s_add_u32 m0, s63, 8192
  s_add_u32 s65, s60, 163840
  buffer_load_dwordx4 v12, s[4:7], s65 offen lds
  s_add_u32 m0, s63, 9216
  s_add_u32 s65, s60, 184320
  buffer_load_dwordx4 v12, s[4:7], s65 offen lds
  s_add_u32 m0, s63, 10240
  s_add_u32 s65, s60, 204800
  buffer_load_dwordx4 v12, s[4:7], s65 offen lds
  s_add_u32 m0, s63, 11264
  s_add_u32 s65, s60, 225280
  buffer_load_dwordx4 v12, s[4:7], s65 offen lds
  s_add_u32 m0, s63, 12288
  s_add_u32 s65, s60, 245760
  buffer_load_dwordx4 v12, s[4:7], s65 offen lds
  s_add_u32 m0, s63, 13312
  s_add_u32 s65, s60, 266240
  buffer_load_dwordx4 v12, s[4:7], s65 offen lds
  s_add_u32 m0, s63, 14336
  s_add_u32 s65, s60, 286720
  buffer_load_dwordx4 v12, s[4:7], s65 offen lds
  s_add_u32 m0, s63, 15360
  s_add_u32 s65, s60, 307200
  buffer_load_dwordx4 v12, s[4:7], s65 offen lds
  s_add_u32 m0, s63, 16384
  s_add_u32 s65, s60, 327680
  buffer_load_dwordx4 v12, s[4:7], s65 offen lds
  s_add_u32 m0, s63, 17408
  s_add_u32 s65, s60, 348160
  buffer_load_dwordx4 v12, s[4:7], s65 offen lds
  s_add_u32 m0, s63, 18432
  s_add_u32 s65, s60, 368640
  buffer_load_dwordx4 v12, s[4:7], s65 offen lds
  s_add_u32 m0, s63, 19456
  s_add_u32 s65, s60, 389120
  buffer_load_dwordx4 v12, s[4:7], s65 offen lds
  s_add_u32 m0, s63, 20480
  s_add_u32 s65, s60, 409600
  buffer_load_dwordx4 v12, s[4:7], s65 offen lds
  s_add_u32 m0, s63, 21504
  s_add_u32 s65, s60, 430080
  buffer_load_dwordx4 v12, s[4:7], s65 offen lds
  s_add_u32 m0, s63, 22528
  s_add_u32 s65, s60, 450560
  buffer_load_dwordx4 v12, s[4:7], s65 offen lds
  s_add_u32 m0, s63, 23552
  s_add_u32 s65, s60, 471040
  buffer_load_dwordx4 v12, s[4:7], s65 offen lds
  s_add_u32 m0, s63, 24576
  s_add_u32 s65, s60, 491520
  buffer_load_dwordx4 v12, s[4:7], s65 offen lds
  s_add_u32 m0, s63, 25600
  s_add_u32 s65, s60, 512000
  buffer_load_dwordx4 v12, s[4:7], s65 offen lds
  s_add_u32 m0, s63, 26624
  s_add_u32 s65, s60, 532480
  buffer_load_dwordx4 v12, s[4:7], s65 offen lds
  s_add_u32 m0, s63, 27648
  s_add_u32 s65, s60, 552960
  buffer_load_dwordx4 v12, s[4:7], s65 offen lds
  s_add_u32 m0, s63, 28672
  s_add_u32 s65, s60, 573440
  buffer_load_dwordx4 v12, s[4:7], s65 offen lds
  s_add_u32 m0, s63, 29696
  s_add_u32 s65, s60, 593920
  buffer_load_dwordx4 v12, s[4:7], s65 offen lds
  s_add_u32 m0, s63, 30720
  s_add_u32 s65, s60, 614400
  buffer_load_dwordx4 v12, s[4:7], s65 offen lds
  s_add_u32 m0, s63, 31744
  s_add_u32 s65, s60, 634880
  buffer_load_dwordx4 v12, s[4:7], s65 offen lds
  s_add_u32 m0, s63, 32768
  s_add_u32 s65, s60, 655360
  buffer_load_dwordx4 v12, s[4:7], s65 offen lds
  s_add_u32 m0, s63, 33792
  s_add_u32 s65, s60, 675840
  buffer_load_dwordx4 v12, s[4:7], s65 offen lds
  s_add_u32 m0, s63, 34816
  s_add_u32 s65, s60, 696320
  buffer_load_dwordx4 v12, s[4:7], s65 offen lds
  s_add_u32 m0, s63, 35840
  s_add_u32 s65, s60, 716800
  buffer_load_dwordx4 v12, s[4:7], s65 offen lds
  s_add_u32 m0, s63, 36864
  s_add_u32 s65, s60, 737280
  buffer_load_dwordx4 v12, s[4:7], s65 offen lds
  s_add_u32 m0, s63, 37888
  s_add_u32 s65, s60, 757760
  buffer_load_dwordx4 v12, s[4:7], s65 offen lds
  s_add_u32 m0, s63, 38912
  s_add_u32 s65, s60, 778240
  buffer_load_dwordx4 v12, s[4:7], s65 offen lds
  s_add_u32 m0, s63, 39936
  s_add_u32 s65, s60, 798720
  buffer_load_dwordx4 v12, s[4:7], s65 offen lds
  s_waitcnt vmcnt(20)
  ds_read_b64_tr_b16 a[0:1], v13 offset:0
  ds_read_b64_tr_b16 a[2:3], v13 offset:1024
  ds_read_b64_tr_b16 a[4:5], v13 offset:32
  ds_read_b64_tr_b16 a[6:7], v13 offset:1056
  ds_read_b64_tr_b16 a[8:9], v13 offset:2048
  ds_read_b64_tr_b16 a[10:11], v13 offset:3072
  ds_read_b64_tr_b16 a[12:13], v13 offset:2080
  ds_read_b64_tr_b16 a[14:15], v13 offset:3104
  ds_read_b64_tr_b16 a[16:17], v13 offset:4096
  ds_read_b64_tr_b16 a[18:19], v13 offset:5120
  ds_read_b64_tr_b16 a[20:21], v13 offset:4128
  ds_read_b64_tr_b16 a[22:23], v13 offset:5152
  s_waitcnt lgkmcnt(4)
  ds_read_b64_tr_b16 a[24:25], v13 offset:6144
  ds_read_b64_tr_b16 a[26:27], v13 offset:7168
  ds_read_b64_tr_b16 a[28:29], v13 offset:6176
  ds_read_b64_tr_b16 a[30:31], v13 offset:7200
  ds_read_b64_tr_b16 a[32:33], v13 offset:8192
  ds_read_b64_tr_b16 a[34:35], v13 offset:9216
  ds_read_b64_tr_b16 a[36:37], v13 offset:8224
  ds_read_b64_tr_b16 a[38:39], v13 offset:9248
  ds_read_b64_tr_b16 a[40:41], v13 offset:10240
  ds_read_b64_tr_b16 a[42:43], v13 offset:11264
  ds_read_b64_tr_b16 a[44:45], v13 offset:10272
  ds_read_b64_tr_b16 a[46:47], v13 offset:11296
  s_waitcnt lgkmcnt(4)
  ds_read_b64_tr_b16 a[48:49], v13 offset:12288
  ds_read_b64_tr_b16 a[50:51], v13 offset:13312
  ds_read_b64_tr_b16 a[52:53], v13 offset:12320
  ds_read_b64_tr_b16 a[54:55], v13 offset:13344
  ds_read_b64_tr_b16 a[56:57], v13 offset:14336
  ds_read_b64_tr_b16 a[58:59], v13 offset:15360
  ds_read_b64_tr_b16 a[60:61], v13 offset:14368
  ds_read_b64_tr_b16 a[62:63], v13 offset:15392
  ds_read_b64_tr_b16 a[64:65], v13 offset:16384
  ds_read_b64_tr_b16 a[66:67], v13 offset:17408
  ds_read_b64_tr_b16 a[68:69], v13 offset:16416
  ds_read_b64_tr_b16 a[70:71], v13 offset:17440
  s_waitcnt lgkmcnt(4)
  ds_read_b64_tr_b16 a[72:73], v13 offset:18432
  ds_read_b64_tr_b16 a[74:75], v13 offset:19456
  ds_read_b64_tr_b16 a[76:77], v13 offset:18464
  ds_read_b64_tr_b16 a[78:79], v13 offset:19488
  s_waitcnt lgkmcnt(0)
  s_waitcnt vmcnt(0)
  ds_read_b64_tr_b16 a[80:81], v13 offset:20480
  ds_read_b64_tr_b16 a[82:83], v13 offset:21504
  ds_read_b64_tr_b16 a[84:85], v13 offset:20512
  ds_read_b64_tr_b16 a[86:87], v13 offset:21536
  ds_read_b64_tr_b16 a[88:89], v13 offset:22528
  ds_read_b64_tr_b16 a[90:91], v13 offset:23552
  ds_read_b64_tr_b16 a[92:93], v13 offset:22560
  ds_read_b64_tr_b16 a[94:95], v13 offset:23584
  ds_read_b64_tr_b16 a[96:97], v13 offset:24576
  ds_read_b64_tr_b16 a[98:99], v13 offset:25600
  ds_read_b64_tr_b16 a[100:101], v13 offset:24608
  ds_read_b64_tr_b16 a[102:103], v13 offset:25632
  s_waitcnt lgkmcnt(4)
  ds_read_b64_tr_b16 a[104:105], v13 offset:26624
  ds_read_b64_tr_b16 a[106:107], v13 offset:27648
  ds_read_b64_tr_b16 a[108:109], v13 offset:26656
  ds_read_b64_tr_b16 a[110:111], v13 offset:27680
  ds_read_b64_tr_b16 a[112:113], v13 offset:28672
  ds_read_b64_tr_b16 a[114:115], v13 offset:29696
  ds_read_b64_tr_b16 a[116:117], v13 offset:28704
  ds_read_b64_tr_b16 a[118:119], v13 offset:29728
  ds_read_b64_tr_b16 a[120:121], v13 offset:30720
  ds_read_b64_tr_b16 a[122:123], v13 offset:31744
  ds_read_b64_tr_b16 a[124:125], v13 offset:30752
  ds_read_b64_tr_b16 a[126:127], v13 offset:31776
  s_waitcnt lgkmcnt(4)
  ds_read_b64_tr_b16 a[128:129], v13 offset:32768
  ds_read_b64_tr_b16 a[130:131], v13 offset:33792
  ds_read_b64_tr_b16 a[132:133], v13 offset:32800
  ds_read_b64_tr_b16 a[134:135], v13 offset:33824
  ds_read_b64_tr_b16 a[136:137], v13 offset:34816
  ds_read_b64_tr_b16 a[138:139], v13 offset:35840
  ds_read_b64_tr_b16 a[140:141], v13 offset:34848
  ds_read_b64_tr_b16 a[142:143], v13 offset:35872
  ds_read_b64_tr_b16 a[144:145], v13 offset:36864
  ds_read_b64_tr_b16 a[146:147], v13 offset:37888
  ds_read_b64_tr_b16 a[148:149], v13 offset:36896
  ds_read_b64_tr_b16 a[150:151], v13 offset:37920
  s_waitcnt lgkmcnt(4)
  ds_read_b64_tr_b16 a[152:153], v13 offset:38912
  ds_read_b64_tr_b16 a[154:155], v13 offset:39936
  ds_read_b64_tr_b16 a[156:157], v13 offset:38944
  ds_read_b64_tr_b16 a[158:159], v13 offset:39968
  s_waitcnt lgkmcnt(0)
  v_lshrrev_b32 v12, 4, v0
  v_mul_u32_u24 v12, 46080, v12
  v_lshl_add_u32 v12, v6, 4, v12
  s_lshl_b32 s60, s55, 11
  s_add_u32 s61, s60, 22282240
  buffer_load_dword v13, v12, s[8:11], s61 offen sc1
  s_lshl_b32 s61, s55, 8
  s_add_u32 s61, s61, 22323200
  buffer_load_dword v13, v12, s[8:11], s61 offen sc1
  s_add_u32 s61, s60, 22466560
  buffer_load_dword v13, v12, s[8:11], s61 offen sc1
  s_lshl_b32 s61, s55, 8
  s_add_u32 s61, s61, 22507520
  buffer_load_dword v13, v12, s[8:11], s61 offen sc1
  s_waitcnt vmcnt(0)
  s_barrier
  s_mov_b32 s50, 0
  s_mov_b32 s56, 0
  s_add_u32 s62, s50, 0
  s_min_u32 s62, s62, 127
  s_sub_i32 s60, s62, 13
  s_sub_i32 s53, s62, 12
  s_ashr_i32 s60, s60, 1
  s_ashr_i32 s53, s53, 1
  s_sub_i32 s61, s62, 64
  s_max_i32 s60, s60, s61
  s_add_i32 s61, s61, 1
  s_max_i32 s53, s53, s61
  s_max_i32 s60, s60, 0
  s_max_i32 s53, s53, 0
  s_sub_i32 s53, s53, s60
  s_sub_i32 s54, s62, s60
  s_sub_i32 s60, s60, s54
  s_mul_i32 s60, s60, s53
  s_add_i32 s54, s54, s60
  s_lshl_b32 s82, s53, 15
  s_add_u32 s82, s82, 327680
  s_lshl_b32 s60, s53, 6
  s_add_u32 s60, s60, s54
  s_mul_i32 s69, s60, 46080
  s_add_u32 s69, s69, 16384000
  s_mul_i32 s68, s53, 163840
  s_add_u32 s68, s68, 22650880
  s_add_u32 s68, s68, s58
  s_and_b32 s60, s54, 3
  s_mul_i32 s70, s60, 40960
  s_and_b32 s60, s46, 1
  s_lshl1_add_u32 s60, s60, s54
  s_sub_u32 s60, s60, 1
  s_and_b32 s61, s60, 3
  s_mul_i32 s85, s61, 40960
  s_and_b32 s60, s60, 64
  s_lshl_b32 s60, s60, 23
  s_add_u32 s85, s85, s60
  v_add_u32 v20, s70, v22
  v_add_u32 v18, s85, v22
  v_cndmask_b32 v20, v20, v18, s[78:79]
  v_add_u32 v21, s70, v23
  v_add_u32 v18, s85, v23
  v_cndmask_b32 v21, v21, v18, s[80:81]
  s_add_u32 s71, s56, s58
  v_lshrrev_b32 v2, 5, v0
  v_lshl_add_u32 v2, v2, 7, v6
  s_nop 1
W2_F_WAIT:
su_411:
  buffer_load_dword v156, v8, s[8:11], s82 offen sc1
  s_waitcnt vmcnt(0)
  v_add_u32 v156, v156, v9
  v_cmp_ge_i32 vcc, s54, v156
  s_nop 0
  s_cbranch_vccz so_412
  s_sleep 2
  s_sub_u32 s47, s47, 1
  s_cbranch_scc0 su_411
  s_branch ABORT
so_412:
  s_add_u32 m0, s71, 0
  s_add_u32 s65, s68, 0
  buffer_load_dwordx4 v20, s[8:11], s65 offen offset:0 sc1 lds
  buffer_load_dwordx4 v20, s[8:11], s65 offen offset:2048 sc1 lds
  s_add_u32 m0, s71, 4096
  s_add_u32 s65, s68, 4096
  buffer_load_dwordx4 v20, s[8:11], s65 offen offset:0 sc1 lds
  buffer_load_dwordx4 v20, s[8:11], s65 offen offset:2048 sc1 lds
  s_add_u32 m0, s71, 8192
  s_add_u32 s65, s68, 8192
  buffer_load_dwordx4 v20, s[8:11], s65 offen offset:0 sc1 lds
  s_add_u32 m0, s56, s75
  s_add_u32 s65, s69, s75
  buffer_load_dwordx4 v1, s[8:11], s65 offen sc1 lds
  buffer_load_dwordx4 v1, s[8:11], s65 offen offset:1024 sc1 lds
  s_add_u32 m0, s71, 1024
  s_add_u32 s65, s68, 0
  buffer_load_dwordx4 v21, s[8:11], s65 offen offset:0 sc1 lds
  buffer_load_dwordx4 v21, s[8:11], s65 offen offset:2048 sc1 lds
  s_add_u32 m0, s71, 5120
  s_add_u32 s65, s68, 4096
  buffer_load_dwordx4 v21, s[8:11], s65 offen offset:0 sc1 lds
  buffer_load_dwordx4 v21, s[8:11], s65 offen offset:2048 sc1 lds
  s_add_u32 m0, s71, 9216
  s_add_u32 s65, s68, 8192
  buffer_load_dwordx4 v21, s[8:11], s65 offen offset:0 sc1 lds
  s_waitcnt vmcnt(5)
W2_F_LOOP:
  v_add_u32 v7, s56, v1
  v_add_u32 v4, s56, v3
  s_barrier
  ds_read_b128 v[32:35], v7 offset:0
  ds_read_b128 v[36:39], v7 offset:2048
  ds_read_b128 v[40:43], v7 offset:4096
  ds_read_b128 v[44:47], v7 offset:6144
  s_xor_b32 s56, s56, 46080
  s_mov_b32 s51, s53
  s_mov_b32 s52, s54
  s_lshl2_add_u32 s74, s55, s82
  s_add_u32 s74, s74, 80
  s_lshl_b32 s64, s55, 11
  s_add_u32 s64, s64, s69
  buffer_load_dwordx4 v[124:127], v1, s[8:11], s64 offen offset:0 sc1
  buffer_load_dwordx4 v[128:131], v1, s[8:11], s64 offen offset:1024 sc1
  s_add_u32 s62, s50, 1
  s_min_u32 s62, s62, 127
  s_sub_i32 s60, s62, 13
  s_sub_i32 s53, s62, 12
  s_ashr_i32 s60, s60, 1
  s_ashr_i32 s53, s53, 1
  s_sub_i32 s61, s62, 64
  s_max_i32 s60, s60, s61
  s_waitcnt lgkmcnt(3)
  v_mfma_f32_16x16x32_bf16 v[64:67], a[0:3], v[32:35], 0
  s_add_i32 s61, s61, 1
  ds_read_b128 v[48:51], v7 offset:8192
  v_add_u32 v12, 0x800, v4
  v_mfma_f32_16x16x32_bf16 v[68:71], a[4:7], v[32:35], 0
  s_waitcnt lgkmcnt(3)
  ds_read_b128 v[52:55], v7 offset:10240
  s_max_i32 s53, s53, s61
  v_mfma_f32_16x16x32_bf16 v[64:67], a[8:11], v[36:39], v[64:67]
  s_max_i32 s60, s60, 0
  ds_read_b128 v[56:59], v7 offset:12288
  s_max_i32 s53, s53, 0
  v_mfma_f32_16x16x32_bf16 v[68:71], a[12:15], v[36:39], v[68:71]
  s_waitcnt lgkmcnt(4)
  ds_read_b128 v[60:63], v7 offset:14336
  s_sub_i32 s53, s53, s60
  v_mfma_f32_16x16x32_bf16 v[64:67], a[16:19], v[40:43], v[64:67]
  s_sub_i32 s54, s62, s60
  ds_read_b128 v[32:35], v7 offset:16384
  s_sub_i32 s60, s60, s54
  v_mfma_f32_16x16x32_bf16 v[68:71], a[20:23], v[40:43], v[68:71]
  s_waitcnt lgkmcnt(5)
  ds_read_b128 v[36:39], v7 offset:18432
  ds_read2_b64 v[88:91], v4 offset0:0 offset1:32
  v_mfma_f32_16x16x32_bf16 v[64:67], a[24:27], v[44:47], v[64:67]
  s_mul_i32 s60, s60, s53
  ds_read_b128 v[40:43], v7 offset:20480
  s_add_i32 s54, s54, s60
  v_mfma_f32_16x16x32_bf16 v[68:71], a[28:31], v[44:47], v[68:71]
  s_waitcnt lgkmcnt(6)
  ds_read2_b64 v[92:95], v4 offset0:64 offset1:96
  s_lshl_b32 s82, s53, 15
  v_mfma_f32_16x16x32_bf16 v[64:67], a[32:35], v[48:51], v[64:67]
  s_add_u32 s82, s82, 327680
  ds_read_b128 v[44:47], v7 offset:22528
  ds_read2_b64 v[96:99], v4 offset0:128 offset1:160
  v_mfma_f32_16x16x32_bf16 v[68:71], a[36:39], v[48:51], v[68:71]
  s_lshl_b32 s60, s53, 6
  ds_read2_b64 v[100:103], v4 offset0:192 offset1:224
  s_add_u32 s60, s60, s54
  v_mfma_f32_16x16x32_bf16 v[64:67], a[40:43], v[52:55], v[64:67]
  ds_read_b128 v[48:51], v7 offset:24576
  v_mfma_f32_16x16x32_bf16 v[68:71], a[44:47], v[52:55], v[68:71]
  s_waitcnt lgkmcnt(9)
  ds_read2_b64 v[104:107], v12 offset0:0 offset1:32
  v_mfma_f32_16x16x32_bf16 v[64:67], a[48:51], v[56:59], v[64:67]
  ds_read_b128 v[52:55], v7 offset:26624
  v_mfma_f32_16x16x32_bf16 v[68:71], a[52:55], v[56:59], v[68:71]
  v_mfma_f32_16x16x32_bf16 v[64:67], a[56:59], v[60:63], v[64:67]
  ds_read_b128 v[56:59], v7 offset:28672
  v_mfma_f32_16x16x32_bf16 v[68:71], a[60:63], v[60:63], v[68:71]
  s_waitcnt lgkmcnt(10)
  s_waitcnt lgkmcnt(2)
  v_add_f32 v88, v88, v98
  v_mfma_f32_16x16x32_bf16 v[64:67], a[64:67], v[32:35], v[64:67]
  ds_read_b128 v[60:63], v7 offset:30720
  v_add_f32 v89, v89, v99
  v_mfma_f32_16x16x32_bf16 v[68:71], a[68:71], v[32:35], v[68:71]
  v_add_f32 v90, v90, v100
  v_add_f32 v91, v91, v101
  v_mfma_f32_16x16x32_bf16 v[64:67], a[72:75], v[36:39], v[64:67]
  ds_read_b128 v[32:35], v7 offset:32768
  v_add_f32 v92, v92, v102
  v_mfma_f32_16x16x32_bf16 v[68:71], a[76:79], v[36:39], v[68:71]
  v_add_f32 v93, v93, v103
  v_add_f32 v94, v94, v104
  v_mfma_f32_16x16x32_bf16 v[64:67], a[80:83], v[40:43], v[64:67]
  ds_read_b128 v[36:39], v7 offset:34816
  v_add_f32 v95, v95, v105
  v_mfma_f32_16x16x32_bf16 v[68:71], a[84:87], v[40:43], v[68:71]
  v_add_f32 v96, v96, v106
  v_add_f32 v97, v97, v107
  v_mfma_f32_16x16x32_bf16 v[64:67], a[88:91], v[44:47], v[64:67]
  ds_read_b128 v[40:43], v7 offset:36864
  v_add_f32 v88, v88, v90
  v_mfma_f32_16x16x32_bf16 v[68:71], a[92:95], v[44:47], v[68:71]
  s_waitcnt lgkmcnt(5)
  v_add_f32 v89, v89, v91
  v_add_f32 v92, v92, v94
  v_mfma_f32_16x16x32_bf16 v[64:67], a[96:99], v[48:51], v[64:67]
  ds_read_b128 v[44:47], v7 offset:38912
  v_add_f32 v93, v93, v95
  v_mfma_f32_16x16x32_bf16 v[68:71], a[100:103], v[48:51], v[68:71]
  s_waitcnt vmcnt(0)
  v_mov_b32 v19, s83
  s_and_b64 exec, s[76:77], 1
  s_cmp_lg_u32 s49, 0
  s_cbranch_scc1 wt_413
  buffer_store_dword v19, v1, s[8:11], s59 offen
wb_414:
  s_mov_b64 exec, -1
  s_barrier
  v_mfma_f32_16x16x32_bf16 v[64:67], a[104:107], v[52:55], v[64:67]
  s_and_b32 s63, s52, 3
  ds_read_b128 v[48:51], v7 offset:1024
  v_add_f32 v88, v88, v92
  v_mfma_f32_16x16x32_bf16 v[68:71], a[108:111], v[52:55], v[68:71]
  s_waitcnt lgkmcnt(5)
  v_add_f32 v89, v89, v93
  v_add_f32 v88, v88, v96
  v_mfma_f32_16x16x32_bf16 v[64:67], a[112:115], v[56:59], v[64:67]
  s_lshl2_add_u32 s63, s51, s63
  ds_read_b128 v[52:55], v7 offset:3072
  v_add_f32 v89, v89, v97
  v_mfma_f32_16x16x32_bf16 v[68:71], a[116:119], v[56:59], v[68:71]
  s_mul_i32 s72, s63, 46080
  v_mov_b32 v90, v88
  v_mov_b32 v91, v89
  v_mfma_f32_16x16x32_bf16 v[64:67], a[120:123], v[60:63], v[64:67]
  s_add_u32 s72, s72, 22282240
  ds_read_b128 v[56:59], v7 offset:5120
  s_lshl_b32 s73, s55, 8
  v_mfma_f32_16x16x32_bf16 v[68:71], a[124:127], v[60:63], v[68:71]
  s_waitcnt lgkmcnt(5)
  v_permlane16_swap_b32 v88, v90
  v_mfma_f32_16x16x32_bf16 v[64:67], a[128:131], v[32:35], v[64:67]
  s_add_u32 s73, s73, s72
  ds_read_b128 v[60:63], v7 offset:7168
  s_add_u32 s73, s73, 40960
  v_mfma_f32_16x16x32_bf16 v[68:71], a[132:135], v[32:35], v[68:71]
  s_lshl_b32 s63, s55, 11
  buffer_load_dword v156, v8, s[8:11], s82 offen sc1
  s_add_u32 s72, s72, s63
  v_mfma_f32_16x16x32_bf16 v[64:67], a[136:139], v[36:39], v[64:67]
  s_mul_i32 s69, s60, 46080
  ds_read_b128 v[32:35], v7 offset:9216
  s_add_u32 s69, s69, 16384000
  v_mfma_f32_16x16x32_bf16 v[68:71], a[140:143], v[36:39], v[68:71]
  s_waitcnt lgkmcnt(5)
  v_permlane16_swap_b32 v89, v91
  v_mfma_f32_16x16x32_bf16 v[64:67], a[144:147], v[40:43], v[64:67]
  s_mul_i32 s68, s53, 163840
  ds_read_b128 v[36:39], v7 offset:11264
  v_add_f32 v27, v88, v90
  v_mfma_f32_16x16x32_bf16 v[68:71], a[148:151], v[40:43], v[68:71]
  s_add_u32 s68, s68, 22650880
  v_add_f32 v28, v89, v91
  v_mul_f32 v27, 0x3acccccd, v27
  v_mfma_f32_16x16x32_bf16 v[64:67], a[152:155], v[44:47], v[64:67]
  s_add_u32 s68, s68, s58
  ds_read_b128 v[40:43], v7 offset:13312
  v_mul_f32 v28, 0x3acccccd, v28
  v_mfma_f32_16x16x32_bf16 v[68:71], a[156:159], v[44:47], v[68:71]
  s_waitcnt lgkmcnt(5)
  v_fma_f32 v28, -v27, v27, v28
  v_max_f32 v28, 0, v28
  v_mfma_f32_16x16x32_bf16 v[72:75], a[0:3], v[48:51], 0
  s_and_b32 s60, s54, 3
  ds_read_b128 v[44:47], v7 offset:15360
  v_add_f32 v28, 0x3727c5ac, v28
  v_mfma_f32_16x16x32_bf16 v[76:79], a[4:7], v[48:51], 0
  s_mul_i32 s70, s60, 40960
  v_rsq_f32 v28, v28
  v_mfma_f32_16x16x32_bf16 v[72:75], a[8:11], v[52:55], v[72:75]
  s_and_b32 s60, s46, 1
  ds_read_b128 v[48:51], v7 offset:17408
  v_mul_f32 v27, v27, v28
  v_mfma_f32_16x16x32_bf16 v[76:79], a[12:15], v[52:55], v[76:79]
  s_waitcnt lgkmcnt(5)
  v_mov_b32 v24, v28
  v_mov_b32 v31, v27
  v_mfma_f32_16x16x32_bf16 v[72:75], a[16:19], v[56:59], v[72:75]
  s_lshl1_add_u32 s60, s60, s54
  ds_read_b128 v[52:55], v7 offset:19456
  s_sub_u32 s60, s60, 1
  v_mfma_f32_16x16x32_bf16 v[76:79], a[20:23], v[56:59], v[76:79]
  s_and_b32 s61, s60, 3
  v_permlane32_swap_b32 v24, v28
  v_mfma_f32_16x16x32_bf16 v[72:75], a[24:27], v[60:63], v[72:75]
  s_mul_i32 s85, s61, 40960
  ds_read_b128 v[56:59], v7 offset:21504
  s_and_b32 s60, s60, 64
  v_mfma_f32_16x16x32_bf16 v[76:79], a[28:31], v[60:63], v[76:79]
  s_waitcnt lgkmcnt(5)
  v_permlane32_swap_b32 v27, v31
  v_mfma_f32_16x16x32_bf16 v[72:75], a[32:35], v[32:35], v[72:75]
  s_lshl_b32 s60, s60, 23
  ds_read_b128 v[60:63], v7 offset:23552
  v_lshlrev_b32 v132, 16, v124
  v_mfma_f32_16x16x32_bf16 v[76:79], a[36:39], v[32:35], v[76:79]
  s_add_u32 s85, s85, s60
  v_and_b32 v133, 0xffff0000, v124
  v_lshlrev_b32 v134, 16, v125
  v_mfma_f32_16x16x32_bf16 v[72:75], a[40:43], v[36:39], v[72:75]
  s_add_u32 s71, s56, s58
  ds_read_b128 v[32:35], v7 offset:25600
  v_and_b32 v135, 0xffff0000, v125
  v_mfma_f32_16x16x32_bf16 v[76:79], a[44:47], v[36:39], v[76:79]
  s_waitcnt lgkmcnt(5)
  v_lshlrev_b32 v136, 16, v126
  v_and_b32 v137, 0xffff0000, v126
  v_mfma_f32_16x16x32_bf16 v[72:75], a[48:51], v[40:43], v[72:75]
  ds_read_b128 v[36:39], v7 offset:27648
  v_lshlrev_b32 v138, 16, v127
  v_mfma_f32_16x16x32_bf16 v[76:79], a[52:55], v[40:43], v[76:79]
  v_and_b32 v139, 0xffff0000, v127
  v_fma_f32 v132, v132, v24, -v27
  v_mfma_f32_16x16x32_bf16 v[72:75], a[56:59], v[44:47], v[72:75]
  s_waitcnt vmcnt(0)
  ds_read_b128 v[40:43], v7 offset:29696
  v_add_u32 v20, s70, v22
  v_mfma_f32_16x16x32_bf16 v[76:79], a[60:63], v[44:47], v[76:79]
  s_waitcnt lgkmcnt(5)
  v_add_u32 v18, s85, v22
  v_cndmask_b32 v20, v20, v18, s[78:79]
  v_mfma_f32_16x16x32_bf16 v[72:75], a[64:67], v[48:51], v[72:75]
  ds_read_b128 v[44:47], v7 offset:31744
  v_add_u32 v21, s70, v23
  v_mfma_f32_16x16x32_bf16 v[76:79], a[68:71], v[48:51], v[76:79]
  v_add_u32 v18, s85, v23
  v_cndmask_b32 v21, v21, v18, s[80:81]
  v_mfma_f32_16x16x32_bf16 v[72:75], a[72:75], v[52:55], v[72:75]
  ds_read_b128 v[48:51], v7 offset:33792
  v_add_u32 v156, v156, v9
  v_mfma_f32_16x16x32_bf16 v[76:79], a[76:79], v[52:55], v[76:79]
  s_waitcnt lgkmcnt(5)
  v_cmp_ge_i32 vcc, s54, v156
  v_mfma_f32_16x16x32_bf16 v[72:75], a[80:83], v[56:59], v[72:75]
  ds_read_b128 v[52:55], v7 offset:35840
  v_mfma_f32_16x16x32_bf16 v[76:79], a[84:87], v[56:59], v[76:79]
  s_cmp_lg_u64 vcc, 0
  s_cselect_b32 s57, 536870912, 0
  s_or_b32 s66, s68, s57
  v_mfma_f32_16x16x32_bf16 v[72:75], a[88:91], v[60:63], v[72:75]
  s_or_b32 s67, s69, s57
  ds_read_b128 v[56:59], v7 offset:37888
  v_fma_f32 v133, v133, v24, -v27
  v_mfma_f32_16x16x32_bf16 v[76:79], a[92:95], v[60:63], v[76:79]
  s_waitcnt lgkmcnt(5)
  s_add_u32 m0, s71, 0
  s_add_u32 s65, s66, 0
  buffer_load_dwordx4 v20, s[8:11], s65 offen offset:0 sc1 lds
  v_mfma_f32_16x16x32_bf16 v[72:75], a[96:99], v[32:35], v[72:75]
  ds_read_b128 v[60:63], v7 offset:39936
  v_fma_f32 v134, v134, v24, -v27
  v_mfma_f32_16x16x32_bf16 v[76:79], a[100:103], v[32:35], v[76:79]
  v_fma_f32 v135, v135, v24, -v27
  v_fma_f32 v136, v136, v24, -v27
  v_mfma_f32_16x16x32_bf16 v[72:75], a[104:107], v[36:39], v[72:75]
  v_fma_f32 v137, v137, v24, -v27
  v_fma_f32 v138, v138, v24, -v27
  v_mfma_f32_16x16x32_bf16 v[76:79], a[108:111], v[36:39], v[76:79]
  s_waitcnt lgkmcnt(4)
  buffer_load_dwordx4 v20, s[8:11], s65 offen offset:2048 sc1 lds
  v_fma_f32 v139, v139, v24, -v27
  v_mfma_f32_16x16x32_bf16 v[72:75], a[112:115], v[40:43], v[72:75]
  v_add_f32 v64, v64, v132
  v_add_f32 v65, v65, v133
  v_mfma_f32_16x16x32_bf16 v[76:79], a[116:119], v[40:43], v[76:79]
  v_add_f32 v66, v66, v134
  v_add_f32 v67, v67, v135
  v_mfma_f32_16x16x32_bf16 v[72:75], a[120:123], v[44:47], v[72:75]
  v_add_f32 v68, v68, v136
  v_add_f32 v69, v69, v137
  v_mfma_f32_16x16x32_bf16 v[76:79], a[124:127], v[44:47], v[76:79]
  s_waitcnt lgkmcnt(2)
  s_add_u32 m0, s71, 4096
  s_add_u32 s65, s66, 4096
  buffer_load_dwordx4 v20, s[8:11], s65 offen offset:0 sc1 lds
  v_mfma_f32_16x16x32_bf16 v[72:75], a[128:131], v[48:51], v[72:75]
  v_add_f32 v70, v70, v138
  v_add_f32 v71, v71, v139
  v_mfma_f32_16x16x32_bf16 v[76:79], a[132:135], v[48:51], v[76:79]
  v_cvt_pk_bf16_f32 v108, v64, v65
  v_lshlrev_b32 v64, 16, v108
  v_mfma_f32_16x16x32_bf16 v[72:75], a[136:139], v[52:55], v[72:75]
  v_and_b32 v65, 0xffff0000, v108
  v_cvt_pk_bf16_f32 v109, v66, v67
  v_mfma_f32_16x16x32_bf16 v[76:79], a[140:143], v[52:55], v[76:79]
  s_waitcnt lgkmcnt(0)
  buffer_load_dwordx4 v20, s[8:11], s65 offen offset:2048 sc1 lds
  v_lshlrev_b32 v66, 16, v109
  v_mfma_f32_16x16x32_bf16 v[72:75], a[144:147], v[56:59], v[72:75]
  v_and_b32 v67, 0xffff0000, v109
  v_cvt_pk_bf16_f32 v110, v68, v69
  v_mfma_f32_16x16x32_bf16 v[76:79], a[148:151], v[56:59], v[76:79]
  v_lshlrev_b32 v68, 16, v110
  v_and_b32 v69, 0xffff0000, v110
  v_mfma_f32_16x16x32_bf16 v[72:75], a[152:155], v[60:63], v[72:75]
  v_cvt_pk_bf16_f32 v111, v70, v71
  v_lshlrev_b32 v70, 16, v111
  v_mfma_f32_16x16x32_bf16 v[76:79], a[156:159], v[60:63], v[76:79]
  s_add_u32 m0, s71, 8192
  s_add_u32 s65, s66, 8192
  buffer_load_dwordx4 v20, s[8:11], s65 offen offset:0 sc1 lds
  s_add_u32 m0, s56, s75
  s_add_u32 s65, s67, s75
  buffer_load_dwordx4 v1, s[8:11], s65 offen sc1 lds
  v_and_b32 v71, 0xffff0000, v111
  s_cmp_lg_u32 s49, 0
  s_cbranch_scc1 wt_415
  buffer_store_dwordx4 v[108:111], v1, s[8:11], s72 offen offset:0
wb_416:
  v_add_f32 v148, v64, v65
  v_mul_f32 v149, v64, v64
  v_fmac_f32 v149, v65, v65
  v_add_f32 v148, v148, v66
  v_fmac_f32 v149, v66, v66
  v_add_f32 v148, v148, v67
  v_fmac_f32 v149, v67, v67
  v_add_f32 v148, v148, v68
  buffer_load_dwordx4 v1, s[8:11], s65 offen offset:1024 sc1 lds
  v_fmac_f32 v149, v68, v68
  v_add_f32 v148, v148, v69
  v_fmac_f32 v149, v69, v69
  v_add_f32 v148, v148, v70
  v_fmac_f32 v149, v70, v70
  v_add_f32 v148, v148, v71
  v_fmac_f32 v149, v71, v71
  v_lshlrev_b32 v140, 16, v128
  v_and_b32 v141, 0xffff0000, v128
  v_lshlrev_b32 v142, 16, v129
  s_add_u32 m0, s71, 1024
  s_add_u32 s65, s66, 0
  buffer_load_dwordx4 v21, s[8:11], s65 offen offset:0 sc1 lds
  v_and_b32 v143, 0xffff0000, v129
  v_lshlrev_b32 v144, 16, v130
  v_and_b32 v145, 0xffff0000, v130
  v_lshlrev_b32 v146, 16, v131
  v_and_b32 v147, 0xffff0000, v131
  v_fma_f32 v140, v140, v28, -v31
  v_fma_f32 v141, v141, v28, -v31
  v_fma_f32 v142, v142, v28, -v31
  v_fma_f32 v143, v143, v28, -v31
  v_fma_f32 v144, v144, v28, -v31
  buffer_load_dwordx4 v21, s[8:11], s65 offen offset:2048 sc1 lds
  v_fma_f32 v145, v145, v28, -v31
  v_fma_f32 v146, v146, v28, -v31
  v_fma_f32 v147, v147, v28, -v31
  v_add_f32 v72, v72, v140
  v_add_f32 v73, v73, v141
  v_add_f32 v74, v74, v142
  v_add_f32 v75, v75, v143
  v_add_f32 v76, v76, v144
  v_add_f32 v77, v77, v145
  v_add_f32 v78, v78, v146
  s_add_u32 m0, s71, 5120
  s_add_u32 s65, s66, 4096
  buffer_load_dwordx4 v21, s[8:11], s65 offen offset:0 sc1 lds
  v_add_f32 v79, v79, v147
  v_cvt_pk_bf16_f32 v112, v72, v73
  v_lshlrev_b32 v72, 16, v112
  v_and_b32 v73, 0xffff0000, v112
  v_cvt_pk_bf16_f32 v113, v74, v75
  v_lshlrev_b32 v74, 16, v113
  v_and_b32 v75, 0xffff0000, v113
  v_cvt_pk_bf16_f32 v114, v76, v77
  v_lshlrev_b32 v76, 16, v114
  v_and_b32 v77, 0xffff0000, v114
  buffer_load_dwordx4 v21, s[8:11], s65 offen offset:2048 sc1 lds
  v_cvt_pk_bf16_f32 v115, v78, v79
  v_lshlrev_b32 v78, 16, v115
  v_and_b32 v79, 0xffff0000, v115
  s_cmp_lg_u32 s49, 0
  s_cbranch_scc1 wt_417
  buffer_store_dwordx4 v[112:115], v1, s[8:11], s72 offen offset:1024
wb_418:
  v_add_f32 v150, v72, v73
  v_mul_f32 v151, v72, v72
  v_fmac_f32 v151, v73, v73
  v_add_f32 v150, v150, v74
  v_fmac_f32 v151, v74, v74
  v_add_f32 v150, v150, v75
  s_add_u32 m0, s71, 9216
  s_add_u32 s65, s66, 8192
  buffer_load_dwordx4 v21, s[8:11], s65 offen offset:0 sc1 lds
  v_fmac_f32 v151, v75, v75
  v_add_f32 v150, v150, v76
  v_fmac_f32 v151, v76, v76
  v_add_f32 v150, v150, v77
  v_fmac_f32 v151, v77, v77
  v_add_f32 v150, v150, v78
  v_fmac_f32 v151, v78, v78
  v_add_f32 v150, v150, v79
  v_fmac_f32 v151, v79, v79
  s_nop 0
  v_permlane32_swap_b32 v148, v150
  v_permlane32_swap_b32 v149, v151
  v_pk_add_f32 v[148:149], v[148:149], v[150:151]
  v_mov_b64 v[150:151], v[148:149]
  s_nop 1
  v_permlane16_swap_b32 v148, v150
  v_permlane16_swap_b32 v149, v151
  v_pk_add_f32 v[148:149], v[148:149], v[150:151]
  s_cmp_lg_u32 s49, 0
  s_cbranch_scc1 wt_419
  buffer_store_dwordx2 v[148:149], v2, s[8:11], s73 offen
wb_420:
  s_mov_b32 s59, s74
  s_add_u32 s83, s52, 1
  s_mov_b64 s[76:77], -1
  s_add_u32 s50, s50, 1
  s_cmp_eq_u32 s50, 128
  s_cselect_b32 s57, 1, s57
  s_waitcnt vmcnt(7)
  s_cmp_eq_u32 s57, 0
  s_cbranch_scc1 W2_F_LOOP
  s_waitcnt vmcnt(0)
  v_mov_b32 v19, s83
  s_and_b64 exec, s[76:77], 1
  s_cmp_lg_u32 s49, 0
  s_cbranch_scc1 wt_421
  buffer_store_dword v19, v1, s[8:11], s59 offen
wb_422:
  s_mov_b64 exec, -1
  s_mov_b64 s[76:77], 0
  s_cmp_lt_u32 s50, 128
  s_cbranch_scc1 W2_F_WAIT
  s_endpgm
wt_413:
  s_nop 7
  buffer_store_dword v19, v1, s[8:11], s59 offen sc1
  s_branch wb_414
wt_415:
  s_nop 7
  buffer_store_dwordx4 v[108:111], v1, s[8:11], s72 offen offset:0 sc1
  s_branch wb_416
wt_417:
  s_nop 7
  buffer_store_dwordx4 v[112:115], v1, s[8:11], s72 offen offset:1024 sc1
  s_branch wb_418
wt_419:
  s_nop 7
  buffer_store_dwordx2 v[148:149], v2, s[8:11], s73 offen sc1
  s_branch wb_420
wt_421:
  s_nop 7
  buffer_store_dword v19, v1, s[8:11], s59 offen sc1
  s_branch wb_422
GO_W3:
ROLE_W3:
  v_lshlrev_b32 v1, 4, v0
  s_lshl2_add_u32 s55, s48, s46
  v_min_u32 v2, 39, v0
  v_lshlrev_b32 v2, 3, v2
  v_min_u32 v8, 39, v0
  v_mov_b32 v9, 0
  v_cmp_le_u32 vcc, 20, v8
  v_mov_b32 v12, 4
  s_nop 0
  v_cndmask_b32 v9, v9, v12, vcc
  v_mov_b32 v12, 48
  v_cndmask_b32 v12, 0, v12, vcc
  v_add_u32 v8, v8, v12
  v_add_lshl_u32 v8, v8, 20, 2
  v_bfe_u32 v12, v0, 4, 1
  v_mul_u32_u24 v3, 2560, v12
  v_lshrrev_b32 v12, 5, v0
  v_lshl_add_u32 v3, v12, 7, v3
  v_and_b32 v6, 15, v0
  v_lshlrev_b32 v6, 3, v6
  v_add_u32 v3, v3, v6
  v_add_u32 v3, 0xa000, v3
  s_mul_i32 s58, s46, 10240
  s_lshl_b32 s75, s46, 10
  s_add_u32 s75, s75, 40960
  s_mov_b64 s[76:77], 0
  s_mov_b32 s59, 0
  s_mov_b32 s83, 0
  s_mov_b32 s84, 0
  v_mov_b32 v20, v1
  v_add_u32 v21, 0x400, v1
  s_waitcnt vmcnt(0)
  s_barrier
  s_cmp_lg_u32 s46, 0
  s_cbranch_scc1 arr_423
  v_mov_b32 v12, 1
  s_lshl_b32 s3, s49, 2
  v_mov_b32 v13, s3
  s_mov_b64 exec, 1
  buffer_atomic_add v12, v13, s[12:15], 0 offen sc1
  s_mov_b64 exec, -1
arr_423:
  s_lshl_b32 s3, s49, 2
  v_mov_b32 v13, s3
  s_nop 1
ibw_424:
  buffer_load_dword v12, v13, s[12:15], 0 offen sc1
  s_waitcnt vmcnt(0)
  v_cmp_ne_u32 vcc, 256, v12
  s_nop 0
  s_cbranch_vccz ibw_425
  s_sleep 8
  s_sub_u32 s47, s47, 1
  s_cbranch_scc0 ibw_424
  s_branch ABORT
ibw_425:
  s_cmp_lg_u32 s49, 0
  s_cbranch_scc1 ibok_426
  v_and_b32 v13, 7, v0
  v_lshlrev_b32 v13, 2, v13
  buffer_load_dword v12, v13, s[12:15], 0 offen offset:32 sc1
  s_waitcnt vmcnt(0)
  v_cmp_ne_u32 vcc, 32, v12
  s_nop 0
  s_cbranch_vccz ibok_426
  s_barrier
  s_mov_b32 s49, 1
  s_mov_b32 s3, s2
  s_branch DISPATCH
ibok_426:
  s_mov_b32 s60, 0
  v_mov_b32 v13, 0
  s_cmp_lg_u32 s46, 0
  s_cbranch_scc1 w0_427
fl_428:
  buffer_load_dword v12, v13, s[8:11], s60 offen sc1
  s_waitcnt vmcnt(0)
  v_cmp_eq_u32 vcc, 0, v12
  s_nop 0
  s_cbranch_vccz fo_429
  s_sleep 32
  s_sub_u32 s47, s47, 1
  s_cbranch_scc0 fl_428
  s_branch ABORT
fo_429:
w0_427:
  s_barrier
  s_mov_b32 s4, s36
  s_mov_b32 s5, s37
  s_mov_b32 s6, 1966080
  s_mov_b32 s7, 0x20000
  s_lshl_b32 s60, s55, 6
  s_mul_i32 s63, s46, 40960
  v_lshrrev_b32 v15, 2, v0
  v_mul_u32_u24 v15, 3072, v15
  v_and_b32 v16, 3, v0
  v_lshl_add_u32 v12, v16, 4, v15
  v_lshrrev_b32 v15, 2, v0
  v_mul_u32_u24 v15, 64, v15
  v_and_b32 v16, 3, v0
  v_lshl_add_u32 v15, v16, 3, v15
  v_add_u32 v13, s63, v15
  s_add_u32 m0, s63, 0
  s_add_u32 s65, s60, 0
  buffer_load_dwordx4 v12, s[4:7], s65 offen lds
  s_add_u32 m0, s63, 1024
  s_add_u32 s65, s60, 49152
  buffer_load_dwordx4 v12, s[4:7], s65 offen lds
  s_add_u32 m0, s63, 2048
  s_add_u32 s65, s60, 98304
  buffer_load_dwordx4 v12, s[4:7], s65 offen lds
  s_add_u32 m0, s63, 3072
  s_add_u32 s65, s60, 147456
  buffer_load_dwordx4 v12, s[4:7], s65 offen lds
  s_add_u32 m0, s63, 4096
  s_add_u32 s65, s60, 196608
  buffer_load_dwordx4 v12, s[4:7], s65 offen lds
  s_add_u32 m0, s63, 5120
  s_add_u32 s65, s60, 245760
  buffer_load_dwordx4 v12, s[4:7], s65 offen lds
  s_add_u32 m0, s63, 6144
  s_add_u32 s65, s60, 294912
  buffer_load_dwordx4 v12, s[4:7], s65 offen lds
  s_add_u32 m0, s63, 7168
  s_add_u32 s65, s60, 344064
  buffer_load_dwordx4 v12, s[4:7], s65 offen lds
  s_add_u32 m0, s63, 8192
  s_add_u32 s65, s60, 393216
  buffer_load_dwordx4 v12, s[4:7], s65 offen lds
  s_add_u32 m0, s63, 9216
  s_add_u32 s65, s60, 442368
  buffer_load_dwordx4 v12, s[4:7], s65 offen lds
  s_add_u32 m0, s63, 10240
  s_add_u32 s65, s60, 491520
  buffer_load_dwordx4 v12, s[4:7], s65 offen lds
  s_add_u32 m0, s63, 11264
  s_add_u32 s65, s60, 540672
  buffer_load_dwordx4 v12, s[4:7], s65 offen lds
  s_add_u32 m0, s63, 12288
  s_add_u32 s65, s60, 589824
  buffer_load_dwordx4 v12, s[4:7], s65 offen lds
  s_add_u32 m0, s63, 13312
  s_add_u32 s65, s60, 638976
  buffer_load_dwordx4 v12, s[4:7], s65 offen lds
  s_add_u32 m0, s63, 14336
  s_add_u32 s65, s60, 688128
  buffer_load_dwordx4 v12, s[4:7], s65 offen lds
  s_add_u32 m0, s63, 15360
  s_add_u32 s65, s60, 737280
  buffer_load_dwordx4 v12, s[4:7], s65 offen lds
  s_add_u32 m0, s63, 16384
  s_add_u32 s65, s60, 786432
  buffer_load_dwordx4 v12, s[4:7], s65 offen lds
  s_add_u32 m0, s63, 17408
  s_add_u32 s65, s60, 835584
  buffer_load_dwordx4 v12, s[4:7], s65 offen lds
  s_add_u32 m0, s63, 18432
  s_add_u32 s65, s60, 884736
  buffer_load_dwordx4 v12, s[4:7], s65 offen lds
  s_add_u32 m0, s63, 19456
  s_add_u32 s65, s60, 933888
  buffer_load_dwordx4 v12, s[4:7], s65 offen lds
  s_add_u32 m0, s63, 20480
  s_add_u32 s65, s60, 983040
  buffer_load_dwordx4 v12, s[4:7], s65 offen lds
  s_add_u32 m0, s63, 21504
  s_add_u32 s65, s60, 1032192
  buffer_load_dwordx4 v12, s[4:7], s65 offen lds
  s_add_u32 m0, s63, 22528
  s_add_u32 s65, s60, 1081344
  buffer_load_dwordx4 v12, s[4:7], s65 offen lds
  s_add_u32 m0, s63, 23552
  s_add_u32 s65, s60, 1130496
  buffer_load_dwordx4 v12, s[4:7], s65 offen lds
  s_add_u32 m0, s63, 24576
  s_add_u32 s65, s60, 1179648
  buffer_load_dwordx4 v12, s[4:7], s65 offen lds
  s_add_u32 m0, s63, 25600
  s_add_u32 s65, s60, 1228800
  buffer_load_dwordx4 v12, s[4:7], s65 offen lds
  s_add_u32 m0, s63, 26624
  s_add_u32 s65, s60, 1277952
  buffer_load_dwordx4 v12, s[4:7], s65 offen lds
  s_add_u32 m0, s63, 27648
  s_add_u32 s65, s60, 1327104
  buffer_load_dwordx4 v12, s[4:7], s65 offen lds
  s_add_u32 m0, s63, 28672
  s_add_u32 s65, s60, 1376256
  buffer_load_dwordx4 v12, s[4:7], s65 offen lds
  s_add_u32 m0, s63, 29696
  s_add_u32 s65, s60, 1425408
  buffer_load_dwordx4 v12, s[4:7], s65 offen lds
  s_add_u32 m0, s63, 30720
  s_add_u32 s65, s60, 1474560
  buffer_load_dwordx4 v12, s[4:7], s65 offen lds
  s_add_u32 m0, s63, 31744
  s_add_u32 s65, s60, 1523712
  buffer_load_dwordx4 v12, s[4:7], s65 offen lds
  s_add_u32 m0, s63, 32768
  s_add_u32 s65, s60, 1572864
  buffer_load_dwordx4 v12, s[4:7], s65 offen lds
  s_add_u32 m0, s63, 33792
  s_add_u32 s65, s60, 1622016
  buffer_load_dwordx4 v12, s[4:7], s65 offen lds
  s_add_u32 m0, s63, 34816
  s_add_u32 s65, s60, 1671168
  buffer_load_dwordx4 v12, s[4:7], s65 offen lds
  s_add_u32 m0, s63, 35840
  s_add_u32 s65, s60, 1720320
  buffer_load_dwordx4 v12, s[4:7], s65 offen lds
  s_add_u32 m0, s63, 36864
  s_add_u32 s65, s60, 1769472
  buffer_load_dwordx4 v12, s[4:7], s65 offen lds
  s_add_u32 m0, s63, 37888
  s_add_u32 s65, s60, 1818624
  buffer_load_dwordx4 v12, s[4:7], s65 offen lds
  s_add_u32 m0, s63, 38912
  s_add_u32 s65, s60, 1867776
  buffer_load_dwordx4 v12, s[4:7], s65 offen lds
  s_add_u32 m0, s63, 39936
  s_add_u32 s65, s60, 1916928
  buffer_load_dwordx4 v12, s[4:7], s65 offen lds
  s_waitcnt vmcnt(20)
  ds_read_b64_tr_b16 a[0:1], v13 offset:0
  ds_read_b64_tr_b16 a[2:3], v13 offset:1024
  ds_read_b64_tr_b16 a[4:5], v13 offset:32
  ds_read_b64_tr_b16 a[6:7], v13 offset:1056
  ds_read_b64_tr_b16 a[8:9], v13 offset:2048
  ds_read_b64_tr_b16 a[10:11], v13 offset:3072
  ds_read_b64_tr_b16 a[12:13], v13 offset:2080
  ds_read_b64_tr_b16 a[14:15], v13 offset:3104
  ds_read_b64_tr_b16 a[16:17], v13 offset:4096
  ds_read_b64_tr_b16 a[18:19], v13 offset:5120
  ds_read_b64_tr_b16 a[20:21], v13 offset:4128
  ds_read_b64_tr_b16 a[22:23], v13 offset:5152
  s_waitcnt lgkmcnt(4)
  ds_read_b64_tr_b16 a[24:25], v13 offset:6144
  ds_read_b64_tr_b16 a[26:27], v13 offset:7168
  ds_read_b64_tr_b16 a[28:29], v13 offset:6176
  ds_read_b64_tr_b16 a[30:31], v13 offset:7200
  ds_read_b64_tr_b16 a[32:33], v13 offset:8192
  ds_read_b64_tr_b16 a[34:35], v13 offset:9216
  ds_read_b64_tr_b16 a[36:37], v13 offset:8224
  ds_read_b64_tr_b16 a[38:39], v13 offset:9248
  ds_read_b64_tr_b16 a[40:41], v13 offset:10240
  ds_read_b64_tr_b16 a[42:43], v13 offset:11264
  ds_read_b64_tr_b16 a[44:45], v13 offset:10272
  ds_read_b64_tr_b16 a[46:47], v13 offset:11296
  s_waitcnt lgkmcnt(4)
  ds_read_b64_tr_b16 a[48:49], v13 offset:12288
  ds_read_b64_tr_b16 a[50:51], v13 offset:13312
  ds_read_b64_tr_b16 a[52:53], v13 offset:12320
  ds_read_b64_tr_b16 a[54:55], v13 offset:13344
  ds_read_b64_tr_b16 a[56:57], v13 offset:14336
  ds_read_b64_tr_b16 a[58:59], v13 offset:15360
  ds_read_b64_tr_b16 a[60:61], v13 offset:14368
  ds_read_b64_tr_b16 a[62:63], v13 offset:15392
  ds_read_b64_tr_b16 a[64:65], v13 offset:16384
  ds_read_b64_tr_b16 a[66:67], v13 offset:17408
  ds_read_b64_tr_b16 a[68:69], v13 offset:16416
  ds_read_b64_tr_b16 a[70:71], v13 offset:17440
  s_waitcnt lgkmcnt(4)
  ds_read_b64_tr_b16 a[72:73], v13 offset:18432
  ds_read_b64_tr_b16 a[74:75], v13 offset:19456
  ds_read_b64_tr_b16 a[76:77], v13 offset:18464
  ds_read_b64_tr_b16 a[78:79], v13 offset:19488
  s_waitcnt lgkmcnt(0)
  s_waitcnt vmcnt(0)
  ds_read_b64_tr_b16 a[80:81], v13 offset:20480
  ds_read_b64_tr_b16 a[82:83], v13 offset:21504
  ds_read_b64_tr_b16 a[84:85], v13 offset:20512
  ds_read_b64_tr_b16 a[86:87], v13 offset:21536
  ds_read_b64_tr_b16 a[88:89], v13 offset:22528
  ds_read_b64_tr_b16 a[90:91], v13 offset:23552
  ds_read_b64_tr_b16 a[92:93], v13 offset:22560
  ds_read_b64_tr_b16 a[94:95], v13 offset:23584
  ds_read_b64_tr_b16 a[96:97], v13 offset:24576
  ds_read_b64_tr_b16 a[98:99], v13 offset:25600
  ds_read_b64_tr_b16 a[100:101], v13 offset:24608
  ds_read_b64_tr_b16 a[102:103], v13 offset:25632
  s_waitcnt lgkmcnt(4)
  ds_read_b64_tr_b16 a[104:105], v13 offset:26624
  ds_read_b64_tr_b16 a[106:107], v13 offset:27648
  ds_read_b64_tr_b16 a[108:109], v13 offset:26656
  ds_read_b64_tr_b16 a[110:111], v13 offset:27680
  ds_read_b64_tr_b16 a[112:113], v13 offset:28672
  ds_read_b64_tr_b16 a[114:115], v13 offset:29696
  ds_read_b64_tr_b16 a[116:117], v13 offset:28704
  ds_read_b64_tr_b16 a[118:119], v13 offset:29728
  ds_read_b64_tr_b16 a[120:121], v13 offset:30720
  ds_read_b64_tr_b16 a[122:123], v13 offset:31744
  ds_read_b64_tr_b16 a[124:125], v13 offset:30752
  ds_read_b64_tr_b16 a[126:127], v13 offset:31776
  s_waitcnt lgkmcnt(4)
  ds_read_b64_tr_b16 a[128:129], v13 offset:32768
  ds_read_b64_tr_b16 a[130:131], v13 offset:33792
  ds_read_b64_tr_b16 a[132:133], v13 offset:32800
  ds_read_b64_tr_b16 a[134:135], v13 offset:33824
  ds_read_b64_tr_b16 a[136:137], v13 offset:34816
  ds_read_b64_tr_b16 a[138:139], v13 offset:35840
  ds_read_b64_tr_b16 a[140:141], v13 offset:34848
  ds_read_b64_tr_b16 a[142:143], v13 offset:35872
  ds_read_b64_tr_b16 a[144:145], v13 offset:36864
  ds_read_b64_tr_b16 a[146:147], v13 offset:37888
  ds_read_b64_tr_b16 a[148:149], v13 offset:36896
  ds_read_b64_tr_b16 a[150:151], v13 offset:37920
  s_waitcnt lgkmcnt(4)
  ds_read_b64_tr_b16 a[152:153], v13 offset:38912
  ds_read_b64_tr_b16 a[154:155], v13 offset:39936
  ds_read_b64_tr_b16 a[156:157], v13 offset:38944
  ds_read_b64_tr_b16 a[158:159], v13 offset:39968
  s_waitcnt lgkmcnt(0)
  v_mov_b32 v32, 0x3f803f80
  v_mov_b32 v33, 0x3f803f80
  v_mov_b32 v34, 0x3f803f80
  v_mov_b32 v35, 0x3f803f80
  s_nop 1
  v_mfma_f32_16x16x32_bf16 v[80:83], a[0:3], v[32:35], 0
  v_mfma_f32_16x16x32_bf16 v[84:87], a[4:7], v[32:35], 0
  v_mfma_f32_16x16x32_bf16 v[80:83], a[8:11], v[32:35], v[80:83]
  v_mfma_f32_16x16x32_bf16 v[84:87], a[12:15], v[32:35], v[84:87]
  v_mfma_f32_16x16x32_bf16 v[80:83], a[16:19], v[32:35], v[80:83]
  v_mfma_f32_16x16x32_bf16 v[84:87], a[20:23], v[32:35], v[84:87]
  v_mfma_f32_16x16x32_bf16 v[80:83], a[24:27], v[32:35], v[80:83]
  v_mfma_f32_16x16x32_bf16 v[84:87], a[28:31], v[32:35], v[84:87]
  v_mfma_f32_16x16x32_bf16 v[80:83], a[32:35], v[32:35], v[80:83]
  v_mfma_f32_16x16x32_bf16 v[84:87], a[36:39], v[32:35], v[84:87]
  v_mfma_f32_16x16x32_bf16 v[80:83], a[40:43], v[32:35], v[80:83]
  v_mfma_f32_16x16x32_bf16 v[84:87], a[44:47], v[32:35], v[84:87]
  v_mfma_f32_16x16x32_bf16 v[80:83], a[48:51], v[32:35], v[80:83]
  v_mfma_f32_16x16x32_bf16 v[84:87], a[52:55], v[32:35], v[84:87]
  v_mfma_f32_16x16x32_bf16 v[80:83], a[56:59], v[32:35], v[80:83]
  v_mfma_f32_16x16x32_bf16 v[84:87], a[60:63], v[32:35], v[84:87]
  v_mfma_f32_16x16x32_bf16 v[80:83], a[64:67], v[32:35], v[80:83]
  v_mfma_f32_16x16x32_bf16 v[84:87], a[68:71], v[32:35], v[84:87]
  v_mfma_f32_16x16x32_bf16 v[80:83], a[72:75], v[32:35], v[80:83]
  v_mfma_f32_16x16x32_bf16 v[84:87], a[76:79], v[32:35], v[84:87]
  v_mfma_f32_16x16x32_bf16 v[80:83], a[80:83], v[32:35], v[80:83]
  v_mfma_f32_16x16x32_bf16 v[84:87], a[84:87], v[32:35], v[84:87]
  v_mfma_f32_16x16x32_bf16 v[80:83], a[88:91], v[32:35], v[80:83]
  v_mfma_f32_16x16x32_bf16 v[84:87], a[92:95], v[32:35], v[84:87]
  v_mfma_f32_16x16x32_bf16 v[80:83], a[96:99], v[32:35], v[80:83]
  v_mfma_f32_16x16x32_bf16 v[84:87], a[100:103], v[32:35], v[84:87]
  v_mfma_f32_16x16x32_bf16 v[80:83], a[104:107], v[32:35], v[80:83]
  v_mfma_f32_16x16x32_bf16 v[84:87], a[108:111], v[32:35], v[84:87]
  v_mfma_f32_16x16x32_bf16 v[80:83], a[112:115], v[32:35], v[80:83]
  v_mfma_f32_16x16x32_bf16 v[84:87], a[116:119], v[32:35], v[84:87]
  v_mfma_f32_16x16x32_bf16 v[80:83], a[120:123], v[32:35], v[80:83]
  v_mfma_f32_16x16x32_bf16 v[84:87], a[124:127], v[32:35], v[84:87]
  v_mfma_f32_16x16x32_bf16 v[80:83], a[128:131], v[32:35], v[80:83]
  v_mfma_f32_16x16x32_bf16 v[84:87], a[132:135], v[32:35], v[84:87]
  v_mfma_f32_16x16x32_bf16 v[80:83], a[136:139], v[32:35], v[80:83]
  v_mfma_f32_16x16x32_bf16 v[84:87], a[140:143], v[32:35], v[84:87]
  v_mfma_f32_16x16x32_bf16 v[80:83], a[144:147], v[32:35], v[80:83]
  v_mfma_f32_16x16x32_bf16 v[84:87], a[148:151], v[32:35], v[84:87]
  v_mfma_f32_16x16x32_bf16 v[80:83], a[152:155], v[32:35], v[80:83]
  v_mfma_f32_16x16x32_bf16 v[84:87], a[156:159], v[32:35], v[84:87]
  v_lshrrev_b32 v12, 4, v0
  v_mul_u32_u24 v12, 98304, v12
  v_lshl_add_u32 v12, v6, 4, v12
  s_lshl_b32 s60, s55, 11
  s_add_u32 s61, s60, 22978560
  buffer_load_dword v13, v12, s[8:11], s61 offen sc1
  s_add_u32 s61, s60, 23371776
  buffer_load_dword v13, v12, s[8:11], s61 offen sc1
  s_waitcnt vmcnt(0)
  s_barrier
  s_mov_b32 s50, 0
  s_mov_b32 s56, 0
  s_add_u32 s62, s50, 0
  s_min_u32 s62, s62, 127
  s_sub_i32 s60, s62, 13
  s_sub_i32 s53, s62, 12
  s_ashr_i32 s60, s60, 1
  s_ashr_i32 s53, s53, 1
  s_sub_i32 s61, s62, 64
  s_max_i32 s60, s60, s61
  s_add_i32 s61, s61, 1
  s_max_i32 s53, s53, s61
  s_max_i32 s60, s60, 0
  s_max_i32 s53, s53, 0
  s_sub_i32 s53, s53, s60
  s_sub_i32 s54, s62, s60
  s_sub_i32 s60, s60, s54
  s_mul_i32 s60, s60, s53
  s_add_i32 s54, s54, s60
  s_lshl_b32 s82, s53, 15
  s_add_u32 s82, s82, 327680
  s_and_b32 s60, s54, 3
  s_lshl2_add_u32 s60, s53, s60
  s_mul_i32 s69, s60, 46080
  s_add_u32 s69, s69, 22282240
  s_add_u32 s68, s69, s58
  s_add_u32 s71, s56, s58
W3_F_WAIT:
su_430:
  buffer_load_dword v156, v8, s[8:11], s82 offen sc1
  s_waitcnt vmcnt(0)
  v_add_u32 v156, v156, v9
  v_cmp_ge_i32 vcc, s54, v156
  s_nop 0
  s_cbranch_vccz so_431
  s_sleep 2
  s_sub_u32 s47, s47, 1
  s_cbranch_scc0 su_430
  s_branch ABORT
so_431:
  s_add_u32 m0, s71, 0
  s_add_u32 s65, s68, 0
  buffer_load_dwordx4 v20, s[8:11], s65 offen offset:0 sc1 lds
  buffer_load_dwordx4 v20, s[8:11], s65 offen offset:2048 sc1 lds
  s_add_u32 m0, s71, 4096
  s_add_u32 s65, s68, 4096
  buffer_load_dwordx4 v20, s[8:11], s65 offen offset:0 sc1 lds
  buffer_load_dwordx4 v20, s[8:11], s65 offen offset:2048 sc1 lds
  s_add_u32 m0, s71, 8192
  s_add_u32 s65, s68, 8192
  buffer_load_dwordx4 v20, s[8:11], s65 offen offset:0 sc1 lds
  s_add_u32 m0, s56, s75
  s_add_u32 s65, s69, s75
  buffer_load_dwordx4 v1, s[8:11], s65 offen sc1 lds
  buffer_load_dwordx4 v1, s[8:11], s65 offen offset:1024 sc1 lds
  s_add_u32 m0, s71, 1024
  s_add_u32 s65, s68, 0
  buffer_load_dwordx4 v21, s[8:11], s65 offen offset:0 sc1 lds
  buffer_load_dwordx4 v21, s[8:11], s65 offen offset:2048 sc1 lds
  s_add_u32 m0, s71, 5120
  s_add_u32 s65, s68, 4096
  buffer_load_dwordx4 v21, s[8:11], s65 offen offset:0 sc1 lds
  buffer_load_dwordx4 v21, s[8:11], s65 offen offset:2048 sc1 lds
  s_add_u32 m0, s71, 9216
  s_add_u32 s65, s68, 8192
  buffer_load_dwordx4 v21, s[8:11], s65 offen offset:0 sc1 lds
  s_waitcnt vmcnt(5)
W3_F_LOOP:
  v_add_u32 v7, s56, v1
  v_add_u32 v4, s56, v3
  s_barrier
  ds_read_b128 v[32:35], v7 offset:0
  ds_read_b128 v[36:39], v7 offset:2048
  ds_read_b128 v[40:43], v7 offset:4096
  ds_read_b128 v[44:47], v7 offset:6144
  s_xor_b32 s56, s56, 46080
  s_mov_b32 s51, s53
  s_mov_b32 s52, s54
  s_lshl2_add_u32 s74, s55, s82
  s_add_u32 s74, s74, 160
  s_add_u32 s62, s50, 1
  s_min_u32 s62, s62, 127
  s_sub_i32 s60, s62, 13
  s_sub_i32 s53, s62, 12
  s_ashr_i32 s60, s60, 1
  s_ashr_i32 s53, s53, 1
  s_sub_i32 s61, s62, 64
  s_max_i32 s60, s60, s61
  s_waitcnt lgkmcnt(3)
  v_mfma_f32_16x16x32_bf16 v[64:67], a[0:3], v[32:35], 0
  s_add_i32 s61, s61, 1
  ds_read_b128 v[48:51], v7 offset:8192
  v_add_u32 v12, 0x800, v4
  v_mfma_f32_16x16x32_bf16 v[68:71], a[4:7], v[32:35], 0
  s_waitcnt lgkmcnt(3)
  ds_read_b128 v[52:55], v7 offset:10240
  s_max_i32 s53, s53, s61
  v_mfma_f32_16x16x32_bf16 v[64:67], a[8:11], v[36:39], v[64:67]
  s_max_i32 s60, s60, 0
  ds_read_b128 v[56:59], v7 offset:12288
  s_max_i32 s53, s53, 0
  v_mfma_f32_16x16x32_bf16 v[68:71], a[12:15], v[36:39], v[68:71]
  s_waitcnt lgkmcnt(4)
  ds_read_b128 v[60:63], v7 offset:14336
  s_sub_i32 s53, s53, s60
  v_mfma_f32_16x16x32_bf16 v[64:67], a[16:19], v[40:43], v[64:67]
  s_sub_i32 s54, s62, s60
  ds_read_b128 v[32:35], v7 offset:16384
  s_sub_i32 s60, s60, s54
  v_mfma_f32_16x16x32_bf16 v[68:71], a[20:23], v[40:43], v[68:71]
  s_waitcnt lgkmcnt(5)
  ds_read_b128 v[36:39], v7 offset:18432
  ds_read2_b64 v[88:91], v4 offset0:0 offset1:32
  v_mfma_f32_16x16x32_bf16 v[64:67], a[24:27], v[44:47], v[64:67]
  s_mul_i32 s60, s60, s53
  ds_read_b128 v[40:43], v7 offset:20480
  s_add_i32 s54, s54, s60
  v_mfma_f32_16x16x32_bf16 v[68:71], a[28:31], v[44:47], v[68:71]
  s_waitcnt lgkmcnt(6)
  ds_read2_b64 v[92:95], v4 offset0:64 offset1:96
  s_lshl_b32 s82, s53, 15
  v_mfma_f32_16x16x32_bf16 v[64:67], a[32:35], v[48:51], v[64:67]
  s_add_u32 s82, s82, 327680
  ds_read_b128 v[44:47], v7 offset:22528
  ds_read2_b64 v[96:99], v4 offset0:128 offset1:160
  v_mfma_f32_16x16x32_bf16 v[68:71], a[36:39], v[48:51], v[68:71]
  ds_read2_b64 v[100:103], v4 offset0:192 offset1:224
  v_mfma_f32_16x16x32_bf16 v[64:67], a[40:43], v[52:55], v[64:67]
  ds_read_b128 v[48:51], v7 offset:24576
  v_mfma_f32_16x16x32_bf16 v[68:71], a[44:47], v[52:55], v[68:71]
  s_waitcnt lgkmcnt(9)
  ds_read2_b64 v[104:107], v12 offset0:0 offset1:32
  v_mfma_f32_16x16x32_bf16 v[64:67], a[48:51], v[56:59], v[64:67]
  ds_read_b128 v[52:55], v7 offset:26624
  v_mfma_f32_16x16x32_bf16 v[68:71], a[52:55], v[56:59], v[68:71]
  v_mfma_f32_16x16x32_bf16 v[64:67], a[56:59], v[60:63], v[64:67]
  ds_read_b128 v[56:59], v7 offset:28672
  v_mfma_f32_16x16x32_bf16 v[68:71], a[60:63], v[60:63], v[68:71]
  s_waitcnt lgkmcnt(10)
  s_waitcnt lgkmcnt(2)
  v_add_f32 v88, v88, v98
  v_mfma_f32_16x16x32_bf16 v[64:67], a[64:67], v[32:35], v[64:67]
  ds_read_b128 v[60:63], v7 offset:30720
  v_add_f32 v89, v89, v99
  v_mfma_f32_16x16x32_bf16 v[68:71], a[68:71], v[32:35], v[68:71]
  v_add_f32 v90, v90, v100
  v_add_f32 v91, v91, v101
  v_mfma_f32_16x16x32_bf16 v[64:67], a[72:75], v[36:39], v[64:67]
  ds_read_b128 v[32:35], v7 offset:32768
  v_add_f32 v92, v92, v102
  v_mfma_f32_16x16x32_bf16 v[68:71], a[76:79], v[36:39], v[68:71]
  v_add_f32 v93, v93, v103
  v_add_f32 v94, v94, v104
  v_mfma_f32_16x16x32_bf16 v[64:67], a[80:83], v[40:43], v[64:67]
  ds_read_b128 v[36:39], v7 offset:34816
  v_add_f32 v95, v95, v105
  v_mfma_f32_16x16x32_bf16 v[68:71], a[84:87], v[40:43], v[68:71]
  v_add_f32 v96, v96, v106
  v_add_f32 v97, v97, v107
  v_mfma_f32_16x16x32_bf16 v[64:67], a[88:91], v[44:47], v[64:67]
  ds_read_b128 v[40:43], v7 offset:36864
  v_add_f32 v88, v88, v90
  v_mfma_f32_16x16x32_bf16 v[68:71], a[92:95], v[44:47], v[68:71]
  s_waitcnt lgkmcnt(5)
  v_add_f32 v89, v89, v91
  v_add_f32 v92, v92, v94
  v_mfma_f32_16x16x32_bf16 v[64:67], a[96:99], v[48:51], v[64:67]
  ds_read_b128 v[44:47], v7 offset:38912
  v_add_f32 v93, v93, v95
  v_mfma_f32_16x16x32_bf16 v[68:71], a[100:103], v[48:51], v[68:71]
  s_waitcnt vmcnt(0)
  v_mov_b32 v19, s83
  s_and_b64 exec, s[76:77], 1
  s_cmp_lg_u32 s49, 0
  s_cbranch_scc1 wt_432
  buffer_store_dword v19, v1, s[8:11], s59 offen
wb_433:
  s_mov_b64 exec, -1
  s_barrier
  v_mfma_f32_16x16x32_bf16 v[64:67], a[104:107], v[52:55], v[64:67]
  s_and_b32 s63, s52, 3
  ds_read_b128 v[48:51], v7 offset:1024
  v_add_f32 v88, v88, v92
  v_mfma_f32_16x16x32_bf16 v[68:71], a[108:111], v[52:55], v[68:71]
  s_waitcnt lgkmcnt(5)
  v_add_f32 v89, v89, v93
  v_add_f32 v88, v88, v96
  v_mfma_f32_16x16x32_bf16 v[64:67], a[112:115], v[56:59], v[64:67]
  s_lshl2_add_u32 s63, s51, s63
  ds_read_b128 v[52:55], v7 offset:3072
  v_add_f32 v89, v89, v97
  v_mfma_f32_16x16x32_bf16 v[68:71], a[116:119], v[56:59], v[68:71]
  s_mul_i32 s72, s63, 98304
  v_mov_b32 v90, v88
  v_mov_b32 v91, v89
  v_mfma_f32_16x16x32_bf16 v[64:67], a[120:123], v[60:63], v[64:67]
  s_add_u32 s72, s72, 22978560
  ds_read_b128 v[56:59], v7 offset:5120
  s_lshl_b32 s63, s55, 11
  v_mfma_f32_16x16x32_bf16 v[68:71], a[124:127], v[60:63], v[68:71]
  s_waitcnt lgkmcnt(5)
  v_permlane16_swap_b32 v88, v90
  v_mfma_f32_16x16x32_bf16 v[64:67], a[128:131], v[32:35], v[64:67]
  s_add_u32 s72, s72, s63
  ds_read_b128 v[60:63], v7 offset:7168
  s_and_b32 s60, s54, 3
  v_mfma_f32_16x16x32_bf16 v[68:71], a[132:135], v[32:35], v[68:71]
  s_lshl2_add_u32 s60, s53, s60
  buffer_load_dword v156, v8, s[8:11], s82 offen sc1
  s_mul_i32 s69, s60, 46080
  v_mfma_f32_16x16x32_bf16 v[64:67], a[136:139], v[36:39], v[64:67]
  s_add_u32 s69, s69, 22282240
  ds_read_b128 v[32:35], v7 offset:9216
  s_add_u32 s68, s69, s58
  v_mfma_f32_16x16x32_bf16 v[68:71], a[140:143], v[36:39], v[68:71]
  s_waitcnt lgkmcnt(5)
  v_permlane16_swap_b32 v89, v91
  v_mfma_f32_16x16x32_bf16 v[64:67], a[144:147], v[40:43], v[64:67]
  s_add_u32 s71, s56, s58
  ds_read_b128 v[36:39], v7 offset:11264
  v_add_f32 v27, v88, v90
  v_mfma_f32_16x16x32_bf16 v[68:71], a[148:151], v[40:43], v[68:71]
  v_add_f32 v28, v89, v91
  v_mul_f32 v27, 0x3acccccd, v27
  v_mfma_f32_16x16x32_bf16 v[64:67], a[152:155], v[44:47], v[64:67]
  ds_read_b128 v[40:43], v7 offset:13312
  v_mul_f32 v28, 0x3acccccd, v28
  v_mfma_f32_16x16x32_bf16 v[68:71], a[156:159], v[44:47], v[68:71]
  s_waitcnt lgkmcnt(5)
  v_fma_f32 v28, -v27, v27, v28
  v_max_f32 v28, 0, v28
  v_mfma_f32_16x16x32_bf16 v[72:75], a[0:3], v[48:51], 0
  ds_read_b128 v[44:47], v7 offset:15360
  v_add_f32 v28, 0x3727c5ac, v28
  v_mfma_f32_16x16x32_bf16 v[76:79], a[4:7], v[48:51], 0
  v_rsq_f32 v28, v28
  v_mfma_f32_16x16x32_bf16 v[72:75], a[8:11], v[52:55], v[72:75]
  ds_read_b128 v[48:51], v7 offset:17408
  v_mul_f32 v25, v28, v28
  v_mfma_f32_16x16x32_bf16 v[76:79], a[12:15], v[52:55], v[76:79]
  s_waitcnt lgkmcnt(5)
  v_mul_f32 v24, 0xc0135761, v28
  v_mfma_f32_16x16x32_bf16 v[72:75], a[16:19], v[56:59], v[72:75]
  ds_read_b128 v[52:55], v7 offset:19456
  v_mfma_f32_16x16x32_bf16 v[76:79], a[20:23], v[56:59], v[76:79]
  v_rcp_f32 v26, v28
  v_mfma_f32_16x16x32_bf16 v[72:75], a[24:27], v[60:63], v[72:75]
  ds_read_b128 v[56:59], v7 offset:21504
  v_mul_f32 v25, 0x3d372713, v25
  v_mfma_f32_16x16x32_bf16 v[76:79], a[28:31], v[60:63], v[76:79]
  s_waitcnt lgkmcnt(5)
  v_mul_f32 v25, v25, v24
  v_mov_b32 v28, v24
  v_mfma_f32_16x16x32_bf16 v[72:75], a[32:35], v[32:35], v[72:75]
  ds_read_b128 v[60:63], v7 offset:23552
  v_mov_b32 v29, v25
  v_mfma_f32_16x16x32_bf16 v[76:79], a[36:39], v[32:35], v[76:79]
  v_mov_b32 v30, v26
  v_mov_b32 v31, v27
  v_mfma_f32_16x16x32_bf16 v[72:75], a[40:43], v[36:39], v[72:75]
  ds_read_b128 v[32:35], v7 offset:25600
  v_mfma_f32_16x16x32_bf16 v[76:79], a[44:47], v[36:39], v[76:79]
  s_waitcnt lgkmcnt(5)
  v_permlane32_swap_b32 v24, v28
  v_mfma_f32_16x16x32_bf16 v[72:75], a[48:51], v[40:43], v[72:75]
  ds_read_b128 v[36:39], v7 offset:27648
  v_mfma_f32_16x16x32_bf16 v[76:79], a[52:55], v[40:43], v[76:79]
  v_permlane32_swap_b32 v25, v29
  v_mfma_f32_16x16x32_bf16 v[72:75], a[56:59], v[44:47], v[72:75]
  s_waitcnt vmcnt(0)
  ds_read_b128 v[40:43], v7 offset:29696
  v_add_u32 v156, v156, v9
  v_mfma_f32_16x16x32_bf16 v[76:79], a[60:63], v[44:47], v[76:79]
  s_waitcnt lgkmcnt(5)
  v_cmp_ge_i32 vcc, s54, v156
  v_mfma_f32_16x16x32_bf16 v[72:75], a[64:67], v[48:51], v[72:75]
  ds_read_b128 v[44:47], v7 offset:31744
  v_mfma_f32_16x16x32_bf16 v[76:79], a[68:71], v[48:51], v[76:79]
  s_cmp_lg_u64 vcc, 0
  s_cselect_b32 s57, 536870912, 0
  s_or_b32 s66, s68, s57
  v_mfma_f32_16x16x32_bf16 v[72:75], a[72:75], v[52:55], v[72:75]
  s_or_b32 s67, s69, s57
  ds_read_b128 v[48:51], v7 offset:33792
  v_mfma_f32_16x16x32_bf16 v[76:79], a[76:79], v[52:55], v[76:79]
  s_waitcnt lgkmcnt(5)
  s_add_u32 m0, s71, 0
  s_add_u32 s65, s66, 0
  buffer_load_dwordx4 v20, s[8:11], s65 offen offset:0 sc1 lds
  v_mfma_f32_16x16x32_bf16 v[72:75], a[80:83], v[56:59], v[72:75]
  ds_read_b128 v[52:55], v7 offset:35840
  v_mfma_f32_16x16x32_bf16 v[76:79], a[84:87], v[56:59], v[76:79]
  v_permlane32_swap_b32 v26, v30
  v_mfma_f32_16x16x32_bf16 v[72:75], a[88:91], v[60:63], v[72:75]
  ds_read_b128 v[56:59], v7 offset:37888
  v_mfma_f32_16x16x32_bf16 v[76:79], a[92:95], v[60:63], v[76:79]
  s_waitcnt lgkmcnt(5)
  buffer_load_dwordx4 v20, s[8:11], s65 offen offset:2048 sc1 lds
  v_mfma_f32_16x16x32_bf16 v[72:75], a[96:99], v[32:35], v[72:75]
  ds_read_b128 v[60:63], v7 offset:39936
  v_mfma_f32_16x16x32_bf16 v[76:79], a[100:103], v[32:35], v[76:79]
  v_permlane32_swap_b32 v27, v31
  v_mfma_f32_16x16x32_bf16 v[72:75], a[104:107], v[36:39], v[72:75]
  v_fma_f32 v64, -v27, v80, v64
  v_fma_f32 v65, -v27, v81, v65
  v_mfma_f32_16x16x32_bf16 v[76:79], a[108:111], v[36:39], v[76:79]
  s_waitcnt lgkmcnt(4)
  s_add_u32 m0, s71, 4096
  s_add_u32 s65, s66, 4096
  buffer_load_dwordx4 v20, s[8:11], s65 offen offset:0 sc1 lds
  v_mfma_f32_16x16x32_bf16 v[72:75], a[112:115], v[40:43], v[72:75]
  v_fma_f32 v66, -v27, v82, v66
  v_fma_f32 v67, -v27, v83, v67
  v_mfma_f32_16x16x32_bf16 v[76:79], a[116:119], v[40:43], v[76:79]
  v_fma_f32 v68, -v27, v84, v68
  v_fma_f32 v69, -v27, v85, v69
  v_mfma_f32_16x16x32_bf16 v[72:75], a[120:123], v[44:47], v[72:75]
  v_fma_f32 v70, -v27, v86, v70
  v_fma_f32 v71, -v27, v87, v71
  v_mfma_f32_16x16x32_bf16 v[76:79], a[124:127], v[44:47], v[76:79]
  s_waitcnt lgkmcnt(2)
  buffer_load_dwordx4 v20, s[8:11], s65 offen offset:2048 sc1 lds
  v_mul_f32 v116, v64, v64
  v_mfma_f32_16x16x32_bf16 v[72:75], a[128:131], v[48:51], v[72:75]
  v_mul_f32 v117, v65, v65
  v_mul_f32 v118, v66, v66
  v_mfma_f32_16x16x32_bf16 v[76:79], a[132:135], v[48:51], v[76:79]
  v_mul_f32 v119, v67, v67
  v_mul_f32 v120, v68, v68
  v_mfma_f32_16x16x32_bf16 v[72:75], a[136:139], v[52:55], v[72:75]
  v_mul_f32 v121, v69, v69
  v_mul_f32 v122, v70, v70
  v_mfma_f32_16x16x32_bf16 v[76:79], a[140:143], v[52:55], v[76:79]
  s_waitcnt lgkmcnt(0)
  s_add_u32 m0, s71, 8192
  s_add_u32 s65, s66, 8192
  buffer_load_dwordx4 v20, s[8:11], s65 offen offset:0 sc1 lds
  v_mfma_f32_16x16x32_bf16 v[72:75], a[144:147], v[56:59], v[72:75]
  v_mul_f32 v123, v71, v71
  v_fma_f32 v116, v116, v25, v24
  v_mfma_f32_16x16x32_bf16 v[76:79], a[148:151], v[56:59], v[76:79]
  v_fma_f32 v117, v117, v25, v24
  v_fma_f32 v118, v118, v25, v24
  v_mfma_f32_16x16x32_bf16 v[72:75], a[152:155], v[60:63], v[72:75]
  v_fma_f32 v119, v119, v25, v24
  v_fma_f32 v120, v120, v25, v24
  v_mfma_f32_16x16x32_bf16 v[76:79], a[156:159], v[60:63], v[76:79]
  s_add_u32 m0, s56, s75
  s_add_u32 s65, s67, s75
  buffer_load_dwordx4 v1, s[8:11], s65 offen sc1 lds
  buffer_load_dwordx4 v1, s[8:11], s65 offen offset:1024 sc1 lds
  v_fma_f32 v121, v121, v25, v24
  v_fma_f32 v122, v122, v25, v24
  v_fma_f32 v123, v123, v25, v24
  v_mul_f32 v116, v116, v64
  v_mul_f32 v117, v117, v65
  v_mul_f32 v118, v118, v66
  v_mul_f32 v119, v119, v67
  v_mul_f32 v120, v120, v68
  v_mul_f32 v121, v121, v69
  v_mul_f32 v122, v122, v70
  v_mul_f32 v123, v123, v71
  v_exp_f32 v116, v116
  v_exp_f32 v117, v117
  v_exp_f32 v118, v118
  s_add_u32 m0, s71, 1024
  s_add_u32 s65, s66, 0
  buffer_load_dwordx4 v21, s[8:11], s65 offen offset:0 sc1 lds
  v_exp_f32 v119, v119
  v_exp_f32 v120, v120
  v_exp_f32 v121, v121
  v_exp_f32 v122, v122
  v_exp_f32 v123, v123
  v_fma_f32 v116, v116, v26, v26
  v_fma_f32 v117, v117, v26, v26
  v_fma_f32 v118, v118, v26, v26
  v_fma_f32 v119, v119, v26, v26
  v_fma_f32 v120, v120, v26, v26
  v_fma_f32 v121, v121, v26, v26
  v_fma_f32 v122, v122, v26, v26
  v_fma_f32 v123, v123, v26, v26
  v_rcp_f32 v116, v116
  buffer_load_dwordx4 v21, s[8:11], s65 offen offset:2048 sc1 lds
  v_rcp_f32 v117, v117
  v_rcp_f32 v118, v118
  v_rcp_f32 v119, v119
  v_rcp_f32 v120, v120
  v_rcp_f32 v121, v121
  v_rcp_f32 v122, v122
  v_rcp_f32 v123, v123
  v_mul_f32 v64, v64, v116
  v_mul_f32 v65, v65, v117
  v_mul_f32 v66, v66, v118
  v_mul_f32 v67, v67, v119
  v_mul_f32 v68, v68, v120
  v_mul_f32 v69, v69, v121
  v_mul_f32 v70, v70, v122
  s_add_u32 m0, s71, 5120
  s_add_u32 s65, s66, 4096
  buffer_load_dwordx4 v21, s[8:11], s65 offen offset:0 sc1 lds
  v_mul_f32 v71, v71, v123
  v_cvt_pk_bf16_f32 v108, v64, v65
  v_cvt_pk_bf16_f32 v109, v66, v67
  v_cvt_pk_bf16_f32 v110, v68, v69
  v_cvt_pk_bf16_f32 v111, v70, v71
  s_cmp_lg_u32 s49, 0
  s_cbranch_scc1 wt_434
  buffer_store_dwordx4 v[108:111], v1, s[8:11], s72 offen offset:0
wb_435:
  v_pk_fma_f32 v[72:73], v[80:81], v[30:31], v[72:73] op_sel:[0,1,0] op_sel_hi:[1,1,1] neg_lo:[0,1,0] neg_hi:[0,1,0]
  v_pk_fma_f32 v[74:75], v[82:83], v[30:31], v[74:75] op_sel:[0,1,0] op_sel_hi:[1,1,1] neg_lo:[0,1,0] neg_hi:[0,1,0]
  v_pk_fma_f32 v[76:77], v[84:85], v[30:31], v[76:77] op_sel:[0,1,0] op_sel_hi:[1,1,1] neg_lo:[0,1,0] neg_hi:[0,1,0]
  v_pk_fma_f32 v[78:79], v[86:87], v[30:31], v[78:79] op_sel:[0,1,0] op_sel_hi:[1,1,1] neg_lo:[0,1,0] neg_hi:[0,1,0]
  v_pk_mul_f32 v[116:117], v[72:73], v[72:73]
  v_pk_mul_f32 v[118:119], v[74:75], v[74:75]
  v_pk_mul_f32 v[120:121], v[76:77], v[76:77]
  v_pk_mul_f32 v[122:123], v[78:79], v[78:79]
  buffer_load_dwordx4 v21, s[8:11], s65 offen offset:2048 sc1 lds
  v_pk_fma_f32 v[116:117], v[116:117], v[28:29], v[28:29] op_sel:[0,1,0] op_sel_hi:[1,1,0]
  v_pk_fma_f32 v[118:119], v[118:119], v[28:29], v[28:29] op_sel:[0,1,0] op_sel_hi:[1,1,0]
  v_pk_fma_f32 v[120:121], v[120:121], v[28:29], v[28:29] op_sel:[0,1,0] op_sel_hi:[1,1,0]
  v_pk_fma_f32 v[122:123], v[122:123], v[28:29], v[28:29] op_sel:[0,1,0] op_sel_hi:[1,1,0]
  v_pk_mul_f32 v[116:117], v[116:117], v[72:73]
  v_pk_mul_f32 v[118:119], v[118:119], v[74:75]
  v_pk_mul_f32 v[120:121], v[120:121], v[76:77]
  v_pk_mul_f32 v[122:123], v[122:123], v[78:79]
  v_exp_f32 v116, v116
  v_exp_f32 v117, v117
  v_exp_f32 v118, v118
  v_exp_f32 v119, v119
  v_exp_f32 v120, v120
  v_exp_f32 v121, v121
  s_add_u32 m0, s71, 9216
  s_add_u32 s65, s66, 8192
  buffer_load_dwordx4 v21, s[8:11], s65 offen offset:0 sc1 lds
  v_exp_f32 v122, v122
  v_exp_f32 v123, v123
  v_pk_fma_f32 v[116:117], v[116:117], v[30:31], v[30:31] op_sel_hi:[1,0,0]
  v_pk_fma_f32 v[118:119], v[118:119], v[30:31], v[30:31] op_sel_hi:[1,0,0]
  v_pk_fma_f32 v[120:121], v[120:121], v[30:31], v[30:31] op_sel_hi:[1,0,0]
  v_pk_fma_f32 v[122:123], v[122:123], v[30:31], v[30:31] op_sel_hi:[1,0,0]
  v_rcp_f32 v116, v116
  v_rcp_f32 v117, v117
  v_rcp_f32 v118, v118
  v_rcp_f32 v119, v119
  v_rcp_f32 v120, v120
  v_rcp_f32 v121, v121
  v_rcp_f32 v122, v122
  v_rcp_f32 v123, v123
  v_pk_mul_f32 v[72:73], v[72:73], v[116:117]
  v_pk_mul_f32 v[74:75], v[74:75], v[118:119]
  v_pk_mul_f32 v[76:77], v[76:77], v[120:121]
  v_pk_mul_f32 v[78:79], v[78:79], v[122:123]
  v_cvt_pk_bf16_f32 v112, v72, v73
  v_cvt_pk_bf16_f32 v113, v74, v75
  v_cvt_pk_bf16_f32 v114, v76, v77
  v_cvt_pk_bf16_f32 v115, v78, v79
  s_cmp_lg_u32 s49, 0
  s_cbranch_scc1 wt_436
  buffer_store_dwordx4 v[112:115], v1, s[8:11], s72 offen offset:1024
wb_437:
  s_mov_b32 s59, s74
  s_add_u32 s83, s52, 1
  s_mov_b64 s[76:77], -1
  s_add_u32 s50, s50, 1
  s_cmp_eq_u32 s50, 128
  s_cselect_b32 s57, 1, s57
  s_waitcnt vmcnt(7)
  s_cmp_eq_u32 s57, 0
  s_cbranch_scc1 W3_F_LOOP
  s_waitcnt vmcnt(0)
  v_mov_b32 v19, s83
  s_and_b64 exec, s[76:77], 1
  s_cmp_lg_u32 s49, 0
  s_cbranch_scc1 wt_438
  buffer_store_dword v19, v1, s[8:11], s59 offen
wb_439:
  s_mov_b64 exec, -1
  s_mov_b64 s[76:77], 0
  s_cmp_lt_u32 s50, 128
  s_cbranch_scc1 W3_F_WAIT
  s_endpgm
wt_432:
  s_nop 7
  buffer_store_dword v19, v1, s[8:11], s59 offen sc1
  s_branch wb_433
wt_434:
  s_nop 7
  buffer_store_dwordx4 v[108:111], v1, s[8:11], s72 offen offset:0 sc1
  s_branch wb_435
wt_436:
  s_nop 7
  buffer_store_dwordx4 v[112:115], v1, s[8:11], s72 offen offset:1024 sc1
  s_branch wb_437
wt_438:
  s_nop 7
  buffer_store_dword v19, v1, s[8:11], s59 offen sc1
  s_branch wb_439
GO_W4:
ROLE_W4:
  v_lshlrev_b32 v1, 4, v0
  v_add_u32 v7, 0xc000, v1
  v_mov_b32 v4, 1
  s_cmp_ge_u32 s48, 5
  s_cselect_b32 s51, 1, 0
  s_mul_i32 s60, s51, 5
  s_sub_u32 s60, s48, s60
  s_lshl2_add_u32 s52, s60, s46
  v_min_u32 v2, 11, v0
  s_mul_i32 s60, s46, 12
  s_add_u32 s60, s60, 40
  v_add_lshl_u32 v2, v2, s60, 2
  v_and_b32 v12, 15, v0
  v_lshrrev_b32 v5, 5, v0
  v_lshlrev_b32 v5, 7, v5
  v_lshl_add_u32 v5, v12, 3, v5
  v_mul_u32_u24 v6, 1280, v12
  v_lshrrev_b32 v12, 4, v0
  v_lshl_add_u32 v6, v12, 3, v6
  s_lshl_b32 s71, s52, 6
  s_mul_i32 s57, s46, 12288
  s_mul_i32 s68, s51, 393216
  s_lshl1_add_u32 s68, s57, s68
  s_add_u32 s68, s68, 22978560
  s_lshl_b32 s60, s52, 11
  s_mul_i32 s69, s51, 184320
  s_add_u32 s69, s69, s60
  s_add_u32 s69, s69, 22282240
  s_mul_i32 s55, s51, 2949120
  s_add_u32 s55, s55, s60
  s_add_u32 s55, s55, 16384000
  s_add_u32 s70, s60, 13434880
  s_lshl_b32 s59, s51, 15
  s_add_u32 s59, s59, 327680
  s_lshl2_add_u32 s72, s52, s59
  s_add_u32 s72, s72, 352
  s_lshl_b32 s58, s52, 2
  s_add_u32 s58, s58, 32256
  s_mov_b64 s[76:77], 0
  s_mov_b32 s80, s40
  s_mov_b32 s81, s41
  s_mov_b32 s82, 2621440
  s_mov_b32 s83, 0x20000
  s_waitcnt vmcnt(0)
  s_barrier
  s_cmp_lg_u32 s46, 0
  s_cbranch_scc1 arr_440
  v_mov_b32 v12, 1
  s_lshl_b32 s3, s49, 2
  v_mov_b32 v13, s3
  s_mov_b64 exec, 1
  buffer_atomic_add v12, v13, s[12:15], 0 offen sc1
  s_mov_b64 exec, -1
arr_440:
  s_lshl_b32 s3, s49, 2
  v_mov_b32 v13, s3
  s_nop 1
ibw_441:
  buffer_load_dword v12, v13, s[12:15], 0 offen sc1
  s_waitcnt vmcnt(0)
  v_cmp_ne_u32 vcc, 256, v12
  s_nop 0
  s_cbranch_vccz ibw_442
  s_sleep 8
  s_sub_u32 s47, s47, 1
  s_cbranch_scc0 ibw_441
  s_branch ABORT
ibw_442:
  s_cmp_lg_u32 s49, 0
  s_cbranch_scc1 ibok_443
  v_and_b32 v13, 7, v0
  v_lshlrev_b32 v13, 2, v13
  buffer_load_dword v12, v13, s[12:15], 0 offen offset:32 sc1
  s_waitcnt vmcnt(0)
  v_cmp_ne_u32 vcc, 32, v12
  s_nop 0
  s_cbranch_vccz ibok_443
  s_barrier
  s_mov_b32 s49, 1
  s_mov_b32 s3, s2
  s_branch DISPATCH
ibok_443:
  s_mov_b32 s60, 0
  v_mov_b32 v13, 0
  s_cmp_lg_u32 s46, 0
  s_cbranch_scc1 w0_444
fl_445:
  buffer_load_dword v12, v13, s[8:11], s60 offen sc1
  s_waitcnt vmcnt(0)
  v_cmp_eq_u32 vcc, 0, v12
  s_nop 0
  s_cbranch_vccz fo_446
  s_sleep 32
  s_sub_u32 s47, s47, 1
  s_cbranch_scc0 fl_445
  s_branch ABORT
fo_446:
w0_444:
  s_barrier
  s_mov_b32 s4, s38
  s_mov_b32 s5, s39
  s_mov_b32 s6, 1966080
  s_mov_b32 s7, 0x20000
  s_mul_i32 s63, s46, 40960
  v_lshrrev_b32 v15, 2, v0
  v_mul_u32_u24 v15, 1280, v15
  v_and_b32 v16, 3, v0
  v_lshl_add_u32 v12, v16, 4, v15
  v_lshrrev_b32 v15, 2, v0
  v_mul_u32_u24 v15, 64, v15
  v_and_b32 v16, 3, v0
  v_lshl_add_u32 v15, v16, 3, v15
  v_add_u32 v13, s63, v15
  s_add_u32 m0, s63, 0
  s_add_u32 s65, s71, 0
  buffer_load_dwordx4 v12, s[4:7], s65 offen lds
  s_add_u32 m0, s63, 1024
  s_add_u32 s65, s71, 20480
  buffer_load_dwordx4 v12, s[4:7], s65 offen lds
  s_add_u32 m0, s63, 2048
  s_add_u32 s65, s71, 40960
  buffer_load_dwordx4 v12, s[4:7], s65 offen lds
  s_add_u32 m0, s63, 3072
  s_add_u32 s65, s71, 61440
  buffer_load_dwordx4 v12, s[4:7], s65 offen lds
  s_add_u32 m0, s63, 4096
  s_add_u32 s65, s71, 81920
  buffer_load_dwordx4 v12, s[4:7], s65 offen lds
  s_add_u32 m0, s63, 5120
  s_add_u32 s65, s71, 102400
  buffer_load_dwordx4 v12, s[4:7], s65 offen lds
  s_add_u32 m0, s63, 6144
  s_add_u32 s65, s71, 122880
  buffer_load_dwordx4 v12, s[4:7], s65 offen lds
  s_add_u32 m0, s63, 7168
  s_add_u32 s65, s71, 143360
  buffer_load_dwordx4 v12, s[4:7], s65 offen lds
  s_add_u32 m0, s63, 8192
  s_add_u32 s65, s71, 163840
  buffer_load_dwordx4 v12, s[4:7], s65 offen lds
  s_add_u32 m0, s63, 9216
  s_add_u32 s65, s71, 184320
  buffer_load_dwordx4 v12, s[4:7], s65 offen lds
  s_add_u32 m0, s63, 10240
  s_add_u32 s65, s71, 204800
  buffer_load_dwordx4 v12, s[4:7], s65 offen lds
  s_add_u32 m0, s63, 11264
  s_add_u32 s65, s71, 225280
  buffer_load_dwordx4 v12, s[4:7], s65 offen lds
  s_add_u32 m0, s63, 12288
  s_add_u32 s65, s71, 245760
  buffer_load_dwordx4 v12, s[4:7], s65 offen lds
  s_add_u32 m0, s63, 13312
  s_add_u32 s65, s71, 266240
  buffer_load_dwordx4 v12, s[4:7], s65 offen lds
  s_add_u32 m0, s63, 14336
  s_add_u32 s65, s71, 286720
  buffer_load_dwordx4 v12, s[4:7], s65 offen lds
  s_add_u32 m0, s63, 15360
  s_add_u32 s65, s71, 307200
  buffer_load_dwordx4 v12, s[4:7], s65 offen lds
  s_add_u32 m0, s63, 16384
  s_add_u32 s65, s71, 327680
  buffer_load_dwordx4 v12, s[4:7], s65 offen lds
  s_add_u32 m0, s63, 17408
  s_add_u32 s65, s71, 348160
  buffer_load_dwordx4 v12, s[4:7], s65 offen lds
  s_add_u32 m0, s63, 18432
  s_add_u32 s65, s71, 368640
  buffer_load_dwordx4 v12, s[4:7], s65 offen lds
  s_add_u32 m0, s63, 19456
  s_add_u32 s65, s71, 389120
  buffer_load_dwordx4 v12, s[4:7], s65 offen lds
  s_add_u32 m0, s63, 20480
  s_add_u32 s65, s71, 409600
  buffer_load_dwordx4 v12, s[4:7], s65 offen lds
  s_add_u32 m0, s63, 21504
  s_add_u32 s65, s71, 430080
  buffer_load_dwordx4 v12, s[4:7], s65 offen lds
  s_add_u32 m0, s63, 22528
  s_add_u32 s65, s71, 450560
  buffer_load_dwordx4 v12, s[4:7], s65 offen lds
  s_add_u32 m0, s63, 23552
  s_add_u32 s65, s71, 471040
  buffer_load_dwordx4 v12, s[4:7], s65 offen lds
  s_add_u32 m0, s63, 24576
  s_add_u32 s65, s71, 491520
  buffer_load_dwordx4 v12, s[4:7], s65 offen lds
  s_add_u32 m0, s63, 25600
  s_add_u32 s65, s71, 512000
  buffer_load_dwordx4 v12, s[4:7], s65 offen lds
  s_add_u32 m0, s63, 26624
  s_add_u32 s65, s71, 532480
  buffer_load_dwordx4 v12, s[4:7], s65 offen lds
  s_add_u32 m0, s63, 27648
  s_add_u32 s65, s71, 552960
  buffer_load_dwordx4 v12, s[4:7], s65 offen lds
  s_add_u32 m0, s63, 28672
  s_add_u32 s65, s71, 573440
  buffer_load_dwordx4 v12, s[4:7], s65 offen lds
  s_add_u32 m0, s63, 29696
  s_add_u32 s65, s71, 593920
  buffer_load_dwordx4 v12, s[4:7], s65 offen lds
  s_add_u32 m0, s63, 30720
  s_add_u32 s65, s71, 614400
  buffer_load_dwordx4 v12, s[4:7], s65 offen lds
  s_add_u32 m0, s63, 31744
  s_add_u32 s65, s71, 634880
  buffer_load_dwordx4 v12, s[4:7], s65 offen lds
  s_add_u32 m0, s63, 32768
  s_add_u32 s65, s71, 655360
  buffer_load_dwordx4 v12, s[4:7], s65 offen lds
  s_add_u32 m0, s63, 33792
  s_add_u32 s65, s71, 675840
  buffer_load_dwordx4 v12, s[4:7], s65 offen lds
  s_add_u32 m0, s63, 34816
  s_add_u32 s65, s71, 696320
  buffer_load_dwordx4 v12, s[4:7], s65 offen lds
  s_add_u32 m0, s63, 35840
  s_add_u32 s65, s71, 716800
  buffer_load_dwordx4 v12, s[4:7], s65 offen lds
  s_add_u32 m0, s63, 36864
  s_add_u32 s65, s71, 737280
  buffer_load_dwordx4 v12, s[4:7], s65 offen lds
  s_add_u32 m0, s63, 37888
  s_add_u32 s65, s71, 757760
  buffer_load_dwordx4 v12, s[4:7], s65 offen lds
  s_add_u32 m0, s63, 38912
  s_add_u32 s65, s71, 778240
  buffer_load_dwordx4 v12, s[4:7], s65 offen lds
  s_add_u32 m0, s63, 39936
  s_add_u32 s65, s71, 798720
  buffer_load_dwordx4 v12, s[4:7], s65 offen lds
  s_waitcnt vmcnt(20)
  ds_read_b64_tr_b16 a[0:1], v13 offset:0
  ds_read_b64_tr_b16 a[2:3], v13 offset:1024
  ds_read_b64_tr_b16 a[4:5], v13 offset:32
  ds_read_b64_tr_b16 a[6:7], v13 offset:1056
  ds_read_b64_tr_b16 a[8:9], v13 offset:2048
  ds_read_b64_tr_b16 a[10:11], v13 offset:3072
  ds_read_b64_tr_b16 a[12:13], v13 offset:2080
  ds_read_b64_tr_b16 a[14:15], v13 offset:3104
  ds_read_b64_tr_b16 a[16:17], v13 offset:4096
  ds_read_b64_tr_b16 a[18:19], v13 offset:5120
  ds_read_b64_tr_b16 a[20:21], v13 offset:4128
  ds_read_b64_tr_b16 a[22:23], v13 offset:5152
  s_waitcnt lgkmcnt(4)
  ds_read_b64_tr_b16 a[24:25], v13 offset:6144
  ds_read_b64_tr_b16 a[26:27], v13 offset:7168
  ds_read_b64_tr_b16 a[28:29], v13 offset:6176
  ds_read_b64_tr_b16 a[30:31], v13 offset:7200
  ds_read_b64_tr_b16 a[32:33], v13 offset:8192
  ds_read_b64_tr_b16 a[34:35], v13 offset:9216
  ds_read_b64_tr_b16 a[36:37], v13 offset:8224
  ds_read_b64_tr_b16 a[38:39], v13 offset:9248
  ds_read_b64_tr_b16 a[40:41], v13 offset:10240
  ds_read_b64_tr_b16 a[42:43], v13 offset:11264
  ds_read_b64_tr_b16 a[44:45], v13 offset:10272
  ds_read_b64_tr_b16 a[46:47], v13 offset:11296
  s_waitcnt lgkmcnt(4)
  ds_read_b64_tr_b16 a[48:49], v13 offset:12288
  ds_read_b64_tr_b16 a[50:51], v13 offset:13312
  ds_read_b64_tr_b16 a[52:53], v13 offset:12320
  ds_read_b64_tr_b16 a[54:55], v13 offset:13344
  ds_read_b64_tr_b16 a[56:57], v13 offset:14336
  ds_read_b64_tr_b16 a[58:59], v13 offset:15360
  ds_read_b64_tr_b16 a[60:61], v13 offset:14368
  ds_read_b64_tr_b16 a[62:63], v13 offset:15392
  ds_read_b64_tr_b16 a[64:65], v13 offset:16384
  ds_read_b64_tr_b16 a[66:67], v13 offset:17408
  ds_read_b64_tr_b16 a[68:69], v13 offset:16416
  ds_read_b64_tr_b16 a[70:71], v13 offset:17440
  s_waitcnt lgkmcnt(4)
  ds_read_b64_tr_b16 a[72:73], v13 offset:18432
  ds_read_b64_tr_b16 a[74:75], v13 offset:19456
  ds_read_b64_tr_b16 a[76:77], v13 offset:18464
  ds_read_b64_tr_b16 a[78:79], v13 offset:19488
  s_waitcnt lgkmcnt(0)
  s_add_u32 m0, s63, 0
  s_add_u32 s65, s71, 819200
  buffer_load_dwordx4 v12, s[4:7], s65 offen lds
  s_add_u32 m0, s63, 1024
  s_add_u32 s65, s71, 839680
  buffer_load_dwordx4 v12, s[4:7], s65 offen lds
  s_add_u32 m0, s63, 2048
  s_add_u32 s65, s71, 860160
  buffer_load_dwordx4 v12, s[4:7], s65 offen lds
  s_add_u32 m0, s63, 3072
  s_add_u32 s65, s71, 880640
  buffer_load_dwordx4 v12, s[4:7], s65 offen lds
  s_add_u32 m0, s63, 4096
  s_add_u32 s65, s71, 901120
  buffer_load_dwordx4 v12, s[4:7], s65 offen lds
  s_add_u32 m0, s63, 5120
  s_add_u32 s65, s71, 921600
  buffer_load_dwordx4 v12, s[4:7], s65 offen lds
  s_add_u32 m0, s63, 6144
  s_add_u32 s65, s71, 942080
  buffer_load_dwordx4 v12, s[4:7], s65 offen lds
  s_add_u32 m0, s63, 7168
  s_add_u32 s65, s71, 962560
  buffer_load_dwordx4 v12, s[4:7], s65 offen lds
  s_add_u32 m0, s63, 8192
  s_add_u32 s65, s71, 983040
  buffer_load_dwordx4 v12, s[4:7], s65 offen lds
  s_add_u32 m0, s63, 9216
  s_add_u32 s65, s71, 1003520
  buffer_load_dwordx4 v12, s[4:7], s65 offen lds
  s_add_u32 m0, s63, 10240
  s_add_u32 s65, s71, 1024000
  buffer_load_dwordx4 v12, s[4:7], s65 offen lds
  s_add_u32 m0, s63, 11264
  s_add_u32 s65, s71, 1044480
  buffer_load_dwordx4 v12, s[4:7], s65 offen lds
  s_add_u32 m0, s63, 12288
  s_add_u32 s65, s71, 1064960
  buffer_load_dwordx4 v12, s[4:7], s65 offen lds
  s_add_u32 m0, s63, 13312
  s_add_u32 s65, s71, 1085440
  buffer_load_dwordx4 v12, s[4:7], s65 offen lds
  s_add_u32 m0, s63, 14336
  s_add_u32 s65, s71, 1105920
  buffer_load_dwordx4 v12, s[4:7], s65 offen lds
  s_add_u32 m0, s63, 15360
  s_add_u32 s65, s71, 1126400
  buffer_load_dwordx4 v12, s[4:7], s65 offen lds
  s_add_u32 m0, s63, 16384
  s_add_u32 s65, s71, 1146880
  buffer_load_dwordx4 v12, s[4:7], s65 offen lds
  s_add_u32 m0, s63, 17408
  s_add_u32 s65, s71, 1167360
  buffer_load_dwordx4 v12, s[4:7], s65 offen lds
  s_add_u32 m0, s63, 18432
  s_add_u32 s65, s71, 1187840
  buffer_load_dwordx4 v12, s[4:7], s65 offen lds
  s_add_u32 m0, s63, 19456
  s_add_u32 s65, s71, 1208320
  buffer_load_dwordx4 v12, s[4:7], s65 offen lds
  s_waitcnt vmcnt(20)
  ds_read_b64_tr_b16 a[80:81], v13 offset:20480
  ds_read_b64_tr_b16 a[82:83], v13 offset:21504
  ds_read_b64_tr_b16 a[84:85], v13 offset:20512
  ds_read_b64_tr_b16 a[86:87], v13 offset:21536
  ds_read_b64_tr_b16 a[88:89], v13 offset:22528
  ds_read_b64_tr_b16 a[90:91], v13 offset:23552
  ds_read_b64_tr_b16 a[92:93], v13 offset:22560
  ds_read_b64_tr_b16 a[94:95], v13 offset:23584
  ds_read_b64_tr_b16 a[96:97], v13 offset:24576
  ds_read_b64_tr_b16 a[98:99], v13 offset:25600
  ds_read_b64_tr_b16 a[100:101], v13 offset:24608
  ds_read_b64_tr_b16 a[102:103], v13 offset:25632
  s_waitcnt lgkmcnt(4)
  ds_read_b64_tr_b16 a[104:105], v13 offset:26624
  ds_read_b64_tr_b16 a[106:107], v13 offset:27648
  ds_read_b64_tr_b16 a[108:109], v13 offset:26656
  ds_read_b64_tr_b16 a[110:111], v13 offset:27680
  ds_read_b64_tr_b16 a[112:113], v13 offset:28672
  ds_read_b64_tr_b16 a[114:115], v13 offset:29696
  ds_read_b64_tr_b16 a[116:117], v13 offset:28704
  ds_read_b64_tr_b16 a[118:119], v13 offset:29728
  ds_read_b64_tr_b16 a[120:121], v13 offset:30720
  ds_read_b64_tr_b16 a[122:123], v13 offset:31744
  ds_read_b64_tr_b16 a[124:125], v13 offset:30752
  ds_read_b64_tr_b16 a[126:127], v13 offset:31776
  s_waitcnt lgkmcnt(4)
  ds_read_b64_tr_b16 a[128:129], v13 offset:32768
  ds_read_b64_tr_b16 a[130:131], v13 offset:33792
  ds_read_b64_tr_b16 a[132:133], v13 offset:32800
  ds_read_b64_tr_b16 a[134:135], v13 offset:33824
  ds_read_b64_tr_b16 a[136:137], v13 offset:34816
  ds_read_b64_tr_b16 a[138:139], v13 offset:35840
  ds_read_b64_tr_b16 a[140:141], v13 offset:34848
  ds_read_b64_tr_b16 a[142:143], v13 offset:35872
  ds_read_b64_tr_b16 a[144:145], v13 offset:36864
  ds_read_b64_tr_b16 a[146:147], v13 offset:37888
  ds_read_b64_tr_b16 a[148:149], v13 offset:36896
  ds_read_b64_tr_b16 a[150:151], v13 offset:37920
  s_waitcnt lgkmcnt(4)
  ds_read_b64_tr_b16 a[152:153], v13 offset:38912
  ds_read_b64_tr_b16 a[154:155], v13 offset:39936
  ds_read_b64_tr_b16 a[156:157], v13 offset:38944
  ds_read_b64_tr_b16 a[158:159], v13 offset:39968
  s_waitcnt lgkmcnt(0)
  s_add_u32 m0, s63, 20480
  s_add_u32 s65, s71, 1228800
  buffer_load_dwordx4 v12, s[4:7], s65 offen lds
  s_add_u32 m0, s63, 21504
  s_add_u32 s65, s71, 1249280
  buffer_load_dwordx4 v12, s[4:7], s65 offen lds
  s_add_u32 m0, s63, 22528
  s_add_u32 s65, s71, 1269760
  buffer_load_dwordx4 v12, s[4:7], s65 offen lds
  s_add_u32 m0, s63, 23552
  s_add_u32 s65, s71, 1290240
  buffer_load_dwordx4 v12, s[4:7], s65 offen lds
  s_add_u32 m0, s63, 24576
  s_add_u32 s65, s71, 1310720
  buffer_load_dwordx4 v12, s[4:7], s65 offen lds
  s_add_u32 m0, s63, 25600
  s_add_u32 s65, s71, 1331200
  buffer_load_dwordx4 v12, s[4:7], s65 offen lds
  s_add_u32 m0, s63, 26624
  s_add_u32 s65, s71, 1351680
  buffer_load_dwordx4 v12, s[4:7], s65 offen lds
  s_add_u32 m0, s63, 27648
  s_add_u32 s65, s71, 1372160
  buffer_load_dwordx4 v12, s[4:7], s65 offen lds
  s_add_u32 m0, s63, 28672
  s_add_u32 s65, s71, 1392640
  buffer_load_dwordx4 v12, s[4:7], s65 offen lds
  s_add_u32 m0, s63, 29696
  s_add_u32 s65, s71, 1413120
  buffer_load_dwordx4 v12, s[4:7], s65 offen lds
  s_add_u32 m0, s63, 30720
  s_add_u32 s65, s71, 1433600
  buffer_load_dwordx4 v12, s[4:7], s65 offen lds
  s_add_u32 m0, s63, 31744
  s_add_u32 s65, s71, 1454080
  buffer_load_dwordx4 v12, s[4:7], s65 offen lds
  s_add_u32 m0, s63, 32768
  s_add_u32 s65, s71, 1474560
  buffer_load_dwordx4 v12, s[4:7], s65 offen lds
  s_add_u32 m0, s63, 33792
  s_add_u32 s65, s71, 1495040
  buffer_load_dwordx4 v12, s[4:7], s65 offen lds
  s_add_u32 m0, s63, 34816
  s_add_u32 s65, s71, 1515520
  buffer_load_dwordx4 v12, s[4:7], s65 offen lds
  s_add_u32 m0, s63, 35840
  s_add_u32 s65, s71, 1536000
  buffer_load_dwordx4 v12, s[4:7], s65 offen lds
  s_add_u32 m0, s63, 36864
  s_add_u32 s65, s71, 1556480
  buffer_load_dwordx4 v12, s[4:7], s65 offen lds
  s_add_u32 m0, s63, 37888
  s_add_u32 s65, s71, 1576960
  buffer_load_dwordx4 v12, s[4:7], s65 offen lds
  s_add_u32 m0, s63, 38912
  s_add_u32 s65, s71, 1597440
  buffer_load_dwordx4 v12, s[4:7], s65 offen lds
  s_add_u32 m0, s63, 39936
  s_add_u32 s65, s71, 1617920
  buffer_load_dwordx4 v12, s[4:7], s65 offen lds
  s_waitcnt vmcnt(20)
  ds_read_b64_tr_b16 a[160:161], v13 offset:0
  ds_read_b64_tr_b16 a[162:163], v13 offset:1024
  ds_read_b64_tr_b16 a[164:165], v13 offset:32
  ds_read_b64_tr_b16 a[166:167], v13 offset:1056
  ds_read_b64_tr_b16 a[168:169], v13 offset:2048
  ds_read_b64_tr_b16 a[170:171], v13 offset:3072
  ds_read_b64_tr_b16 a[172:173], v13 offset:2080
  ds_read_b64_tr_b16 a[174:175], v13 offset:3104
  ds_read_b64_tr_b16 a[176:177], v13 offset:4096
  ds_read_b64_tr_b16 a[178:179], v13 offset:5120
  ds_read_b64_tr_b16 a[180:181], v13 offset:4128
  ds_read_b64_tr_b16 a[182:183], v13 offset:5152
  s_waitcnt lgkmcnt(4)
  ds_read_b64_tr_b16 a[184:185], v13 offset:6144
  ds_read_b64_tr_b16 a[186:187], v13 offset:7168
  ds_read_b64_tr_b16 a[188:189], v13 offset:6176
  ds_read_b64_tr_b16 a[190:191], v13 offset:7200
  ds_read_b64_tr_b16 a[192:193], v13 offset:8192
  ds_read_b64_tr_b16 a[194:195], v13 offset:9216
  ds_read_b64_tr_b16 a[196:197], v13 offset:8224
  ds_read_b64_tr_b16 a[198:199], v13 offset:9248
  ds_read_b64_tr_b16 a[200:201], v13 offset:10240
  ds_read_b64_tr_b16 a[202:203], v13 offset:11264
  ds_read_b64_tr_b16 a[204:205], v13 offset:10272
  ds_read_b64_tr_b16 a[206:207], v13 offset:11296
  s_waitcnt lgkmcnt(4)
  ds_read_b64_tr_b16 a[208:209], v13 offset:12288
  ds_read_b64_tr_b16 a[210:211], v13 offset:13312
  ds_read_b64_tr_b16 a[212:213], v13 offset:12320
  ds_read_b64_tr_b16 a[214:215], v13 offset:13344
  ds_read_b64_tr_b16 a[216:217], v13 offset:14336
  ds_read_b64_tr_b16 a[218:219], v13 offset:15360
  ds_read_b64_tr_b16 a[220:221], v13 offset:14368
  ds_read_b64_tr_b16 a[222:223], v13 offset:15392
  ds_read_b64_tr_b16 a[224:225], v13 offset:16384
  ds_read_b64_tr_b16 a[226:227], v13 offset:17408
  ds_read_b64_tr_b16 a[228:229], v13 offset:16416
  ds_read_b64_tr_b16 a[230:231], v13 offset:17440
  s_waitcnt lgkmcnt(4)
  ds_read_b64_tr_b16 a[232:233], v13 offset:18432
  ds_read_b64_tr_b16 a[234:235], v13 offset:19456
  ds_read_b64_tr_b16 a[236:237], v13 offset:18464
  ds_read_b64_tr_b16 a[238:239], v13 offset:19488
  s_waitcnt lgkmcnt(0)
  s_add_u32 m0, s63, 0
  s_add_u32 s65, s71, 1638400
  buffer_load_dwordx4 v12, s[4:7], s65 offen lds
  s_add_u32 m0, s63, 1024
  s_add_u32 s65, s71, 1658880
  buffer_load_dwordx4 v12, s[4:7], s65 offen lds
  s_add_u32 m0, s63, 2048
  s_add_u32 s65, s71, 1679360
  buffer_load_dwordx4 v12, s[4:7], s65 offen lds
  s_add_u32 m0, s63, 3072
  s_add_u32 s65, s71, 1699840
  buffer_load_dwordx4 v12, s[4:7], s65 offen lds
  s_add_u32 m0, s63, 4096
  s_add_u32 s65, s71, 1720320
  buffer_load_dwordx4 v12, s[4:7], s65 offen lds
  s_add_u32 m0, s63, 5120
  s_add_u32 s65, s71, 1740800
  buffer_load_dwordx4 v12, s[4:7], s65 offen lds
  s_add_u32 m0, s63, 6144
  s_add_u32 s65, s71, 1761280
  buffer_load_dwordx4 v12, s[4:7], s65 offen lds
  s_add_u32 m0, s63, 7168
  s_add_u32 s65, s71, 1781760
  buffer_load_dwordx4 v12, s[4:7], s65 offen lds
  s_add_u32 m0, s63, 8192
  s_add_u32 s65, s71, 1802240
  buffer_load_dwordx4 v12, s[4:7], s65 offen lds
  s_add_u32 m0, s63, 9216
  s_add_u32 s65, s71, 1822720
  buffer_load_dwordx4 v12, s[4:7], s65 offen lds
  s_add_u32 m0, s63, 10240
  s_add_u32 s65, s71, 1843200
  buffer_load_dwordx4 v12, s[4:7], s65 offen lds
  s_add_u32 m0, s63, 11264
  s_add_u32 s65, s71, 1863680
  buffer_load_dwordx4 v12, s[4:7], s65 offen lds
  s_add_u32 m0, s63, 12288
  s_add_u32 s65, s71, 1884160
  buffer_load_dwordx4 v12, s[4:7], s65 offen lds
  s_add_u32 m0, s63, 13312
  s_add_u32 s65, s71, 1904640
  buffer_load_dwordx4 v12, s[4:7], s65 offen lds
  s_add_u32 m0, s63, 14336
  s_add_u32 s65, s71, 1925120
  buffer_load_dwordx4 v12, s[4:7], s65 offen lds
  s_add_u32 m0, s63, 15360
  s_add_u32 s65, s71, 1945600
  buffer_load_dwordx4 v12, s[4:7], s65 offen lds
  s_waitcnt vmcnt(16)
  ds_read_b64_tr_b16 a[240:241], v13 offset:20480
  ds_read_b64_tr_b16 a[242:243], v13 offset:21504
  ds_read_b64_tr_b16 a[244:245], v13 offset:20512
  ds_read_b64_tr_b16 a[246:247], v13 offset:21536
  ds_read_b64_tr_b16 a[248:249], v13 offset:22528
  ds_read_b64_tr_b16 a[250:251], v13 offset:23552
  ds_read_b64_tr_b16 a[252:253], v13 offset:22560
  ds_read_b64_tr_b16 a[254:255], v13 offset:23584
  ds_read_b64_tr_b16 v[128:129], v13 offset:24576
  ds_read_b64_tr_b16 v[130:131], v13 offset:25600
  ds_read_b64_tr_b16 v[132:133], v13 offset:24608
  ds_read_b64_tr_b16 v[134:135], v13 offset:25632
  s_waitcnt lgkmcnt(4)
  ds_read_b64_tr_b16 v[136:137], v13 offset:26624
  ds_read_b64_tr_b16 v[138:139], v13 offset:27648
  ds_read_b64_tr_b16 v[140:141], v13 offset:26656
  ds_read_b64_tr_b16 v[142:143], v13 offset:27680
  ds_read_b64_tr_b16 v[144:145], v13 offset:28672
  ds_read_b64_tr_b16 v[146:147], v13 offset:29696
  ds_read_b64_tr_b16 v[148:149], v13 offset:28704
  ds_read_b64_tr_b16 v[150:151], v13 offset:29728
  ds_read_b64_tr_b16 v[152:153], v13 offset:30720
  ds_read_b64_tr_b16 v[154:155], v13 offset:31744
  ds_read_b64_tr_b16 v[156:157], v13 offset:30752
  ds_read_b64_tr_b16 v[158:159], v13 offset:31776
  s_waitcnt lgkmcnt(4)
  ds_read_b64_tr_b16 v[160:161], v13 offset:32768
  ds_read_b64_tr_b16 v[162:163], v13 offset:33792
  ds_read_b64_tr_b16 v[164:165], v13 offset:32800
  ds_read_b64_tr_b16 v[166:167], v13 offset:33824
  ds_read_b64_tr_b16 v[168:169], v13 offset:34816
  ds_read_b64_tr_b16 v[170:171], v13 offset:35840
  ds_read_b64_tr_b16 v[172:173], v13 offset:34848
  ds_read_b64_tr_b16 v[174:175], v13 offset:35872
  ds_read_b64_tr_b16 v[176:177], v13 offset:36864
  ds_read_b64_tr_b16 v[178:179], v13 offset:37888
  ds_read_b64_tr_b16 v[180:181], v13 offset:36896
  ds_read_b64_tr_b16 v[182:183], v13 offset:37920
  s_waitcnt lgkmcnt(4)
  ds_read_b64_tr_b16 v[184:185], v13 offset:38912
  ds_read_b64_tr_b16 v[186:187], v13 offset:39936
  ds_read_b64_tr_b16 v[188:189], v13 offset:38944
  ds_read_b64_tr_b16 v[190:191], v13 offset:39968
  s_waitcnt lgkmcnt(0)
  s_waitcnt vmcnt(0)
  ds_read_b64_tr_b16 v[192:193], v13 offset:0
  ds_read_b64_tr_b16 v[194:195], v13 offset:1024
  ds_read_b64_tr_b16 v[196:197], v13 offset:32
  ds_read_b64_tr_b16 v[198:199], v13 offset:1056
  ds_read_b64_tr_b16 v[200:201], v13 offset:2048
  ds_read_b64_tr_b16 v[202:203], v13 offset:3072
  ds_read_b64_tr_b16 v[204:205], v13 offset:2080
  ds_read_b64_tr_b16 v[206:207], v13 offset:3104
  ds_read_b64_tr_b16 v[208:209], v13 offset:4096
  ds_read_b64_tr_b16 v[210:211], v13 offset:5120
  ds_read_b64_tr_b16 v[212:213], v13 offset:4128
  ds_read_b64_tr_b16 v[214:215], v13 offset:5152
  s_waitcnt lgkmcnt(4)
  ds_read_b64_tr_b16 v[216:217], v13 offset:6144
  ds_read_b64_tr_b16 v[218:219], v13 offset:7168
  ds_read_b64_tr_b16 v[220:221], v13 offset:6176
  ds_read_b64_tr_b16 v[222:223], v13 offset:7200
  ds_read_b64_tr_b16 v[224:225], v13 offset:8192
  ds_read_b64_tr_b16 v[226:227], v13 offset:9216
  ds_read_b64_tr_b16 v[228:229], v13 offset:8224
  ds_read_b64_tr_b16 v[230:231], v13 offset:9248
  ds_read_b64_tr_b16 v[232:233], v13 offset:10240
  ds_read_b64_tr_b16 v[234:235], v13 offset:11264
  ds_read_b64_tr_b16 v[236:237], v13 offset:10272
  ds_read_b64_tr_b16 v[238:239], v13 offset:11296
  s_waitcnt lgkmcnt(4)
  ds_read_b64_tr_b16 v[240:241], v13 offset:12288
  ds_read_b64_tr_b16 v[242:243], v13 offset:13312
  ds_read_b64_tr_b16 v[244:245], v13 offset:12320
  ds_read_b64_tr_b16 v[246:247], v13 offset:13344
  ds_read_b64_tr_b16 v[248:249], v13 offset:14336
  ds_read_b64_tr_b16 v[250:251], v13 offset:15360
  ds_read_b64_tr_b16 v[252:253], v13 offset:14368
  ds_read_b64_tr_b16 v[254:255], v13 offset:15392
  s_waitcnt lgkmcnt(0)
  s_barrier
  s_mov_b32 s50, 0
  s_mov_b32 s73, 0
  s_mov_b32 s74, s68
  s_mov_b32 s60, s51
  s_cmp_eq_u32 s60, 1
  s_cbranch_scc1 W4_WAITF1
W4_WAITF0:
su_447:
  buffer_load_dword v3, v2, s[8:11], s59 offen sc1
  s_waitcnt vmcnt(0)
  v_cmp_ge_i32 vcc, s73, v3
  s_nop 0
  s_cbranch_vccz so_448
  s_sleep 2
  s_sub_u32 s47, s47, 1
  s_cbranch_scc0 su_447
  s_branch ABORT
so_448:
  s_add_u32 m0, s57, 0
  s_add_u32 s65, s74, 0
  buffer_load_dwordx4 v1, s[8:11], s65 offen sc1 lds
  s_add_u32 m0, s57, 1024
  s_add_u32 s65, s74, 2048
  buffer_load_dwordx4 v1, s[8:11], s65 offen sc1 lds
  s_add_u32 m0, s57, 2048
  s_add_u32 s65, s74, 4096
  buffer_load_dwordx4 v1, s[8:11], s65 offen sc1 lds
  s_add_u32 m0, s57, 3072
  s_add_u32 s65, s74, 6144
  buffer_load_dwordx4 v1, s[8:11], s65 offen sc1 lds
  s_add_u32 m0, s57, 4096
  s_add_u32 s65, s74, 8192
  buffer_load_dwordx4 v1, s[8:11], s65 offen sc1 lds
  s_add_u32 m0, s57, 5120
  s_add_u32 s65, s74, 10240
  buffer_load_dwordx4 v1, s[8:11], s65 offen sc1 lds
  s_add_u32 m0, s57, 6144
  s_add_u32 s65, s74, 12288
  buffer_load_dwordx4 v1, s[8:11], s65 offen sc1 lds
  s_add_u32 m0, s57, 7168
  s_add_u32 s65, s74, 14336
  buffer_load_dwordx4 v1, s[8:11], s65 offen sc1 lds
  s_add_u32 m0, s57, 8192
  s_add_u32 s65, s74, 16384
  buffer_load_dwordx4 v1, s[8:11], s65 offen sc1 lds
  s_add_u32 m0, s57, 9216
  s_add_u32 s65, s74, 18432
  buffer_load_dwordx4 v1, s[8:11], s65 offen sc1 lds
  s_add_u32 m0, s57, 10240
  s_add_u32 s65, s74, 20480
  buffer_load_dwordx4 v1, s[8:11], s65 offen sc1 lds
  s_add_u32 m0, s57, 11264
  s_add_u32 s65, s74, 22528
  buffer_load_dwordx4 v1, s[8:11], s65 offen sc1 lds
  s_waitcnt vmcnt(0)
W4_LOOPF0:
  s_barrier
  ds_read_b128 v[20:23], v1 offset:0
  ds_read_b128 v[24:27], v1 offset:1024
  ds_read_b128 v[28:31], v1 offset:2048
  ds_read_b128 v[32:35], v1 offset:3072
  s_mov_b32 s53, s74
  s_and_b32 s60, s50, 3
  s_mul_i32 s54, s60, 46080
  s_add_u32 s54, s54, s69
  s_add_u32 s73, s50, 1
  s_and_b32 s60, s73, 3
  s_mul_i32 s74, s60, 98304
  s_add_u32 s74, s74, s68
  s_waitcnt lgkmcnt(3)
  v_mfma_f32_16x16x32_bf16 v[52:55], a[0:3], v[20:23], 0
  ds_read_b128 v[36:39], v1 offset:4096
  v_mfma_f32_16x16x32_bf16 v[56:59], a[4:7], v[20:23], 0
  s_waitcnt lgkmcnt(3)
  ds_read_b128 v[40:43], v1 offset:5120
  v_mfma_f32_16x16x32_bf16 v[52:55], a[8:11], v[24:27], v[52:55]
  ds_read_b128 v[44:47], v1 offset:6144
  v_mfma_f32_16x16x32_bf16 v[56:59], a[12:15], v[24:27], v[56:59]
  s_waitcnt lgkmcnt(4)
  ds_read_b128 v[48:51], v1 offset:7168
  v_mfma_f32_16x16x32_bf16 v[52:55], a[16:19], v[28:31], v[52:55]
  ds_read_b128 v[20:23], v1 offset:8192
  v_mfma_f32_16x16x32_bf16 v[56:59], a[20:23], v[28:31], v[56:59]
  s_waitcnt lgkmcnt(5)
  ds_read_b128 v[24:27], v1 offset:9216
  v_mfma_f32_16x16x32_bf16 v[52:55], a[24:27], v[32:35], v[52:55]
  ds_read_b128 v[28:31], v1 offset:10240
  v_mfma_f32_16x16x32_bf16 v[56:59], a[28:31], v[32:35], v[56:59]
  s_waitcnt lgkmcnt(5)
  s_add_u32 m0, s57, 49152
  s_add_u32 s65, s53, 1024
  buffer_load_dwordx4 v1, s[8:11], s65 offen sc1 lds
  v_mfma_f32_16x16x32_bf16 v[52:55], a[32:35], v[36:39], v[52:55]
  ds_read_b128 v[32:35], v1 offset:11264
  v_mfma_f32_16x16x32_bf16 v[56:59], a[36:39], v[36:39], v[56:59]
  v_mfma_f32_16x16x32_bf16 v[52:55], a[40:43], v[40:43], v[52:55]
  ds_read_b128 v[36:39], v1 offset:12288
  v_mfma_f32_16x16x32_bf16 v[56:59], a[44:47], v[40:43], v[56:59]
  s_waitcnt lgkmcnt(5)
  s_add_u32 m0, s57, 50176
  s_add_u32 s65, s53, 3072
  buffer_load_dwordx4 v1, s[8:11], s65 offen sc1 lds
  v_mfma_f32_16x16x32_bf16 v[52:55], a[48:51], v[44:47], v[52:55]
  ds_read_b128 v[40:43], v1 offset:13312
  v_mfma_f32_16x16x32_bf16 v[56:59], a[52:55], v[44:47], v[56:59]
  v_mfma_f32_16x16x32_bf16 v[52:55], a[56:59], v[48:51], v[52:55]
  ds_read_b128 v[44:47], v1 offset:14336
  v_mfma_f32_16x16x32_bf16 v[56:59], a[60:63], v[48:51], v[56:59]
  s_waitcnt lgkmcnt(5)
  s_add_u32 m0, s57, 51200
  s_add_u32 s65, s53, 5120
  buffer_load_dwordx4 v1, s[8:11], s65 offen sc1 lds
  v_mfma_f32_16x16x32_bf16 v[52:55], a[64:67], v[20:23], v[52:55]
  ds_read_b128 v[48:51], v1 offset:15360
  v_mfma_f32_16x16x32_bf16 v[56:59], a[68:71], v[20:23], v[56:59]
  v_mfma_f32_16x16x32_bf16 v[52:55], a[72:75], v[24:27], v[52:55]
  ds_read_b128 v[20:23], v1 offset:16384
  v_mfma_f32_16x16x32_bf16 v[56:59], a[76:79], v[24:27], v[56:59]
  s_waitcnt lgkmcnt(5)
  s_add_u32 m0, s57, 52224
  s_add_u32 s65, s53, 7168
  buffer_load_dwordx4 v1, s[8:11], s65 offen sc1 lds
  v_mfma_f32_16x16x32_bf16 v[52:55], a[80:83], v[28:31], v[52:55]
  ds_read_b128 v[24:27], v1 offset:17408
  v_mfma_f32_16x16x32_bf16 v[56:59], a[84:87], v[28:31], v[56:59]
  v_mfma_f32_16x16x32_bf16 v[52:55], a[88:91], v[32:35], v[52:55]
  ds_read_b128 v[28:31], v1 offset:18432
  v_mfma_f32_16x16x32_bf16 v[56:59], a[92:95], v[32:35], v[56:59]
  s_waitcnt lgkmcnt(5)
  s_add_u32 m0, s57, 53248
  s_add_u32 s65, s53, 9216
  buffer_load_dwordx4 v1, s[8:11], s65 offen sc1 lds
  v_mfma_f32_16x16x32_bf16 v[52:55], a[96:99], v[36:39], v[52:55]
  ds_read_b128 v[32:35], v1 offset:19456
  v_mfma_f32_16x16x32_bf16 v[56:59], a[100:103], v[36:39], v[56:59]
  v_mfma_f32_16x16x32_bf16 v[52:55], a[104:107], v[40:43], v[52:55]
  ds_read_b128 v[36:39], v1 offset:20480
  v_mfma_f32_16x16x32_bf16 v[56:59], a[108:111], v[40:43], v[56:59]
  s_waitcnt lgkmcnt(5)
  s_add_u32 m0, s57, 54272
  s_add_u32 s65, s53, 11264
  buffer_load_dwordx4 v1, s[8:11], s65 offen sc1 lds
  v_mfma_f32_16x16x32_bf16 v[52:55], a[112:115], v[44:47], v[52:55]
  ds_read_b128 v[40:43], v1 offset:21504
  v_mfma_f32_16x16x32_bf16 v[56:59], a[116:119], v[44:47], v[56:59]
  v_mfma_f32_16x16x32_bf16 v[52:55], a[120:123], v[48:51], v[52:55]
  ds_read_b128 v[44:47], v1 offset:22528
  v_mfma_f32_16x16x32_bf16 v[56:59], a[124:127], v[48:51], v[56:59]
  s_waitcnt lgkmcnt(5)
  s_add_u32 m0, s57, 55296
  s_add_u32 s65, s53, 13312
  buffer_load_dwordx4 v1, s[8:11], s65 offen sc1 lds
  v_mfma_f32_16x16x32_bf16 v[52:55], a[128:131], v[20:23], v[52:55]
  ds_read_b128 v[48:51], v1 offset:23552
  v_mfma_f32_16x16x32_bf16 v[56:59], a[132:135], v[20:23], v[56:59]
  v_mfma_f32_16x16x32_bf16 v[52:55], a[136:139], v[24:27], v[52:55]
  ds_read_b128 v[20:23], v1 offset:24576
  v_mfma_f32_16x16x32_bf16 v[56:59], a[140:143], v[24:27], v[56:59]
  s_waitcnt lgkmcnt(5)
  s_add_u32 m0, s57, 56320
  s_add_u32 s65, s53, 15360
  buffer_load_dwordx4 v1, s[8:11], s65 offen sc1 lds
  v_mfma_f32_16x16x32_bf16 v[52:55], a[144:147], v[28:31], v[52:55]
  ds_read_b128 v[24:27], v1 offset:25600
  v_mfma_f32_16x16x32_bf16 v[56:59], a[148:151], v[28:31], v[56:59]
  v_mfma_f32_16x16x32_bf16 v[52:55], a[152:155], v[32:35], v[52:55]
  ds_read_b128 v[28:31], v1 offset:26624
  v_mfma_f32_16x16x32_bf16 v[56:59], a[156:159], v[32:35], v[56:59]
  s_waitcnt lgkmcnt(5)
  s_add_u32 m0, s57, 57344
  s_add_u32 s65, s53, 17408
  buffer_load_dwordx4 v1, s[8:11], s65 offen sc1 lds
  v_mfma_f32_16x16x32_bf16 v[52:55], a[160:163], v[36:39], v[52:55]
  ds_read_b128 v[32:35], v1 offset:27648
  v_mfma_f32_16x16x32_bf16 v[56:59], a[164:167], v[36:39], v[56:59]
  v_mfma_f32_16x16x32_bf16 v[52:55], a[168:171], v[40:43], v[52:55]
  ds_read_b128 v[36:39], v1 offset:28672
  v_mfma_f32_16x16x32_bf16 v[56:59], a[172:175], v[40:43], v[56:59]
  s_waitcnt lgkmcnt(5)
  s_add_u32 m0, s57, 58368
  s_add_u32 s65, s53, 19456
  buffer_load_dwordx4 v1, s[8:11], s65 offen sc1 lds
  v_mfma_f32_16x16x32_bf16 v[52:55], a[176:179], v[44:47], v[52:55]
  ds_read_b128 v[40:43], v1 offset:29696
  v_mfma_f32_16x16x32_bf16 v[56:59], a[180:183], v[44:47], v[56:59]
  v_mfma_f32_16x16x32_bf16 v[52:55], a[184:187], v[48:51], v[52:55]
  ds_read_b128 v[44:47], v1 offset:30720
  v_mfma_f32_16x16x32_bf16 v[56:59], a[188:191], v[48:51], v[56:59]
  s_waitcnt lgkmcnt(5)
  s_add_u32 m0, s57, 59392
  s_add_u32 s65, s53, 21504
  buffer_load_dwordx4 v1, s[8:11], s65 offen sc1 lds
  v_mfma_f32_16x16x32_bf16 v[52:55], a[192:195], v[20:23], v[52:55]
  ds_read_b128 v[48:51], v1 offset:31744
  v_mfma_f32_16x16x32_bf16 v[56:59], a[196:199], v[20:23], v[56:59]
  v_mfma_f32_16x16x32_bf16 v[52:55], a[200:203], v[24:27], v[52:55]
  ds_read_b128 v[20:23], v1 offset:32768
  v_mfma_f32_16x16x32_bf16 v[56:59], a[204:207], v[24:27], v[56:59]
  s_waitcnt lgkmcnt(5)
  s_add_u32 m0, s57, 60416
  s_add_u32 s65, s53, 23552
  buffer_load_dwordx4 v1, s[8:11], s65 offen sc1 lds
  v_mfma_f32_16x16x32_bf16 v[52:55], a[208:211], v[28:31], v[52:55]
  ds_read_b128 v[24:27], v1 offset:33792
  v_mfma_f32_16x16x32_bf16 v[56:59], a[212:215], v[28:31], v[56:59]
  v_mfma_f32_16x16x32_bf16 v[52:55], a[216:219], v[32:35], v[52:55]
  ds_read_b128 v[28:31], v1 offset:34816
  v_mfma_f32_16x16x32_bf16 v[56:59], a[220:223], v[32:35], v[56:59]
  s_waitcnt lgkmcnt(5)
  buffer_load_dwordx4 v[68:71], v1, s[8:11], s54 offen offset:0 sc1
  v_mfma_f32_16x16x32_bf16 v[52:55], a[224:227], v[36:39], v[52:55]
  ds_read_b128 v[32:35], v1 offset:35840
  v_mfma_f32_16x16x32_bf16 v[56:59], a[228:231], v[36:39], v[56:59]
  buffer_load_dwordx4 v[72:75], v1, s[8:11], s55 offen offset:0 sc1
  v_mfma_f32_16x16x32_bf16 v[52:55], a[232:235], v[40:43], v[52:55]
  ds_read_b128 v[36:39], v1 offset:36864
  v_mfma_f32_16x16x32_bf16 v[56:59], a[236:239], v[40:43], v[56:59]
  s_waitcnt lgkmcnt(5)
  buffer_load_dwordx4 v[76:79], v1, s[8:11], s54 offen offset:1024 sc1
  v_mfma_f32_16x16x32_bf16 v[52:55], a[240:243], v[44:47], v[52:55]
  ds_read_b128 v[40:43], v1 offset:37888
  v_mfma_f32_16x16x32_bf16 v[56:59], a[244:247], v[44:47], v[56:59]
  buffer_load_dwordx4 v[80:83], v1, s[8:11], s55 offen offset:1024 sc1
  v_mfma_f32_16x16x32_bf16 v[52:55], a[248:251], v[48:51], v[52:55]
  ds_read_b128 v[44:47], v1 offset:38912
  v_mfma_f32_16x16x32_bf16 v[56:59], a[252:255], v[48:51], v[56:59]
  s_waitcnt lgkmcnt(5)
  v_mfma_f32_16x16x32_bf16 v[52:55], v[128:131], v[20:23], v[52:55]
  ds_read_b128 v[48:51], v1 offset:39936
  v_mfma_f32_16x16x32_bf16 v[56:59], v[132:135], v[20:23], v[56:59]
  v_mfma_f32_16x16x32_bf16 v[52:55], v[136:139], v[24:27], v[52:55]
  ds_read_b128 v[20:23], v1 offset:40960
  v_mfma_f32_16x16x32_bf16 v[56:59], v[140:143], v[24:27], v[56:59]
  s_waitcnt lgkmcnt(5)
  v_mfma_f32_16x16x32_bf16 v[52:55], v[144:147], v[28:31], v[52:55]
  ds_read_b128 v[24:27], v1 offset:41984
  v_mfma_f32_16x16x32_bf16 v[56:59], v[148:151], v[28:31], v[56:59]
  v_mfma_f32_16x16x32_bf16 v[52:55], v[152:155], v[32:35], v[52:55]
  ds_read_b128 v[28:31], v1 offset:43008
  v_mfma_f32_16x16x32_bf16 v[56:59], v[156:159], v[32:35], v[56:59]
  s_waitcnt lgkmcnt(5)
  v_mfma_f32_16x16x32_bf16 v[52:55], v[160:163], v[36:39], v[52:55]
  ds_read_b128 v[32:35], v1 offset:44032
  v_mfma_f32_16x16x32_bf16 v[56:59], v[164:167], v[36:39], v[56:59]
  v_mfma_f32_16x16x32_bf16 v[52:55], v[168:171], v[40:43], v[52:55]
  ds_read_b128 v[36:39], v1 offset:45056
  v_mfma_f32_16x16x32_bf16 v[56:59], v[172:175], v[40:43], v[56:59]
  s_waitcnt lgkmcnt(5)
  v_mfma_f32_16x16x32_bf16 v[52:55], v[176:179], v[44:47], v[52:55]
  ds_read_b128 v[40:43], v1 offset:46080
  v_mfma_f32_16x16x32_bf16 v[56:59], v[180:183], v[44:47], v[56:59]
  v_mfma_f32_16x16x32_bf16 v[52:55], v[184:187], v[48:51], v[52:55]
  ds_read_b128 v[44:47], v1 offset:47104
  v_mfma_f32_16x16x32_bf16 v[56:59], v[188:191], v[48:51], v[56:59]
  s_waitcnt lgkmcnt(5)
  v_mfma_f32_16x16x32_bf16 v[52:55], v[192:195], v[20:23], v[52:55]
  ds_read_b128 v[48:51], v1 offset:48128
  v_mfma_f32_16x16x32_bf16 v[56:59], v[196:199], v[20:23], v[56:59]
  s_waitcnt vmcnt(0)
  s_and_b64 exec, s[76:77], 1
  buffer_store_dword v4, v1, s[8:11], s58 offen sc1
  s_mov_b64 exec, -1
  v_mov_b32 v19, s73
  s_mov_b64 exec, 1
  s_cmp_lg_u32 s49, 0
  s_cbranch_scc1 wt_449
  buffer_store_dword v19, v1, s[8:11], s72 offen
wb_450:
  s_mov_b64 exec, -1
  s_barrier
  v_mfma_f32_16x16x32_bf16 v[52:55], v[200:203], v[24:27], v[52:55]
  ds_read_b128 v[20:23], v7 offset:0
  v_lshlrev_b32 v84, 16, v68
  v_mfma_f32_16x16x32_bf16 v[56:59], v[204:207], v[24:27], v[56:59]
  s_waitcnt lgkmcnt(5)
  v_and_b32 v85, 0xffff0000, v68
  v_lshlrev_b32 v86, 16, v69
  v_mfma_f32_16x16x32_bf16 v[52:55], v[208:211], v[28:31], v[52:55]
  ds_read_b128 v[24:27], v7 offset:1024
  v_and_b32 v87, 0xffff0000, v69
  v_mfma_f32_16x16x32_bf16 v[56:59], v[212:215], v[28:31], v[56:59]
  v_lshlrev_b32 v88, 16, v70
  v_and_b32 v89, 0xffff0000, v70
  v_mfma_f32_16x16x32_bf16 v[52:55], v[216:219], v[32:35], v[52:55]
  ds_read_b128 v[28:31], v7 offset:2048
  v_lshlrev_b32 v90, 16, v71
  v_mfma_f32_16x16x32_bf16 v[56:59], v[220:223], v[32:35], v[56:59]
  s_waitcnt lgkmcnt(5)
  v_and_b32 v91, 0xffff0000, v71
  v_lshlrev_b32 v12, 16, v72
  v_mfma_f32_16x16x32_bf16 v[52:55], v[224:227], v[36:39], v[52:55]
  ds_read_b128 v[32:35], v7 offset:3072
  v_and_b32 v13, 0xffff0000, v72
  v_mfma_f32_16x16x32_bf16 v[56:59], v[228:231], v[36:39], v[56:59]
  v_add_f32 v84, v84, v12
  v_add_f32 v85, v85, v13
  v_mfma_f32_16x16x32_bf16 v[52:55], v[232:235], v[40:43], v[52:55]
  ds_read_b128 v[36:39], v7 offset:4096
  v_lshlrev_b32 v12, 16, v73
  v_mfma_f32_16x16x32_bf16 v[56:59], v[236:239], v[40:43], v[56:59]
  s_waitcnt lgkmcnt(5)
  v_and_b32 v13, 0xffff0000, v73
  v_add_f32 v86, v86, v12
  v_mfma_f32_16x16x32_bf16 v[52:55], v[240:243], v[44:47], v[52:55]
  ds_read_b128 v[40:43], v7 offset:5120
  v_add_f32 v87, v87, v13
  v_mfma_f32_16x16x32_bf16 v[56:59], v[244:247], v[44:47], v[56:59]
  v_lshlrev_b32 v12, 16, v74
  v_and_b32 v13, 0xffff0000, v74
  v_mfma_f32_16x16x32_bf16 v[52:55], v[248:251], v[48:51], v[52:55]
  ds_read_b128 v[44:47], v7 offset:6144
  v_add_f32 v88, v88, v12
  v_mfma_f32_16x16x32_bf16 v[56:59], v[252:255], v[48:51], v[56:59]
  s_waitcnt lgkmcnt(5)
  v_add_f32 v89, v89, v13
  v_lshlrev_b32 v12, 16, v75
  v_mfma_f32_16x16x32_bf16 v[60:63], a[0:3], v[20:23], 0
  ds_read_b128 v[48:51], v7 offset:7168
  v_and_b32 v13, 0xffff0000, v75
  v_mfma_f32_16x16x32_bf16 v[64:67], a[4:7], v[20:23], 0
  v_add_f32 v90, v90, v12
  v_add_f32 v91, v91, v13
  v_mfma_f32_16x16x32_bf16 v[60:63], a[8:11], v[24:27], v[60:63]
  ds_read_b128 v[20:23], v7 offset:8192
  v_lshlrev_b32 v92, 16, v76
  v_mfma_f32_16x16x32_bf16 v[64:67], a[12:15], v[24:27], v[64:67]
  s_waitcnt lgkmcnt(5)
  v_and_b32 v93, 0xffff0000, v76
  v_lshlrev_b32 v94, 16, v77
  v_mfma_f32_16x16x32_bf16 v[60:63], a[16:19], v[28:31], v[60:63]
  ds_read_b128 v[24:27], v7 offset:9216
  v_and_b32 v95, 0xffff0000, v77
  v_mfma_f32_16x16x32_bf16 v[64:67], a[20:23], v[28:31], v[64:67]
  v_lshlrev_b32 v96, 16, v78
  v_and_b32 v97, 0xffff0000, v78
  v_mfma_f32_16x16x32_bf16 v[60:63], a[24:27], v[32:35], v[60:63]
  ds_read_b128 v[28:31], v7 offset:10240
  v_lshlrev_b32 v98, 16, v79
  v_mfma_f32_16x16x32_bf16 v[64:67], a[28:31], v[32:35], v[64:67]
  s_waitcnt lgkmcnt(5)
  v_and_b32 v99, 0xffff0000, v79
  v_lshlrev_b32 v12, 16, v80
  v_mfma_f32_16x16x32_bf16 v[60:63], a[32:35], v[36:39], v[60:63]
  ds_read_b128 v[32:35], v7 offset:11264
  v_and_b32 v13, 0xffff0000, v80
  v_mfma_f32_16x16x32_bf16 v[64:67], a[36:39], v[36:39], v[64:67]
  v_add_f32 v92, v92, v12
  v_add_f32 v93, v93, v13
  v_mfma_f32_16x16x32_bf16 v[60:63], a[40:43], v[40:43], v[60:63]
  ds_read_b128 v[36:39], v7 offset:12288
  buffer_load_dword v3, v2, s[8:11], s59 offen sc1
  v_mfma_f32_16x16x32_bf16 v[64:67], a[44:47], v[40:43], v[64:67]
  s_waitcnt lgkmcnt(5)
  v_lshlrev_b32 v12, 16, v81
  v_and_b32 v13, 0xffff0000, v81
  v_mfma_f32_16x16x32_bf16 v[60:63], a[48:51], v[44:47], v[60:63]
  ds_read_b128 v[40:43], v7 offset:13312
  v_add_f32 v94, v94, v12
  v_mfma_f32_16x16x32_bf16 v[64:67], a[52:55], v[44:47], v[64:67]
  v_add_f32 v95, v95, v13
  v_lshlrev_b32 v12, 16, v82
  v_mfma_f32_16x16x32_bf16 v[60:63], a[56:59], v[48:51], v[60:63]
  ds_read_b128 v[44:47], v7 offset:14336
  v_and_b32 v13, 0xffff0000, v82
  v_mfma_f32_16x16x32_bf16 v[64:67], a[60:63], v[48:51], v[64:67]
  s_waitcnt lgkmcnt(5)
  v_add_f32 v96, v96, v12
  v_add_f32 v97, v97, v13
  v_mfma_f32_16x16x32_bf16 v[60:63], a[64:67], v[20:23], v[60:63]
  ds_read_b128 v[48:51], v7 offset:15360
  v_lshlrev_b32 v12, 16, v83
  v_mfma_f32_16x16x32_bf16 v[64:67], a[68:71], v[20:23], v[64:67]
  v_and_b32 v13, 0xffff0000, v83
  v_add_f32 v98, v98, v12
  v_mfma_f32_16x16x32_bf16 v[60:63], a[72:75], v[24:27], v[60:63]
  ds_read_b128 v[20:23], v7 offset:16384
  v_add_f32 v99, v99, v13
  v_mfma_f32_16x16x32_bf16 v[64:67], a[76:79], v[24:27], v[64:67]
  s_waitcnt lgkmcnt(5)
  v_add_f32 v52, v52, v84
  v_add_f32 v53, v53, v85
  v_mfma_f32_16x16x32_bf16 v[60:63], a[80:83], v[28:31], v[60:63]
  ds_read_b128 v[24:27], v7 offset:17408
  v_add_f32 v54, v54, v86
  v_mfma_f32_16x16x32_bf16 v[64:67], a[84:87], v[28:31], v[64:67]
  v_add_f32 v55, v55, v87
  v_add_f32 v56, v56, v88
  v_mfma_f32_16x16x32_bf16 v[60:63], a[88:91], v[32:35], v[60:63]
  ds_read_b128 v[28:31], v7 offset:18432
  v_add_f32 v57, v57, v89
  v_mfma_f32_16x16x32_bf16 v[64:67], a[92:95], v[32:35], v[64:67]
  s_waitcnt lgkmcnt(5)
  v_add_f32 v58, v58, v90
  v_add_f32 v59, v59, v91
  v_mfma_f32_16x16x32_bf16 v[60:63], a[96:99], v[36:39], v[60:63]
  ds_read_b128 v[32:35], v7 offset:19456
  v_cvt_pk_bf16_f32 v100, v52, v53
  v_mfma_f32_16x16x32_bf16 v[64:67], a[100:103], v[36:39], v[64:67]
  v_lshlrev_b32 v52, 16, v100
  v_and_b32 v53, 0xffff0000, v100
  v_mfma_f32_16x16x32_bf16 v[60:63], a[104:107], v[40:43], v[60:63]
  ds_read_b128 v[36:39], v7 offset:20480
  v_cvt_pk_bf16_f32 v101, v54, v55
  v_mfma_f32_16x16x32_bf16 v[64:67], a[108:111], v[40:43], v[64:67]
  s_waitcnt lgkmcnt(5)
  v_lshlrev_b32 v54, 16, v101
  v_and_b32 v55, 0xffff0000, v101
  v_mfma_f32_16x16x32_bf16 v[60:63], a[112:115], v[44:47], v[60:63]
  ds_read_b128 v[40:43], v7 offset:21504
  v_cvt_pk_bf16_f32 v102, v56, v57
  v_mfma_f32_16x16x32_bf16 v[64:67], a[116:119], v[44:47], v[64:67]
  v_lshlrev_b32 v56, 16, v102
  v_and_b32 v57, 0xffff0000, v102
  v_mfma_f32_16x16x32_bf16 v[60:63], a[120:123], v[48:51], v[60:63]
  ds_read_b128 v[44:47], v7 offset:22528
  v_cvt_pk_bf16_f32 v103, v58, v59
  v_mfma_f32_16x16x32_bf16 v[64:67], a[124:127], v[48:51], v[64:67]
  s_waitcnt lgkmcnt(5)
  v_lshlrev_b32 v58, 16, v103
  v_and_b32 v59, 0xffff0000, v103
  v_mfma_f32_16x16x32_bf16 v[60:63], a[128:131], v[20:23], v[60:63]
  ds_read_b128 v[48:51], v7 offset:23552
  v_add_f32 v108, v52, v53
  v_mfma_f32_16x16x32_bf16 v[64:67], a[132:135], v[20:23], v[64:67]
  v_mul_f32 v109, v52, v52
  v_fmac_f32 v109, v53, v53
  v_mfma_f32_16x16x32_bf16 v[60:63], a[136:139], v[24:27], v[60:63]
  s_waitcnt vmcnt(0)
  s_barrier
  ds_read_b128 v[20:23], v7 offset:24576
  v_mfma_f32_16x16x32_bf16 v[64:67], a[140:143], v[24:27], v[64:67]
  s_waitcnt lgkmcnt(5)
  v_cmp_ge_i32 vcc, s73, v3
  v_mfma_f32_16x16x32_bf16 v[60:63], a[144:147], v[28:31], v[60:63]
  ds_read_b128 v[24:27], v7 offset:25600
  v_mfma_f32_16x16x32_bf16 v[64:67], a[148:151], v[28:31], v[64:67]
  s_cmp_lg_u64 vcc, 0
  s_cselect_b32 s56, 536870912, 0
  s_or_b32 s66, s74, s56
  v_mfma_f32_16x16x32_bf16 v[60:63], a[152:155], v[32:35], v[60:63]
  ds_read_b128 v[28:31], v7 offset:26624
  v_add_f32 v108, v108, v54
  v_mfma_f32_16x16x32_bf16 v[64:67], a[156:159], v[32:35], v[64:67]
  s_waitcnt lgkmcnt(5)
  s_add_u32 m0, s57, 0
  s_add_u32 s65, s66, 0
  buffer_load_dwordx4 v1, s[8:11], s65 offen sc1 lds
  v_mfma_f32_16x16x32_bf16 v[60:63], a[160:163], v[36:39], v[60:63]
  ds_read_b128 v[32:35], v7 offset:27648
  v_fmac_f32 v109, v54, v54
  v_mfma_f32_16x16x32_bf16 v[64:67], a[164:167], v[36:39], v[64:67]
  v_add_f32 v108, v108, v55
  v_fmac_f32 v109, v55, v55
  v_mfma_f32_16x16x32_bf16 v[60:63], a[168:171], v[40:43], v[60:63]
  ds_read_b128 v[36:39], v7 offset:28672
  v_add_f32 v108, v108, v56
  v_mfma_f32_16x16x32_bf16 v[64:67], a[172:175], v[40:43], v[64:67]
  s_waitcnt lgkmcnt(5)
  s_add_u32 m0, s57, 1024
  s_add_u32 s65, s66, 2048
  buffer_load_dwordx4 v1, s[8:11], s65 offen sc1 lds
  v_mfma_f32_16x16x32_bf16 v[60:63], a[176:179], v[44:47], v[60:63]
  ds_read_b128 v[40:43], v7 offset:29696
  v_fmac_f32 v109, v56, v56
  v_mfma_f32_16x16x32_bf16 v[64:67], a[180:183], v[44:47], v[64:67]
  v_add_f32 v108, v108, v57
  v_fmac_f32 v109, v57, v57
  v_mfma_f32_16x16x32_bf16 v[60:63], a[184:187], v[48:51], v[60:63]
  ds_read_b128 v[44:47], v7 offset:30720
  v_add_f32 v108, v108, v58
  v_mfma_f32_16x16x32_bf16 v[64:67], a[188:191], v[48:51], v[64:67]
  s_waitcnt lgkmcnt(5)
  s_add_u32 m0, s57, 2048
  s_add_u32 s65, s66, 4096
  buffer_load_dwordx4 v1, s[8:11], s65 offen sc1 lds
  v_mfma_f32_16x16x32_bf16 v[60:63], a[192:195], v[20:23], v[60:63]
  ds_read_b128 v[48:51], v7 offset:31744
  v_fmac_f32 v109, v58, v58
  v_mfma_f32_16x16x32_bf16 v[64:67], a[196:199], v[20:23], v[64:67]
  v_add_f32 v108, v108, v59
  v_fmac_f32 v109, v59, v59
  v_mfma_f32_16x16x32_bf16 v[60:63], a[200:203], v[24:27], v[60:63]
  ds_read_b128 v[20:23], v7 offset:32768
  v_mfma_f32_16x16x32_bf16 v[64:67], a[204:207], v[24:27], v[64:67]
  s_waitcnt lgkmcnt(5)
  s_add_u32 m0, s57, 3072
  s_add_u32 s65, s66, 6144
  buffer_load_dwordx4 v1, s[8:11], s65 offen sc1 lds
  v_mfma_f32_16x16x32_bf16 v[60:63], a[208:211], v[28:31], v[60:63]
  ds_read_b128 v[24:27], v7 offset:33792
  v_mfma_f32_16x16x32_bf16 v[64:67], a[212:215], v[28:31], v[64:67]
  v_mfma_f32_16x16x32_bf16 v[60:63], a[216:219], v[32:35], v[60:63]
  ds_read_b128 v[28:31], v7 offset:34816
  v_mfma_f32_16x16x32_bf16 v[64:67], a[220:223], v[32:35], v[64:67]
  s_waitcnt lgkmcnt(5)
  s_add_u32 m0, s57, 4096
  s_add_u32 s65, s66, 8192
  buffer_load_dwordx4 v1, s[8:11], s65 offen sc1 lds
  v_mfma_f32_16x16x32_bf16 v[60:63], a[224:227], v[36:39], v[60:63]
  ds_read_b128 v[32:35], v7 offset:35840
  v_mfma_f32_16x16x32_bf16 v[64:67], a[228:231], v[36:39], v[64:67]
  v_mfma_f32_16x16x32_bf16 v[60:63], a[232:235], v[40:43], v[60:63]
  ds_read_b128 v[36:39], v7 offset:36864
  v_mfma_f32_16x16x32_bf16 v[64:67], a[236:239], v[40:43], v[64:67]
  s_waitcnt lgkmcnt(5)
  s_add_u32 m0, s57, 5120
  s_add_u32 s65, s66, 10240
  buffer_load_dwordx4 v1, s[8:11], s65 offen sc1 lds
  v_mfma_f32_16x16x32_bf16 v[60:63], a[240:243], v[44:47], v[60:63]
  ds_read_b128 v[40:43], v7 offset:37888
  v_mfma_f32_16x16x32_bf16 v[64:67], a[244:247], v[44:47], v[64:67]
  v_mfma_f32_16x16x32_bf16 v[60:63], a[248:251], v[48:51], v[60:63]
  ds_read_b128 v[44:47], v7 offset:38912
  v_mfma_f32_16x16x32_bf16 v[64:67], a[252:255], v[48:51], v[64:67]
  s_waitcnt lgkmcnt(5)
  s_add_u32 m0, s57, 6144
  s_add_u32 s65, s66, 12288
  buffer_load_dwordx4 v1, s[8:11], s65 offen sc1 lds
  v_mfma_f32_16x16x32_bf16 v[60:63], v[128:131], v[20:23], v[60:63]
  ds_read_b128 v[48:51], v7 offset:39936
  v_mfma_f32_16x16x32_bf16 v[64:67], v[132:135], v[20:23], v[64:67]
  v_mfma_f32_16x16x32_bf16 v[60:63], v[136:139], v[24:27], v[60:63]
  ds_read_b128 v[20:23], v7 offset:40960
  v_mfma_f32_16x16x32_bf16 v[64:67], v[140:143], v[24:27], v[64:67]
  s_waitcnt lgkmcnt(5)
  s_add_u32 m0, s57, 7168
  s_add_u32 s65, s66, 14336
  buffer_load_dwordx4 v1, s[8:11], s65 offen sc1 lds
  v_mfma_f32_16x16x32_bf16 v[60:63], v[144:147], v[28:31], v[60:63]
  ds_read_b128 v[24:27], v7 offset:41984
  v_mfma_f32_16x16x32_bf16 v[64:67], v[148:151], v[28:31], v[64:67]
  v_mfma_f32_16x16x32_bf16 v[60:63], v[152:155], v[32:35], v[60:63]
  ds_read_b128 v[28:31], v7 offset:43008
  v_mfma_f32_16x16x32_bf16 v[64:67], v[156:159], v[32:35], v[64:67]
  s_waitcnt lgkmcnt(5)
  s_add_u32 m0, s57, 8192
  s_add_u32 s65, s66, 16384
  buffer_load_dwordx4 v1, s[8:11], s65 offen sc1 lds
  v_mfma_f32_16x16x32_bf16 v[60:63], v[160:163], v[36:39], v[60:63]
  ds_read_b128 v[32:35], v7 offset:44032
  v_mfma_f32_16x16x32_bf16 v[64:67], v[164:167], v[36:39], v[64:67]
  v_mfma_f32_16x16x32_bf16 v[60:63], v[168:171], v[40:43], v[60:63]
  ds_read_b128 v[36:39], v7 offset:45056
  v_mfma_f32_16x16x32_bf16 v[64:67], v[172:175], v[40:43], v[64:67]
  s_waitcnt lgkmcnt(5)
  s_add_u32 m0, s57, 9216
  s_add_u32 s65, s66, 18432
  buffer_load_dwordx4 v1, s[8:11], s65 offen sc1 lds
  v_mfma_f32_16x16x32_bf16 v[60:63], v[176:179], v[44:47], v[60:63]
  ds_read_b128 v[40:43], v7 offset:46080
  v_mfma_f32_16x16x32_bf16 v[64:67], v[180:183], v[44:47], v[64:67]
  v_mfma_f32_16x16x32_bf16 v[60:63], v[184:187], v[48:51], v[60:63]
  ds_read_b128 v[44:47], v7 offset:47104
  v_mfma_f32_16x16x32_bf16 v[64:67], v[188:191], v[48:51], v[64:67]
  s_waitcnt lgkmcnt(5)
  s_add_u32 m0, s57, 10240
  s_add_u32 s65, s66, 20480
  buffer_load_dwordx4 v1, s[8:11], s65 offen sc1 lds
  v_mfma_f32_16x16x32_bf16 v[60:63], v[192:195], v[20:23], v[60:63]
  ds_read_b128 v[48:51], v7 offset:48128
  v_mfma_f32_16x16x32_bf16 v[64:67], v[196:199], v[20:23], v[64:67]
  v_mfma_f32_16x16x32_bf16 v[60:63], v[200:203], v[24:27], v[60:63]
  v_mfma_f32_16x16x32_bf16 v[64:67], v[204:207], v[24:27], v[64:67]
  s_waitcnt lgkmcnt(4)
  s_add_u32 m0, s57, 11264
  s_add_u32 s65, s66, 22528
  buffer_load_dwordx4 v1, s[8:11], s65 offen sc1 lds
  v_mfma_f32_16x16x32_bf16 v[60:63], v[208:211], v[28:31], v[60:63]
  v_mfma_f32_16x16x32_bf16 v[64:67], v[212:215], v[28:31], v[64:67]
  v_mfma_f32_16x16x32_bf16 v[60:63], v[216:219], v[32:35], v[60:63]
  v_mfma_f32_16x16x32_bf16 v[64:67], v[220:223], v[32:35], v[64:67]
  s_waitcnt lgkmcnt(2)
  v_mfma_f32_16x16x32_bf16 v[60:63], v[224:227], v[36:39], v[60:63]
  v_mfma_f32_16x16x32_bf16 v[64:67], v[228:231], v[36:39], v[64:67]
  v_mfma_f32_16x16x32_bf16 v[60:63], v[232:235], v[40:43], v[60:63]
  v_mfma_f32_16x16x32_bf16 v[64:67], v[236:239], v[40:43], v[64:67]
  s_waitcnt lgkmcnt(0)
  v_mfma_f32_16x16x32_bf16 v[60:63], v[240:243], v[44:47], v[60:63]
  v_mfma_f32_16x16x32_bf16 v[64:67], v[244:247], v[44:47], v[64:67]
  v_mfma_f32_16x16x32_bf16 v[60:63], v[248:251], v[48:51], v[60:63]
  v_mfma_f32_16x16x32_bf16 v[64:67], v[252:255], v[48:51], v[64:67]
  s_nop 6
  v_add_f32 v60, v60, v92
  v_add_f32 v61, v61, v93
  v_add_f32 v62, v62, v94
  v_add_f32 v63, v63, v95
  v_add_f32 v64, v64, v96
  v_add_f32 v65, v65, v97
  v_add_f32 v66, v66, v98
  v_add_f32 v67, v67, v99
  v_cvt_pk_bf16_f32 v104, v60, v61
  v_lshlrev_b32 v60, 16, v104
  v_and_b32 v61, 0xffff0000, v104
  v_cvt_pk_bf16_f32 v105, v62, v63
  v_lshlrev_b32 v62, 16, v105
  v_and_b32 v63, 0xffff0000, v105
  v_cvt_pk_bf16_f32 v106, v64, v65
  v_lshlrev_b32 v64, 16, v106
  v_and_b32 v65, 0xffff0000, v106
  v_cvt_pk_bf16_f32 v107, v66, v67
  v_lshlrev_b32 v66, 16, v107
  v_and_b32 v67, 0xffff0000, v107
  buffer_store_dwordx4 v[100:103], v1, s[8:11], s70 offen offset:0 sc1
  buffer_store_dwordx4 v[104:107], v1, s[8:11], s70 offen offset:1024 sc1
  v_add_f32 v110, v60, v61
  v_mul_f32 v111, v60, v60
  v_fmac_f32 v111, v61, v61
  v_add_f32 v110, v110, v62
  v_fmac_f32 v111, v62, v62
  v_add_f32 v110, v110, v63
  v_fmac_f32 v111, v63, v63
  v_add_f32 v110, v110, v64
  v_fmac_f32 v111, v64, v64
  v_add_f32 v110, v110, v65
  v_fmac_f32 v111, v65, v65
  v_add_f32 v110, v110, v66
  v_fmac_f32 v111, v66, v66
  v_add_f32 v110, v110, v67
  v_fmac_f32 v111, v67, v67
  s_nop 0
  v_permlane32_swap_b32 v108, v110
  v_permlane32_swap_b32 v109, v111
  s_mul_i32 s60, s52, 1792
  s_sub_u32 s60, s70, s60
  v_pk_add_f32 v[108:109], v[108:109], v[110:111]
  v_mov_b64 v[110:111], v[108:109]
  s_add_u32 s60, s60, 40960
  s_add_u32 s70, s70, 46080
  v_permlane16_swap_b32 v108, v110
  v_permlane16_swap_b32 v109, v111
  v_pk_add_f32 v[108:109], v[108:109], v[110:111]
  buffer_store_dwordx2 v[108:109], v5, s[8:11], s60 offen sc1
  s_add_u32 s58, s58, 512
  s_mov_b64 s[76:77], -1
  s_add_u32 s55, s55, 46080
  s_mov_b32 s50, s73
  s_cmp_eq_u32 s50, 64
  s_cselect_b32 s56, 1, s56
  s_waitcnt vmcnt(3)
  s_cmp_eq_u32 s56, 0
  s_cbranch_scc1 W4_LOOPF0
  s_waitcnt vmcnt(0)
  s_and_b64 exec, s[76:77], 1
  buffer_store_dword v4, v1, s[8:11], s58 offen sc1
  s_mov_b64 exec, -1
  s_mov_b64 s[76:77], 0
  s_cmp_lt_u32 s50, 64
  s_cbranch_scc1 W4_WAITF0
  s_branch W4_END
W4_WAITF1:
su_451:
  buffer_load_dword v3, v2, s[8:11], s59 offen sc1
  s_waitcnt vmcnt(0)
  v_cmp_ge_i32 vcc, s73, v3
  s_nop 0
  s_cbranch_vccz so_452
  s_sleep 2
  s_sub_u32 s47, s47, 1
  s_cbranch_scc0 su_451
  s_branch ABORT
so_452:
  s_add_u32 m0, s57, 0
  s_add_u32 s65, s74, 0
  buffer_load_dwordx4 v1, s[8:11], s65 offen sc1 lds
  s_add_u32 m0, s57, 1024
  s_add_u32 s65, s74, 2048
  buffer_load_dwordx4 v1, s[8:11], s65 offen sc1 lds
  s_add_u32 m0, s57, 2048
  s_add_u32 s65, s74, 4096
  buffer_load_dwordx4 v1, s[8:11], s65 offen sc1 lds
  s_add_u32 m0, s57, 3072
  s_add_u32 s65, s74, 6144
  buffer_load_dwordx4 v1, s[8:11], s65 offen sc1 lds
  s_add_u32 m0, s57, 4096
  s_add_u32 s65, s74, 8192
  buffer_load_dwordx4 v1, s[8:11], s65 offen sc1 lds
  s_add_u32 m0, s57, 5120
  s_add_u32 s65, s74, 10240
  buffer_load_dwordx4 v1, s[8:11], s65 offen sc1 lds
  s_add_u32 m0, s57, 6144
  s_add_u32 s65, s74, 12288
  buffer_load_dwordx4 v1, s[8:11], s65 offen sc1 lds
  s_add_u32 m0, s57, 7168
  s_add_u32 s65, s74, 14336
  buffer_load_dwordx4 v1, s[8:11], s65 offen sc1 lds
  s_add_u32 m0, s57, 8192
  s_add_u32 s65, s74, 16384
  buffer_load_dwordx4 v1, s[8:11], s65 offen sc1 lds
  s_add_u32 m0, s57, 9216
  s_add_u32 s65, s74, 18432
  buffer_load_dwordx4 v1, s[8:11], s65 offen sc1 lds
  s_add_u32 m0, s57, 10240
  s_add_u32 s65, s74, 20480
  buffer_load_dwordx4 v1, s[8:11], s65 offen sc1 lds
  s_add_u32 m0, s57, 11264
  s_add_u32 s65, s74, 22528
  buffer_load_dwordx4 v1, s[8:11], s65 offen sc1 lds
  s_waitcnt vmcnt(0)
W4_LOOPF1:
  s_barrier
  ds_read_b128 v[20:23], v1 offset:0
  ds_read_b128 v[24:27], v1 offset:1024
  ds_read_b128 v[28:31], v1 offset:2048
  ds_read_b128 v[32:35], v1 offset:3072
  s_mov_b32 s53, s74
  s_and_b32 s60, s50, 3
  s_mul_i32 s54, s60, 46080
  s_add_u32 s54, s54, s69
  s_add_u32 s73, s50, 1
  s_and_b32 s60, s73, 3
  s_mul_i32 s74, s60, 98304
  s_add_u32 s74, s74, s68
  s_waitcnt lgkmcnt(3)
  v_mfma_f32_16x16x32_bf16 v[52:55], a[0:3], v[20:23], 0
  ds_read_b128 v[36:39], v1 offset:4096
  v_mfma_f32_16x16x32_bf16 v[56:59], a[4:7], v[20:23], 0
  s_waitcnt lgkmcnt(3)
  ds_read_b128 v[40:43], v1 offset:5120
  v_mfma_f32_16x16x32_bf16 v[52:55], a[8:11], v[24:27], v[52:55]
  ds_read_b128 v[44:47], v1 offset:6144
  v_mfma_f32_16x16x32_bf16 v[56:59], a[12:15], v[24:27], v[56:59]
  s_waitcnt lgkmcnt(4)
  ds_read_b128 v[48:51], v1 offset:7168
  v_mfma_f32_16x16x32_bf16 v[52:55], a[16:19], v[28:31], v[52:55]
  ds_read_b128 v[20:23], v1 offset:8192
  v_mfma_f32_16x16x32_bf16 v[56:59], a[20:23], v[28:31], v[56:59]
  s_waitcnt lgkmcnt(5)
  ds_read_b128 v[24:27], v1 offset:9216
  v_mfma_f32_16x16x32_bf16 v[52:55], a[24:27], v[32:35], v[52:55]
  ds_read_b128 v[28:31], v1 offset:10240
  v_mfma_f32_16x16x32_bf16 v[56:59], a[28:31], v[32:35], v[56:59]
  s_waitcnt lgkmcnt(5)
  s_add_u32 m0, s57, 49152
  s_add_u32 s65, s53, 1024
  buffer_load_dwordx4 v1, s[8:11], s65 offen sc1 lds
  v_mfma_f32_16x16x32_bf16 v[52:55], a[32:35], v[36:39], v[52:55]
  ds_read_b128 v[32:35], v1 offset:11264
  v_mfma_f32_16x16x32_bf16 v[56:59], a[36:39], v[36:39], v[56:59]
  v_mfma_f32_16x16x32_bf16 v[52:55], a[40:43], v[40:43], v[52:55]
  ds_read_b128 v[36:39], v1 offset:12288
  v_mfma_f32_16x16x32_bf16 v[56:59], a[44:47], v[40:43], v[56:59]
  s_waitcnt lgkmcnt(5)
  s_add_u32 m0, s57, 50176
  s_add_u32 s65, s53, 3072
  buffer_load_dwordx4 v1, s[8:11], s65 offen sc1 lds
  v_mfma_f32_16x16x32_bf16 v[52:55], a[48:51], v[44:47], v[52:55]
  ds_read_b128 v[40:43], v1 offset:13312
  v_mfma_f32_16x16x32_bf16 v[56:59], a[52:55], v[44:47], v[56:59]
  v_mfma_f32_16x16x32_bf16 v[52:55], a[56:59], v[48:51], v[52:55]
  ds_read_b128 v[44:47], v1 offset:14336
  v_mfma_f32_16x16x32_bf16 v[56:59], a[60:63], v[48:51], v[56:59]
  s_waitcnt lgkmcnt(5)
  s_add_u32 m0, s57, 51200
  s_add_u32 s65, s53, 5120
  buffer_load_dwordx4 v1, s[8:11], s65 offen sc1 lds
  v_mfma_f32_16x16x32_bf16 v[52:55], a[64:67], v[20:23], v[52:55]
  ds_read_b128 v[48:51], v1 offset:15360
  v_mfma_f32_16x16x32_bf16 v[56:59], a[68:71], v[20:23], v[56:59]
  v_mfma_f32_16x16x32_bf16 v[52:55], a[72:75], v[24:27], v[52:55]
  ds_read_b128 v[20:23], v1 offset:16384
  v_mfma_f32_16x16x32_bf16 v[56:59], a[76:79], v[24:27], v[56:59]
  s_waitcnt lgkmcnt(5)
  s_add_u32 m0, s57, 52224
  s_add_u32 s65, s53, 7168
  buffer_load_dwordx4 v1, s[8:11], s65 offen sc1 lds
  v_mfma_f32_16x16x32_bf16 v[52:55], a[80:83], v[28:31], v[52:55]
  ds_read_b128 v[24:27], v1 offset:17408
  v_mfma_f32_16x16x32_bf16 v[56:59], a[84:87], v[28:31], v[56:59]
  v_mfma_f32_16x16x32_bf16 v[52:55], a[88:91], v[32:35], v[52:55]
  ds_read_b128 v[28:31], v1 offset:18432
  v_mfma_f32_16x16x32_bf16 v[56:59], a[92:95], v[32:35], v[56:59]
  s_waitcnt lgkmcnt(5)
  s_add_u32 m0, s57, 53248
  s_add_u32 s65, s53, 9216
  buffer_load_dwordx4 v1, s[8:11], s65 offen sc1 lds
  v_mfma_f32_16x16x32_bf16 v[52:55], a[96:99], v[36:39], v[52:55]
  ds_read_b128 v[32:35], v1 offset:19456
  v_mfma_f32_16x16x32_bf16 v[56:59], a[100:103], v[36:39], v[56:59]
  v_mfma_f32_16x16x32_bf16 v[52:55], a[104:107], v[40:43], v[52:55]
  ds_read_b128 v[36:39], v1 offset:20480
  v_mfma_f32_16x16x32_bf16 v[56:59], a[108:111], v[40:43], v[56:59]
  s_waitcnt lgkmcnt(5)
  s_add_u32 m0, s57, 54272
  s_add_u32 s65, s53, 11264
  buffer_load_dwordx4 v1, s[8:11], s65 offen sc1 lds
  v_mfma_f32_16x16x32_bf16 v[52:55], a[112:115], v[44:47], v[52:55]
  ds_read_b128 v[40:43], v1 offset:21504
  v_mfma_f32_16x16x32_bf16 v[56:59], a[116:119], v[44:47], v[56:59]
  v_mfma_f32_16x16x32_bf16 v[52:55], a[120:123], v[48:51], v[52:55]
  ds_read_b128 v[44:47], v1 offset:22528
  v_mfma_f32_16x16x32_bf16 v[56:59], a[124:127], v[48:51], v[56:59]
  s_waitcnt lgkmcnt(5)
  s_add_u32 m0, s57, 55296
  s_add_u32 s65, s53, 13312
  buffer_load_dwordx4 v1, s[8:11], s65 offen sc1 lds
  v_mfma_f32_16x16x32_bf16 v[52:55], a[128:131], v[20:23], v[52:55]
  ds_read_b128 v[48:51], v1 offset:23552
  v_mfma_f32_16x16x32_bf16 v[56:59], a[132:135], v[20:23], v[56:59]
  v_mfma_f32_16x16x32_bf16 v[52:55], a[136:139], v[24:27], v[52:55]
  ds_read_b128 v[20:23], v1 offset:24576
  v_mfma_f32_16x16x32_bf16 v[56:59], a[140:143], v[24:27], v[56:59]
  s_waitcnt lgkmcnt(5)
  s_add_u32 m0, s57, 56320
  s_add_u32 s65, s53, 15360
  buffer_load_dwordx4 v1, s[8:11], s65 offen sc1 lds
  v_mfma_f32_16x16x32_bf16 v[52:55], a[144:147], v[28:31], v[52:55]
  ds_read_b128 v[24:27], v1 offset:25600
  v_mfma_f32_16x16x32_bf16 v[56:59], a[148:151], v[28:31], v[56:59]
  v_mfma_f32_16x16x32_bf16 v[52:55], a[152:155], v[32:35], v[52:55]
  ds_read_b128 v[28:31], v1 offset:26624
  v_mfma_f32_16x16x32_bf16 v[56:59], a[156:159], v[32:35], v[56:59]
  s_waitcnt lgkmcnt(5)
  s_add_u32 m0, s57, 57344
  s_add_u32 s65, s53, 17408
  buffer_load_dwordx4 v1, s[8:11], s65 offen sc1 lds
  v_mfma_f32_16x16x32_bf16 v[52:55], a[160:163], v[36:39], v[52:55]
  ds_read_b128 v[32:35], v1 offset:27648
  v_mfma_f32_16x16x32_bf16 v[56:59], a[164:167], v[36:39], v[56:59]
  v_mfma_f32_16x16x32_bf16 v[52:55], a[168:171], v[40:43], v[52:55]
  ds_read_b128 v[36:39], v1 offset:28672
  v_mfma_f32_16x16x32_bf16 v[56:59], a[172:175], v[40:43], v[56:59]
  s_waitcnt lgkmcnt(5)
  s_add_u32 m0, s57, 58368
  s_add_u32 s65, s53, 19456
  buffer_load_dwordx4 v1, s[8:11], s65 offen sc1 lds
  v_mfma_f32_16x16x32_bf16 v[52:55], a[176:179], v[44:47], v[52:55]
  ds_read_b128 v[40:43], v1 offset:29696
  v_mfma_f32_16x16x32_bf16 v[56:59], a[180:183], v[44:47], v[56:59]
  v_mfma_f32_16x16x32_bf16 v[52:55], a[184:187], v[48:51], v[52:55]
  ds_read_b128 v[44:47], v1 offset:30720
  v_mfma_f32_16x16x32_bf16 v[56:59], a[188:191], v[48:51], v[56:59]
  s_waitcnt lgkmcnt(5)
  s_add_u32 m0, s57, 59392
  s_add_u32 s65, s53, 21504
  buffer_load_dwordx4 v1, s[8:11], s65 offen sc1 lds
  v_mfma_f32_16x16x32_bf16 v[52:55], a[192:195], v[20:23], v[52:55]
  ds_read_b128 v[48:51], v1 offset:31744
  v_mfma_f32_16x16x32_bf16 v[56:59], a[196:199], v[20:23], v[56:59]
  v_mfma_f32_16x16x32_bf16 v[52:55], a[200:203], v[24:27], v[52:55]
  ds_read_b128 v[20:23], v1 offset:32768
  v_mfma_f32_16x16x32_bf16 v[56:59], a[204:207], v[24:27], v[56:59]
  s_waitcnt lgkmcnt(5)
  s_add_u32 m0, s57, 60416
  s_add_u32 s65, s53, 23552
  buffer_load_dwordx4 v1, s[8:11], s65 offen sc1 lds
  v_mfma_f32_16x16x32_bf16 v[52:55], a[208:211], v[28:31], v[52:55]
  ds_read_b128 v[24:27], v1 offset:33792
  v_mfma_f32_16x16x32_bf16 v[56:59], a[212:215], v[28:31], v[56:59]
  v_mfma_f32_16x16x32_bf16 v[52:55], a[216:219], v[32:35], v[52:55]
  ds_read_b128 v[28:31], v1 offset:34816
  v_mfma_f32_16x16x32_bf16 v[56:59], a[220:223], v[32:35], v[56:59]
  s_waitcnt lgkmcnt(5)
  buffer_load_dwordx4 v[68:71], v1, s[8:11], s54 offen offset:0 sc1
  v_mfma_f32_16x16x32_bf16 v[52:55], a[224:227], v[36:39], v[52:55]
  ds_read_b128 v[32:35], v1 offset:35840
  v_mfma_f32_16x16x32_bf16 v[56:59], a[228:231], v[36:39], v[56:59]
  buffer_load_dwordx4 v[72:75], v1, s[8:11], s55 offen offset:0 sc1
  v_mfma_f32_16x16x32_bf16 v[52:55], a[232:235], v[40:43], v[52:55]
  ds_read_b128 v[36:39], v1 offset:36864
  v_mfma_f32_16x16x32_bf16 v[56:59], a[236:239], v[40:43], v[56:59]
  s_waitcnt lgkmcnt(5)
  buffer_load_dwordx4 v[76:79], v1, s[8:11], s54 offen offset:1024 sc1
  v_mfma_f32_16x16x32_bf16 v[52:55], a[240:243], v[44:47], v[52:55]
  ds_read_b128 v[40:43], v1 offset:37888
  v_mfma_f32_16x16x32_bf16 v[56:59], a[244:247], v[44:47], v[56:59]
  buffer_load_dwordx4 v[80:83], v1, s[8:11], s55 offen offset:1024 sc1
  v_mfma_f32_16x16x32_bf16 v[52:55], a[248:251], v[48:51], v[52:55]
  ds_read_b128 v[44:47], v1 offset:38912
  v_mfma_f32_16x16x32_bf16 v[56:59], a[252:255], v[48:51], v[56:59]
  s_waitcnt lgkmcnt(5)
  v_mfma_f32_16x16x32_bf16 v[52:55], v[128:131], v[20:23], v[52:55]
  ds_read_b128 v[48:51], v1 offset:39936
  v_mfma_f32_16x16x32_bf16 v[56:59], v[132:135], v[20:23], v[56:59]
  v_mfma_f32_16x16x32_bf16 v[52:55], v[136:139], v[24:27], v[52:55]
  ds_read_b128 v[20:23], v1 offset:40960
  v_mfma_f32_16x16x32_bf16 v[56:59], v[140:143], v[24:27], v[56:59]
  s_waitcnt lgkmcnt(5)
  v_mfma_f32_16x16x32_bf16 v[52:55], v[144:147], v[28:31], v[52:55]
  ds_read_b128 v[24:27], v1 offset:41984
  v_mfma_f32_16x16x32_bf16 v[56:59], v[148:151], v[28:31], v[56:59]
  v_mfma_f32_16x16x32_bf16 v[52:55], v[152:155], v[32:35], v[52:55]
  ds_read_b128 v[28:31], v1 offset:43008
  v_mfma_f32_16x16x32_bf16 v[56:59], v[156:159], v[32:35], v[56:59]
  s_waitcnt lgkmcnt(5)
  v_mfma_f32_16x16x32_bf16 v[52:55], v[160:163], v[36:39], v[52:55]
  ds_read_b128 v[32:35], v1 offset:44032
  v_mfma_f32_16x16x32_bf16 v[56:59], v[164:167], v[36:39], v[56:59]
  v_mfma_f32_16x16x32_bf16 v[52:55], v[168:171], v[40:43], v[52:55]
  ds_read_b128 v[36:39], v1 offset:45056
  v_mfma_f32_16x16x32_bf16 v[56:59], v[172:175], v[40:43], v[56:59]
  s_waitcnt lgkmcnt(5)
  v_mfma_f32_16x16x32_bf16 v[52:55], v[176:179], v[44:47], v[52:55]
  ds_read_b128 v[40:43], v1 offset:46080
  v_mfma_f32_16x16x32_bf16 v[56:59], v[180:183], v[44:47], v[56:59]
  v_mfma_f32_16x16x32_bf16 v[52:55], v[184:187], v[48:51], v[52:55]
  ds_read_b128 v[44:47], v1 offset:47104
  v_mfma_f32_16x16x32_bf16 v[56:59], v[188:191], v[48:51], v[56:59]
  s_waitcnt lgkmcnt(5)
  v_mfma_f32_16x16x32_bf16 v[52:55], v[192:195], v[20:23], v[52:55]
  ds_read_b128 v[48:51], v1 offset:48128
  v_mfma_f32_16x16x32_bf16 v[56:59], v[196:199], v[20:23], v[56:59]
  s_waitcnt vmcnt(0)
  v_mov_b32 v19, s73
  s_mov_b64 exec, 1
  s_cmp_lg_u32 s49, 0
  s_cbranch_scc1 wt_453
  buffer_store_dword v19, v1, s[8:11], s72 offen
wb_454:
  s_mov_b64 exec, -1
  s_barrier
  v_mfma_f32_16x16x32_bf16 v[52:55], v[200:203], v[24:27], v[52:55]
  ds_read_b128 v[20:23], v7 offset:0
  v_lshlrev_b32 v84, 16, v68
  v_mfma_f32_16x16x32_bf16 v[56:59], v[204:207], v[24:27], v[56:59]
  s_waitcnt lgkmcnt(5)
  v_and_b32 v85, 0xffff0000, v68
  v_lshlrev_b32 v86, 16, v69
  v_mfma_f32_16x16x32_bf16 v[52:55], v[208:211], v[28:31], v[52:55]
  ds_read_b128 v[24:27], v7 offset:1024
  v_and_b32 v87, 0xffff0000, v69
  v_mfma_f32_16x16x32_bf16 v[56:59], v[212:215], v[28:31], v[56:59]
  v_lshlrev_b32 v88, 16, v70
  v_and_b32 v89, 0xffff0000, v70
  v_mfma_f32_16x16x32_bf16 v[52:55], v[216:219], v[32:35], v[52:55]
  ds_read_b128 v[28:31], v7 offset:2048
  v_lshlrev_b32 v90, 16, v71
  v_mfma_f32_16x16x32_bf16 v[56:59], v[220:223], v[32:35], v[56:59]
  s_waitcnt lgkmcnt(5)
  v_and_b32 v91, 0xffff0000, v71
  v_lshlrev_b32 v12, 16, v72
  v_mfma_f32_16x16x32_bf16 v[52:55], v[224:227], v[36:39], v[52:55]
  ds_read_b128 v[32:35], v7 offset:3072
  v_and_b32 v13, 0xffff0000, v72
  v_mfma_f32_16x16x32_bf16 v[56:59], v[228:231], v[36:39], v[56:59]
  v_add_f32 v84, v84, v12
  v_add_f32 v85, v85, v13
  v_mfma_f32_16x16x32_bf16 v[52:55], v[232:235], v[40:43], v[52:55]
  ds_read_b128 v[36:39], v7 offset:4096
  v_lshlrev_b32 v12, 16, v73
  v_mfma_f32_16x16x32_bf16 v[56:59], v[236:239], v[40:43], v[56:59]
  s_waitcnt lgkmcnt(5)
  v_and_b32 v13, 0xffff0000, v73
  v_add_f32 v86, v86, v12
  v_mfma_f32_16x16x32_bf16 v[52:55], v[240:243], v[44:47], v[52:55]
  ds_read_b128 v[40:43], v7 offset:5120
  v_add_f32 v87, v87, v13
  v_mfma_f32_16x16x32_bf16 v[56:59], v[244:247], v[44:47], v[56:59]
  v_lshlrev_b32 v12, 16, v74
  v_and_b32 v13, 0xffff0000, v74
  v_mfma_f32_16x16x32_bf16 v[52:55], v[248:251], v[48:51], v[52:55]
  ds_read_b128 v[44:47], v7 offset:6144
  v_add_f32 v88, v88, v12
  v_mfma_f32_16x16x32_bf16 v[56:59], v[252:255], v[48:51], v[56:59]
  s_waitcnt lgkmcnt(5)
  v_add_f32 v89, v89, v13
  v_lshlrev_b32 v12, 16, v75
  v_mfma_f32_16x16x32_bf16 v[60:63], a[0:3], v[20:23], 0
  ds_read_b128 v[48:51], v7 offset:7168
  v_and_b32 v13, 0xffff0000, v75
  v_mfma_f32_16x16x32_bf16 v[64:67], a[4:7], v[20:23], 0
  v_add_f32 v90, v90, v12
  v_add_f32 v91, v91, v13
  v_mfma_f32_16x16x32_bf16 v[60:63], a[8:11], v[24:27], v[60:63]
  ds_read_b128 v[20:23], v7 offset:8192
  v_lshlrev_b32 v92, 16, v76
  v_mfma_f32_16x16x32_bf16 v[64:67], a[12:15], v[24:27], v[64:67]
  s_waitcnt lgkmcnt(5)
  v_and_b32 v93, 0xffff0000, v76
  v_lshlrev_b32 v94, 16, v77
  v_mfma_f32_16x16x32_bf16 v[60:63], a[16:19], v[28:31], v[60:63]
  ds_read_b128 v[24:27], v7 offset:9216
  v_and_b32 v95, 0xffff0000, v77
  v_mfma_f32_16x16x32_bf16 v[64:67], a[20:23], v[28:31], v[64:67]
  v_lshlrev_b32 v96, 16, v78
  v_and_b32 v97, 0xffff0000, v78
  v_mfma_f32_16x16x32_bf16 v[60:63], a[24:27], v[32:35], v[60:63]
  ds_read_b128 v[28:31], v7 offset:10240
  v_lshlrev_b32 v98, 16, v79
  v_mfma_f32_16x16x32_bf16 v[64:67], a[28:31], v[32:35], v[64:67]
  s_waitcnt lgkmcnt(5)
  v_and_b32 v99, 0xffff0000, v79
  v_lshlrev_b32 v12, 16, v80
  v_mfma_f32_16x16x32_bf16 v[60:63], a[32:35], v[36:39], v[60:63]
  ds_read_b128 v[32:35], v7 offset:11264
  v_and_b32 v13, 0xffff0000, v80
  v_mfma_f32_16x16x32_bf16 v[64:67], a[36:39], v[36:39], v[64:67]
  v_add_f32 v92, v92, v12
  v_add_f32 v93, v93, v13
  v_mfma_f32_16x16x32_bf16 v[60:63], a[40:43], v[40:43], v[60:63]
  ds_read_b128 v[36:39], v7 offset:12288
  buffer_load_dword v3, v2, s[8:11], s59 offen sc1
  v_mfma_f32_16x16x32_bf16 v[64:67], a[44:47], v[40:43], v[64:67]
  s_waitcnt lgkmcnt(5)
  v_lshlrev_b32 v12, 16, v81
  v_and_b32 v13, 0xffff0000, v81
  v_mfma_f32_16x16x32_bf16 v[60:63], a[48:51], v[44:47], v[60:63]
  ds_read_b128 v[40:43], v7 offset:13312
  v_add_f32 v94, v94, v12
  v_mfma_f32_16x16x32_bf16 v[64:67], a[52:55], v[44:47], v[64:67]
  v_add_f32 v95, v95, v13
  v_lshlrev_b32 v12, 16, v82
  v_mfma_f32_16x16x32_bf16 v[60:63], a[56:59], v[48:51], v[60:63]
  ds_read_b128 v[44:47], v7 offset:14336
  v_and_b32 v13, 0xffff0000, v82
  v_mfma_f32_16x16x32_bf16 v[64:67], a[60:63], v[48:51], v[64:67]
  s_waitcnt lgkmcnt(5)
  v_add_f32 v96, v96, v12
  v_add_f32 v97, v97, v13
  v_mfma_f32_16x16x32_bf16 v[60:63], a[64:67], v[20:23], v[60:63]
  ds_read_b128 v[48:51], v7 offset:15360
  v_lshlrev_b32 v12, 16, v83
  v_mfma_f32_16x16x32_bf16 v[64:67], a[68:71], v[20:23], v[64:67]
  v_and_b32 v13, 0xffff0000, v83
  v_add_f32 v98, v98, v12
  v_mfma_f32_16x16x32_bf16 v[60:63], a[72:75], v[24:27], v[60:63]
  ds_read_b128 v[20:23], v7 offset:16384
  v_add_f32 v99, v99, v13
  v_mfma_f32_16x16x32_bf16 v[64:67], a[76:79], v[24:27], v[64:67]
  s_waitcnt lgkmcnt(5)
  v_add_f32 v52, v52, v84
  v_add_f32 v53, v53, v85
  v_mfma_f32_16x16x32_bf16 v[60:63], a[80:83], v[28:31], v[60:63]
  ds_read_b128 v[24:27], v7 offset:17408
  v_add_f32 v54, v54, v86
  v_mfma_f32_16x16x32_bf16 v[64:67], a[84:87], v[28:31], v[64:67]
  v_add_f32 v55, v55, v87
  v_add_f32 v56, v56, v88
  v_mfma_f32_16x16x32_bf16 v[60:63], a[88:91], v[32:35], v[60:63]
  ds_read_b128 v[28:31], v7 offset:18432
  v_add_f32 v57, v57, v89
  v_mfma_f32_16x16x32_bf16 v[64:67], a[92:95], v[32:35], v[64:67]
  s_waitcnt lgkmcnt(5)
  v_add_f32 v58, v58, v90
  v_add_f32 v59, v59, v91
  v_mfma_f32_16x16x32_bf16 v[60:63], a[96:99], v[36:39], v[60:63]
  ds_read_b128 v[32:35], v7 offset:19456
  v_cvt_pk_bf16_f32 v100, v52, v53
  v_mfma_f32_16x16x32_bf16 v[64:67], a[100:103], v[36:39], v[64:67]
  v_cvt_pk_bf16_f32 v101, v54, v55
  v_cvt_pk_bf16_f32 v102, v56, v57
  v_mfma_f32_16x16x32_bf16 v[60:63], a[104:107], v[40:43], v[60:63]
  ds_read_b128 v[36:39], v7 offset:20480
  v_cvt_pk_bf16_f32 v103, v58, v59
  v_mfma_f32_16x16x32_bf16 v[64:67], a[108:111], v[40:43], v[64:67]
  s_waitcnt lgkmcnt(5)
  buffer_store_dwordx2 v[100:101], v6, s[80:83], s71 offen offset:0
  buffer_store_dwordx2 v[102:103], v6, s[80:83], s71 offen offset:32
  v_mfma_f32_16x16x32_bf16 v[60:63], a[112:115], v[44:47], v[60:63]
  s_add_u32 s71, s71, 20480
  ds_read_b128 v[40:43], v7 offset:21504
  v_mfma_f32_16x16x32_bf16 v[64:67], a[116:119], v[44:47], v[64:67]
  v_mfma_f32_16x16x32_bf16 v[60:63], a[120:123], v[48:51], v[60:63]
  ds_read_b128 v[44:47], v7 offset:22528
  v_mfma_f32_16x16x32_bf16 v[64:67], a[124:127], v[48:51], v[64:67]
  s_waitcnt lgkmcnt(5)
  v_mfma_f32_16x16x32_bf16 v[60:63], a[128:131], v[20:23], v[60:63]
  ds_read_b128 v[48:51], v7 offset:23552
  v_mfma_f32_16x16x32_bf16 v[64:67], a[132:135], v[20:23], v[64:67]
  v_mfma_f32_16x16x32_bf16 v[60:63], a[136:139], v[24:27], v[60:63]
  s_waitcnt vmcnt(2)
  s_barrier
  ds_read_b128 v[20:23], v7 offset:24576
  v_mfma_f32_16x16x32_bf16 v[64:67], a[140:143], v[24:27], v[64:67]
  s_waitcnt lgkmcnt(5)
  v_cmp_ge_i32 vcc, s73, v3
  v_mfma_f32_16x16x32_bf16 v[60:63], a[144:147], v[28:31], v[60:63]
  ds_read_b128 v[24:27], v7 offset:25600
  v_mfma_f32_16x16x32_bf16 v[64:67], a[148:151], v[28:31], v[64:67]
  s_cmp_lg_u64 vcc, 0
  s_cselect_b32 s56, 536870912, 0
  s_or_b32 s66, s74, s56
  v_mfma_f32_16x16x32_bf16 v[60:63], a[152:155], v[32:35], v[60:63]
  ds_read_b128 v[28:31], v7 offset:26624
  v_mfma_f32_16x16x32_bf16 v[64:67], a[156:159], v[32:35], v[64:67]
  s_waitcnt lgkmcnt(5)
  s_add_u32 m0, s57, 0
  s_add_u32 s65, s66, 0
  buffer_load_dwordx4 v1, s[8:11], s65 offen sc1 lds
  v_mfma_f32_16x16x32_bf16 v[60:63], a[160:163], v[36:39], v[60:63]
  ds_read_b128 v[32:35], v7 offset:27648
  v_mfma_f32_16x16x32_bf16 v[64:67], a[164:167], v[36:39], v[64:67]
  v_mfma_f32_16x16x32_bf16 v[60:63], a[168:171], v[40:43], v[60:63]
  ds_read_b128 v[36:39], v7 offset:28672
  v_mfma_f32_16x16x32_bf16 v[64:67], a[172:175], v[40:43], v[64:67]
  s_waitcnt lgkmcnt(5)
  s_add_u32 m0, s57, 1024
  s_add_u32 s65, s66, 2048
  buffer_load_dwordx4 v1, s[8:11], s65 offen sc1 lds
  v_mfma_f32_16x16x32_bf16 v[60:63], a[176:179], v[44:47], v[60:63]
  ds_read_b128 v[40:43], v7 offset:29696
  v_mfma_f32_16x16x32_bf16 v[64:67], a[180:183], v[44:47], v[64:67]
  v_mfma_f32_16x16x32_bf16 v[60:63], a[184:187], v[48:51], v[60:63]
  ds_read_b128 v[44:47], v7 offset:30720
  v_mfma_f32_16x16x32_bf16 v[64:67], a[188:191], v[48:51], v[64:67]
  s_waitcnt lgkmcnt(5)
  s_add_u32 m0, s57, 2048
  s_add_u32 s65, s66, 4096
  buffer_load_dwordx4 v1, s[8:11], s65 offen sc1 lds
  v_mfma_f32_16x16x32_bf16 v[60:63], a[192:195], v[20:23], v[60:63]
  ds_read_b128 v[48:51], v7 offset:31744
  v_mfma_f32_16x16x32_bf16 v[64:67], a[196:199], v[20:23], v[64:67]
  v_mfma_f32_16x16x32_bf16 v[60:63], a[200:203], v[24:27], v[60:63]
  ds_read_b128 v[20:23], v7 offset:32768
  v_mfma_f32_16x16x32_bf16 v[64:67], a[204:207], v[24:27], v[64:67]
  s_waitcnt lgkmcnt(5)
  s_add_u32 m0, s57, 3072
  s_add_u32 s65, s66, 6144
  buffer_load_dwordx4 v1, s[8:11], s65 offen sc1 lds
  v_mfma_f32_16x16x32_bf16 v[60:63], a[208:211], v[28:31], v[60:63]
  ds_read_b128 v[24:27], v7 offset:33792
  v_mfma_f32_16x16x32_bf16 v[64:67], a[212:215], v[28:31], v[64:67]
  v_mfma_f32_16x16x32_bf16 v[60:63], a[216:219], v[32:35], v[60:63]
  ds_read_b128 v[28:31], v7 offset:34816
  v_mfma_f32_16x16x32_bf16 v[64:67], a[220:223], v[32:35], v[64:67]
  s_waitcnt lgkmcnt(5)
  s_add_u32 m0, s57, 4096
  s_add_u32 s65, s66, 8192
  buffer_load_dwordx4 v1, s[8:11], s65 offen sc1 lds
  v_mfma_f32_16x16x32_bf16 v[60:63], a[224:227], v[36:39], v[60:63]
  ds_read_b128 v[32:35], v7 offset:35840
  v_mfma_f32_16x16x32_bf16 v[64:67], a[228:231], v[36:39], v[64:67]
  v_mfma_f32_16x16x32_bf16 v[60:63], a[232:235], v[40:43], v[60:63]
  ds_read_b128 v[36:39], v7 offset:36864
  v_mfma_f32_16x16x32_bf16 v[64:67], a[236:239], v[40:43], v[64:67]
  s_waitcnt lgkmcnt(5)
  s_add_u32 m0, s57, 5120
  s_add_u32 s65, s66, 10240
  buffer_load_dwordx4 v1, s[8:11], s65 offen sc1 lds
  v_mfma_f32_16x16x32_bf16 v[60:63], a[240:243], v[44:47], v[60:63]
  ds_read_b128 v[40:43], v7 offset:37888
  v_mfma_f32_16x16x32_bf16 v[64:67], a[244:247], v[44:47], v[64:67]
  v_mfma_f32_16x16x32_bf16 v[60:63], a[248:251], v[48:51], v[60:63]
  ds_read_b128 v[44:47], v7 offset:38912
  v_mfma_f32_16x16x32_bf16 v[64:67], a[252:255], v[48:51], v[64:67]
  s_waitcnt lgkmcnt(5)
  s_add_u32 m0, s57, 6144
  s_add_u32 s65, s66, 12288
  buffer_load_dwordx4 v1, s[8:11], s65 offen sc1 lds
  v_mfma_f32_16x16x32_bf16 v[60:63], v[128:131], v[20:23], v[60:63]
  ds_read_b128 v[48:51], v7 offset:39936
  v_mfma_f32_16x16x32_bf16 v[64:67], v[132:135], v[20:23], v[64:67]
  v_mfma_f32_16x16x32_bf16 v[60:63], v[136:139], v[24:27], v[60:63]
  ds_read_b128 v[20:23], v7 offset:40960
  v_mfma_f32_16x16x32_bf16 v[64:67], v[140:143], v[24:27], v[64:67]
  s_waitcnt lgkmcnt(5)
  s_add_u32 m0, s57, 7168
  s_add_u32 s65, s66, 14336
  buffer_load_dwordx4 v1, s[8:11], s65 offen sc1 lds
  v_mfma_f32_16x16x32_bf16 v[60:63], v[144:147], v[28:31], v[60:63]
  ds_read_b128 v[24:27], v7 offset:41984
  v_mfma_f32_16x16x32_bf16 v[64:67], v[148:151], v[28:31], v[64:67]
  v_mfma_f32_16x16x32_bf16 v[60:63], v[152:155], v[32:35], v[60:63]
  ds_read_b128 v[28:31], v7 offset:43008
  v_mfma_f32_16x16x32_bf16 v[64:67], v[156:159], v[32:35], v[64:67]
  s_waitcnt lgkmcnt(5)
  s_add_u32 m0, s57, 8192
  s_add_u32 s65, s66, 16384
  buffer_load_dwordx4 v1, s[8:11], s65 offen sc1 lds
  v_mfma_f32_16x16x32_bf16 v[60:63], v[160:163], v[36:39], v[60:63]
  ds_read_b128 v[32:35], v7 offset:44032
  v_mfma_f32_16x16x32_bf16 v[64:67], v[164:167], v[36:39], v[64:67]
  v_mfma_f32_16x16x32_bf16 v[60:63], v[168:171], v[40:43], v[60:63]
  ds_read_b128 v[36:39], v7 offset:45056
  v_mfma_f32_16x16x32_bf16 v[64:67], v[172:175], v[40:43], v[64:67]
  s_waitcnt lgkmcnt(5)
  s_add_u32 m0, s57, 9216
  s_add_u32 s65, s66, 18432
  buffer_load_dwordx4 v1, s[8:11], s65 offen sc1 lds
  v_mfma_f32_16x16x32_bf16 v[60:63], v[176:179], v[44:47], v[60:63]
  ds_read_b128 v[40:43], v7 offset:46080
  v_mfma_f32_16x16x32_bf16 v[64:67], v[180:183], v[44:47], v[64:67]
  v_mfma_f32_16x16x32_bf16 v[60:63], v[184:187], v[48:51], v[60:63]
  ds_read_b128 v[44:47], v7 offset:47104
  v_mfma_f32_16x16x32_bf16 v[64:67], v[188:191], v[48:51], v[64:67]
  s_waitcnt lgkmcnt(5)
  s_add_u32 m0, s57, 10240
  s_add_u32 s65, s66, 20480
  buffer_load_dwordx4 v1, s[8:11], s65 offen sc1 lds
  v_mfma_f32_16x16x32_bf16 v[60:63], v[192:195], v[20:23], v[60:63]
  ds_read_b128 v[48:51], v7 offset:48128
  v_mfma_f32_16x16x32_bf16 v[64:67], v[196:199], v[20:23], v[64:67]
  v_mfma_f32_16x16x32_bf16 v[60:63], v[200:203], v[24:27], v[60:63]
  v_mfma_f32_16x16x32_bf16 v[64:67], v[204:207], v[24:27], v[64:67]
  s_waitcnt lgkmcnt(4)
  s_add_u32 m0, s57, 11264
  s_add_u32 s65, s66, 22528
  buffer_load_dwordx4 v1, s[8:11], s65 offen sc1 lds
  v_mfma_f32_16x16x32_bf16 v[60:63], v[208:211], v[28:31], v[60:63]
  v_mfma_f32_16x16x32_bf16 v[64:67], v[212:215], v[28:31], v[64:67]
  v_mfma_f32_16x16x32_bf16 v[60:63], v[216:219], v[32:35], v[60:63]
  v_mfma_f32_16x16x32_bf16 v[64:67], v[220:223], v[32:35], v[64:67]
  s_waitcnt lgkmcnt(2)
  v_mfma_f32_16x16x32_bf16 v[60:63], v[224:227], v[36:39], v[60:63]
  v_mfma_f32_16x16x32_bf16 v[64:67], v[228:231], v[36:39], v[64:67]
  v_mfma_f32_16x16x32_bf16 v[60:63], v[232:235], v[40:43], v[60:63]
  v_mfma_f32_16x16x32_bf16 v[64:67], v[236:239], v[40:43], v[64:67]
  s_waitcnt lgkmcnt(0)
  v_mfma_f32_16x16x32_bf16 v[60:63], v[240:243], v[44:47], v[60:63]
  v_mfma_f32_16x16x32_bf16 v[64:67], v[244:247], v[44:47], v[64:67]
  v_mfma_f32_16x16x32_bf16 v[60:63], v[248:251], v[48:51], v[60:63]
  v_mfma_f32_16x16x32_bf16 v[64:67], v[252:255], v[48:51], v[64:67]
  s_nop 6
  v_add_f32 v60, v60, v92
  v_add_f32 v61, v61, v93
  v_add_f32 v62, v62, v94
  v_add_f32 v63, v63, v95
  v_add_f32 v64, v64, v96
  v_add_f32 v65, v65, v97
  v_add_f32 v66, v66, v98
  v_add_f32 v67, v67, v99
  v_cvt_pk_bf16_f32 v104, v60, v61
  v_cvt_pk_bf16_f32 v105, v62, v63
  v_cvt_pk_bf16_f32 v106, v64, v65
  v_cvt_pk_bf16_f32 v107, v66, v67
  buffer_store_dwordx2 v[104:105], v6, s[80:83], s71 offen offset:0
  buffer_store_dwordx2 v[106:107], v6, s[80:83], s71 offen offset:32
  s_add_u32 s71, s71, 20480
  s_add_u32 s58, s58, 512
  s_mov_b64 s[76:77], -1
  s_add_u32 s55, s55, 46080
  s_mov_b32 s50, s73
  s_cmp_eq_u32 s50, 64
  s_cselect_b32 s56, 1, s56
  s_waitcnt vmcnt(2)
  s_cmp_eq_u32 s56, 0
  s_cbranch_scc1 W4_LOOPF1
  s_waitcnt vmcnt(0)
  s_mov_b64 s[76:77], 0
  s_cmp_lt_u32 s50, 64
  s_cbranch_scc1 W4_WAITF1
  s_branch W4_END
W4_END:
  s_endpgm
wt_449:
  s_nop 7
  buffer_store_dword v19, v1, s[8:11], s72 offen sc1
  s_branch wb_450
wt_453:
  s_nop 7
  buffer_store_dword v19, v1, s[8:11], s72 offen sc1
  s_branch wb_454
.section .rodata,"a"
.p2align 6
.amdhsa_kernel interleave_layers__memory_aug_recurrent_mem_tr__mixer_s_mlp__prompt_kernel
  .amdhsa_next_free_vgpr 512
  .amdhsa_next_free_sgpr 102
  .amdhsa_accum_offset 256
  .amdhsa_group_segment_fixed_size 0
  .amdhsa_kernarg_size 120
  .amdhsa_user_sgpr_count 2
  .amdhsa_user_sgpr_kernarg_segment_ptr 1
  .amdhsa_system_sgpr_workgroup_id_x 1
.end_amdhsa_kernel
```
